```python
import torch

def _softmax(x, axis=-1):
    return torch.softmax(x, dim=axis)
def _gelu(x):
    return torch.nn.functional.gelu(x, approximate="tanh")
def _silu(x):
    return torch.nn.functional.silu(x)
def _sigmoid(x):
    return torch.sigmoid(x)
def _layernorm(x, axis=-1, eps=1e-5):
    m = x.mean(dim=axis, keepdim=True)
    v = x.var(dim=axis, keepdim=True, unbiased=False)
    return (x - m) / torch.sqrt(v + eps)
def _scatter_add(tgt, idx, src, axis=0):
    return tgt.clone().index_add_(axis, idx, src)
def _segment_sum(src, seg, n):
    out = torch.zeros((n,) + src.shape[1:], dtype=src.dtype)
    return out.index_add_(0, seg, src)
def _pad(x, pw):
    flat = tuple(v for pair in reversed(pw) for v in pair)
    return torch.nn.functional.pad(x, flat)

kernel_name = 'parallel_sum__compressed_kv_cla__dense_activation_gelu__prompt'

def setup_inputs():

    _w = (lambda a: (lambda t: t.to(torch.bfloat16) if t.is_floating_point() else t)(torch.as_tensor(a)))
    def _A_setup():
        B, H, Sq, Sk, D, M = 1, 32, 2048, 2048, 128, 512
        Dc = 4 * D
        return {
            "x": _w((lambda *s: torch.randn(*s, dtype=torch.bfloat16) * 0.05)(B, Sq, M)),
            "c_kv": _w((lambda *s: torch.randn(*s, dtype=torch.bfloat16) * 0.4)(B, Sk, Dc)),
            "w_q": _w((lambda *s: torch.randn(*s, dtype=torch.bfloat16) * 3.2)(M, H, D) * (M ** -0.5)),
            "w_uk": _w((lambda *s: torch.randn(*s, dtype=torch.bfloat16) * 3.2)(Dc, H, D) * (Dc ** -0.5)),
            "w_uv": _w((lambda *s: torch.randn(*s, dtype=torch.bfloat16) * 0.4)(Dc, H, D) * (Dc ** -0.5)),
            "w_o": _w((lambda *s: torch.randn(*s, dtype=torch.bfloat16) * 0.4)(H, D, M) * ((H * D) ** -0.5)),
        }
    _A_in = _A_setup()

    def _B_setup():
        B, S, D, F = 1, 2048, 512, 1792
        return {
            "x": _w((lambda *s: torch.randn(*s, dtype=torch.bfloat16) * 0.05)(B, S, D)),
            "w1": _w((lambda *s: torch.randn(*s, dtype=torch.bfloat16) * 0.8)(D, F) * (D ** -0.5)),
            "b1": _w((lambda *s: torch.randn(*s, dtype=torch.bfloat16) * 12.8)(F) * 0.01),
            "w2": _w((lambda *s: torch.randn(*s, dtype=torch.bfloat16) * 0.2)(F, D) * (F ** -0.5)),
            "b2": _w((lambda *s: torch.randn(*s, dtype=torch.bfloat16) * 3.2)(D) * 0.01),
        }
    _B_in = _B_setup()

    return {
        "A_x": _A_in["x"],
        "A_c_kv": _A_in["c_kv"],
        "A_w_q": _A_in["w_q"],
        "A_w_uk": _A_in["w_uk"],
        "A_w_uv": _A_in["w_uv"],
        "A_w_o": _A_in["w_o"],
        "B_x": _B_in["x"],
        "B_w1": _B_in["w1"],
        "B_b1": _B_in["b1"],
        "B_w2": _B_in["w2"],
        "B_b2": _B_in["b2"],
    }

def reference(A_x, A_c_kv, A_w_q, A_w_uk, A_w_uv, A_w_o, B_x, B_w1, B_b1, B_w2, B_b2):
    def _A_ref(x, c_kv, w_q, w_uk, w_uv, w_o):
        B, Sq, M = x.shape[0], x.shape[1], x.shape[2]
        Sk = c_kv.shape[1]
        H, D = w_q.shape[1], w_q.shape[2]
        q = torch.einsum("bqm,mhd->bhqd", x, w_q)
        k = torch.einsum("bkc,chd->bhkd", c_kv, w_uk)
        v = torch.einsum("bkc,chd->bhkd", c_kv, w_uv)
        scores = torch.einsum("bhqd,bhkd->bhqk", q, k) * (D ** -0.5)
        off = Sk - Sq
        qi = torch.arange(Sq)[:, None]
        kj = torch.arange(Sk)[None, :]
        cmask = kj <= (qi + off)
        scores = torch.where(cmask[None, None], scores, -1e9)
        p = _softmax(scores, axis=-1)
        ctx = torch.einsum("bhqk,bhkd->bhqd", p, v)
        return torch.einsum("bhqd,hdm->bqm", ctx, w_o)

    def _B_ref(x, w1, b1, w2, b2):
        h = torch.einsum("bsd,df->bsf", x, w1) + b1
        h = _gelu(h)
        return torch.einsum("bsf,fd->bsd", h, w2) + b2

    x = A_x
    xn = _layernorm(x, axis=-1)
    return x + _A_ref(xn, A_c_kv, A_w_q, A_w_uk, A_w_uv, A_w_o) + _B_ref(xn, B_w1, B_b1, B_w2, B_b2)
```

```asm
; @launch grid=(256,1,1) block=(256,1,1) lds=163840
.amdgcn_target "amdgcn-amd-amdhsa--gfx950"
.text
.globl parallel_sum__compressed_kv_cla__dense_activation_gelu__prompt_kernel
.p2align 8
.type parallel_sum__compressed_kv_cla__dense_activation_gelu__prompt_kernel,@function
parallel_sum__compressed_kv_cla__dense_activation_gelu__prompt_kernel:
.set CODE_A, k2_Y1-k2_D
.set CODE_B, L_end-k2_Y1
.set CODE_0, L_end-L_p0
    s_cmp_ge_u32 s2, 256
    s_cbranch_scc1 L_end
    s_load_dwordx4 s[60:63], s[0:1], 0
    s_load_dwordx4 s[88:91], s[0:1], 24
    s_load_dwordx4 s[84:87], s[0:1], 96
    s_load_dwordx2 s[78:79], s[0:1], 16
    s_load_dwordx4 s[80:83], s[0:1], 56
L_p0:
    s_lshr_b32 s3, s2, 3
    s_mul_i32 s3, s3, 2560
    v_lshrrev_b32 v85, 6, v0
    v_and_b32 v84, 7, v0
    v_min_u32 v84, 4, v84
    v_mad_u32_u24 v84, v85, 5, v84
    v_lshl_add_u32 v84, v84, 7, s3
    s_getpc_b64 s[4:5]
L_pc0:
    s_add_u32 s4, s4, L_p0-L_pc0+4096
    s_addc_u32 s5, s5, 0
    v_min_u32 v84, CODE_0-4, v84
    v_mov_b32 v85, s5
    v_add_co_u32 v84, vcc, s4, v84
    s_nop 1
    v_addc_co_u32 v85, vcc, 0, v85, vcc
    global_load_dword v86, v[84:85], off offset:-4096
    v_lshrrev_b32 v1, 6, v0
    v_and_b32 v64, 63, v0
    v_readfirstlane_b32 s40, v1
    s_and_b32 s3, s2, 7
    s_lshl_b32 s3, s3, 2
    s_bfe_u32 s41, s2, 0x20003
    s_add_u32 s41, s41, s3
    s_lshr_b32 s42, s2, 5
    s_and_b32 s4, s40, 1
    s_lshl_b32 s4, s4, 5
    v_lshrrev_b32 v80, 3, v64
    v_add_u32 v80, s4, v80
    s_mov_b32 s3, 8192
    v_mul_lo_u32 v80, v80, s3
    v_bfe_u32 v81, v64, 4, 1
    v_lshlrev_b32 v81, 1, v81
    v_and_b32 v82, 7, v64
    v_xor_b32 v81, v81, v82
    v_lshl_add_u32 v2, v81, 4, v80
    v_xor_b32 v81, 4, v81
    v_lshl_add_u32 v3, v81, 4, v80
    s_lshr_b32 s5, s40, 1
    s_lshl_b32 s5, s5, 7
    v_add_u32 v66, s5, v2
    v_add_u32 v67, s5, v3
    s_lshl_b32 s6, s42, 2
    s_add_u32 s6, s6, s40
    s_lshl_b32 s4, s6, 16
    v_lshrrev_b32 v80, 3, v64
    v_lshlrev_b32 v80, 10, v80
    v_add_u32 v80, s4, v80
    v_lshrrev_b32 v81, 4, v64
    v_and_b32 v82, 7, v64
    v_xor_b32 v82, v82, v81
    v_lshl_add_u32 v68, v82, 4, v80
    v_xor_b32 v82, 4, v82
    v_lshl_add_u32 v69, v82, 4, v80
    s_lshl_b32 s46, s41, 8
    s_lshl_b32 s45, s41, 1
    s_add_u32 s45, s45, s42
    s_and_b32 s3, s2, 1
    s_add_u32 s45, s45, s3
    s_lshl_b32 s44, s40, 12
    s_lshl_b32 s47, s40, 13
    s_bfe_u32 s45, s2, 0x20003
    s_lshl_b32 s45, s45, 1
    s_add_u32 s45, s45, s42
    s_cmp_ge_u32 s45, 7
    s_cselect_b32 s3, 7, 0
    s_sub_u32 s45, s45, s3
    s_mov_b32 s3, s2
    s_and_b32 s3, s3, 7
    s_lshl_b32 s65, s3, 7
    s_lshl_b32 s3, s3, 19
    s_add_u32 s57, s3, s46
    s_waitcnt lgkmcnt(0)
    s_mov_b32 s8, s62
    s_mov_b32 s9, s63
    s_mov_b32 s10, 2097152
    s_mov_b32 s11, 0x20000
    s_mov_b32 s12, s88
    s_mov_b32 s13, s89
    s_mov_b32 s14, 4194304
    s_mov_b32 s15, 0x20000
    s_mov_b32 s24, s60
    s_mov_b32 s25, s61
    s_mov_b32 s26, 2097152
    s_mov_b32 s27, 0x20000
    s_add_u32 m0, s44, 65536
    s_add_u32 s43, s57, 0
    buffer_load_dwordx4 v66, s[12:15], s43 offen offset:0 lds
    s_add_u32 s43, s57, 64512
    buffer_load_dwordx4 v67, s[12:15], s43 offen offset:1024 lds
    s_add_u32 s43, s57, 129024
    buffer_load_dwordx4 v66, s[12:15], s43 offen offset:2048 lds
    s_add_u32 s43, s57, 193536
    buffer_load_dwordx4 v67, s[12:15], s43 offen offset:3072 lds
    s_add_u32 m0, s47, 32768
    s_add_u32 s43, s65, 0
    buffer_load_dwordx4 v68, s[8:11], s43 offen offset:0 lds
    s_add_u32 s43, s65, 7168
    buffer_load_dwordx4 v69, s[8:11], s43 offen offset:1024 lds
    s_add_u32 s43, s65, 14336
    buffer_load_dwordx4 v68, s[8:11], s43 offen offset:2048 lds
    s_add_u32 s43, s65, 21504
    buffer_load_dwordx4 v69, s[8:11], s43 offen offset:3072 lds
    s_add_u32 m0, s47, 36864
    s_add_u32 s43, s65, 32768
    buffer_load_dwordx4 v68, s[8:11], s43 offen offset:0 lds
    s_add_u32 s43, s65, 39936
    buffer_load_dwordx4 v69, s[8:11], s43 offen offset:1024 lds
    s_add_u32 s43, s65, 47104
    buffer_load_dwordx4 v68, s[8:11], s43 offen offset:2048 lds
    s_add_u32 s43, s65, 54272
    buffer_load_dwordx4 v69, s[8:11], s43 offen offset:3072 lds
    s_add_u32 s3, s45, 1
    s_cmp_ge_u32 s3, 8
    s_cselect_b32 s96, 7, 0
    s_sub_u32 s3, s3, s96
    s_add_u32 s3, s3, s2
    s_and_b32 s3, s3, 7
    s_lshl_b32 s66, s3, 7
    s_lshl_b32 s3, s3, 19
    s_add_u32 s58, s3, s46
    s_add_u32 s3, s45, 2
    s_cmp_ge_u32 s3, 8
    s_cselect_b32 s96, 7, 0
    s_sub_u32 s3, s3, s96
    s_add_u32 s3, s3, s2
    s_and_b32 s3, s3, 7
    s_lshl_b32 s67, s3, 7
    s_lshl_b32 s3, s3, 19
    s_add_u32 s59, s3, s46
    s_add_u32 m0, s47, 131072
    s_add_u32 s43, s66, 0
    buffer_load_dwordx4 v68, s[8:11], s43 offen offset:0 lds
    s_add_u32 s43, s66, 7168
    buffer_load_dwordx4 v69, s[8:11], s43 offen offset:1024 lds
    s_add_u32 s43, s66, 14336
    buffer_load_dwordx4 v68, s[8:11], s43 offen offset:2048 lds
    s_add_u32 s43, s66, 21504
    buffer_load_dwordx4 v69, s[8:11], s43 offen offset:3072 lds
    s_add_u32 m0, s47, 135168
    s_add_u32 s43, s66, 32768
    buffer_load_dwordx4 v68, s[8:11], s43 offen offset:0 lds
    s_add_u32 s43, s66, 39936
    buffer_load_dwordx4 v69, s[8:11], s43 offen offset:1024 lds
    s_add_u32 s43, s66, 47104
    buffer_load_dwordx4 v68, s[8:11], s43 offen offset:2048 lds
    s_add_u32 s43, s66, 54272
    buffer_load_dwordx4 v69, s[8:11], s43 offen offset:3072 lds
    s_lshl_b32 s3, s2, 2
    s_add_u32 s3, s3, s40
    s_lshl_b32 s3, s3, 1
    v_lshrrev_b32 v76, 5, v64
    v_add_u32 v76, s3, v76
    v_and_b32 v77, 31, v64
    v_lshlrev_b32 v74, 10, v76
    v_lshl_add_u32 v74, v77, 5, v74
    s_add_u32 s3, s45, 3
    s_cmp_ge_u32 s3, 8
    s_cselect_b32 s96, 7, 0
    s_sub_u32 s3, s3, s96
    s_add_u32 s3, s3, s2
    s_and_b32 s3, s3, 7
    s_lshl_b32 s68, s3, 7
    s_lshl_b32 s3, s3, 19
    s_add_u32 s60, s3, s46
    s_add_u32 s3, s45, 4
    s_cmp_ge_u32 s3, 8
    s_cselect_b32 s96, 7, 0
    s_sub_u32 s3, s3, s96
    s_add_u32 s3, s3, s2
    s_and_b32 s3, s3, 7
    s_lshl_b32 s69, s3, 7
    s_lshl_b32 s3, s3, 19
    s_add_u32 s61, s3, s46
    s_add_u32 s3, s45, 5
    s_cmp_ge_u32 s3, 8
    s_cselect_b32 s96, 7, 0
    s_sub_u32 s3, s3, s96
    s_add_u32 s3, s3, s2
    s_and_b32 s3, s3, 7
    s_lshl_b32 s70, s3, 7
    s_lshl_b32 s3, s3, 19
    s_add_u32 s62, s3, s46
    s_add_u32 s3, s45, 6
    s_cmp_ge_u32 s3, 8
    s_cselect_b32 s96, 7, 0
    s_sub_u32 s3, s3, s96
    s_add_u32 s3, s3, s2
    s_and_b32 s3, s3, 7
    s_lshl_b32 s71, s3, 7
    s_lshl_b32 s3, s3, 19
    s_add_u32 s63, s3, s46
    s_add_u32 s3, s45, 7
    s_cmp_ge_u32 s3, 8
    s_cselect_b32 s96, 7, 0
    s_sub_u32 s3, s3, s96
    s_add_u32 s3, s3, s2
    s_and_b32 s3, s3, 7
    s_lshl_b32 s72, s3, 7
    s_lshl_b32 s3, s3, 19
    s_add_u32 s64, s3, s46
    s_lshr_b32 s97, s40, 1
    s_add_u32 s97, s97, 0
    s_add_u32 s3, s45, s97
    s_cmp_ge_u32 s3, 8
    s_cselect_b32 s96, 7, 0
    s_sub_u32 s3, s3, s96
    s_cmp_eq_u32 s97, 0
    s_cselect_b32 s3, 0, s3
    s_add_u32 s3, s3, s2
    s_and_b32 s3, s3, 7
    s_lshl_b32 s3, s3, 19
    s_add_u32 s73, s3, s46
    s_lshr_b32 s97, s40, 1
    s_add_u32 s97, s97, 2
    s_add_u32 s3, s45, s97
    s_cmp_ge_u32 s3, 8
    s_cselect_b32 s96, 7, 0
    s_sub_u32 s3, s3, s96
    s_cmp_eq_u32 s97, 0
    s_cselect_b32 s3, 0, s3
    s_add_u32 s3, s3, s2
    s_and_b32 s3, s3, 7
    s_lshl_b32 s3, s3, 19
    s_add_u32 s74, s3, s46
    s_lshr_b32 s97, s40, 1
    s_add_u32 s97, s97, 4
    s_add_u32 s3, s45, s97
    s_cmp_ge_u32 s3, 8
    s_cselect_b32 s96, 7, 0
    s_sub_u32 s3, s3, s96
    s_cmp_eq_u32 s97, 0
    s_cselect_b32 s3, 0, s3
    s_add_u32 s3, s3, s2
    s_and_b32 s3, s3, 7
    s_lshl_b32 s3, s3, 19
    s_add_u32 s75, s3, s46
    s_lshr_b32 s97, s40, 1
    s_add_u32 s97, s97, 6
    s_add_u32 s3, s45, s97
    s_cmp_ge_u32 s3, 8
    s_cselect_b32 s96, 7, 0
    s_sub_u32 s3, s3, s96
    s_cmp_eq_u32 s97, 0
    s_cselect_b32 s3, 0, s3
    s_add_u32 s3, s3, s2
    s_and_b32 s3, s3, 7
    s_lshl_b32 s3, s3, 19
    s_add_u32 s76, s3, s46
    s_mov_b32 s16, s90
    s_mov_b32 s17, s91
    s_mov_b32 s18, 4194304
    s_mov_b32 s19, 0x20000
    s_add_u32 s28, s86, 0
    s_addc_u32 s29, s87, 0
    s_mov_b32 s30, 2097152
    s_mov_b32 s31, 0x20000
    s_mov_b32 s36, s84
    s_mov_b32 s37, s85
    s_mov_b32 s38, 256
    s_mov_b32 s39, 0x20000
    s_lshl_b32 s3, s41, 20
    s_add_u32 s3, s3, 2097152
    s_add_u32 s20, s86, s3
    s_addc_u32 s21, s87, 0
    s_mov_b32 s22, 1048576
    s_mov_b32 s23, 0x20000
    s_add_u32 s32, s86, 92274688
    s_addc_u32 s33, s87, 0
    s_mov_b32 s34, 16384
    s_mov_b32 s35, 0x20000
    v_lshlrev_b32 v1, 4, v64
    s_lshl_b32 s4, s6, 15
    s_add_u32 s49, s4, 0
    s_add_u32 s50, s4, 4096
    s_add_u32 s51, s4, 16384
    s_add_u32 s52, s4, 20480
    s_add_u32 s53, s4, 8192
    s_add_u32 s54, s4, 12288
    s_add_u32 s55, s4, 24576
    s_add_u32 s56, s4, 28672
    s_mov_b32 s48, 0x3e0293ee
    v_lshrrev_b32 v80, 4, v64
    v_bfe_u32 v81, v64, 2, 2
    v_lshl_add_u32 v82, v80, 3, v81
    v_lshlrev_b32 v82, 7, v82
    v_and_b32 v83, 3, v64
    v_lshl_add_u32 v82, v83, 3, v82
    v_lshrrev_b32 v81, 1, v81
    v_and_b32 v80, 1, v80
    v_lshl_add_u32 v81, v80, 1, v81
    v_xor_b32 v83, 0, v81
    v_lshl_add_u32 v4, v83, 5, v82
    v_add_u32 v8, 0x10000, v4
    v_xor_b32 v83, 1, v81
    v_lshl_add_u32 v5, v83, 5, v82
    v_add_u32 v9, 0x10000, v5
    v_xor_b32 v83, 2, v81
    v_lshl_add_u32 v6, v83, 5, v82
    v_add_u32 v10, 0x10000, v6
    v_xor_b32 v83, 3, v81
    v_lshl_add_u32 v7, v83, 5, v82
    v_add_u32 v11, 0x10000, v7
    v_and_b32 v80, 15, v64
    v_lshrrev_b32 v81, 4, v64
    v_lshrrev_b32 v82, 1, v80
    v_xor_b32 v81, v81, v82
    v_lshlrev_b32 v80, 7, v80
    v_add_u32 v80, s47, v80
    v_lshl_add_u32 v70, v81, 4, v80
    v_xor_b32 v71, 64, v70
    v_add_u32 v72, 0x20000, v70
    v_add_u32 v73, 0x20000, v71
    v_lshrrev_b32 v78, 4, v76
    v_lshlrev_b32 v75, 14, v78
    v_lshrrev_b32 v78, 1, v77
    v_lshl_add_u32 v75, v78, 10, v75
    v_and_b32 v78, 1, v77
    v_lshl_add_u32 v75, v78, 9, v75
    v_and_b32 v78, 15, v76
    v_lshl_add_u32 v75, v78, 4, v75
    v_cmp_eq_u32 vcc, 0, v0
    v_mov_b32 v80, 0x40000000
    v_mov_b32 v81, 0
    v_cndmask_b32 v30, v80, v81, vcc
    v_mov_b32 v0, 1
    s_and_b32 s3, s2, 7
    s_lshl_b32 s4, s42, 3
    s_add_u32 s3, s3, s4
    s_lshl_b32 s3, s3, 5
    s_bfe_u32 s4, s2, 0x20003
    s_add_u32 s3, s3, s4
    s_lshl_b32 s4, s3, 2
    s_add_u32 s5, s4, 16
    s_lshr_b32 s3, s2, 3
    s_lshl_b32 s3, s3, 3
    s_and_b32 s7, s2, 7
    s_add_u32 s3, s3, s7
    s_lshl_b32 s3, s3, 4
    s_add_u32 s7, s3, 8192
    v_mov_b32 v88, 0
    v_mov_b32 v89, 0
    v_mov_b32 v90, 0
    v_mov_b32 v91, 0
    s_lshl_b32 s48, s41, 5
    s_add_u32 s48, s48, s42
    s_lshl_b32 s48, s48, 2
    s_add_u32 s93, s48, 12288
    s_mov_b32 s48, 0x3e0293ee
    s_waitcnt vmcnt(8)
    ds_read_b128 a[0:3], v70 offset:32768
    ds_read_b128 a[64:67], v70 offset:34816
    ds_read_b128 a[128:131], v70 offset:36864
    ds_read_b128 a[192:195], v70 offset:38912
    ds_read_b128 a[4:7], v71 offset:32768
    ds_read_b128 a[68:71], v71 offset:34816
    ds_read_b128 a[132:135], v71 offset:36864
    ds_read_b128 a[196:199], v71 offset:38912
    s_barrier
    ds_read_b64_tr_b16 v[32:33], v8 offset:0
    ds_read_b64_tr_b16 v[34:35], v8 offset:512
    ds_read_b64_tr_b16 v[36:37], v8 offset:4096
    ds_read_b64_tr_b16 v[38:39], v8 offset:4608
    ds_read_b64_tr_b16 v[40:41], v9 offset:0
    ds_read_b64_tr_b16 v[42:43], v9 offset:512
    ds_read_b64_tr_b16 v[44:45], v9 offset:4096
    ds_read_b64_tr_b16 v[46:47], v9 offset:4608
    ds_read_b64_tr_b16 v[48:49], v10 offset:0
    ds_read_b64_tr_b16 v[50:51], v10 offset:512
    ds_read_b64_tr_b16 v[52:53], v10 offset:4096
    ds_read_b64_tr_b16 v[54:55], v10 offset:4608
    s_waitcnt lgkmcnt(8)
    v_mfma_f32_16x16x32_bf16 v[128:131], v[32:35], a[0:3], 0
    s_add_u32 m0, s44, 81920
    ds_read_b64_tr_b16 v[56:57], v11 offset:0
    v_mfma_f32_16x16x32_bf16 v[128:131], v[36:39], a[4:7], v[128:131]
    s_add_u32 s43, s58, 0
    ds_read_b64_tr_b16 v[58:59], v11 offset:512
    buffer_load_dwordx4 v66, s[12:15], s43 offen offset:0 lds
    v_mfma_f32_16x16x32_bf16 v[132:135], v[36:39], a[68:71], 0
    s_add_u32 s43, s58, 64512
    buffer_load_dwordx4 v67, s[12:15], s43 offen offset:1024 lds
    v_mfma_f32_16x16x32_bf16 v[132:135], v[32:35], a[64:67], v[132:135]
    v_mfma_f32_16x16x32_bf16 v[136:139], v[32:35], a[128:131], 0
    s_add_u32 s43, s58, 129024
    ds_read_b64_tr_b16 v[60:61], v11 offset:4096
    v_mfma_f32_16x16x32_bf16 v[136:139], v[36:39], a[132:135], v[136:139]
    ds_read_b64_tr_b16 v[62:63], v11 offset:4608
    buffer_load_dwordx4 v66, s[12:15], s43 offen offset:2048 lds
    v_mfma_f32_16x16x32_bf16 v[140:143], v[36:39], a[196:199], 0
    s_add_u32 s43, s58, 193536
    buffer_load_dwordx4 v67, s[12:15], s43 offen offset:3072 lds
    v_mfma_f32_16x16x32_bf16 v[140:143], v[32:35], a[192:195], v[140:143]
    s_waitcnt lgkmcnt(8)
    v_mfma_f32_16x16x32_bf16 v[144:147], v[40:43], a[0:3], 0
    ds_read_b64_tr_b16 v[32:33], v8 offset:8192
    v_mfma_f32_16x16x32_bf16 v[144:147], v[44:47], a[4:7], v[144:147]
    ds_read_b64_tr_b16 v[34:35], v8 offset:8704
    buffer_load_dwordx4 v[96:99], v74, s[24:27], 0 offen
    v_mfma_f32_16x16x32_bf16 v[148:151], v[44:47], a[68:71], 0
    v_mfma_f32_16x16x32_bf16 v[148:151], v[40:43], a[64:67], v[148:151]
    buffer_load_dwordx4 v[100:103], v74, s[24:27], 0 offen offset:16
    v_mfma_f32_16x16x32_bf16 v[152:155], v[40:43], a[128:131], 0
    ds_read_b64_tr_b16 v[36:37], v8 offset:12288
    v_mfma_f32_16x16x32_bf16 v[152:155], v[44:47], a[132:135], v[152:155]
    s_add_u32 m0, s47, 0
    ds_read_b64_tr_b16 v[38:39], v8 offset:12800
    v_mfma_f32_16x16x32_bf16 v[156:159], v[44:47], a[196:199], 0
    s_add_u32 s43, s67, 0
    buffer_load_dwordx4 v68, s[8:11], s43 offen offset:0 lds
    v_mfma_f32_16x16x32_bf16 v[156:159], v[40:43], a[192:195], v[156:159]
    s_waitcnt lgkmcnt(8)
    v_mfma_f32_16x16x32_bf16 v[160:163], v[48:51], a[0:3], 0
    s_add_u32 s43, s67, 7168
    ds_read_b64_tr_b16 v[40:41], v9 offset:8192
    buffer_load_dwordx4 v69, s[8:11], s43 offen offset:1024 lds
    v_mfma_f32_16x16x32_bf16 v[160:163], v[52:55], a[4:7], v[160:163]
    s_add_u32 s43, s67, 14336
    ds_read_b64_tr_b16 v[42:43], v9 offset:8704
    v_mfma_f32_16x16x32_bf16 v[164:167], v[52:55], a[68:71], 0
    buffer_load_dwordx4 v68, s[8:11], s43 offen offset:2048 lds
    v_mfma_f32_16x16x32_bf16 v[164:167], v[48:51], a[64:67], v[164:167]
    v_mfma_f32_16x16x32_bf16 v[168:171], v[48:51], a[128:131], 0
    s_add_u32 s43, s67, 21504
    ds_read_b64_tr_b16 v[44:45], v9 offset:12288
    v_mfma_f32_16x16x32_bf16 v[168:171], v[52:55], a[132:135], v[168:171]
    ds_read_b64_tr_b16 v[46:47], v9 offset:12800
    buffer_load_dwordx4 v69, s[8:11], s43 offen offset:3072 lds
    v_mfma_f32_16x16x32_bf16 v[172:175], v[52:55], a[196:199], 0
    s_add_u32 m0, s47, 4096
    v_mfma_f32_16x16x32_bf16 v[172:175], v[48:51], a[192:195], v[172:175]
    s_waitcnt lgkmcnt(8)
    s_add_u32 s43, s67, 32768
    buffer_load_dwordx4 v68, s[8:11], s43 offen offset:0 lds
    v_mfma_f32_16x16x32_bf16 v[176:179], v[56:59], a[0:3], 0
    s_add_u32 s43, s67, 39936
    ds_read_b64_tr_b16 v[48:49], v10 offset:8192
    v_mfma_f32_16x16x32_bf16 v[176:179], v[60:63], a[4:7], v[176:179]
    ds_read_b64_tr_b16 v[50:51], v10 offset:8704
    buffer_load_dwordx4 v69, s[8:11], s43 offen offset:1024 lds
    v_mfma_f32_16x16x32_bf16 v[180:183], v[60:63], a[68:71], 0
    s_add_u32 s43, s67, 47104
    buffer_load_dwordx4 v68, s[8:11], s43 offen offset:2048 lds
    v_mfma_f32_16x16x32_bf16 v[180:183], v[56:59], a[64:67], v[180:183]
    v_mfma_f32_16x16x32_bf16 v[184:187], v[56:59], a[128:131], 0
    s_add_u32 s43, s67, 54272
    ds_read_b64_tr_b16 v[52:53], v10 offset:12288
    v_mfma_f32_16x16x32_bf16 v[184:187], v[60:63], a[132:135], v[184:187]
    ds_read_b64_tr_b16 v[54:55], v10 offset:12800
    buffer_load_dwordx4 v69, s[8:11], s43 offen offset:3072 lds
    v_mfma_f32_16x16x32_bf16 v[188:191], v[60:63], a[196:199], 0
    v_mfma_f32_16x16x32_bf16 v[188:191], v[56:59], a[192:195], v[188:191]
    s_waitcnt lgkmcnt(8)
    v_mfma_f32_16x16x32_bf16 v[192:195], v[32:35], a[0:3], 0
    s_add_u32 m0, s44, 98304
    ds_read_b64_tr_b16 v[56:57], v11 offset:8192
    s_add_u32 s43, s59, 0
    buffer_load_dwordx4 v66, s[12:15], s43 offen offset:0 lds
    v_mfma_f32_16x16x32_bf16 v[192:195], v[36:39], a[4:7], v[192:195]
    s_add_u32 s43, s59, 64512
    ds_read_b64_tr_b16 v[58:59], v11 offset:8704
    v_mfma_f32_16x16x32_bf16 v[196:199], v[36:39], a[68:71], 0
    buffer_load_dwordx4 v67, s[12:15], s43 offen offset:1024 lds
    v_mfma_f32_16x16x32_bf16 v[196:199], v[32:35], a[64:67], v[196:199]
    s_add_u32 s43, s59, 129024
    buffer_load_dwordx4 v66, s[12:15], s43 offen offset:2048 lds
    v_mfma_f32_16x16x32_bf16 v[200:203], v[32:35], a[128:131], 0
    ds_read_b64_tr_b16 v[60:61], v11 offset:12288
    v_mfma_f32_16x16x32_bf16 v[200:203], v[36:39], a[132:135], v[200:203]
    s_add_u32 s43, s59, 193536
    ds_read_b64_tr_b16 v[62:63], v11 offset:12800
    v_mfma_f32_16x16x32_bf16 v[204:207], v[36:39], a[196:199], 0
    buffer_load_dwordx4 v67, s[12:15], s43 offen offset:3072 lds
    v_mfma_f32_16x16x32_bf16 v[204:207], v[32:35], a[192:195], v[204:207]
    s_waitcnt lgkmcnt(8)
    v_mfma_f32_16x16x32_bf16 v[208:211], v[40:43], a[0:3], 0
    s_waitcnt vmcnt(14)
    s_barrier
    ds_read_b64_tr_b16 v[32:33], v8 offset:16384
    v_mfma_f32_16x16x32_bf16 v[208:211], v[44:47], a[4:7], v[208:211]
    ds_read_b64_tr_b16 v[34:35], v8 offset:16896
    v_mfma_f32_16x16x32_bf16 v[212:215], v[44:47], a[68:71], 0
    v_mfma_f32_16x16x32_bf16 v[212:215], v[40:43], a[64:67], v[212:215]
    v_mfma_f32_16x16x32_bf16 v[216:219], v[40:43], a[128:131], 0
    ds_read_b64_tr_b16 v[36:37], v8 offset:20480
    ds_read_b128 a[8:11], v72 offset:0
    v_mfma_f32_16x16x32_bf16 v[216:219], v[44:47], a[132:135], v[216:219]
    ds_read_b64_tr_b16 v[38:39], v8 offset:20992
    ds_read_b128 a[72:75], v72 offset:2048
    v_mfma_f32_16x16x32_bf16 v[220:223], v[44:47], a[196:199], 0
    ds_read_b128 a[136:139], v72 offset:4096
    ds_read_b128 a[200:203], v72 offset:6144
    v_mfma_f32_16x16x32_bf16 v[220:223], v[40:43], a[192:195], v[220:223]
    s_waitcnt lgkmcnt(12)
    ds_read_b128 a[12:15], v73 offset:0
    ds_read_b128 a[76:79], v73 offset:2048
    v_mfma_f32_16x16x32_bf16 v[224:227], v[48:51], a[0:3], 0
    ds_read_b64_tr_b16 v[40:41], v9 offset:16384
    ds_read_b128 a[140:143], v73 offset:4096
    v_mfma_f32_16x16x32_bf16 v[224:227], v[52:55], a[4:7], v[224:227]
    ds_read_b64_tr_b16 v[42:43], v9 offset:16896
    ds_read_b128 a[204:207], v73 offset:6144
    v_mfma_f32_16x16x32_bf16 v[228:231], v[52:55], a[68:71], 0
    v_mfma_f32_16x16x32_bf16 v[228:231], v[48:51], a[64:67], v[228:231]
    v_mfma_f32_16x16x32_bf16 v[232:235], v[48:51], a[128:131], 0
    ds_read_b64_tr_b16 v[44:45], v9 offset:20480
    v_mfma_f32_16x16x32_bf16 v[232:235], v[52:55], a[132:135], v[232:235]
    ds_read_b64_tr_b16 v[46:47], v9 offset:20992
    v_mfma_f32_16x16x32_bf16 v[236:239], v[52:55], a[196:199], 0
    v_mfma_f32_16x16x32_bf16 v[236:239], v[48:51], a[192:195], v[236:239]
    s_waitcnt lgkmcnt(15)
    v_mfma_f32_16x16x32_bf16 v[240:243], v[56:59], a[0:3], 0
    ds_read_b64_tr_b16 v[48:49], v10 offset:16384
    v_mfma_f32_16x16x32_bf16 v[240:243], v[60:63], a[4:7], v[240:243]
    ds_read_b64_tr_b16 v[50:51], v10 offset:16896
    v_mfma_f32_16x16x32_bf16 v[244:247], v[60:63], a[68:71], 0
    v_mfma_f32_16x16x32_bf16 v[244:247], v[56:59], a[64:67], v[244:247]
    v_mfma_f32_16x16x32_bf16 v[248:251], v[56:59], a[128:131], 0
    ds_read_b64_tr_b16 v[52:53], v10 offset:20480
    v_mfma_f32_16x16x32_bf16 v[248:251], v[60:63], a[132:135], v[248:251]
    ds_read_b64_tr_b16 v[54:55], v10 offset:20992
    v_mfma_f32_16x16x32_bf16 v[252:255], v[60:63], a[196:199], 0
    v_mfma_f32_16x16x32_bf16 v[252:255], v[56:59], a[192:195], v[252:255]
    s_waitcnt lgkmcnt(6)
    v_mfma_f32_16x16x32_bf16 v[128:131], v[32:35], a[8:11], v[128:131]
    s_add_u32 m0, s47, 32768
    ds_read_b64_tr_b16 v[56:57], v11 offset:16384
    v_mfma_f32_16x16x32_bf16 v[128:131], v[36:39], a[12:15], v[128:131]
    s_add_u32 s43, s68, 0
    ds_read_b64_tr_b16 v[58:59], v11 offset:16896
    buffer_load_dwordx4 v68, s[8:11], s43 offen offset:0 lds
    v_mfma_f32_16x16x32_bf16 v[132:135], v[36:39], a[76:79], v[132:135]
    s_add_u32 s43, s68, 7168
    buffer_load_dwordx4 v69, s[8:11], s43 offen offset:1024 lds
    v_mfma_f32_16x16x32_bf16 v[132:135], v[32:35], a[72:75], v[132:135]
    s_waitcnt vmcnt(14)
    v_lshlrev_b32 v104, 16, v96
    v_and_b32 v105, 0xffff0000, v96
    v_mfma_f32_16x16x32_bf16 v[136:139], v[32:35], a[136:139], v[136:139]
    ds_read_b64_tr_b16 v[60:61], v11 offset:20480
    v_lshlrev_b32 v106, 16, v97
    v_mfma_f32_16x16x32_bf16 v[136:139], v[36:39], a[140:143], v[136:139]
    s_add_u32 s43, s68, 14336
    ds_read_b64_tr_b16 v[62:63], v11 offset:20992
    v_and_b32 v107, 0xffff0000, v97
    v_mfma_f32_16x16x32_bf16 v[140:143], v[36:39], a[204:207], v[140:143]
    buffer_load_dwordx4 v68, s[8:11], s43 offen offset:2048 lds
    v_mfma_f32_16x16x32_bf16 v[140:143], v[32:35], a[200:203], v[140:143]
    s_waitcnt lgkmcnt(8)
    v_lshlrev_b32 v108, 16, v98
    v_and_b32 v109, 0xffff0000, v98
    v_mfma_f32_16x16x32_bf16 v[144:147], v[40:43], a[8:11], v[144:147]
    s_waitcnt vmcnt(7)
    ds_read_b64_tr_b16 v[32:33], v8 offset:24576
    s_add_u32 s43, s68, 21504
    buffer_load_dwordx4 v69, s[8:11], s43 offen offset:3072 lds
    v_mfma_f32_16x16x32_bf16 v[144:147], v[44:47], a[12:15], v[144:147]
    ds_read_b64_tr_b16 v[34:35], v8 offset:25088
    ds_read_b128 a[16:19], v70 offset:0
    v_mfma_f32_16x16x32_bf16 v[148:151], v[44:47], a[76:79], v[148:151]
    s_add_u32 m0, s47, 36864
    ds_read_b128 a[80:83], v70 offset:2048
    ds_read_b128 a[144:147], v70 offset:4096
    v_mfma_f32_16x16x32_bf16 v[148:151], v[40:43], a[72:75], v[148:151]
    s_add_u32 s43, s68, 32768
    buffer_load_dwordx4 v68, s[8:11], s43 offen offset:0 lds
    v_mfma_f32_16x16x32_bf16 v[152:155], v[40:43], a[136:139], v[152:155]
    s_add_u32 s43, s68, 39936
    ds_read_b64_tr_b16 v[36:37], v8 offset:28672
    ds_read_b128 a[208:211], v70 offset:6144
    v_mfma_f32_16x16x32_bf16 v[152:155], v[44:47], a[140:143], v[152:155]
    ds_read_b64_tr_b16 v[38:39], v8 offset:29184
    buffer_load_dwordx4 v69, s[8:11], s43 offen offset:1024 lds
    v_mfma_f32_16x16x32_bf16 v[156:159], v[44:47], a[204:207], v[156:159]
    ds_read_b128 a[20:23], v71 offset:0
    ds_read_b128 a[84:87], v71 offset:2048
    v_mfma_f32_16x16x32_bf16 v[156:159], v[40:43], a[200:203], v[156:159]
    s_waitcnt lgkmcnt(14)
    ds_read_b128 a[148:151], v71 offset:4096
    ds_read_b128 a[212:215], v71 offset:6144
    v_mfma_f32_16x16x32_bf16 v[160:163], v[48:51], a[8:11], v[160:163]
    s_add_u32 s43, s68, 47104
    ds_read_b64_tr_b16 v[40:41], v9 offset:24576
    buffer_load_dwordx4 v68, s[8:11], s43 offen offset:2048 lds
    v_mfma_f32_16x16x32_bf16 v[160:163], v[52:55], a[12:15], v[160:163]
    ds_read_b64_tr_b16 v[42:43], v9 offset:25088
    v_lshlrev_b32 v110, 16, v99
    v_mfma_f32_16x16x32_bf16 v[164:167], v[52:55], a[76:79], v[164:167]
    s_add_u32 s43, s68, 54272
    buffer_load_dwordx4 v69, s[8:11], s43 offen offset:3072 lds
    v_mfma_f32_16x16x32_bf16 v[164:167], v[48:51], a[72:75], v[164:167]
    v_and_b32 v111, 0xffff0000, v99
    v_lshlrev_b32 v112, 16, v100
    v_mfma_f32_16x16x32_bf16 v[168:171], v[48:51], a[136:139], v[168:171]
    ds_read_b64_tr_b16 v[44:45], v9 offset:28672
    v_and_b32 v113, 0xffff0000, v100
    v_mfma_f32_16x16x32_bf16 v[168:171], v[52:55], a[140:143], v[168:171]
    ds_read_b64_tr_b16 v[46:47], v9 offset:29184
    buffer_store_dword v81, v30, s[32:35], s4 offen sc0 sc1
    v_mfma_f32_16x16x32_bf16 v[172:175], v[52:55], a[204:207], v[172:175]
    v_lshlrev_b32 v114, 16, v101
    v_and_b32 v115, 0xffff0000, v101
    v_mfma_f32_16x16x32_bf16 v[172:175], v[48:51], a[200:203], v[172:175]
    s_waitcnt lgkmcnt(15)
    buffer_store_dword v81, v30, s[32:35], s5 offen sc0 sc1
    v_mfma_f32_16x16x32_bf16 v[176:179], v[56:59], a[8:11], v[176:179]
    ds_read_b64_tr_b16 v[48:49], v10 offset:24576
    v_lshlrev_b32 v116, 16, v102
    v_mfma_f32_16x16x32_bf16 v[176:179], v[60:63], a[12:15], v[176:179]
    ds_read_b64_tr_b16 v[50:51], v10 offset:25088
    v_and_b32 v117, 0xffff0000, v102
    v_mfma_f32_16x16x32_bf16 v[180:183], v[60:63], a[76:79], v[180:183]
    buffer_store_dword v81, v30, s[32:35], s93 offen sc0 sc1
    v_mfma_f32_16x16x32_bf16 v[180:183], v[56:59], a[72:75], v[180:183]
    v_lshlrev_b32 v118, 16, v103
    v_and_b32 v119, 0xffff0000, v103
    v_mfma_f32_16x16x32_bf16 v[184:187], v[56:59], a[136:139], v[184:187]
    ds_read_b64_tr_b16 v[52:53], v10 offset:28672
    v_add_f32 v120, v104, v105
    v_mfma_f32_16x16x32_bf16 v[184:187], v[60:63], a[140:143], v[184:187]
    ds_read_b64_tr_b16 v[54:55], v10 offset:29184
    buffer_store_dwordx4 v[88:91], v30, s[32:35], s7 offen sc0 sc1
    v_mfma_f32_16x16x32_bf16 v[188:191], v[60:63], a[204:207], v[188:191]
    v_add_f32 v120, v120, v106
    v_add_f32 v120, v120, v107
    v_mfma_f32_16x16x32_bf16 v[188:191], v[56:59], a[200:203], v[188:191]
    s_waitcnt lgkmcnt(12)
    v_add_f32 v120, v120, v108
    v_add_f32 v120, v120, v109
    v_mfma_f32_16x16x32_bf16 v[192:195], v[32:35], a[8:11], v[192:195]
    s_add_u32 m0, s44, 114688
    ds_read_b64_tr_b16 v[56:57], v11 offset:24576
    s_add_u32 s43, s60, 0
    buffer_load_dwordx4 v66, s[12:15], s43 offen offset:0 lds
    v_mfma_f32_16x16x32_bf16 v[192:195], v[36:39], a[12:15], v[192:195]
    s_add_u32 s43, s60, 64512
    ds_read_b64_tr_b16 v[58:59], v11 offset:25088
    v_add_f32 v120, v120, v110
    v_mfma_f32_16x16x32_bf16 v[196:199], v[36:39], a[76:79], v[196:199]
    buffer_load_dwordx4 v67, s[12:15], s43 offen offset:1024 lds
    v_mfma_f32_16x16x32_bf16 v[196:199], v[32:35], a[72:75], v[196:199]
    v_add_f32 v120, v120, v111
    v_add_f32 v120, v120, v112
    v_mfma_f32_16x16x32_bf16 v[200:203], v[32:35], a[136:139], v[200:203]
    s_add_u32 s43, s60, 129024
    ds_read_b64_tr_b16 v[60:61], v11 offset:28672
    v_add_f32 v120, v120, v113
    v_mfma_f32_16x16x32_bf16 v[200:203], v[36:39], a[140:143], v[200:203]
    ds_read_b64_tr_b16 v[62:63], v11 offset:29184
    buffer_load_dwordx4 v66, s[12:15], s43 offen offset:2048 lds
    v_mfma_f32_16x16x32_bf16 v[204:207], v[36:39], a[204:207], v[204:207]
    s_add_u32 s43, s60, 193536
    buffer_load_dwordx4 v67, s[12:15], s43 offen offset:3072 lds
    v_mfma_f32_16x16x32_bf16 v[204:207], v[32:35], a[200:203], v[204:207]
    s_waitcnt lgkmcnt(8)
    v_add_f32 v120, v120, v114
    v_add_f32 v120, v120, v115
    v_mfma_f32_16x16x32_bf16 v[208:211], v[40:43], a[8:11], v[208:211]
    s_waitcnt vmcnt(16)
    s_barrier
    ds_read_b64_tr_b16 v[32:33], v8 offset:32768
    v_mfma_f32_16x16x32_bf16 v[208:211], v[44:47], a[12:15], v[208:211]
    s_add_u32 m0, s47, 131072
    ds_read_b64_tr_b16 v[34:35], v8 offset:33280
    v_add_f32 v120, v120, v116
    v_mfma_f32_16x16x32_bf16 v[212:215], v[44:47], a[76:79], v[212:215]
    s_add_u32 s43, s69, 0
    buffer_load_dwordx4 v68, s[8:11], s43 offen offset:0 lds
    v_mfma_f32_16x16x32_bf16 v[212:215], v[40:43], a[72:75], v[212:215]
    s_add_u32 s43, s69, 7168
    buffer_load_dwordx4 v69, s[8:11], s43 offen offset:1024 lds
    v_mfma_f32_16x16x32_bf16 v[216:219], v[40:43], a[136:139], v[216:219]
    ds_read_b64_tr_b16 v[36:37], v8 offset:36864
    v_add_f32 v120, v120, v117
    v_mfma_f32_16x16x32_bf16 v[216:219], v[44:47], a[140:143], v[216:219]
    ds_read_b64_tr_b16 v[38:39], v8 offset:37376
    v_add_f32 v120, v120, v118
    v_mfma_f32_16x16x32_bf16 v[220:223], v[44:47], a[204:207], v[220:223]
    s_add_u32 s43, s69, 14336
    buffer_load_dwordx4 v68, s[8:11], s43 offen offset:2048 lds
    v_mfma_f32_16x16x32_bf16 v[220:223], v[40:43], a[200:203], v[220:223]
    s_waitcnt lgkmcnt(8)
    v_add_f32 v120, v120, v119
    s_nop 1
    v_mfma_f32_16x16x32_bf16 v[224:227], v[48:51], a[8:11], v[224:227]
    ds_read_b64_tr_b16 v[40:41], v9 offset:32768
    v_add_f32_dpp v120, v120, v120 row_ror:8 row_mask:0xf bank_mask:0xf
    v_mfma_f32_16x16x32_bf16 v[224:227], v[52:55], a[12:15], v[224:227]
    s_add_u32 s43, s69, 21504
    ds_read_b64_tr_b16 v[42:43], v9 offset:33280
    s_nop 1
    v_mfma_f32_16x16x32_bf16 v[228:231], v[52:55], a[76:79], v[228:231]
    buffer_load_dwordx4 v69, s[8:11], s43 offen offset:3072 lds
    v_mfma_f32_16x16x32_bf16 v[228:231], v[48:51], a[72:75], v[228:231]
    s_add_u32 m0, s47, 135168
    v_add_f32_dpp v120, v120, v120 row_ror:4 row_mask:0xf bank_mask:0xf
    s_nop 1
    v_mfma_f32_16x16x32_bf16 v[232:235], v[48:51], a[136:139], v[232:235]
    s_add_u32 s43, s69, 32768
    ds_read_b64_tr_b16 v[44:45], v9 offset:36864
    buffer_load_dwordx4 v68, s[8:11], s43 offen offset:0 lds
    v_mfma_f32_16x16x32_bf16 v[232:235], v[52:55], a[140:143], v[232:235]
    ds_read_b64_tr_b16 v[46:47], v9 offset:37376
    v_add_f32_dpp v120, v120, v120 row_ror:2 row_mask:0xf bank_mask:0xf
    v_mfma_f32_16x16x32_bf16 v[236:239], v[52:55], a[204:207], v[236:239]
    s_add_u32 s43, s69, 39936
    buffer_load_dwordx4 v69, s[8:11], s43 offen offset:1024 lds
    v_mfma_f32_16x16x32_bf16 v[236:239], v[48:51], a[200:203], v[236:239]
    s_waitcnt lgkmcnt(8)
    s_nop 1
    v_add_f32_dpp v120, v120, v120 row_ror:1 row_mask:0xf bank_mask:0xf
    v_mfma_f32_16x16x32_bf16 v[240:243], v[56:59], a[8:11], v[240:243]
    s_add_u32 s43, s69, 47104
    ds_read_b64_tr_b16 v[48:49], v10 offset:32768
    v_mov_b32 v121, v120
    v_mfma_f32_16x16x32_bf16 v[240:243], v[60:63], a[12:15], v[240:243]
    ds_read_b64_tr_b16 v[50:51], v10 offset:33280
    buffer_load_dwordx4 v68, s[8:11], s43 offen offset:2048 lds
    v_mfma_f32_16x16x32_bf16 v[244:247], v[60:63], a[76:79], v[244:247]
    s_nop 1
    v_permlane16_swap_b32 v120, v121
    v_mfma_f32_16x16x32_bf16 v[244:247], v[56:59], a[72:75], v[244:247]
    s_add_u32 s43, s69, 54272
    buffer_load_dwordx4 v69, s[8:11], s43 offen offset:3072 lds
    v_mfma_f32_16x16x32_bf16 v[248:251], v[56:59], a[136:139], v[248:251]
    ds_read_b64_tr_b16 v[52:53], v10 offset:36864
    v_add_f32 v120, v120, v121
    v_mfma_f32_16x16x32_bf16 v[248:251], v[60:63], a[140:143], v[248:251]
    ds_read_b64_tr_b16 v[54:55], v10 offset:37376
    v_mul_f32 v122, 0x3b000000, v120
    v_mfma_f32_16x16x32_bf16 v[252:255], v[60:63], a[204:207], v[252:255]
    v_sub_f32 v124, v104, v122
    v_mul_f32 v120, v124, v124
    v_mfma_f32_16x16x32_bf16 v[252:255], v[56:59], a[200:203], v[252:255]
    s_waitcnt lgkmcnt(8)
    v_sub_f32 v124, v105, v122
    v_fmac_f32 v120, v124, v124
    v_sub_f32 v124, v106, v122
    v_mfma_f32_16x16x32_bf16 v[128:131], v[32:35], a[16:19], v[128:131]
    s_add_u32 m0, s44, 65536
    ds_read_b64_tr_b16 v[56:57], v11 offset:32768
    v_fmac_f32 v120, v124, v124
    v_mfma_f32_16x16x32_bf16 v[128:131], v[36:39], a[20:23], v[128:131]
    s_add_u32 s43, s61, 0
    ds_read_b64_tr_b16 v[58:59], v11 offset:33280
    buffer_load_dwordx4 v66, s[12:15], s43 offen offset:0 lds
    v_mfma_f32_16x16x32_bf16 v[132:135], v[36:39], a[84:87], v[132:135]
    v_sub_f32 v124, v107, v122
    v_fmac_f32 v120, v124, v124
    v_mfma_f32_16x16x32_bf16 v[132:135], v[32:35], a[80:83], v[132:135]
    v_sub_f32 v124, v108, v122
    v_fmac_f32 v120, v124, v124
    v_mfma_f32_16x16x32_bf16 v[136:139], v[32:35], a[144:147], v[136:139]
    ds_read_b64_tr_b16 v[60:61], v11 offset:36864
    v_sub_f32 v124, v109, v122
    v_mfma_f32_16x16x32_bf16 v[136:139], v[36:39], a[148:151], v[136:139]
    s_add_u32 s43, s61, 64512
    ds_read_b64_tr_b16 v[62:63], v11 offset:37376
    v_fmac_f32 v120, v124, v124
    v_mfma_f32_16x16x32_bf16 v[140:143], v[36:39], a[212:215], v[140:143]
    buffer_load_dwordx4 v67, s[12:15], s43 offen offset:1024 lds
    v_mfma_f32_16x16x32_bf16 v[140:143], v[32:35], a[208:211], v[140:143]
    s_waitcnt lgkmcnt(8)
    v_sub_f32 v124, v110, v122
    v_fmac_f32 v120, v124, v124
    v_mfma_f32_16x16x32_bf16 v[144:147], v[40:43], a[16:19], v[144:147]
    s_waitcnt vmcnt(18)
    ds_read_b64_tr_b16 v[32:33], v8 offset:40960
    ds_read_b128 a[24:27], v70 offset:32768
    v_mfma_f32_16x16x32_bf16 v[144:147], v[44:47], a[20:23], v[144:147]
    ds_read_b64_tr_b16 v[34:35], v8 offset:41472
    ds_read_b128 a[88:91], v70 offset:34816
    v_mfma_f32_16x16x32_bf16 v[148:151], v[44:47], a[84:87], v[148:151]
    s_add_u32 s43, s61, 129024
    buffer_load_dwordx4 v66, s[12:15], s43 offen offset:2048 lds
    v_mfma_f32_16x16x32_bf16 v[148:151], v[40:43], a[80:83], v[148:151]
    ds_read_b128 a[152:155], v70 offset:36864
    ds_read_b128 a[216:219], v70 offset:38912
    v_mfma_f32_16x16x32_bf16 v[152:155], v[40:43], a[144:147], v[152:155]
    ds_read_b64_tr_b16 v[36:37], v8 offset:45056
    ds_read_b128 a[28:31], v71 offset:32768
    v_mfma_f32_16x16x32_bf16 v[152:155], v[44:47], a[148:151], v[152:155]
    ds_read_b64_tr_b16 v[38:39], v8 offset:45568
    ds_read_b128 a[92:95], v71 offset:34816
    v_mfma_f32_16x16x32_bf16 v[156:159], v[44:47], a[212:215], v[156:159]
    ds_read_b128 a[156:159], v71 offset:36864
    ds_read_b128 a[220:223], v71 offset:38912
    v_mfma_f32_16x16x32_bf16 v[156:159], v[40:43], a[208:211], v[156:159]
    s_waitcnt lgkmcnt(15)
    v_sub_f32 v124, v111, v122
    v_fmac_f32 v120, v124, v124
    v_mfma_f32_16x16x32_bf16 v[160:163], v[48:51], a[16:19], v[160:163]
    s_add_u32 s43, s61, 193536
    ds_read_b64_tr_b16 v[40:41], v9 offset:40960
    buffer_load_dwordx4 v67, s[12:15], s43 offen offset:3072 lds
    v_mfma_f32_16x16x32_bf16 v[160:163], v[52:55], a[20:23], v[160:163]
    ds_read_b64_tr_b16 v[42:43], v9 offset:41472
    v_sub_f32 v124, v112, v122
    v_mfma_f32_16x16x32_bf16 v[164:167], v[52:55], a[84:87], v[164:167]
    v_fmac_f32 v120, v124, v124
    v_sub_f32 v124, v113, v122
    v_mfma_f32_16x16x32_bf16 v[164:167], v[48:51], a[80:83], v[164:167]
    v_fmac_f32 v120, v124, v124
    v_sub_f32 v124, v114, v122
    v_mfma_f32_16x16x32_bf16 v[168:171], v[48:51], a[144:147], v[168:171]
    s_add_u32 m0, s47, 0
    ds_read_b64_tr_b16 v[44:45], v9 offset:45056
    v_fmac_f32 v120, v124, v124
    v_mfma_f32_16x16x32_bf16 v[168:171], v[52:55], a[148:151], v[168:171]
    s_add_u32 s43, s70, 0
    ds_read_b64_tr_b16 v[46:47], v9 offset:45568
    buffer_load_dwordx4 v68, s[8:11], s43 offen offset:0 lds
    v_mfma_f32_16x16x32_bf16 v[172:175], v[52:55], a[212:215], v[172:175]
    v_sub_f32 v124, v115, v122
    v_fmac_f32 v120, v124, v124
    v_mfma_f32_16x16x32_bf16 v[172:175], v[48:51], a[208:211], v[172:175]
    s_waitcnt lgkmcnt(15)
    v_sub_f32 v124, v116, v122
    v_fmac_f32 v120, v124, v124
    v_mfma_f32_16x16x32_bf16 v[176:179], v[56:59], a[16:19], v[176:179]
    ds_read_b64_tr_b16 v[48:49], v10 offset:40960
    v_sub_f32 v124, v117, v122
    v_mfma_f32_16x16x32_bf16 v[176:179], v[60:63], a[20:23], v[176:179]
    s_add_u32 s43, s70, 7168
    ds_read_b64_tr_b16 v[50:51], v10 offset:41472
    v_fmac_f32 v120, v124, v124
    v_mfma_f32_16x16x32_bf16 v[180:183], v[60:63], a[84:87], v[180:183]
    buffer_load_dwordx4 v69, s[8:11], s43 offen offset:1024 lds
    v_mfma_f32_16x16x32_bf16 v[180:183], v[56:59], a[80:83], v[180:183]
    v_sub_f32 v124, v118, v122
    v_fmac_f32 v120, v124, v124
    v_mfma_f32_16x16x32_bf16 v[184:187], v[56:59], a[144:147], v[184:187]
    ds_read_b64_tr_b16 v[52:53], v10 offset:45056
    v_sub_f32 v124, v119, v122
    v_mfma_f32_16x16x32_bf16 v[184:187], v[60:63], a[148:151], v[184:187]
    ds_read_b64_tr_b16 v[54:55], v10 offset:45568
    v_fmac_f32 v120, v124, v124
    v_mfma_f32_16x16x32_bf16 v[188:191], v[60:63], a[212:215], v[188:191]
    s_nop 1
    v_add_f32_dpp v120, v120, v120 row_ror:8 row_mask:0xf bank_mask:0xf
    v_mfma_f32_16x16x32_bf16 v[188:191], v[56:59], a[208:211], v[188:191]
    s_waitcnt lgkmcnt(11)
    s_nop 1
    v_add_f32_dpp v120, v120, v120 row_ror:4 row_mask:0xf bank_mask:0xf
    v_mfma_f32_16x16x32_bf16 v[192:195], v[32:35], a[16:19], v[192:195]
    s_add_u32 s43, s70, 14336
    ds_read_b64_tr_b16 v[56:57], v11 offset:40960
    buffer_load_dwordx4 v68, s[8:11], s43 offen offset:2048 lds
    v_mfma_f32_16x16x32_bf16 v[192:195], v[36:39], a[20:23], v[192:195]
    ds_read_b64_tr_b16 v[58:59], v11 offset:41472
    s_nop 1
    v_mfma_f32_16x16x32_bf16 v[196:199], v[36:39], a[84:87], v[196:199]
    v_add_f32_dpp v120, v120, v120 row_ror:2 row_mask:0xf bank_mask:0xf
    s_nop 1
    v_mfma_f32_16x16x32_bf16 v[196:199], v[32:35], a[80:83], v[196:199]
    v_add_f32_dpp v120, v120, v120 row_ror:1 row_mask:0xf bank_mask:0xf
    v_mov_b32 v121, v120
    v_mfma_f32_16x16x32_bf16 v[200:203], v[32:35], a[144:147], v[200:203]
    s_add_u32 s43, s70, 21504
    ds_read_b64_tr_b16 v[60:61], v11 offset:45056
    s_nop 1
    v_mfma_f32_16x16x32_bf16 v[200:203], v[36:39], a[148:151], v[200:203]
    ds_read_b64_tr_b16 v[62:63], v11 offset:45568
    buffer_load_dwordx4 v69, s[8:11], s43 offen offset:3072 lds
    v_mfma_f32_16x16x32_bf16 v[204:207], v[36:39], a[212:215], v[204:207]
    v_permlane16_swap_b32 v120, v121
    v_add_f32 v120, v120, v121
    v_mfma_f32_16x16x32_bf16 v[204:207], v[32:35], a[208:211], v[204:207]
    s_waitcnt lgkmcnt(8)
    v_mul_f32 v120, 0x3b000000, v120
    v_cvt_pk_bf16_f32 v120, v120, v120
    v_mfma_f32_16x16x32_bf16 v[208:211], v[40:43], a[16:19], v[208:211]
    s_waitcnt vmcnt(16)
    s_barrier
    ds_read_b64_tr_b16 v[32:33], v8 offset:49152
    v_mfma_f32_16x16x32_bf16 v[208:211], v[44:47], a[20:23], v[208:211]
    s_add_u32 m0, s47, 4096
    ds_read_b64_tr_b16 v[34:35], v8 offset:49664
    v_and_b32 v120, 0xffff0000, v120
    v_mfma_f32_16x16x32_bf16 v[212:215], v[44:47], a[84:87], v[212:215]
    s_add_u32 s43, s70, 32768
    buffer_load_dwordx4 v68, s[8:11], s43 offen offset:0 lds
    v_mfma_f32_16x16x32_bf16 v[212:215], v[40:43], a[80:83], v[212:215]
    v_cvt_pk_bf16_f32 v122, v122, v122
    v_and_b32 v122, 0xffff0000, v122
    v_mfma_f32_16x16x32_bf16 v[216:219], v[40:43], a[144:147], v[216:219]
    ds_read_b64_tr_b16 v[36:37], v8 offset:53248
    v_add_f32 v120, 0x3727c5ac, v120
    v_mfma_f32_16x16x32_bf16 v[216:219], v[44:47], a[148:151], v[216:219]
    ds_read_b64_tr_b16 v[38:39], v8 offset:53760
    v_cvt_pk_bf16_f32 v120, v120, v120
    v_mfma_f32_16x16x32_bf16 v[220:223], v[44:47], a[212:215], v[220:223]
    s_add_u32 s43, s70, 39936
    buffer_load_dwordx4 v69, s[8:11], s43 offen offset:1024 lds
    v_mfma_f32_16x16x32_bf16 v[220:223], v[40:43], a[208:211], v[220:223]
    s_waitcnt lgkmcnt(8)
    v_and_b32 v120, 0xffff0000, v120
    v_mfma_f32_16x16x32_bf16 v[224:227], v[48:51], a[16:19], v[224:227]
    ds_read_b64_tr_b16 v[40:41], v9 offset:49152
    v_mfma_f32_16x16x32_bf16 v[224:227], v[52:55], a[20:23], v[224:227]
    ds_read_b64_tr_b16 v[42:43], v9 offset:49664
    v_mfma_f32_16x16x32_bf16 v[228:231], v[52:55], a[84:87], v[228:231]
    v_sqrt_f32 v120, v120
    v_mfma_f32_16x16x32_bf16 v[228:231], v[48:51], a[80:83], v[228:231]
    s_add_u32 s43, s70, 47104
    buffer_load_dwordx4 v68, s[8:11], s43 offen offset:2048 lds
    v_mfma_f32_16x16x32_bf16 v[232:235], v[48:51], a[144:147], v[232:235]
    ds_read_b64_tr_b16 v[44:45], v9 offset:53248
    s_nop 0
    v_mfma_f32_16x16x32_bf16 v[232:235], v[52:55], a[148:151], v[232:235]
    ds_read_b64_tr_b16 v[46:47], v9 offset:53760
    v_cvt_pk_bf16_f32 v120, v120, v120
    v_mfma_f32_16x16x32_bf16 v[236:239], v[52:55], a[212:215], v[236:239]
    v_mfma_f32_16x16x32_bf16 v[236:239], v[48:51], a[208:211], v[236:239]
    s_waitcnt lgkmcnt(8)
    v_mfma_f32_16x16x32_bf16 v[240:243], v[56:59], a[16:19], v[240:243]
    s_add_u32 s43, s70, 54272
    ds_read_b64_tr_b16 v[48:49], v10 offset:49152
    v_mfma_f32_16x16x32_bf16 v[240:243], v[60:63], a[20:23], v[240:243]
    ds_read_b64_tr_b16 v[50:51], v10 offset:49664
    buffer_load_dwordx4 v69, s[8:11], s43 offen offset:3072 lds
    v_mfma_f32_16x16x32_bf16 v[244:247], v[60:63], a[84:87], v[244:247]
    v_mfma_f32_16x16x32_bf16 v[244:247], v[56:59], a[80:83], v[244:247]
    v_mfma_f32_16x16x32_bf16 v[248:251], v[56:59], a[144:147], v[248:251]
    ds_read_b64_tr_b16 v[52:53], v10 offset:53248
    v_mfma_f32_16x16x32_bf16 v[248:251], v[60:63], a[148:151], v[248:251]
    ds_read_b64_tr_b16 v[54:55], v10 offset:53760
    v_mfma_f32_16x16x32_bf16 v[252:255], v[60:63], a[212:215], v[252:255]
    v_mfma_f32_16x16x32_bf16 v[252:255], v[56:59], a[208:211], v[252:255]
    s_waitcnt lgkmcnt(8)
    v_mfma_f32_16x16x32_bf16 v[128:131], v[32:35], a[24:27], v[128:131]
    s_add_u32 m0, s44, 81920
    ds_read_b64_tr_b16 v[56:57], v11 offset:49152
    v_and_b32 v120, 0xffff0000, v120
    v_mfma_f32_16x16x32_bf16 v[128:131], v[36:39], a[28:31], v[128:131]
    s_add_u32 s43, s62, 0
    ds_read_b64_tr_b16 v[58:59], v11 offset:49664
    buffer_load_dwordx4 v66, s[12:15], s43 offen offset:0 lds
    v_mfma_f32_16x16x32_bf16 v[132:135], v[36:39], a[92:95], v[132:135]
    v_rcp_f32 v123, v120
    v_mfma_f32_16x16x32_bf16 v[132:135], v[32:35], a[88:91], v[132:135]
    v_sub_f32 v104, v104, v122
    v_sub_f32 v105, v105, v122
    v_mfma_f32_16x16x32_bf16 v[136:139], v[32:35], a[152:155], v[136:139]
    ds_read_b64_tr_b16 v[60:61], v11 offset:53248
    v_cvt_pk_bf16_f32 v124, v104, v105
    v_mfma_f32_16x16x32_bf16 v[136:139], v[36:39], a[156:159], v[136:139]
    s_add_u32 s43, s62, 64512
    ds_read_b64_tr_b16 v[62:63], v11 offset:53760
    v_lshlrev_b32 v104, 16, v124
    v_mfma_f32_16x16x32_bf16 v[140:143], v[36:39], a[220:223], v[140:143]
    buffer_load_dwordx4 v67, s[12:15], s43 offen offset:1024 lds
    v_mfma_f32_16x16x32_bf16 v[140:143], v[32:35], a[216:219], v[140:143]
    s_waitcnt lgkmcnt(8)
    v_and_b32 v105, 0xffff0000, v124
    v_sub_f32 v106, v106, v122
    v_mfma_f32_16x16x32_bf16 v[144:147], v[40:43], a[24:27], v[144:147]
    s_waitcnt vmcnt(14)
    ds_read_b64_tr_b16 v[32:33], v8 offset:57344
    ds_read_b128 a[32:35], v72 offset:0
    v_mfma_f32_16x16x32_bf16 v[144:147], v[44:47], a[28:31], v[144:147]
    ds_read_b64_tr_b16 v[34:35], v8 offset:57856
    ds_read_b128 a[96:99], v72 offset:2048
    v_mfma_f32_16x16x32_bf16 v[148:151], v[44:47], a[92:95], v[148:151]
    s_add_u32 s43, s62, 129024
    buffer_load_dwordx4 v66, s[12:15], s43 offen offset:2048 lds
    v_mfma_f32_16x16x32_bf16 v[148:151], v[40:43], a[88:91], v[148:151]
    ds_read_b128 a[160:163], v72 offset:4096
    ds_read_b128 a[224:227], v72 offset:6144
    v_mfma_f32_16x16x32_bf16 v[152:155], v[40:43], a[152:155], v[152:155]
    ds_read_b64_tr_b16 v[36:37], v8 offset:61440
    ds_read_b128 a[36:39], v73 offset:0
    v_mfma_f32_16x16x32_bf16 v[152:155], v[44:47], a[156:159], v[152:155]
    ds_read_b64_tr_b16 v[38:39], v8 offset:61952
    ds_read_b128 a[100:103], v73 offset:2048
    v_mfma_f32_16x16x32_bf16 v[156:159], v[44:47], a[220:223], v[156:159]
    ds_read_b128 a[164:167], v73 offset:4096
    ds_read_b128 a[228:231], v73 offset:6144
    v_mfma_f32_16x16x32_bf16 v[156:159], v[40:43], a[216:219], v[156:159]
    s_waitcnt lgkmcnt(15)
    v_sub_f32 v107, v107, v122
    v_cvt_pk_bf16_f32 v124, v106, v107
    v_mfma_f32_16x16x32_bf16 v[160:163], v[48:51], a[24:27], v[160:163]
    s_add_u32 s43, s62, 193536
    ds_read_b64_tr_b16 v[40:41], v9 offset:57344
    buffer_load_dwordx4 v67, s[12:15], s43 offen offset:3072 lds
    v_mfma_f32_16x16x32_bf16 v[160:163], v[52:55], a[28:31], v[160:163]
    ds_read_b64_tr_b16 v[42:43], v9 offset:57856
    v_lshlrev_b32 v106, 16, v124
    v_mfma_f32_16x16x32_bf16 v[164:167], v[52:55], a[92:95], v[164:167]
    v_and_b32 v107, 0xffff0000, v124
    v_sub_f32 v108, v108, v122
    v_mfma_f32_16x16x32_bf16 v[164:167], v[48:51], a[88:91], v[164:167]
    v_sub_f32 v109, v109, v122
    v_cvt_pk_bf16_f32 v124, v108, v109
    v_mfma_f32_16x16x32_bf16 v[168:171], v[48:51], a[152:155], v[168:171]
    s_add_u32 m0, s47, 32768
    ds_read_b64_tr_b16 v[44:45], v9 offset:61440
    v_lshlrev_b32 v108, 16, v124
    v_mfma_f32_16x16x32_bf16 v[168:171], v[52:55], a[156:159], v[168:171]
    s_add_u32 s43, s71, 0
    ds_read_b64_tr_b16 v[46:47], v9 offset:61952
    buffer_load_dwordx4 v68, s[8:11], s43 offen offset:0 lds
    v_mfma_f32_16x16x32_bf16 v[172:175], v[52:55], a[220:223], v[172:175]
    v_and_b32 v109, 0xffff0000, v124
    v_sub_f32 v110, v110, v122
    v_mfma_f32_16x16x32_bf16 v[172:175], v[48:51], a[216:219], v[172:175]
    s_waitcnt lgkmcnt(15)
    v_sub_f32 v111, v111, v122
    v_cvt_pk_bf16_f32 v124, v110, v111
    v_mfma_f32_16x16x32_bf16 v[176:179], v[56:59], a[24:27], v[176:179]
    ds_read_b64_tr_b16 v[48:49], v10 offset:57344
    v_lshlrev_b32 v110, 16, v124
    v_mfma_f32_16x16x32_bf16 v[176:179], v[60:63], a[28:31], v[176:179]
    s_add_u32 s43, s71, 7168
    ds_read_b64_tr_b16 v[50:51], v10 offset:57856
    v_and_b32 v111, 0xffff0000, v124
    v_mfma_f32_16x16x32_bf16 v[180:183], v[60:63], a[92:95], v[180:183]
    buffer_load_dwordx4 v69, s[8:11], s43 offen offset:1024 lds
    v_mfma_f32_16x16x32_bf16 v[180:183], v[56:59], a[88:91], v[180:183]
    v_sub_f32 v112, v112, v122
    v_sub_f32 v113, v113, v122
    v_mfma_f32_16x16x32_bf16 v[184:187], v[56:59], a[152:155], v[184:187]
    ds_read_b64_tr_b16 v[52:53], v10 offset:61440
    v_cvt_pk_bf16_f32 v124, v112, v113
    v_mfma_f32_16x16x32_bf16 v[184:187], v[60:63], a[156:159], v[184:187]
    ds_read_b64_tr_b16 v[54:55], v10 offset:61952
    v_lshlrev_b32 v112, 16, v124
    v_mfma_f32_16x16x32_bf16 v[188:191], v[60:63], a[220:223], v[188:191]
    v_and_b32 v113, 0xffff0000, v124
    v_sub_f32 v114, v114, v122
    v_mfma_f32_16x16x32_bf16 v[188:191], v[56:59], a[216:219], v[188:191]
    s_waitcnt lgkmcnt(11)
    v_sub_f32 v115, v115, v122
    v_cvt_pk_bf16_f32 v124, v114, v115
    v_mfma_f32_16x16x32_bf16 v[192:195], v[32:35], a[24:27], v[192:195]
    s_add_u32 s43, s71, 14336
    ds_read_b64_tr_b16 v[56:57], v11 offset:57344
    buffer_load_dwordx4 v68, s[8:11], s43 offen offset:2048 lds
    v_mfma_f32_16x16x32_bf16 v[192:195], v[36:39], a[28:31], v[192:195]
    ds_read_b64_tr_b16 v[58:59], v11 offset:57856
    v_lshlrev_b32 v114, 16, v124
    v_mfma_f32_16x16x32_bf16 v[196:199], v[36:39], a[92:95], v[196:199]
    v_and_b32 v115, 0xffff0000, v124
    v_sub_f32 v116, v116, v122
    v_mfma_f32_16x16x32_bf16 v[196:199], v[32:35], a[88:91], v[196:199]
    v_sub_f32 v117, v117, v122
    v_cvt_pk_bf16_f32 v124, v116, v117
    v_mfma_f32_16x16x32_bf16 v[200:203], v[32:35], a[152:155], v[200:203]
    s_add_u32 s43, s71, 21504
    ds_read_b64_tr_b16 v[60:61], v11 offset:61440
    v_lshlrev_b32 v116, 16, v124
    v_mfma_f32_16x16x32_bf16 v[200:203], v[36:39], a[156:159], v[200:203]
    ds_read_b64_tr_b16 v[62:63], v11 offset:61952
    buffer_load_dwordx4 v69, s[8:11], s43 offen offset:3072 lds
    v_mfma_f32_16x16x32_bf16 v[204:207], v[36:39], a[220:223], v[204:207]
    v_and_b32 v117, 0xffff0000, v124
    v_sub_f32 v118, v118, v122
    v_mfma_f32_16x16x32_bf16 v[204:207], v[32:35], a[216:219], v[204:207]
    s_waitcnt lgkmcnt(8)
    v_sub_f32 v119, v119, v122
    v_cvt_pk_bf16_f32 v124, v118, v119
    v_mfma_f32_16x16x32_bf16 v[208:211], v[40:43], a[24:27], v[208:211]
    s_waitcnt vmcnt(16)
    s_barrier
    ds_read_b64_tr_b16 v[32:33], v8 offset:0
    v_mfma_f32_16x16x32_bf16 v[208:211], v[44:47], a[28:31], v[208:211]
    s_add_u32 m0, s47, 36864
    ds_read_b64_tr_b16 v[34:35], v8 offset:512
    v_lshlrev_b32 v118, 16, v124
    v_mfma_f32_16x16x32_bf16 v[212:215], v[44:47], a[92:95], v[212:215]
    s_add_u32 s43, s71, 32768
    buffer_load_dwordx4 v68, s[8:11], s43 offen offset:0 lds
    v_mfma_f32_16x16x32_bf16 v[212:215], v[40:43], a[88:91], v[212:215]
    v_and_b32 v119, 0xffff0000, v124
    v_mul_f32 v124, v104, v123
    v_mfma_f32_16x16x32_bf16 v[216:219], v[40:43], a[152:155], v[216:219]
    ds_read_b64_tr_b16 v[36:37], v8 offset:4096
    v_fma_f32 v125, -v124, v120, v104
    v_mfma_f32_16x16x32_bf16 v[216:219], v[44:47], a[156:159], v[216:219]
    ds_read_b64_tr_b16 v[38:39], v8 offset:4608
    v_fma_f32 v104, v125, v123, v124
    v_mfma_f32_16x16x32_bf16 v[220:223], v[44:47], a[220:223], v[220:223]
    s_add_u32 s43, s71, 39936
    buffer_load_dwordx4 v69, s[8:11], s43 offen offset:1024 lds
    v_mfma_f32_16x16x32_bf16 v[220:223], v[40:43], a[216:219], v[220:223]
    s_waitcnt lgkmcnt(8)
    v_mul_f32 v124, v105, v123
    v_fma_f32 v125, -v124, v120, v105
    v_mfma_f32_16x16x32_bf16 v[224:227], v[48:51], a[24:27], v[224:227]
    ds_read_b64_tr_b16 v[40:41], v9 offset:0
    v_fma_f32 v105, v125, v123, v124
    v_mfma_f32_16x16x32_bf16 v[224:227], v[52:55], a[28:31], v[224:227]
    ds_read_b64_tr_b16 v[42:43], v9 offset:512
    v_mul_f32 v124, v106, v123
    v_mfma_f32_16x16x32_bf16 v[228:231], v[52:55], a[92:95], v[228:231]
    v_fma_f32 v125, -v124, v120, v106
    v_mfma_f32_16x16x32_bf16 v[228:231], v[48:51], a[88:91], v[228:231]
    s_add_u32 s43, s71, 47104
    buffer_load_dwordx4 v68, s[8:11], s43 offen offset:2048 lds
    v_mfma_f32_16x16x32_bf16 v[232:235], v[48:51], a[152:155], v[232:235]
    ds_read_b64_tr_b16 v[44:45], v9 offset:4096
    v_mfma_f32_16x16x32_bf16 v[232:235], v[52:55], a[156:159], v[232:235]
    ds_read_b64_tr_b16 v[46:47], v9 offset:4608
    v_mfma_f32_16x16x32_bf16 v[236:239], v[52:55], a[220:223], v[236:239]
    v_mfma_f32_16x16x32_bf16 v[236:239], v[48:51], a[216:219], v[236:239]
    s_waitcnt lgkmcnt(8)
    v_mfma_f32_16x16x32_bf16 v[240:243], v[56:59], a[24:27], v[240:243]
    s_add_u32 s43, s71, 54272
    ds_read_b64_tr_b16 v[48:49], v10 offset:0
    v_mfma_f32_16x16x32_bf16 v[240:243], v[60:63], a[28:31], v[240:243]
    ds_read_b64_tr_b16 v[50:51], v10 offset:512
    buffer_load_dwordx4 v69, s[8:11], s43 offen offset:3072 lds
    v_mfma_f32_16x16x32_bf16 v[244:247], v[60:63], a[92:95], v[244:247]
    v_mfma_f32_16x16x32_bf16 v[244:247], v[56:59], a[88:91], v[244:247]
    v_mfma_f32_16x16x32_bf16 v[248:251], v[56:59], a[152:155], v[248:251]
    ds_read_b64_tr_b16 v[52:53], v10 offset:4096
    v_mfma_f32_16x16x32_bf16 v[248:251], v[60:63], a[156:159], v[248:251]
    ds_read_b64_tr_b16 v[54:55], v10 offset:4608
    v_mfma_f32_16x16x32_bf16 v[252:255], v[60:63], a[220:223], v[252:255]
    v_mfma_f32_16x16x32_bf16 v[252:255], v[56:59], a[216:219], v[252:255]
    s_waitcnt lgkmcnt(8)
    v_mfma_f32_16x16x32_bf16 v[128:131], v[32:35], a[32:35], v[128:131]
    s_add_u32 m0, s44, 98304
    ds_read_b64_tr_b16 v[56:57], v11 offset:0
    v_fma_f32 v106, v125, v123, v124
    v_mfma_f32_16x16x32_bf16 v[128:131], v[36:39], a[36:39], v[128:131]
    s_add_u32 s43, s63, 0
    ds_read_b64_tr_b16 v[58:59], v11 offset:512
    buffer_load_dwordx4 v66, s[12:15], s43 offen offset:0 lds
    v_mfma_f32_16x16x32_bf16 v[132:135], v[36:39], a[100:103], v[132:135]
    v_mul_f32 v124, v107, v123
    v_fma_f32 v125, -v124, v120, v107
    v_mfma_f32_16x16x32_bf16 v[132:135], v[32:35], a[96:99], v[132:135]
    v_fma_f32 v107, v125, v123, v124
    v_mul_f32 v124, v108, v123
    v_mfma_f32_16x16x32_bf16 v[136:139], v[32:35], a[160:163], v[136:139]
    ds_read_b64_tr_b16 v[60:61], v11 offset:4096
    v_fma_f32 v125, -v124, v120, v108
    v_mfma_f32_16x16x32_bf16 v[136:139], v[36:39], a[164:167], v[136:139]
    s_add_u32 s43, s63, 64512
    ds_read_b64_tr_b16 v[62:63], v11 offset:4608
    v_fma_f32 v108, v125, v123, v124
    v_mfma_f32_16x16x32_bf16 v[140:143], v[36:39], a[228:231], v[140:143]
    buffer_load_dwordx4 v67, s[12:15], s43 offen offset:1024 lds
    v_mfma_f32_16x16x32_bf16 v[140:143], v[32:35], a[224:227], v[140:143]
    s_waitcnt lgkmcnt(8)
    v_mul_f32 v124, v109, v123
    v_fma_f32 v125, -v124, v120, v109
    v_mfma_f32_16x16x32_bf16 v[144:147], v[40:43], a[32:35], v[144:147]
    s_waitcnt vmcnt(14)
    ds_read_b64_tr_b16 v[32:33], v8 offset:8192
    ds_read_b128 a[40:43], v70 offset:0
    v_mfma_f32_16x16x32_bf16 v[144:147], v[44:47], a[36:39], v[144:147]
    ds_read_b64_tr_b16 v[34:35], v8 offset:8704
    ds_read_b128 a[104:107], v70 offset:2048
    v_mfma_f32_16x16x32_bf16 v[148:151], v[44:47], a[100:103], v[148:151]
    s_add_u32 s43, s63, 129024
    buffer_load_dwordx4 v66, s[12:15], s43 offen offset:2048 lds
    v_mfma_f32_16x16x32_bf16 v[148:151], v[40:43], a[96:99], v[148:151]
    ds_read_b128 a[168:171], v70 offset:4096
    ds_read_b128 a[232:235], v70 offset:6144
    v_mfma_f32_16x16x32_bf16 v[152:155], v[40:43], a[160:163], v[152:155]
    ds_read_b64_tr_b16 v[36:37], v8 offset:12288
    ds_read_b128 a[44:47], v71 offset:0
    v_mfma_f32_16x16x32_bf16 v[152:155], v[44:47], a[164:167], v[152:155]
    ds_read_b64_tr_b16 v[38:39], v8 offset:12800
    ds_read_b128 a[108:111], v71 offset:2048
    v_mfma_f32_16x16x32_bf16 v[156:159], v[44:47], a[228:231], v[156:159]
    ds_read_b128 a[172:175], v71 offset:4096
    ds_read_b128 a[236:239], v71 offset:6144
    v_mfma_f32_16x16x32_bf16 v[156:159], v[40:43], a[224:227], v[156:159]
    s_waitcnt lgkmcnt(15)
    v_fma_f32 v109, v125, v123, v124
    v_mul_f32 v124, v110, v123
    v_mfma_f32_16x16x32_bf16 v[160:163], v[48:51], a[32:35], v[160:163]
    s_add_u32 s43, s63, 193536
    ds_read_b64_tr_b16 v[40:41], v9 offset:8192
    buffer_load_dwordx4 v67, s[12:15], s43 offen offset:3072 lds
    v_mfma_f32_16x16x32_bf16 v[160:163], v[52:55], a[36:39], v[160:163]
    ds_read_b64_tr_b16 v[42:43], v9 offset:8704
    v_fma_f32 v125, -v124, v120, v110
    v_mfma_f32_16x16x32_bf16 v[164:167], v[52:55], a[100:103], v[164:167]
    v_fma_f32 v110, v125, v123, v124
    v_mul_f32 v124, v111, v123
    v_mfma_f32_16x16x32_bf16 v[164:167], v[48:51], a[96:99], v[164:167]
    v_fma_f32 v125, -v124, v120, v111
    v_fma_f32 v111, v125, v123, v124
    v_mfma_f32_16x16x32_bf16 v[168:171], v[48:51], a[160:163], v[168:171]
    s_add_u32 m0, s47, 131072
    ds_read_b64_tr_b16 v[44:45], v9 offset:12288
    v_mul_f32 v124, v112, v123
    v_mfma_f32_16x16x32_bf16 v[168:171], v[52:55], a[164:167], v[168:171]
    s_add_u32 s43, s72, 0
    ds_read_b64_tr_b16 v[46:47], v9 offset:12800
    buffer_load_dwordx4 v68, s[8:11], s43 offen offset:0 lds
    v_mfma_f32_16x16x32_bf16 v[172:175], v[52:55], a[228:231], v[172:175]
    v_fma_f32 v125, -v124, v120, v112
    v_fma_f32 v112, v125, v123, v124
    v_mfma_f32_16x16x32_bf16 v[172:175], v[48:51], a[224:227], v[172:175]
    s_waitcnt lgkmcnt(15)
    v_mul_f32 v124, v113, v123
    v_fma_f32 v125, -v124, v120, v113
    v_mfma_f32_16x16x32_bf16 v[176:179], v[56:59], a[32:35], v[176:179]
    ds_read_b64_tr_b16 v[48:49], v10 offset:8192
    v_fma_f32 v113, v125, v123, v124
    v_mfma_f32_16x16x32_bf16 v[176:179], v[60:63], a[36:39], v[176:179]
    s_add_u32 s43, s72, 7168
    ds_read_b64_tr_b16 v[50:51], v10 offset:8704
    v_mul_f32 v124, v114, v123
    v_mfma_f32_16x16x32_bf16 v[180:183], v[60:63], a[100:103], v[180:183]
    buffer_load_dwordx4 v69, s[8:11], s43 offen offset:1024 lds
    v_mfma_f32_16x16x32_bf16 v[180:183], v[56:59], a[96:99], v[180:183]
    v_fma_f32 v125, -v124, v120, v114
    v_fma_f32 v114, v125, v123, v124
    v_mfma_f32_16x16x32_bf16 v[184:187], v[56:59], a[160:163], v[184:187]
    ds_read_b64_tr_b16 v[52:53], v10 offset:12288
    v_mul_f32 v124, v115, v123
    v_mfma_f32_16x16x32_bf16 v[184:187], v[60:63], a[164:167], v[184:187]
    ds_read_b64_tr_b16 v[54:55], v10 offset:12800
    v_fma_f32 v125, -v124, v120, v115
    v_mfma_f32_16x16x32_bf16 v[188:191], v[60:63], a[228:231], v[188:191]
    v_fma_f32 v115, v125, v123, v124
    v_mul_f32 v124, v116, v123
    v_mfma_f32_16x16x32_bf16 v[188:191], v[56:59], a[224:227], v[188:191]
    s_waitcnt lgkmcnt(11)
    v_fma_f32 v125, -v124, v120, v116
    v_fma_f32 v116, v125, v123, v124
    v_mfma_f32_16x16x32_bf16 v[192:195], v[32:35], a[32:35], v[192:195]
    s_add_u32 s43, s72, 14336
    ds_read_b64_tr_b16 v[56:57], v11 offset:8192
    buffer_load_dwordx4 v68, s[8:11], s43 offen offset:2048 lds
    v_mfma_f32_16x16x32_bf16 v[192:195], v[36:39], a[36:39], v[192:195]
    ds_read_b64_tr_b16 v[58:59], v11 offset:8704
    v_mul_f32 v124, v117, v123
    v_mfma_f32_16x16x32_bf16 v[196:199], v[36:39], a[100:103], v[196:199]
    v_fma_f32 v125, -v124, v120, v117
    v_fma_f32 v117, v125, v123, v124
    v_mfma_f32_16x16x32_bf16 v[196:199], v[32:35], a[96:99], v[196:199]
    v_mul_f32 v124, v118, v123
    v_fma_f32 v125, -v124, v120, v118
    v_mfma_f32_16x16x32_bf16 v[200:203], v[32:35], a[160:163], v[200:203]
    s_add_u32 s43, s72, 21504
    ds_read_b64_tr_b16 v[60:61], v11 offset:12288
    v_fma_f32 v118, v125, v123, v124
    v_mfma_f32_16x16x32_bf16 v[200:203], v[36:39], a[164:167], v[200:203]
    ds_read_b64_tr_b16 v[62:63], v11 offset:12800
    buffer_load_dwordx4 v69, s[8:11], s43 offen offset:3072 lds
    v_mfma_f32_16x16x32_bf16 v[204:207], v[36:39], a[228:231], v[204:207]
    v_mul_f32 v124, v119, v123
    v_fma_f32 v125, -v124, v120, v119
    v_mfma_f32_16x16x32_bf16 v[204:207], v[32:35], a[224:227], v[204:207]
    s_waitcnt lgkmcnt(8)
    v_fma_f32 v119, v125, v123, v124
    v_cvt_pk_bf16_f32 v96, v104, v105
    v_mfma_f32_16x16x32_bf16 v[208:211], v[40:43], a[32:35], v[208:211]
    s_waitcnt vmcnt(16)
    s_barrier
    ds_read_b64_tr_b16 v[32:33], v8 offset:16384
    v_mfma_f32_16x16x32_bf16 v[208:211], v[44:47], a[36:39], v[208:211]
    s_add_u32 m0, s47, 135168
    ds_read_b64_tr_b16 v[34:35], v8 offset:16896
    v_cvt_pk_bf16_f32 v97, v106, v107
    v_mfma_f32_16x16x32_bf16 v[212:215], v[44:47], a[100:103], v[212:215]
    s_add_u32 s43, s72, 32768
    buffer_load_dwordx4 v68, s[8:11], s43 offen offset:0 lds
    v_mfma_f32_16x16x32_bf16 v[212:215], v[40:43], a[96:99], v[212:215]
    v_cvt_pk_bf16_f32 v98, v108, v109
    v_cvt_pk_bf16_f32 v99, v110, v111
    v_mfma_f32_16x16x32_bf16 v[216:219], v[40:43], a[160:163], v[216:219]
    ds_read_b64_tr_b16 v[36:37], v8 offset:20480
    v_cvt_pk_bf16_f32 v100, v112, v113
    v_mfma_f32_16x16x32_bf16 v[216:219], v[44:47], a[164:167], v[216:219]
    ds_read_b64_tr_b16 v[38:39], v8 offset:20992
    v_cvt_pk_bf16_f32 v101, v114, v115
    v_mfma_f32_16x16x32_bf16 v[220:223], v[44:47], a[228:231], v[220:223]
    s_add_u32 s43, s72, 39936
    buffer_load_dwordx4 v69, s[8:11], s43 offen offset:1024 lds
    v_mfma_f32_16x16x32_bf16 v[220:223], v[40:43], a[224:227], v[220:223]
    s_waitcnt lgkmcnt(8)
    v_cvt_pk_bf16_f32 v102, v116, v117
    v_cvt_pk_bf16_f32 v103, v118, v119
    v_mfma_f32_16x16x32_bf16 v[224:227], v[48:51], a[32:35], v[224:227]
    ds_read_b64_tr_b16 v[40:41], v9 offset:16384
    v_mfma_f32_16x16x32_bf16 v[224:227], v[52:55], a[36:39], v[224:227]
    ds_read_b64_tr_b16 v[42:43], v9 offset:16896
    v_mfma_f32_16x16x32_bf16 v[228:231], v[52:55], a[100:103], v[228:231]
    v_mfma_f32_16x16x32_bf16 v[228:231], v[48:51], a[96:99], v[228:231]
    s_add_u32 s43, s72, 47104
    buffer_load_dwordx4 v68, s[8:11], s43 offen offset:2048 lds
    v_mfma_f32_16x16x32_bf16 v[232:235], v[48:51], a[160:163], v[232:235]
    ds_read_b64_tr_b16 v[44:45], v9 offset:20480
    v_mfma_f32_16x16x32_bf16 v[232:235], v[52:55], a[164:167], v[232:235]
    ds_read_b64_tr_b16 v[46:47], v9 offset:20992
    v_mfma_f32_16x16x32_bf16 v[236:239], v[52:55], a[228:231], v[236:239]
    v_mfma_f32_16x16x32_bf16 v[236:239], v[48:51], a[224:227], v[236:239]
    s_waitcnt lgkmcnt(8)
    v_mfma_f32_16x16x32_bf16 v[240:243], v[56:59], a[32:35], v[240:243]
    s_add_u32 s43, s72, 54272
    ds_read_b64_tr_b16 v[48:49], v10 offset:16384
    v_mfma_f32_16x16x32_bf16 v[240:243], v[60:63], a[36:39], v[240:243]
    ds_read_b64_tr_b16 v[50:51], v10 offset:16896
    buffer_load_dwordx4 v69, s[8:11], s43 offen offset:3072 lds
    v_mfma_f32_16x16x32_bf16 v[244:247], v[60:63], a[100:103], v[244:247]
    v_mfma_f32_16x16x32_bf16 v[244:247], v[56:59], a[96:99], v[244:247]
    v_mfma_f32_16x16x32_bf16 v[248:251], v[56:59], a[160:163], v[248:251]
    ds_read_b64_tr_b16 v[52:53], v10 offset:20480
    v_mfma_f32_16x16x32_bf16 v[248:251], v[60:63], a[164:167], v[248:251]
    ds_read_b64_tr_b16 v[54:55], v10 offset:20992
    buffer_store_dwordx4 v[96:99], v75, s[28:31], 0 offen sc0 sc1
    v_mfma_f32_16x16x32_bf16 v[252:255], v[60:63], a[228:231], v[252:255]
    v_mfma_f32_16x16x32_bf16 v[252:255], v[56:59], a[224:227], v[252:255]
    s_waitcnt lgkmcnt(8)
    buffer_store_dwordx4 v[100:103], v75, s[28:31], 0 offen offset:256 sc0 sc1
    v_mfma_f32_16x16x32_bf16 v[128:131], v[32:35], a[40:43], v[128:131]
    s_add_u32 m0, s44, 114688
    ds_read_b64_tr_b16 v[56:57], v11 offset:16384
    v_mfma_f32_16x16x32_bf16 v[128:131], v[36:39], a[44:47], v[128:131]
    s_add_u32 s43, s64, 0
    ds_read_b64_tr_b16 v[58:59], v11 offset:16896
    buffer_load_dwordx4 v66, s[12:15], s43 offen offset:0 lds
    v_mfma_f32_16x16x32_bf16 v[132:135], v[36:39], a[108:111], v[132:135]
    v_mfma_f32_16x16x32_bf16 v[132:135], v[32:35], a[104:107], v[132:135]
    v_mfma_f32_16x16x32_bf16 v[136:139], v[32:35], a[168:171], v[136:139]
    ds_read_b64_tr_b16 v[60:61], v11 offset:20480
    v_mfma_f32_16x16x32_bf16 v[136:139], v[36:39], a[172:175], v[136:139]
    ds_read_b64_tr_b16 v[62:63], v11 offset:20992
    v_mfma_f32_16x16x32_bf16 v[140:143], v[36:39], a[236:239], v[140:143]
    v_mfma_f32_16x16x32_bf16 v[140:143], v[32:35], a[232:235], v[140:143]
    s_waitcnt lgkmcnt(8)
    v_mfma_f32_16x16x32_bf16 v[144:147], v[40:43], a[40:43], v[144:147]
    s_waitcnt vmcnt(15)
    ds_read_b64_tr_b16 v[32:33], v8 offset:24576
    ds_read_b128 a[48:51], v70 offset:32768
    v_mfma_f32_16x16x32_bf16 v[144:147], v[44:47], a[44:47], v[144:147]
    ds_read_b64_tr_b16 v[34:35], v8 offset:25088
    ds_read_b128 a[112:115], v70 offset:34816
    v_mfma_f32_16x16x32_bf16 v[148:151], v[44:47], a[108:111], v[148:151]
    ds_read_b128 a[176:179], v70 offset:36864
    ds_read_b128 a[240:243], v70 offset:38912
    v_mfma_f32_16x16x32_bf16 v[148:151], v[40:43], a[104:107], v[148:151]
    ds_read_b128 a[52:55], v71 offset:32768
    ds_read_b128 a[116:119], v71 offset:34816
    v_mfma_f32_16x16x32_bf16 v[152:155], v[40:43], a[168:171], v[152:155]
    ds_read_b64_tr_b16 v[36:37], v8 offset:28672
    ds_read_b128 a[180:183], v71 offset:36864
    v_mfma_f32_16x16x32_bf16 v[152:155], v[44:47], a[172:175], v[152:155]
    ds_read_b64_tr_b16 v[38:39], v8 offset:29184
    ds_read_b128 a[244:247], v71 offset:38912
    v_mfma_f32_16x16x32_bf16 v[156:159], v[44:47], a[236:239], v[156:159]
    v_mfma_f32_16x16x32_bf16 v[156:159], v[40:43], a[232:235], v[156:159]
    s_waitcnt lgkmcnt(15)
    v_mfma_f32_16x16x32_bf16 v[160:163], v[48:51], a[40:43], v[160:163]
    s_add_u32 s43, s64, 64512
    ds_read_b64_tr_b16 v[40:41], v9 offset:24576
    buffer_load_dwordx4 v67, s[12:15], s43 offen offset:1024 lds
    v_mfma_f32_16x16x32_bf16 v[160:163], v[52:55], a[44:47], v[160:163]
    ds_read_b64_tr_b16 v[42:43], v9 offset:25088
    v_mfma_f32_16x16x32_bf16 v[164:167], v[52:55], a[108:111], v[164:167]
    v_mfma_f32_16x16x32_bf16 v[164:167], v[48:51], a[104:107], v[164:167]
    v_mfma_f32_16x16x32_bf16 v[168:171], v[48:51], a[168:171], v[168:171]
    ds_read_b64_tr_b16 v[44:45], v9 offset:28672
    v_mfma_f32_16x16x32_bf16 v[168:171], v[52:55], a[172:175], v[168:171]
    ds_read_b64_tr_b16 v[46:47], v9 offset:29184
    v_mfma_f32_16x16x32_bf16 v[172:175], v[52:55], a[236:239], v[172:175]
    v_mfma_f32_16x16x32_bf16 v[172:175], v[48:51], a[232:235], v[172:175]
    s_waitcnt lgkmcnt(15)
    v_mfma_f32_16x16x32_bf16 v[176:179], v[56:59], a[40:43], v[176:179]
    ds_read_b64_tr_b16 v[48:49], v10 offset:24576
    v_mfma_f32_16x16x32_bf16 v[176:179], v[60:63], a[44:47], v[176:179]
    ds_read_b64_tr_b16 v[50:51], v10 offset:25088
    v_mfma_f32_16x16x32_bf16 v[180:183], v[60:63], a[108:111], v[180:183]
    v_mfma_f32_16x16x32_bf16 v[180:183], v[56:59], a[104:107], v[180:183]
    v_mfma_f32_16x16x32_bf16 v[184:187], v[56:59], a[168:171], v[184:187]
    ds_read_b64_tr_b16 v[52:53], v10 offset:28672
    v_mfma_f32_16x16x32_bf16 v[184:187], v[60:63], a[172:175], v[184:187]
    ds_read_b64_tr_b16 v[54:55], v10 offset:29184
    v_mfma_f32_16x16x32_bf16 v[188:191], v[60:63], a[236:239], v[188:191]
    v_mfma_f32_16x16x32_bf16 v[188:191], v[56:59], a[232:235], v[188:191]
    s_waitcnt lgkmcnt(9)
    v_mfma_f32_16x16x32_bf16 v[192:195], v[32:35], a[40:43], v[192:195]
    s_add_u32 s43, s64, 129024
    ds_read_b64_tr_b16 v[56:57], v11 offset:24576
    buffer_load_dwordx4 v66, s[12:15], s43 offen offset:2048 lds
    v_mfma_f32_16x16x32_bf16 v[192:195], v[36:39], a[44:47], v[192:195]
    ds_read_b64_tr_b16 v[58:59], v11 offset:25088
    v_mfma_f32_16x16x32_bf16 v[196:199], v[36:39], a[108:111], v[196:199]
    v_mfma_f32_16x16x32_bf16 v[196:199], v[32:35], a[104:107], v[196:199]
    v_mfma_f32_16x16x32_bf16 v[200:203], v[32:35], a[168:171], v[200:203]
    ds_read_b64_tr_b16 v[60:61], v11 offset:28672
    v_mfma_f32_16x16x32_bf16 v[200:203], v[36:39], a[172:175], v[200:203]
    ds_read_b64_tr_b16 v[62:63], v11 offset:29184
    v_mfma_f32_16x16x32_bf16 v[204:207], v[36:39], a[236:239], v[204:207]
    v_mfma_f32_16x16x32_bf16 v[204:207], v[32:35], a[232:235], v[204:207]
    s_waitcnt lgkmcnt(8)
    v_mfma_f32_16x16x32_bf16 v[208:211], v[40:43], a[40:43], v[208:211]
    s_waitcnt vmcnt(13)
    s_barrier
    ds_read_b64_tr_b16 v[32:33], v8 offset:32768
    v_mfma_f32_16x16x32_bf16 v[208:211], v[44:47], a[44:47], v[208:211]
    ds_read_b64_tr_b16 v[34:35], v8 offset:33280
    v_mfma_f32_16x16x32_bf16 v[212:215], v[44:47], a[108:111], v[212:215]
    v_mfma_f32_16x16x32_bf16 v[212:215], v[40:43], a[104:107], v[212:215]
    v_mfma_f32_16x16x32_bf16 v[216:219], v[40:43], a[168:171], v[216:219]
    ds_read_b64_tr_b16 v[36:37], v8 offset:36864
    v_mfma_f32_16x16x32_bf16 v[216:219], v[44:47], a[172:175], v[216:219]
    ds_read_b64_tr_b16 v[38:39], v8 offset:37376
    v_mfma_f32_16x16x32_bf16 v[220:223], v[44:47], a[236:239], v[220:223]
    s_add_u32 s43, s64, 193536
    buffer_load_dwordx4 v67, s[12:15], s43 offen offset:3072 lds
    v_mfma_f32_16x16x32_bf16 v[220:223], v[40:43], a[232:235], v[220:223]
    s_waitcnt lgkmcnt(8)
    v_mfma_f32_16x16x32_bf16 v[224:227], v[48:51], a[40:43], v[224:227]
    ds_read_b64_tr_b16 v[40:41], v9 offset:32768
    v_mfma_f32_16x16x32_bf16 v[224:227], v[52:55], a[44:47], v[224:227]
    ds_read_b64_tr_b16 v[42:43], v9 offset:33280
    v_mfma_f32_16x16x32_bf16 v[228:231], v[52:55], a[108:111], v[228:231]
    v_mfma_f32_16x16x32_bf16 v[228:231], v[48:51], a[104:107], v[228:231]
    v_mfma_f32_16x16x32_bf16 v[232:235], v[48:51], a[168:171], v[232:235]
    ds_read_b64_tr_b16 v[44:45], v9 offset:36864
    v_mfma_f32_16x16x32_bf16 v[232:235], v[52:55], a[172:175], v[232:235]
    ds_read_b64_tr_b16 v[46:47], v9 offset:37376
    v_mfma_f32_16x16x32_bf16 v[236:239], v[52:55], a[236:239], v[236:239]
    v_mfma_f32_16x16x32_bf16 v[236:239], v[48:51], a[232:235], v[236:239]
    s_waitcnt lgkmcnt(8)
    v_mfma_f32_16x16x32_bf16 v[240:243], v[56:59], a[40:43], v[240:243]
    ds_read_b64_tr_b16 v[48:49], v10 offset:32768
    v_mfma_f32_16x16x32_bf16 v[240:243], v[60:63], a[44:47], v[240:243]
    ds_read_b64_tr_b16 v[50:51], v10 offset:33280
    v_mfma_f32_16x16x32_bf16 v[244:247], v[60:63], a[108:111], v[244:247]
    v_mfma_f32_16x16x32_bf16 v[244:247], v[56:59], a[104:107], v[244:247]
    v_mfma_f32_16x16x32_bf16 v[248:251], v[56:59], a[168:171], v[248:251]
    ds_read_b64_tr_b16 v[52:53], v10 offset:36864
    v_mfma_f32_16x16x32_bf16 v[248:251], v[60:63], a[172:175], v[248:251]
    ds_read_b64_tr_b16 v[54:55], v10 offset:37376
    v_mfma_f32_16x16x32_bf16 v[252:255], v[60:63], a[236:239], v[252:255]
    v_mfma_f32_16x16x32_bf16 v[252:255], v[56:59], a[232:235], v[252:255]
    s_waitcnt lgkmcnt(8)
    v_mfma_f32_16x16x32_bf16 v[128:131], v[32:35], a[48:51], v[128:131]
    s_add_u32 m0, s44, 0
    ds_read_b64_tr_b16 v[56:57], v11 offset:32768
    v_mfma_f32_16x16x32_bf16 v[128:131], v[36:39], a[52:55], v[128:131]
    s_add_u32 s43, s73, 0
    ds_read_b64_tr_b16 v[58:59], v11 offset:33280
    buffer_load_dwordx4 v2, s[16:19], s43 offen offset:0 lds
    v_mfma_f32_16x16x32_bf16 v[132:135], v[36:39], a[116:119], v[132:135]
    v_mfma_f32_16x16x32_bf16 v[132:135], v[32:35], a[112:115], v[132:135]
    v_mfma_f32_16x16x32_bf16 v[136:139], v[32:35], a[176:179], v[136:139]
    ds_read_b64_tr_b16 v[60:61], v11 offset:36864
    v_mfma_f32_16x16x32_bf16 v[136:139], v[36:39], a[180:183], v[136:139]
    ds_read_b64_tr_b16 v[62:63], v11 offset:37376
    v_mfma_f32_16x16x32_bf16 v[140:143], v[36:39], a[244:247], v[140:143]
    v_mfma_f32_16x16x32_bf16 v[140:143], v[32:35], a[240:243], v[140:143]
    s_waitcnt lgkmcnt(8)
    v_mfma_f32_16x16x32_bf16 v[144:147], v[40:43], a[48:51], v[144:147]
    s_waitcnt vmcnt(7)
    ds_read_b64_tr_b16 v[32:33], v8 offset:40960
    s_add_u32 s43, s73, 64512
    buffer_load_dwordx4 v3, s[16:19], s43 offen offset:1024 lds
    v_mfma_f32_16x16x32_bf16 v[144:147], v[44:47], a[52:55], v[144:147]
    ds_read_b64_tr_b16 v[34:35], v8 offset:41472
    ds_read_b128 a[56:59], v72 offset:0
    v_mfma_f32_16x16x32_bf16 v[148:151], v[44:47], a[116:119], v[148:151]
    ds_read_b128 a[120:123], v72 offset:2048
    ds_read_b128 a[184:187], v72 offset:4096
    v_mfma_f32_16x16x32_bf16 v[148:151], v[40:43], a[112:115], v[148:151]
    ds_read_b128 a[248:251], v72 offset:6144
    ds_read_b128 a[60:63], v73 offset:0
    v_mfma_f32_16x16x32_bf16 v[152:155], v[40:43], a[176:179], v[152:155]
    ds_read_b64_tr_b16 v[36:37], v8 offset:45056
    ds_read_b128 a[124:127], v73 offset:2048
    v_mfma_f32_16x16x32_bf16 v[152:155], v[44:47], a[180:183], v[152:155]
    ds_read_b64_tr_b16 v[38:39], v8 offset:45568
    ds_read_b128 a[188:191], v73 offset:4096
    v_mfma_f32_16x16x32_bf16 v[156:159], v[44:47], a[244:247], v[156:159]
    ds_read_b128 a[252:255], v73 offset:6144
    v_mfma_f32_16x16x32_bf16 v[156:159], v[40:43], a[240:243], v[156:159]
    s_waitcnt lgkmcnt(15)
    v_mfma_f32_16x16x32_bf16 v[160:163], v[48:51], a[48:51], v[160:163]
    s_add_u32 s43, s73, 129024
    ds_read_b64_tr_b16 v[40:41], v9 offset:40960
    buffer_load_dwordx4 v2, s[16:19], s43 offen offset:2048 lds
    v_mfma_f32_16x16x32_bf16 v[160:163], v[52:55], a[52:55], v[160:163]
    ds_read_b64_tr_b16 v[42:43], v9 offset:41472
    v_mfma_f32_16x16x32_bf16 v[164:167], v[52:55], a[116:119], v[164:167]
    v_mfma_f32_16x16x32_bf16 v[164:167], v[48:51], a[112:115], v[164:167]
    v_mfma_f32_16x16x32_bf16 v[168:171], v[48:51], a[176:179], v[168:171]
    ds_read_b64_tr_b16 v[44:45], v9 offset:45056
    v_mfma_f32_16x16x32_bf16 v[168:171], v[52:55], a[180:183], v[168:171]
    ds_read_b64_tr_b16 v[46:47], v9 offset:45568
    v_mfma_f32_16x16x32_bf16 v[172:175], v[52:55], a[244:247], v[172:175]
    v_mfma_f32_16x16x32_bf16 v[172:175], v[48:51], a[240:243], v[172:175]
    s_waitcnt lgkmcnt(15)
    v_mfma_f32_16x16x32_bf16 v[176:179], v[56:59], a[48:51], v[176:179]
    s_add_u32 s43, s73, 193536
    ds_read_b64_tr_b16 v[48:49], v10 offset:40960
    buffer_load_dwordx4 v3, s[16:19], s43 offen offset:3072 lds
    v_mfma_f32_16x16x32_bf16 v[176:179], v[60:63], a[52:55], v[176:179]
    ds_read_b64_tr_b16 v[50:51], v10 offset:41472
    v_mfma_f32_16x16x32_bf16 v[180:183], v[60:63], a[116:119], v[180:183]
    v_mfma_f32_16x16x32_bf16 v[180:183], v[56:59], a[112:115], v[180:183]
    v_mfma_f32_16x16x32_bf16 v[184:187], v[56:59], a[176:179], v[184:187]
    ds_read_b64_tr_b16 v[52:53], v10 offset:45056
    v_mfma_f32_16x16x32_bf16 v[184:187], v[60:63], a[180:183], v[184:187]
    ds_read_b64_tr_b16 v[54:55], v10 offset:45568
    v_mfma_f32_16x16x32_bf16 v[188:191], v[60:63], a[244:247], v[188:191]
    v_mfma_f32_16x16x32_bf16 v[188:191], v[56:59], a[240:243], v[188:191]
    s_waitcnt lgkmcnt(10)
    v_mfma_f32_16x16x32_bf16 v[192:195], v[32:35], a[48:51], v[192:195]
    s_add_u32 m0, s44, 16384
    ds_read_b64_tr_b16 v[56:57], v11 offset:40960
    s_add_u32 s43, s74, 0
    buffer_load_dwordx4 v2, s[16:19], s43 offen offset:0 lds
    v_mfma_f32_16x16x32_bf16 v[192:195], v[36:39], a[52:55], v[192:195]
    ds_read_b64_tr_b16 v[58:59], v11 offset:41472
    v_mfma_f32_16x16x32_bf16 v[196:199], v[36:39], a[116:119], v[196:199]
    v_mfma_f32_16x16x32_bf16 v[196:199], v[32:35], a[112:115], v[196:199]
    v_mfma_f32_16x16x32_bf16 v[200:203], v[32:35], a[176:179], v[200:203]
    ds_read_b64_tr_b16 v[60:61], v11 offset:45056
    v_mfma_f32_16x16x32_bf16 v[200:203], v[36:39], a[180:183], v[200:203]
    ds_read_b64_tr_b16 v[62:63], v11 offset:45568
    v_mfma_f32_16x16x32_bf16 v[204:207], v[36:39], a[244:247], v[204:207]
    s_add_u32 s43, s74, 64512
    buffer_load_dwordx4 v3, s[16:19], s43 offen offset:1024 lds
    v_mfma_f32_16x16x32_bf16 v[204:207], v[32:35], a[240:243], v[204:207]
    s_waitcnt lgkmcnt(8)
    v_mfma_f32_16x16x32_bf16 v[208:211], v[40:43], a[48:51], v[208:211]
    s_waitcnt vmcnt(6)
    s_barrier
    ds_read_b64_tr_b16 v[32:33], v8 offset:49152
    v_mfma_f32_16x16x32_bf16 v[208:211], v[44:47], a[52:55], v[208:211]
    ds_read_b64_tr_b16 v[34:35], v8 offset:49664
    v_mfma_f32_16x16x32_bf16 v[212:215], v[44:47], a[116:119], v[212:215]
    v_mfma_f32_16x16x32_bf16 v[212:215], v[40:43], a[112:115], v[212:215]
    v_mfma_f32_16x16x32_bf16 v[216:219], v[40:43], a[176:179], v[216:219]
    ds_read_b64_tr_b16 v[36:37], v8 offset:53248
    v_mfma_f32_16x16x32_bf16 v[216:219], v[44:47], a[180:183], v[216:219]
    ds_read_b64_tr_b16 v[38:39], v8 offset:53760
    v_mfma_f32_16x16x32_bf16 v[220:223], v[44:47], a[244:247], v[220:223]
    s_add_u32 s43, s74, 129024
    buffer_load_dwordx4 v2, s[16:19], s43 offen offset:2048 lds
    v_mfma_f32_16x16x32_bf16 v[220:223], v[40:43], a[240:243], v[220:223]
    s_waitcnt lgkmcnt(8)
    v_mfma_f32_16x16x32_bf16 v[224:227], v[48:51], a[48:51], v[224:227]
    ds_read_b64_tr_b16 v[40:41], v9 offset:49152
    v_mfma_f32_16x16x32_bf16 v[224:227], v[52:55], a[52:55], v[224:227]
    ds_read_b64_tr_b16 v[42:43], v9 offset:49664
    v_mfma_f32_16x16x32_bf16 v[228:231], v[52:55], a[116:119], v[228:231]
    v_mfma_f32_16x16x32_bf16 v[228:231], v[48:51], a[112:115], v[228:231]
    v_mfma_f32_16x16x32_bf16 v[232:235], v[48:51], a[176:179], v[232:235]
    ds_read_b64_tr_b16 v[44:45], v9 offset:53248
    v_mfma_f32_16x16x32_bf16 v[232:235], v[52:55], a[180:183], v[232:235]
    ds_read_b64_tr_b16 v[46:47], v9 offset:53760
    v_mfma_f32_16x16x32_bf16 v[236:239], v[52:55], a[244:247], v[236:239]
    s_add_u32 s43, s74, 193536
    buffer_load_dwordx4 v3, s[16:19], s43 offen offset:3072 lds
    v_mfma_f32_16x16x32_bf16 v[236:239], v[48:51], a[240:243], v[236:239]
    s_waitcnt lgkmcnt(8)
    v_mfma_f32_16x16x32_bf16 v[240:243], v[56:59], a[48:51], v[240:243]
    ds_read_b64_tr_b16 v[48:49], v10 offset:49152
    v_mfma_f32_16x16x32_bf16 v[240:243], v[60:63], a[52:55], v[240:243]
    ds_read_b64_tr_b16 v[50:51], v10 offset:49664
    v_mfma_f32_16x16x32_bf16 v[244:247], v[60:63], a[116:119], v[244:247]
    v_mfma_f32_16x16x32_bf16 v[244:247], v[56:59], a[112:115], v[244:247]
    v_mfma_f32_16x16x32_bf16 v[248:251], v[56:59], a[176:179], v[248:251]
    ds_read_b64_tr_b16 v[52:53], v10 offset:53248
    v_mfma_f32_16x16x32_bf16 v[248:251], v[60:63], a[180:183], v[248:251]
    ds_read_b64_tr_b16 v[54:55], v10 offset:53760
    v_mfma_f32_16x16x32_bf16 v[252:255], v[60:63], a[244:247], v[252:255]
    v_mfma_f32_16x16x32_bf16 v[252:255], v[56:59], a[240:243], v[252:255]
    s_waitcnt lgkmcnt(8)
    v_mfma_f32_16x16x32_bf16 v[128:131], v[32:35], a[56:59], v[128:131]
    s_add_u32 m0, s44, 32768
    ds_read_b64_tr_b16 v[56:57], v11 offset:49152
    v_mfma_f32_16x16x32_bf16 v[128:131], v[36:39], a[60:63], v[128:131]
    s_add_u32 s43, s75, 0
    ds_read_b64_tr_b16 v[58:59], v11 offset:49664
    buffer_load_dwordx4 v2, s[16:19], s43 offen offset:0 lds
    v_mfma_f32_16x16x32_bf16 v[132:135], v[36:39], a[124:127], v[132:135]
    v_mfma_f32_16x16x32_bf16 v[132:135], v[32:35], a[120:123], v[132:135]
    v_mfma_f32_16x16x32_bf16 v[136:139], v[32:35], a[184:187], v[136:139]
    ds_read_b64_tr_b16 v[60:61], v11 offset:53248
    v_mfma_f32_16x16x32_bf16 v[136:139], v[36:39], a[188:191], v[136:139]
    ds_read_b64_tr_b16 v[62:63], v11 offset:53760
    v_mfma_f32_16x16x32_bf16 v[140:143], v[36:39], a[252:255], v[140:143]
    v_mfma_f32_16x16x32_bf16 v[140:143], v[32:35], a[248:251], v[140:143]
    s_waitcnt lgkmcnt(8)
    v_mfma_f32_16x16x32_bf16 v[144:147], v[40:43], a[56:59], v[144:147]
    s_add_u32 s43, s75, 64512
    ds_read_b64_tr_b16 v[32:33], v8 offset:57344
    buffer_load_dwordx4 v3, s[16:19], s43 offen offset:1024 lds
    v_mfma_f32_16x16x32_bf16 v[144:147], v[44:47], a[60:63], v[144:147]
    ds_read_b64_tr_b16 v[34:35], v8 offset:57856
    v_mfma_f32_16x16x32_bf16 v[148:151], v[44:47], a[124:127], v[148:151]
    v_mfma_f32_16x16x32_bf16 v[148:151], v[40:43], a[120:123], v[148:151]
    v_mfma_f32_16x16x32_bf16 v[152:155], v[40:43], a[184:187], v[152:155]
    ds_read_b64_tr_b16 v[36:37], v8 offset:61440
    v_mfma_f32_16x16x32_bf16 v[152:155], v[44:47], a[188:191], v[152:155]
    ds_read_b64_tr_b16 v[38:39], v8 offset:61952
    v_mfma_f32_16x16x32_bf16 v[156:159], v[44:47], a[252:255], v[156:159]
    v_mfma_f32_16x16x32_bf16 v[156:159], v[40:43], a[248:251], v[156:159]
    s_waitcnt lgkmcnt(8)
    v_mfma_f32_16x16x32_bf16 v[160:163], v[48:51], a[56:59], v[160:163]
    s_add_u32 s43, s75, 129024
    ds_read_b64_tr_b16 v[40:41], v9 offset:57344
    buffer_load_dwordx4 v2, s[16:19], s43 offen offset:2048 lds
    v_mfma_f32_16x16x32_bf16 v[160:163], v[52:55], a[60:63], v[160:163]
    ds_read_b64_tr_b16 v[42:43], v9 offset:57856
    v_mfma_f32_16x16x32_bf16 v[164:167], v[52:55], a[124:127], v[164:167]
    v_mfma_f32_16x16x32_bf16 v[164:167], v[48:51], a[120:123], v[164:167]
    v_mfma_f32_16x16x32_bf16 v[168:171], v[48:51], a[184:187], v[168:171]
    ds_read_b64_tr_b16 v[44:45], v9 offset:61440
    v_mfma_f32_16x16x32_bf16 v[168:171], v[52:55], a[188:191], v[168:171]
    ds_read_b64_tr_b16 v[46:47], v9 offset:61952
    v_mfma_f32_16x16x32_bf16 v[172:175], v[52:55], a[252:255], v[172:175]
    v_mfma_f32_16x16x32_bf16 v[172:175], v[48:51], a[248:251], v[172:175]
    s_waitcnt lgkmcnt(8)
    v_mfma_f32_16x16x32_bf16 v[176:179], v[56:59], a[56:59], v[176:179]
    s_add_u32 s43, s75, 193536
    ds_read_b64_tr_b16 v[48:49], v10 offset:57344
    buffer_load_dwordx4 v3, s[16:19], s43 offen offset:3072 lds
    v_mfma_f32_16x16x32_bf16 v[176:179], v[60:63], a[60:63], v[176:179]
    ds_read_b64_tr_b16 v[50:51], v10 offset:57856
    v_mfma_f32_16x16x32_bf16 v[180:183], v[60:63], a[124:127], v[180:183]
    v_mfma_f32_16x16x32_bf16 v[180:183], v[56:59], a[120:123], v[180:183]
    v_mfma_f32_16x16x32_bf16 v[184:187], v[56:59], a[184:187], v[184:187]
    ds_read_b64_tr_b16 v[52:53], v10 offset:61440
    v_mfma_f32_16x16x32_bf16 v[184:187], v[60:63], a[188:191], v[184:187]
    ds_read_b64_tr_b16 v[54:55], v10 offset:61952
    v_mfma_f32_16x16x32_bf16 v[188:191], v[60:63], a[252:255], v[188:191]
    v_mfma_f32_16x16x32_bf16 v[188:191], v[56:59], a[248:251], v[188:191]
    s_waitcnt lgkmcnt(8)
    v_mfma_f32_16x16x32_bf16 v[192:195], v[32:35], a[56:59], v[192:195]
    s_add_u32 m0, s44, 49152
    ds_read_b64_tr_b16 v[56:57], v11 offset:57344
    s_add_u32 s43, s76, 0
    buffer_load_dwordx4 v2, s[16:19], s43 offen offset:0 lds
    v_mfma_f32_16x16x32_bf16 v[192:195], v[36:39], a[60:63], v[192:195]
    ds_read_b64_tr_b16 v[58:59], v11 offset:57856
    v_mfma_f32_16x16x32_bf16 v[196:199], v[36:39], a[124:127], v[196:199]
    v_mfma_f32_16x16x32_bf16 v[196:199], v[32:35], a[120:123], v[196:199]
    v_mfma_f32_16x16x32_bf16 v[200:203], v[32:35], a[184:187], v[200:203]
    ds_read_b64_tr_b16 v[60:61], v11 offset:61440
    v_mfma_f32_16x16x32_bf16 v[200:203], v[36:39], a[188:191], v[200:203]
    ds_read_b64_tr_b16 v[62:63], v11 offset:61952
    v_mfma_f32_16x16x32_bf16 v[204:207], v[36:39], a[252:255], v[204:207]
    s_add_u32 s43, s76, 64512
    buffer_load_dwordx4 v3, s[16:19], s43 offen offset:1024 lds
    v_mfma_f32_16x16x32_bf16 v[204:207], v[32:35], a[248:251], v[204:207]
    s_waitcnt lgkmcnt(8)
    v_mfma_f32_16x16x32_bf16 v[208:211], v[40:43], a[56:59], v[208:211]
    s_waitcnt vmcnt(10)
    s_barrier
    ds_read_b64_tr_b16 v[32:33], v4 offset:0
    v_mfma_f32_16x16x32_bf16 v[208:211], v[44:47], a[60:63], v[208:211]
    ds_read_b64_tr_b16 v[34:35], v4 offset:512
    v_mfma_f32_16x16x32_bf16 v[212:215], v[44:47], a[124:127], v[212:215]
    s_lshr_b32 s3, s2, 4
    s_lshl_b32 s3, s3, 2
    s_add_u32 s3, s3, 128
    buffer_atomic_add v0, v30, s[36:39], s3 offen sc1
    v_mfma_f32_16x16x32_bf16 v[212:215], v[40:43], a[120:123], v[212:215]
    v_mfma_f32_16x16x32_bf16 v[216:219], v[40:43], a[184:187], v[216:219]
    ds_read_b64_tr_b16 v[36:37], v4 offset:4096
    v_mfma_f32_16x16x32_bf16 v[216:219], v[44:47], a[188:191], v[216:219]
    ds_read_b64_tr_b16 v[38:39], v4 offset:4608
    v_mfma_f32_16x16x32_bf16 v[220:223], v[44:47], a[252:255], v[220:223]
    s_add_u32 s43, s76, 129024
    buffer_load_dwordx4 v2, s[16:19], s43 offen offset:2048 lds
    v_mfma_f32_16x16x32_bf16 v[220:223], v[40:43], a[248:251], v[220:223]
    s_waitcnt lgkmcnt(8)
    v_mfma_f32_16x16x32_bf16 v[224:227], v[48:51], a[56:59], v[224:227]
    ds_read_b64_tr_b16 v[40:41], v5 offset:0
    v_mfma_f32_16x16x32_bf16 v[224:227], v[52:55], a[60:63], v[224:227]
    ds_read_b64_tr_b16 v[42:43], v5 offset:512
    v_mfma_f32_16x16x32_bf16 v[228:231], v[52:55], a[124:127], v[228:231]
    v_mfma_f32_16x16x32_bf16 v[228:231], v[48:51], a[120:123], v[228:231]
    v_mfma_f32_16x16x32_bf16 v[232:235], v[48:51], a[184:187], v[232:235]
    ds_read_b64_tr_b16 v[44:45], v5 offset:4096
    v_mfma_f32_16x16x32_bf16 v[232:235], v[52:55], a[188:191], v[232:235]
    ds_read_b64_tr_b16 v[46:47], v5 offset:4608
    v_mfma_f32_16x16x32_bf16 v[236:239], v[52:55], a[252:255], v[236:239]
    s_add_u32 s43, s76, 193536
    buffer_load_dwordx4 v3, s[16:19], s43 offen offset:3072 lds
    v_mfma_f32_16x16x32_bf16 v[236:239], v[48:51], a[248:251], v[236:239]
    s_waitcnt lgkmcnt(8)
    v_mfma_f32_16x16x32_bf16 v[240:243], v[56:59], a[56:59], v[240:243]
    ds_read_b64_tr_b16 v[48:49], v6 offset:0
    v_mfma_f32_16x16x32_bf16 v[240:243], v[60:63], a[60:63], v[240:243]
    ds_read_b64_tr_b16 v[50:51], v6 offset:512
    v_mfma_f32_16x16x32_bf16 v[244:247], v[60:63], a[124:127], v[244:247]
    v_mfma_f32_16x16x32_bf16 v[244:247], v[56:59], a[120:123], v[244:247]
    v_mfma_f32_16x16x32_bf16 v[248:251], v[56:59], a[184:187], v[248:251]
    ds_read_b64_tr_b16 v[52:53], v6 offset:4096
    v_mfma_f32_16x16x32_bf16 v[248:251], v[60:63], a[188:191], v[248:251]
    ds_read_b64_tr_b16 v[54:55], v6 offset:4608
    v_mfma_f32_16x16x32_bf16 v[252:255], v[60:63], a[252:255], v[252:255]
    v_mfma_f32_16x16x32_bf16 v[252:255], v[56:59], a[248:251], v[252:255]
    s_waitcnt lgkmcnt(8)
    v_mfma_f32_16x16x32_bf16 v[64:67], a[0:3], v[32:35], 0
    s_add_u32 m0, s44, 65536
    ds_read_b64_tr_b16 v[56:57], v7 offset:0
    v_mfma_f32_16x16x32_bf16 v[64:67], a[4:7], v[36:39], v[64:67]
    s_add_u32 s43, s73, 128
    ds_read_b64_tr_b16 v[58:59], v7 offset:512
    buffer_load_dwordx4 v2, s[16:19], s43 offen offset:0 lds
    v_mfma_f32_16x16x32_bf16 v[68:71], a[68:71], v[36:39], 0
    s_lshl_b32 s46, s41, 8
    v_mfma_f32_16x16x32_bf16 v[68:71], a[64:67], v[32:35], v[68:71]
    s_and_b32 s6, s2, 7
    v_mfma_f32_16x16x32_bf16 v[72:75], a[128:131], v[32:35], 0
    s_mul_i32 s6, s6, 7
    ds_read_b64_tr_b16 v[60:61], v7 offset:4096
    v_mfma_f32_16x16x32_bf16 v[72:75], a[132:135], v[36:39], v[72:75]
    s_bfe_u32 s4, s2, 0x20003
    ds_read_b64_tr_b16 v[62:63], v7 offset:4608
    v_mfma_f32_16x16x32_bf16 v[76:79], a[196:199], v[36:39], 0
    s_lshl_b32 s4, s4, 1
    v_mfma_f32_16x16x32_bf16 v[76:79], a[192:195], v[32:35], v[76:79]
    s_waitcnt lgkmcnt(8)
    v_mfma_f32_16x16x32_bf16 v[80:83], a[0:3], v[40:43], 0
    s_add_u32 s6, s6, s4
    ds_read_b64_tr_b16 v[32:33], v4 offset:8192
    v_mul_f32 v128, s48, v128
    v_mfma_f32_16x16x32_bf16 v[80:83], a[4:7], v[44:47], v[80:83]
    ds_read_b64_tr_b16 v[34:35], v4 offset:8704
    v_mul_f32 v129, s48, v129
    v_mfma_f32_16x16x32_bf16 v[84:87], a[68:71], v[44:47], 0
    v_mul_f32 v130, s48, v130
    v_mul_f32 v131, s48, v131
    v_mfma_f32_16x16x32_bf16 v[84:87], a[64:67], v[40:43], v[84:87]
    v_cvt_pk_bf16_f32 v128, v128, v129
    v_cvt_pk_bf16_f32 v129, v130, v131
    v_mfma_f32_16x16x32_bf16 v[88:91], a[128:131], v[40:43], 0
    ds_read_b64_tr_b16 v[36:37], v4 offset:12288
    v_mul_f32 v144, s48, v144
    v_mfma_f32_16x16x32_bf16 v[88:91], a[132:135], v[44:47], v[88:91]
    ds_read_b64_tr_b16 v[38:39], v4 offset:12800
    v_mul_f32 v145, s48, v145
    v_mfma_f32_16x16x32_bf16 v[92:95], a[196:199], v[44:47], 0
    v_mul_f32 v146, s48, v146
    v_mul_f32 v147, s48, v147
    v_mfma_f32_16x16x32_bf16 v[92:95], a[192:195], v[40:43], v[92:95]
    s_waitcnt lgkmcnt(8)
    v_cvt_pk_bf16_f32 v130, v144, v145
    v_cvt_pk_bf16_f32 v131, v146, v147
    v_mfma_f32_16x16x32_bf16 v[96:99], a[0:3], v[48:51], 0
    s_add_u32 s43, s73, 64640
    ds_read_b64_tr_b16 v[40:41], v5 offset:8192
    buffer_load_dwordx4 v3, s[16:19], s43 offen offset:1024 lds
    v_mfma_f32_16x16x32_bf16 v[96:99], a[4:7], v[52:55], v[96:99]
    ds_read_b64_tr_b16 v[42:43], v5 offset:8704
    v_mfma_f32_16x16x32_bf16 v[100:103], a[68:71], v[52:55], 0
    v_mfma_f32_16x16x32_bf16 v[100:103], a[64:67], v[48:51], v[100:103]
    v_mfma_f32_16x16x32_bf16 v[104:107], a[128:131], v[48:51], 0
    ds_read_b64_tr_b16 v[44:45], v5 offset:12288
    v_mfma_f32_16x16x32_bf16 v[104:107], a[132:135], v[52:55], v[104:107]
    ds_read_b64_tr_b16 v[46:47], v5 offset:12800
    v_mfma_f32_16x16x32_bf16 v[108:111], a[196:199], v[52:55], 0
    v_mfma_f32_16x16x32_bf16 v[108:111], a[192:195], v[48:51], v[108:111]
    s_waitcnt lgkmcnt(8)
    v_mfma_f32_16x16x32_bf16 v[112:115], a[0:3], v[56:59], 0
    ds_read_b64_tr_b16 v[48:49], v6 offset:8192
    v_mfma_f32_16x16x32_bf16 v[112:115], a[4:7], v[60:63], v[112:115]
    ds_read_b64_tr_b16 v[50:51], v6 offset:8704
    v_mfma_f32_16x16x32_bf16 v[116:119], a[68:71], v[60:63], 0
    v_mfma_f32_16x16x32_bf16 v[116:119], a[64:67], v[56:59], v[116:119]
    v_mfma_f32_16x16x32_bf16 v[120:123], a[128:131], v[56:59], 0
    ds_read_b64_tr_b16 v[52:53], v6 offset:12288
    v_mfma_f32_16x16x32_bf16 v[120:123], a[132:135], v[60:63], v[120:123]
    ds_read_b64_tr_b16 v[54:55], v6 offset:12800
    v_mfma_f32_16x16x32_bf16 v[124:127], a[196:199], v[60:63], 0
    v_mfma_f32_16x16x32_bf16 v[124:127], a[192:195], v[56:59], v[124:127]
    s_waitcnt lgkmcnt(8)
    v_mfma_f32_16x16x32_bf16 v[64:67], a[8:11], v[32:35], v[64:67]
    s_add_u32 s43, s73, 129152
    ds_read_b64_tr_b16 v[56:57], v7 offset:8192
    buffer_load_dwordx4 v2, s[16:19], s43 offen offset:2048 lds
    v_mfma_f32_16x16x32_bf16 v[64:67], a[12:15], v[36:39], v[64:67]
    ds_read_b64_tr_b16 v[58:59], v7 offset:8704
    v_mfma_f32_16x16x32_bf16 v[68:71], a[76:79], v[36:39], v[68:71]
    s_cmp_eq_u32 s4, 6
    s_cselect_b32 s4, -7, 1
    s_bitcmp1_b32 s2, 0
    s_cselect_b32 s4, s4, 0
    s_add_u32 s6, s6, s4
    v_mfma_f32_16x16x32_bf16 v[68:71], a[72:75], v[32:35], v[68:71]
    s_lshl_b32 s4, s6, 6
    v_mfma_f32_16x16x32_bf16 v[72:75], a[136:139], v[32:35], v[72:75]
    s_movk_i32 s5, 8192
    ds_read_b64_tr_b16 v[60:61], v7 offset:12288
    v_mfma_f32_16x16x32_bf16 v[72:75], a[140:143], v[36:39], v[72:75]
    s_mov_b32 s10, 0x400000
    ds_read_b64_tr_b16 v[62:63], v7 offset:12800
    s_cmp_lt_u32 s40, 2
    s_cselect_b32 s4, s4, s46
    s_cselect_b32 s5, 3584, s5
    s_cselect_b32 s8, s80, s78
    s_cselect_b32 s9, s81, s79
    s_cselect_b32 s10, 1835008, s10
    v_mfma_f32_16x16x32_bf16 v[76:79], a[204:207], v[36:39], v[76:79]
    s_mov_b32 s12, s78
    v_mfma_f32_16x16x32_bf16 v[76:79], a[200:203], v[32:35], v[76:79]
    s_waitcnt lgkmcnt(8)
    v_mfma_f32_16x16x32_bf16 v[80:83], a[8:11], v[40:43], v[80:83]
    s_waitcnt vmcnt(12)
    s_barrier
    ds_read_b64_tr_b16 v[32:33], v4 offset:16384
    v_mfma_f32_16x16x32_bf16 v[80:83], a[12:15], v[44:47], v[80:83]
    s_mov_b32 s13, s79
    ds_read_b64_tr_b16 v[34:35], v4 offset:16896
    v_mfma_f32_16x16x32_bf16 v[84:87], a[76:79], v[44:47], v[84:87]
    s_lshl_b32 s89, s5, 3
    buffer_store_dwordx4 v[128:131], v1, s[20:23], s49 offen offset:0 sc0 sc1
    v_mfma_f32_16x16x32_bf16 v[84:87], a[72:75], v[40:43], v[84:87]
    s_sub_u32 s89, s89, 1024
    v_mul_f32 v132, s48, v132
    v_mul_f32 v133, s48, v133
    v_mfma_f32_16x16x32_bf16 v[88:91], a[136:139], v[40:43], v[88:91]
    s_lshl_b32 s45, s41, 1
    ds_read_b64_tr_b16 v[36:37], v4 offset:20480
    v_mul_f32 v134, s48, v134
    v_mfma_f32_16x16x32_bf16 v[88:91], a[140:143], v[44:47], v[88:91]
    s_add_u32 s45, s45, s42
    ds_read_b64_tr_b16 v[38:39], v4 offset:20992
    v_mul_f32 v135, s48, v135
    v_mfma_f32_16x16x32_bf16 v[92:95], a[204:207], v[44:47], v[92:95]
    s_add_u32 s43, s73, 193664
    buffer_load_dwordx4 v3, s[16:19], s43 offen offset:3072 lds
    v_mfma_f32_16x16x32_bf16 v[92:95], a[200:203], v[40:43], v[92:95]
    s_waitcnt lgkmcnt(8)
    v_cvt_pk_bf16_f32 v132, v132, v133
    v_cvt_pk_bf16_f32 v133, v134, v135
    v_mfma_f32_16x16x32_bf16 v[96:99], a[8:11], v[48:51], v[96:99]
    s_and_b32 s3, s2, 1
    ds_read_b64_tr_b16 v[40:41], v5 offset:16384
    v_mul_f32 v148, s48, v148
    v_mfma_f32_16x16x32_bf16 v[96:99], a[12:15], v[52:55], v[96:99]
    s_add_u32 s45, s45, s3
    ds_read_b64_tr_b16 v[42:43], v5 offset:16896
    v_mul_f32 v149, s48, v149
    v_mfma_f32_16x16x32_bf16 v[100:103], a[76:79], v[52:55], v[100:103]
    s_add_u32 s3, s45, 0
    v_mul_f32 v150, s48, v150
    v_mul_f32 v151, s48, v151
    v_mfma_f32_16x16x32_bf16 v[100:103], a[72:75], v[48:51], v[100:103]
    s_and_b32 s3, s3, 7
    v_cvt_pk_bf16_f32 v134, v148, v149
    v_cvt_pk_bf16_f32 v135, v150, v151
    v_mfma_f32_16x16x32_bf16 v[104:107], a[136:139], v[48:51], v[104:107]
    s_lshl_b32 s65, s3, 11
    ds_read_b64_tr_b16 v[44:45], v5 offset:20480
    v_mfma_f32_16x16x32_bf16 v[104:107], a[140:143], v[52:55], v[104:107]
    s_lshl_b32 s3, s3, 6
    ds_read_b64_tr_b16 v[46:47], v5 offset:20992
    buffer_store_dwordx4 v[132:135], v1, s[20:23], s50 offen offset:0 sc0 sc1
    v_mfma_f32_16x16x32_bf16 v[108:111], a[204:207], v[52:55], v[108:111]
    s_mul_i32 s3, s3, s5
    v_mul_f32 v136, s48, v136
    v_mul_f32 v137, s48, v137
    v_mfma_f32_16x16x32_bf16 v[108:111], a[200:203], v[48:51], v[108:111]
    s_waitcnt lgkmcnt(8)
    v_mul_f32 v138, s48, v138
    v_mul_f32 v139, s48, v139
    v_mfma_f32_16x16x32_bf16 v[112:115], a[8:11], v[56:59], v[112:115]
    s_add_u32 s57, s3, s4
    ds_read_b64_tr_b16 v[48:49], v6 offset:16384
    v_cvt_pk_bf16_f32 v136, v136, v137
    v_mfma_f32_16x16x32_bf16 v[112:115], a[12:15], v[60:63], v[112:115]
    s_add_u32 s3, s45, 1
    ds_read_b64_tr_b16 v[50:51], v6 offset:16896
    v_cvt_pk_bf16_f32 v137, v138, v139
    v_mfma_f32_16x16x32_bf16 v[116:119], a[76:79], v[60:63], v[116:119]
    s_and_b32 s3, s3, 7
    v_mul_f32 v152, s48, v152
    v_mul_f32 v153, s48, v153
    v_mfma_f32_16x16x32_bf16 v[116:119], a[72:75], v[56:59], v[116:119]
    s_lshl_b32 s66, s3, 11
    v_mul_f32 v154, s48, v154
    v_mul_f32 v155, s48, v155
    v_mfma_f32_16x16x32_bf16 v[120:123], a[136:139], v[56:59], v[120:123]
    s_lshl_b32 s3, s3, 6
    ds_read_b64_tr_b16 v[52:53], v6 offset:20480
    v_cvt_pk_bf16_f32 v138, v152, v153
    v_mfma_f32_16x16x32_bf16 v[120:123], a[140:143], v[60:63], v[120:123]
    s_mul_i32 s3, s3, s5
    ds_read_b64_tr_b16 v[54:55], v6 offset:20992
    v_cvt_pk_bf16_f32 v139, v154, v155
    v_mfma_f32_16x16x32_bf16 v[124:127], a[204:207], v[60:63], v[124:127]
    s_add_u32 s58, s3, s4
    v_mfma_f32_16x16x32_bf16 v[124:127], a[200:203], v[56:59], v[124:127]
    s_waitcnt lgkmcnt(8)
    buffer_store_dwordx4 v[136:139], v1, s[20:23], s51 offen offset:0 sc0 sc1
    s_add_u32 s3, s45, 2
    s_and_b32 s3, s3, 7
    s_lshl_b32 s67, s3, 11
    s_lshl_b32 s3, s3, 6
    s_mul_i32 s3, s3, s5
    s_add_u32 s59, s3, s4
    s_add_u32 s3, s45, 3
    s_and_b32 s3, s3, 7
    s_lshl_b32 s68, s3, 11
    v_mfma_f32_16x16x32_bf16 v[64:67], a[16:19], v[32:35], v[64:67]
    s_add_u32 m0, s44, 81920
    ds_read_b64_tr_b16 v[56:57], v7 offset:16384
    v_mul_f32 v140, s48, v140
    v_mfma_f32_16x16x32_bf16 v[64:67], a[20:23], v[36:39], v[64:67]
    s_add_u32 s43, s74, 128
    ds_read_b64_tr_b16 v[58:59], v7 offset:16896
    buffer_load_dwordx4 v2, s[16:19], s43 offen offset:0 lds
    v_mfma_f32_16x16x32_bf16 v[68:71], a[84:87], v[36:39], v[68:71]
    s_lshl_b32 s3, s3, 6
    v_mul_f32 v141, s48, v141
    v_mul_f32 v142, s48, v142
    v_mfma_f32_16x16x32_bf16 v[68:71], a[80:83], v[32:35], v[68:71]
    s_mul_i32 s3, s3, s5
    v_mul_f32 v143, s48, v143
    v_cvt_pk_bf16_f32 v140, v140, v141
    v_mfma_f32_16x16x32_bf16 v[72:75], a[144:147], v[32:35], v[72:75]
    s_add_u32 s60, s3, s4
    ds_read_b64_tr_b16 v[60:61], v7 offset:20480
    v_cvt_pk_bf16_f32 v141, v142, v143
    v_mfma_f32_16x16x32_bf16 v[72:75], a[148:151], v[36:39], v[72:75]
    s_add_u32 s3, s45, 4
    ds_read_b64_tr_b16 v[62:63], v7 offset:20992
    v_mul_f32 v156, s48, v156
    v_mfma_f32_16x16x32_bf16 v[76:79], a[212:215], v[36:39], v[76:79]
    s_and_b32 s3, s3, 7
    v_mul_f32 v157, s48, v157
    v_mul_f32 v158, s48, v158
    v_mfma_f32_16x16x32_bf16 v[76:79], a[208:211], v[32:35], v[76:79]
    s_waitcnt lgkmcnt(8)
    v_mul_f32 v159, s48, v159
    v_cvt_pk_bf16_f32 v142, v156, v157
    v_mfma_f32_16x16x32_bf16 v[80:83], a[16:19], v[40:43], v[80:83]
    s_lshl_b32 s69, s3, 11
    ds_read_b64_tr_b16 v[32:33], v4 offset:24576
    v_cvt_pk_bf16_f32 v143, v158, v159
    v_mfma_f32_16x16x32_bf16 v[80:83], a[20:23], v[44:47], v[80:83]
    s_lshl_b32 s3, s3, 6
    ds_read_b64_tr_b16 v[34:35], v4 offset:25088
    v_mfma_f32_16x16x32_bf16 v[84:87], a[84:87], v[44:47], v[84:87]
    s_mul_i32 s3, s3, s5
    v_mfma_f32_16x16x32_bf16 v[84:87], a[80:83], v[40:43], v[84:87]
    s_add_u32 s61, s3, s4
    v_mfma_f32_16x16x32_bf16 v[88:91], a[144:147], v[40:43], v[88:91]
    s_add_u32 s3, s45, 5
    ds_read_b64_tr_b16 v[36:37], v4 offset:28672
    v_mfma_f32_16x16x32_bf16 v[88:91], a[148:151], v[44:47], v[88:91]
    s_and_b32 s3, s3, 7
    ds_read_b64_tr_b16 v[38:39], v4 offset:29184
    v_mfma_f32_16x16x32_bf16 v[92:95], a[212:215], v[44:47], v[92:95]
    s_lshl_b32 s70, s3, 11
    v_mfma_f32_16x16x32_bf16 v[92:95], a[208:211], v[40:43], v[92:95]
    s_waitcnt lgkmcnt(8)
    v_mfma_f32_16x16x32_bf16 v[96:99], a[16:19], v[48:51], v[96:99]
    s_add_u32 s43, s74, 64640
    ds_read_b64_tr_b16 v[40:41], v5 offset:24576
    buffer_load_dwordx4 v3, s[16:19], s43 offen offset:1024 lds
    v_mfma_f32_16x16x32_bf16 v[96:99], a[20:23], v[52:55], v[96:99]
    s_lshl_b32 s3, s3, 6
    ds_read_b64_tr_b16 v[42:43], v5 offset:25088
    v_mfma_f32_16x16x32_bf16 v[100:103], a[84:87], v[52:55], v[100:103]
    s_mul_i32 s3, s3, s5
    v_mfma_f32_16x16x32_bf16 v[100:103], a[80:83], v[48:51], v[100:103]
    s_add_u32 s62, s3, s4
    v_mfma_f32_16x16x32_bf16 v[104:107], a[144:147], v[48:51], v[104:107]
    s_add_u32 s3, s45, 6
    ds_read_b64_tr_b16 v[44:45], v5 offset:28672
    v_mfma_f32_16x16x32_bf16 v[104:107], a[148:151], v[52:55], v[104:107]
    s_and_b32 s3, s3, 7
    ds_read_b64_tr_b16 v[46:47], v5 offset:29184
    v_mfma_f32_16x16x32_bf16 v[108:111], a[212:215], v[52:55], v[108:111]
    s_lshl_b32 s71, s3, 11
    v_mfma_f32_16x16x32_bf16 v[108:111], a[208:211], v[48:51], v[108:111]
    s_waitcnt lgkmcnt(8)
    v_mfma_f32_16x16x32_bf16 v[112:115], a[16:19], v[56:59], v[112:115]
    s_lshl_b32 s3, s3, 6
    ds_read_b64_tr_b16 v[48:49], v6 offset:24576
    v_mfma_f32_16x16x32_bf16 v[112:115], a[20:23], v[60:63], v[112:115]
    s_mul_i32 s3, s3, s5
    ds_read_b64_tr_b16 v[50:51], v6 offset:25088
    v_mfma_f32_16x16x32_bf16 v[116:119], a[84:87], v[60:63], v[116:119]
    s_add_u32 s63, s3, s4
    v_mfma_f32_16x16x32_bf16 v[116:119], a[80:83], v[56:59], v[116:119]
    s_add_u32 s3, s45, 7
    v_mfma_f32_16x16x32_bf16 v[120:123], a[144:147], v[56:59], v[120:123]
    s_and_b32 s3, s3, 7
    ds_read_b64_tr_b16 v[52:53], v6 offset:28672
    v_mfma_f32_16x16x32_bf16 v[120:123], a[148:151], v[60:63], v[120:123]
    s_lshl_b32 s72, s3, 11
    ds_read_b64_tr_b16 v[54:55], v6 offset:29184
    buffer_store_dwordx4 v[140:143], v1, s[20:23], s52 offen offset:0 sc0 sc1
    v_mfma_f32_16x16x32_bf16 v[124:127], a[212:215], v[60:63], v[124:127]
    s_lshl_b32 s3, s3, 6
    v_mul_f32 v160, s48, v160
    v_mul_f32 v161, s48, v161
    v_mfma_f32_16x16x32_bf16 v[124:127], a[208:211], v[56:59], v[124:127]
    s_waitcnt lgkmcnt(8)
    v_mul_f32 v162, s48, v162
    v_mul_f32 v163, s48, v163
    v_mfma_f32_16x16x32_bf16 v[64:67], a[24:27], v[32:35], v[64:67]
    s_add_u32 s43, s74, 129152
    ds_read_b64_tr_b16 v[56:57], v7 offset:24576
    buffer_load_dwordx4 v2, s[16:19], s43 offen offset:2048 lds
    v_mfma_f32_16x16x32_bf16 v[64:67], a[28:31], v[36:39], v[64:67]
    s_mul_i32 s3, s3, s5
    ds_read_b64_tr_b16 v[58:59], v7 offset:25088
    v_cvt_pk_bf16_f32 v160, v160, v161
    v_mfma_f32_16x16x32_bf16 v[68:71], a[92:95], v[36:39], v[68:71]
    s_add_u32 s64, s3, s4
    v_lshrrev_b32 v12, 7, v1
    s_and_b32 s4, s40, 1
    v_mfma_f32_16x16x32_bf16 v[68:71], a[88:91], v[32:35], v[68:71]
    s_lshl_b32 s4, s4, 5
    v_add_u32 v12, s4, v12
    v_mfma_f32_16x16x32_bf16 v[72:75], a[152:155], v[32:35], v[72:75]
    ds_read_b64_tr_b16 v[60:61], v7 offset:28672
    s_add_u32 s3, s89, 1024
    v_mfma_f32_16x16x32_bf16 v[72:75], a[156:159], v[36:39], v[72:75]
    ds_read_b64_tr_b16 v[62:63], v7 offset:29184
    s_lshr_b32 s3, s3, 3
    v_mfma_f32_16x16x32_bf16 v[76:79], a[220:223], v[36:39], v[76:79]
    v_mul_lo_u32 v12, v12, s3
    v_and_b32 v13, 0x70, v2
    v_mfma_f32_16x16x32_bf16 v[76:79], a[216:219], v[32:35], v[76:79]
    s_waitcnt lgkmcnt(8)
    v_add_u32 v28, v12, v13
    v_xor_b32 v29, 64, v28
    v_mfma_f32_16x16x32_bf16 v[80:83], a[24:27], v[40:43], v[80:83]
    s_waitcnt vmcnt(16)
    s_barrier
    ds_read_b64_tr_b16 v[32:33], v4 offset:32768
    v_mfma_f32_16x16x32_bf16 v[80:83], a[28:31], v[44:47], v[80:83]
    ds_read_b64_tr_b16 v[34:35], v4 offset:33280
    v_lshrrev_b32 v13, 8, v1
    v_mfma_f32_16x16x32_bf16 v[84:87], a[92:95], v[44:47], v[84:87]
    v_lshlrev_b32 v13, 3, v13
    s_lshl_b32 s4, s6, 6
    v_mfma_f32_16x16x32_bf16 v[84:87], a[88:91], v[40:43], v[84:87]
    v_add_u32 v13, s4, v13
    v_bfe_u32 v14, v1, 2, 6
    v_mfma_f32_16x16x32_bf16 v[88:91], a[152:155], v[40:43], v[88:91]
    ds_read_b64_tr_b16 v[36:37], v4 offset:36864
    v_and_b32 v14, 0x3c, v14
    v_mfma_f32_16x16x32_bf16 v[88:91], a[156:159], v[44:47], v[88:91]
    ds_read_b64_tr_b16 v[38:39], v4 offset:37376
    v_cvt_pk_bf16_f32 v161, v162, v163
    v_mfma_f32_16x16x32_bf16 v[92:95], a[220:223], v[44:47], v[92:95]
    s_add_u32 s43, s74, 193664
    buffer_load_dwordx4 v3, s[16:19], s43 offen offset:3072 lds
    v_mfma_f32_16x16x32_bf16 v[92:95], a[216:219], v[40:43], v[92:95]
    s_waitcnt lgkmcnt(8)
    v_mul_f32 v176, s48, v176
    v_mul_f32 v177, s48, v177
    v_mfma_f32_16x16x32_bf16 v[96:99], a[24:27], v[48:51], v[96:99]
    ds_read_b64_tr_b16 v[40:41], v5 offset:32768
    v_mul_f32 v178, s48, v178
    v_mfma_f32_16x16x32_bf16 v[96:99], a[28:31], v[52:55], v[96:99]
    ds_read_b64_tr_b16 v[42:43], v5 offset:33280
    v_mul_f32 v179, s48, v179
    v_mfma_f32_16x16x32_bf16 v[100:103], a[92:95], v[52:55], v[100:103]
    v_cvt_pk_bf16_f32 v162, v176, v177
    v_cvt_pk_bf16_f32 v163, v178, v179
    v_mfma_f32_16x16x32_bf16 v[100:103], a[88:91], v[48:51], v[100:103]
    v_mfma_f32_16x16x32_bf16 v[104:107], a[152:155], v[48:51], v[104:107]
    ds_read_b64_tr_b16 v[44:45], v5 offset:36864
    v_mfma_f32_16x16x32_bf16 v[104:107], a[156:159], v[52:55], v[104:107]
    ds_read_b64_tr_b16 v[46:47], v5 offset:37376
    buffer_store_dwordx4 v[160:163], v1, s[20:23], s49 offen offset:1024 sc0 sc1
    v_mfma_f32_16x16x32_bf16 v[108:111], a[220:223], v[52:55], v[108:111]
    v_mul_f32 v164, s48, v164
    v_mul_f32 v165, s48, v165
    v_mfma_f32_16x16x32_bf16 v[108:111], a[216:219], v[48:51], v[108:111]
    s_waitcnt lgkmcnt(8)
    v_mul_f32 v166, s48, v166
    v_mul_f32 v167, s48, v167
    v_mfma_f32_16x16x32_bf16 v[112:115], a[24:27], v[56:59], v[112:115]
    ds_read_b64_tr_b16 v[48:49], v6 offset:32768
    v_cvt_pk_bf16_f32 v164, v164, v165
    v_mfma_f32_16x16x32_bf16 v[112:115], a[28:31], v[60:63], v[112:115]
    ds_read_b64_tr_b16 v[50:51], v6 offset:33280
    v_cvt_pk_bf16_f32 v165, v166, v167
    v_mfma_f32_16x16x32_bf16 v[116:119], a[92:95], v[60:63], v[116:119]
    v_mul_f32 v180, s48, v180
    v_mul_f32 v181, s48, v181
    v_mfma_f32_16x16x32_bf16 v[116:119], a[88:91], v[56:59], v[116:119]
    v_mul_f32 v182, s48, v182
    v_mul_f32 v183, s48, v183
    v_mfma_f32_16x16x32_bf16 v[120:123], a[152:155], v[56:59], v[120:123]
    ds_read_b64_tr_b16 v[52:53], v6 offset:36864
    v_cvt_pk_bf16_f32 v166, v180, v181
    v_mfma_f32_16x16x32_bf16 v[120:123], a[156:159], v[60:63], v[120:123]
    ds_read_b64_tr_b16 v[54:55], v6 offset:37376
    v_cvt_pk_bf16_f32 v167, v182, v183
    v_mfma_f32_16x16x32_bf16 v[124:127], a[220:223], v[60:63], v[124:127]
    v_mfma_f32_16x16x32_bf16 v[124:127], a[216:219], v[56:59], v[124:127]
    s_waitcnt lgkmcnt(8)
    buffer_store_dwordx4 v[164:167], v1, s[20:23], s50 offen offset:1024 sc0 sc1
    v_mfma_f32_16x16x32_bf16 v[64:67], a[32:35], v[32:35], v[64:67]
    s_add_u32 m0, s44, 98304
    ds_read_b64_tr_b16 v[56:57], v7 offset:32768
    v_mul_f32 v168, s48, v168
    v_mfma_f32_16x16x32_bf16 v[64:67], a[36:39], v[36:39], v[64:67]
    s_add_u32 s43, s75, 128
    ds_read_b64_tr_b16 v[58:59], v7 offset:33280
    buffer_load_dwordx4 v2, s[16:19], s43 offen offset:0 lds
    v_mfma_f32_16x16x32_bf16 v[68:71], a[100:103], v[36:39], v[68:71]
    v_mul_f32 v169, s48, v169
    v_mul_f32 v170, s48, v170
    v_mfma_f32_16x16x32_bf16 v[68:71], a[96:99], v[32:35], v[68:71]
    v_mul_f32 v171, s48, v171
    v_cvt_pk_bf16_f32 v168, v168, v169
    v_mfma_f32_16x16x32_bf16 v[72:75], a[160:163], v[32:35], v[72:75]
    ds_read_b64_tr_b16 v[60:61], v7 offset:36864
    v_cvt_pk_bf16_f32 v169, v170, v171
    v_mfma_f32_16x16x32_bf16 v[72:75], a[164:167], v[36:39], v[72:75]
    ds_read_b64_tr_b16 v[62:63], v7 offset:37376
    v_mul_f32 v184, s48, v184
    v_mfma_f32_16x16x32_bf16 v[76:79], a[228:231], v[36:39], v[76:79]
    v_mul_f32 v185, s48, v185
    v_mul_f32 v186, s48, v186
    v_mfma_f32_16x16x32_bf16 v[76:79], a[224:227], v[32:35], v[76:79]
    s_waitcnt lgkmcnt(8)
    v_mul_f32 v187, s48, v187
    v_cvt_pk_bf16_f32 v170, v184, v185
    v_mfma_f32_16x16x32_bf16 v[80:83], a[32:35], v[40:43], v[80:83]
    s_add_u32 s43, s75, 64640
    ds_read_b64_tr_b16 v[32:33], v4 offset:40960
    buffer_load_dwordx4 v3, s[16:19], s43 offen offset:1024 lds
    v_mfma_f32_16x16x32_bf16 v[80:83], a[36:39], v[44:47], v[80:83]
    ds_read_b64_tr_b16 v[34:35], v4 offset:41472
    v_cvt_pk_bf16_f32 v171, v186, v187
    v_mfma_f32_16x16x32_bf16 v[84:87], a[100:103], v[44:47], v[84:87]
    v_mfma_f32_16x16x32_bf16 v[84:87], a[96:99], v[40:43], v[84:87]
    v_mfma_f32_16x16x32_bf16 v[88:91], a[160:163], v[40:43], v[88:91]
    ds_read_b64_tr_b16 v[36:37], v4 offset:45056
    v_mfma_f32_16x16x32_bf16 v[88:91], a[164:167], v[44:47], v[88:91]
    ds_read_b64_tr_b16 v[38:39], v4 offset:45568
    v_mfma_f32_16x16x32_bf16 v[92:95], a[228:231], v[44:47], v[92:95]
    v_mfma_f32_16x16x32_bf16 v[92:95], a[224:227], v[40:43], v[92:95]
    s_waitcnt lgkmcnt(8)
    v_mfma_f32_16x16x32_bf16 v[96:99], a[32:35], v[48:51], v[96:99]
    s_add_u32 s43, s75, 129152
    ds_read_b64_tr_b16 v[40:41], v5 offset:40960
    buffer_load_dwordx4 v2, s[16:19], s43 offen offset:2048 lds
    v_mfma_f32_16x16x32_bf16 v[96:99], a[36:39], v[52:55], v[96:99]
    ds_read_b64_tr_b16 v[42:43], v5 offset:41472
    v_mfma_f32_16x16x32_bf16 v[100:103], a[100:103], v[52:55], v[100:103]
    v_mfma_f32_16x16x32_bf16 v[100:103], a[96:99], v[48:51], v[100:103]
    v_mfma_f32_16x16x32_bf16 v[104:107], a[160:163], v[48:51], v[104:107]
    ds_read_b64_tr_b16 v[44:45], v5 offset:45056
    v_mfma_f32_16x16x32_bf16 v[104:107], a[164:167], v[52:55], v[104:107]
    ds_read_b64_tr_b16 v[46:47], v5 offset:45568
    v_mfma_f32_16x16x32_bf16 v[108:111], a[228:231], v[52:55], v[108:111]
    v_mfma_f32_16x16x32_bf16 v[108:111], a[224:227], v[48:51], v[108:111]
    s_waitcnt lgkmcnt(8)
    v_mfma_f32_16x16x32_bf16 v[112:115], a[32:35], v[56:59], v[112:115]
    s_add_u32 s43, s75, 193664
    ds_read_b64_tr_b16 v[48:49], v6 offset:40960
    buffer_load_dwordx4 v3, s[16:19], s43 offen offset:3072 lds
    v_mfma_f32_16x16x32_bf16 v[112:115], a[36:39], v[60:63], v[112:115]
    ds_read_b64_tr_b16 v[50:51], v6 offset:41472
    v_mfma_f32_16x16x32_bf16 v[116:119], a[100:103], v[60:63], v[116:119]
    v_mfma_f32_16x16x32_bf16 v[116:119], a[96:99], v[56:59], v[116:119]
    v_mfma_f32_16x16x32_bf16 v[120:123], a[160:163], v[56:59], v[120:123]
    ds_read_b64_tr_b16 v[52:53], v6 offset:45056
    v_mfma_f32_16x16x32_bf16 v[120:123], a[164:167], v[60:63], v[120:123]
    ds_read_b64_tr_b16 v[54:55], v6 offset:45568
    v_mfma_f32_16x16x32_bf16 v[124:127], a[228:231], v[60:63], v[124:127]
    v_mfma_f32_16x16x32_bf16 v[124:127], a[224:227], v[56:59], v[124:127]
    s_waitcnt lgkmcnt(8)
    v_mfma_f32_16x16x32_bf16 v[64:67], a[40:43], v[32:35], v[64:67]
    s_add_u32 m0, s44, 0
    ds_read_b64_tr_b16 v[56:57], v7 offset:40960
    s_mov_b32 s43, s57
    buffer_load_dwordx4 v28, s[8:11], s43 offen offset:0 lds
    v_mfma_f32_16x16x32_bf16 v[64:67], a[44:47], v[36:39], v[64:67]
    ds_read_b64_tr_b16 v[58:59], v7 offset:41472
    v_mfma_f32_16x16x32_bf16 v[68:71], a[108:111], v[36:39], v[68:71]
    v_mfma_f32_16x16x32_bf16 v[68:71], a[104:107], v[32:35], v[68:71]
    v_mfma_f32_16x16x32_bf16 v[72:75], a[168:171], v[32:35], v[72:75]
    ds_read_b64_tr_b16 v[60:61], v7 offset:45056
    v_mfma_f32_16x16x32_bf16 v[72:75], a[172:175], v[36:39], v[72:75]
    ds_read_b64_tr_b16 v[62:63], v7 offset:45568
    v_mfma_f32_16x16x32_bf16 v[76:79], a[236:239], v[36:39], v[76:79]
    s_add_u32 s43, s43, s89
    buffer_load_dwordx4 v29, s[8:11], s43 offen offset:1024 lds
    v_mfma_f32_16x16x32_bf16 v[76:79], a[232:235], v[32:35], v[76:79]
    s_waitcnt lgkmcnt(8)
    v_mfma_f32_16x16x32_bf16 v[80:83], a[40:43], v[40:43], v[80:83]
    s_waitcnt vmcnt(20)
    s_barrier
    ds_read_b64_tr_b16 v[32:33], v4 offset:49152
    v_mfma_f32_16x16x32_bf16 v[80:83], a[44:47], v[44:47], v[80:83]
    ds_read_b64_tr_b16 v[34:35], v4 offset:49664
    buffer_store_dwordx4 v[168:171], v1, s[20:23], s51 offen offset:1024 sc0 sc1
    v_mfma_f32_16x16x32_bf16 v[84:87], a[108:111], v[44:47], v[84:87]
    v_mul_f32 v172, s48, v172
    v_mul_f32 v173, s48, v173
    v_mfma_f32_16x16x32_bf16 v[84:87], a[104:107], v[40:43], v[84:87]
    v_mul_f32 v174, s48, v174
    v_mul_f32 v175, s48, v175
    v_mfma_f32_16x16x32_bf16 v[88:91], a[168:171], v[40:43], v[88:91]
    ds_read_b64_tr_b16 v[36:37], v4 offset:53248
    v_cvt_pk_bf16_f32 v172, v172, v173
    v_mfma_f32_16x16x32_bf16 v[88:91], a[172:175], v[44:47], v[88:91]
    ds_read_b64_tr_b16 v[38:39], v4 offset:53760
    v_cvt_pk_bf16_f32 v173, v174, v175
    v_mfma_f32_16x16x32_bf16 v[92:95], a[236:239], v[44:47], v[92:95]
    s_add_u32 s43, s43, s89
    buffer_load_dwordx4 v28, s[8:11], s43 offen offset:2048 lds
    v_mfma_f32_16x16x32_bf16 v[92:95], a[232:235], v[40:43], v[92:95]
    s_waitcnt lgkmcnt(8)
    v_mul_f32 v188, s48, v188
    v_mul_f32 v189, s48, v189
    v_mfma_f32_16x16x32_bf16 v[96:99], a[40:43], v[48:51], v[96:99]
    ds_read_b64_tr_b16 v[40:41], v5 offset:49152
    v_mul_f32 v190, s48, v190
    v_mfma_f32_16x16x32_bf16 v[96:99], a[44:47], v[52:55], v[96:99]
    ds_read_b64_tr_b16 v[42:43], v5 offset:49664
    v_mul_f32 v191, s48, v191
    v_mfma_f32_16x16x32_bf16 v[100:103], a[108:111], v[52:55], v[100:103]
    v_cvt_pk_bf16_f32 v174, v188, v189
    v_cvt_pk_bf16_f32 v175, v190, v191
    v_mfma_f32_16x16x32_bf16 v[100:103], a[104:107], v[48:51], v[100:103]
    v_mfma_f32_16x16x32_bf16 v[104:107], a[168:171], v[48:51], v[104:107]
    ds_read_b64_tr_b16 v[44:45], v5 offset:53248
    buffer_store_dwordx4 v[172:175], v1, s[20:23], s52 offen offset:1024 sc0 sc1
    v_mfma_f32_16x16x32_bf16 v[104:107], a[172:175], v[52:55], v[104:107]
    ds_read_b64_tr_b16 v[46:47], v5 offset:53760
    v_mul_f32 v192, s48, v192
    v_mfma_f32_16x16x32_bf16 v[108:111], a[236:239], v[52:55], v[108:111]
    s_add_u32 s43, s43, s89
    buffer_load_dwordx4 v29, s[8:11], s43 offen offset:3072 lds
    v_mfma_f32_16x16x32_bf16 v[108:111], a[232:235], v[48:51], v[108:111]
    s_waitcnt lgkmcnt(8)
    v_mul_f32 v193, s48, v193
    v_mul_f32 v194, s48, v194
    v_mfma_f32_16x16x32_bf16 v[112:115], a[40:43], v[56:59], v[112:115]
    ds_read_b64_tr_b16 v[48:49], v6 offset:49152
    v_mul_f32 v195, s48, v195
    v_mfma_f32_16x16x32_bf16 v[112:115], a[44:47], v[60:63], v[112:115]
    ds_read_b64_tr_b16 v[50:51], v6 offset:49664
    v_cvt_pk_bf16_f32 v192, v192, v193
    v_mfma_f32_16x16x32_bf16 v[116:119], a[108:111], v[60:63], v[116:119]
    v_cvt_pk_bf16_f32 v193, v194, v195
    v_mul_f32 v208, s48, v208
    v_mfma_f32_16x16x32_bf16 v[116:119], a[104:107], v[56:59], v[116:119]
    v_mul_f32 v209, s48, v209
    v_mul_f32 v210, s48, v210
    v_mfma_f32_16x16x32_bf16 v[120:123], a[168:171], v[56:59], v[120:123]
    ds_read_b64_tr_b16 v[52:53], v6 offset:53248
    v_mul_f32 v211, s48, v211
    v_mfma_f32_16x16x32_bf16 v[120:123], a[172:175], v[60:63], v[120:123]
    ds_read_b64_tr_b16 v[54:55], v6 offset:53760
    v_cvt_pk_bf16_f32 v194, v208, v209
    v_mfma_f32_16x16x32_bf16 v[124:127], a[236:239], v[60:63], v[124:127]
    v_cvt_pk_bf16_f32 v195, v210, v211
    v_mfma_f32_16x16x32_bf16 v[124:127], a[232:235], v[56:59], v[124:127]
    s_waitcnt lgkmcnt(8)
    buffer_store_dwordx4 v[192:195], v1, s[20:23], s49 offen offset:2048 sc0 sc1
    v_mfma_f32_16x16x32_bf16 v[64:67], a[48:51], v[32:35], v[64:67]
    s_add_u32 m0, s44, 114688
    ds_read_b64_tr_b16 v[56:57], v7 offset:49152
    v_mul_f32 v196, s48, v196
    v_mfma_f32_16x16x32_bf16 v[64:67], a[52:55], v[36:39], v[64:67]
    s_add_u32 s43, s76, 128
    ds_read_b64_tr_b16 v[58:59], v7 offset:49664
    buffer_load_dwordx4 v2, s[16:19], s43 offen offset:0 lds
    v_mfma_f32_16x16x32_bf16 v[68:71], a[116:119], v[36:39], v[68:71]
    v_mul_f32 v197, s48, v197
    v_mul_f32 v198, s48, v198
    v_mfma_f32_16x16x32_bf16 v[68:71], a[112:115], v[32:35], v[68:71]
    v_mul_f32 v199, s48, v199
    v_cvt_pk_bf16_f32 v196, v196, v197
    v_mfma_f32_16x16x32_bf16 v[72:75], a[176:179], v[32:35], v[72:75]
    ds_read_b64_tr_b16 v[60:61], v7 offset:53248
    v_cvt_pk_bf16_f32 v197, v198, v199
    v_mfma_f32_16x16x32_bf16 v[72:75], a[180:183], v[36:39], v[72:75]
    ds_read_b64_tr_b16 v[62:63], v7 offset:53760
    v_mul_f32 v212, s48, v212
    v_mfma_f32_16x16x32_bf16 v[76:79], a[244:247], v[36:39], v[76:79]
    v_mul_f32 v213, s48, v213
    v_mul_f32 v214, s48, v214
    v_mfma_f32_16x16x32_bf16 v[76:79], a[240:243], v[32:35], v[76:79]
    s_waitcnt lgkmcnt(8)
    v_mul_f32 v215, s48, v215
    v_cvt_pk_bf16_f32 v198, v212, v213
    v_mfma_f32_16x16x32_bf16 v[80:83], a[48:51], v[40:43], v[80:83]
    ds_read_b64_tr_b16 v[32:33], v4 offset:57344
    v_cvt_pk_bf16_f32 v199, v214, v215
    v_mfma_f32_16x16x32_bf16 v[80:83], a[52:55], v[44:47], v[80:83]
    ds_read_b64_tr_b16 v[34:35], v4 offset:57856
    v_mfma_f32_16x16x32_bf16 v[84:87], a[116:119], v[44:47], v[84:87]
    v_mfma_f32_16x16x32_bf16 v[84:87], a[112:115], v[40:43], v[84:87]
    v_mfma_f32_16x16x32_bf16 v[88:91], a[176:179], v[40:43], v[88:91]
    ds_read_b64_tr_b16 v[36:37], v4 offset:61440
    v_mfma_f32_16x16x32_bf16 v[88:91], a[180:183], v[44:47], v[88:91]
    ds_read_b64_tr_b16 v[38:39], v4 offset:61952
    v_mfma_f32_16x16x32_bf16 v[92:95], a[244:247], v[44:47], v[92:95]
    v_mfma_f32_16x16x32_bf16 v[92:95], a[240:243], v[40:43], v[92:95]
    s_waitcnt lgkmcnt(8)
    v_mfma_f32_16x16x32_bf16 v[96:99], a[48:51], v[48:51], v[96:99]
    s_add_u32 s43, s76, 64640
    ds_read_b64_tr_b16 v[40:41], v5 offset:57344
    buffer_load_dwordx4 v3, s[16:19], s43 offen offset:1024 lds
    v_mfma_f32_16x16x32_bf16 v[96:99], a[52:55], v[52:55], v[96:99]
    ds_read_b64_tr_b16 v[42:43], v5 offset:57856
    v_mfma_f32_16x16x32_bf16 v[100:103], a[116:119], v[52:55], v[100:103]
    v_mfma_f32_16x16x32_bf16 v[100:103], a[112:115], v[48:51], v[100:103]
    v_mfma_f32_16x16x32_bf16 v[104:107], a[176:179], v[48:51], v[104:107]
    ds_read_b64_tr_b16 v[44:45], v5 offset:61440
    v_mfma_f32_16x16x32_bf16 v[104:107], a[180:183], v[52:55], v[104:107]
    ds_read_b64_tr_b16 v[46:47], v5 offset:61952
    v_mfma_f32_16x16x32_bf16 v[108:111], a[244:247], v[52:55], v[108:111]
    v_mfma_f32_16x16x32_bf16 v[108:111], a[240:243], v[48:51], v[108:111]
    s_waitcnt lgkmcnt(8)
    v_mfma_f32_16x16x32_bf16 v[112:115], a[48:51], v[56:59], v[112:115]
    ds_read_b64_tr_b16 v[48:49], v6 offset:57344
    v_mfma_f32_16x16x32_bf16 v[112:115], a[52:55], v[60:63], v[112:115]
    ds_read_b64_tr_b16 v[50:51], v6 offset:57856
    v_mfma_f32_16x16x32_bf16 v[116:119], a[116:119], v[60:63], v[116:119]
    v_mfma_f32_16x16x32_bf16 v[116:119], a[112:115], v[56:59], v[116:119]
    v_mfma_f32_16x16x32_bf16 v[120:123], a[176:179], v[56:59], v[120:123]
    ds_read_b64_tr_b16 v[52:53], v6 offset:61440
    v_mfma_f32_16x16x32_bf16 v[120:123], a[180:183], v[60:63], v[120:123]
    ds_read_b64_tr_b16 v[54:55], v6 offset:61952
    v_mfma_f32_16x16x32_bf16 v[124:127], a[244:247], v[60:63], v[124:127]
    v_mfma_f32_16x16x32_bf16 v[124:127], a[240:243], v[56:59], v[124:127]
    s_waitcnt lgkmcnt(8)
    v_mfma_f32_16x16x32_bf16 v[64:67], a[56:59], v[32:35], v[64:67]
    s_add_u32 s43, s76, 129152
    ds_read_b64_tr_b16 v[56:57], v7 offset:57344
    buffer_load_dwordx4 v2, s[16:19], s43 offen offset:2048 lds
    v_mfma_f32_16x16x32_bf16 v[64:67], a[60:63], v[36:39], v[64:67]
    ds_read_b64_tr_b16 v[58:59], v7 offset:57856
    v_mfma_f32_16x16x32_bf16 v[68:71], a[124:127], v[36:39], v[68:71]
    v_mfma_f32_16x16x32_bf16 v[68:71], a[120:123], v[32:35], v[68:71]
    v_mfma_f32_16x16x32_bf16 v[72:75], a[184:187], v[32:35], v[72:75]
    ds_read_b64_tr_b16 v[60:61], v7 offset:61440
    v_mfma_f32_16x16x32_bf16 v[72:75], a[188:191], v[36:39], v[72:75]
    ds_read_b64_tr_b16 v[62:63], v7 offset:61952
    v_mfma_f32_16x16x32_bf16 v[76:79], a[252:255], v[36:39], v[76:79]
    v_mfma_f32_16x16x32_bf16 v[76:79], a[248:251], v[32:35], v[76:79]
    s_waitcnt lgkmcnt(8)
    v_mfma_f32_16x16x32_bf16 v[80:83], a[56:59], v[40:43], v[80:83]
    s_waitcnt vmcnt(23)
    s_barrier
    ds_read_b64_tr_b16 v[32:33], v8 offset:0
    v_mfma_f32_16x16x32_bf16 v[80:83], a[60:63], v[44:47], v[80:83]
    ds_read_b64_tr_b16 v[34:35], v8 offset:512
    v_mfma_f32_16x16x32_bf16 v[84:87], a[124:127], v[44:47], v[84:87]
    buffer_store_dwordx4 v[196:199], v1, s[20:23], s50 offen offset:2048 sc0 sc1
    v_mfma_f32_16x16x32_bf16 v[84:87], a[120:123], v[40:43], v[84:87]
    v_mul_f32 v200, s48, v200
    v_mul_f32 v201, s48, v201
    v_mfma_f32_16x16x32_bf16 v[88:91], a[184:187], v[40:43], v[88:91]
    ds_read_b64_tr_b16 v[36:37], v8 offset:4096
    v_mul_f32 v202, s48, v202
    v_mfma_f32_16x16x32_bf16 v[88:91], a[188:191], v[44:47], v[88:91]
    ds_read_b64_tr_b16 v[38:39], v8 offset:4608
    v_mul_f32 v203, s48, v203
    v_mfma_f32_16x16x32_bf16 v[92:95], a[252:255], v[44:47], v[92:95]
    s_add_u32 s43, s76, 193664
    buffer_load_dwordx4 v3, s[16:19], s43 offen offset:3072 lds
    v_mfma_f32_16x16x32_bf16 v[92:95], a[248:251], v[40:43], v[92:95]
    s_waitcnt lgkmcnt(8)
    v_cvt_pk_bf16_f32 v200, v200, v201
    v_cvt_pk_bf16_f32 v201, v202, v203
    v_mfma_f32_16x16x32_bf16 v[96:99], a[56:59], v[48:51], v[96:99]
    ds_read_b64_tr_b16 v[40:41], v9 offset:0
    v_mul_f32 v216, s48, v216
    v_mfma_f32_16x16x32_bf16 v[96:99], a[60:63], v[52:55], v[96:99]
    ds_read_b64_tr_b16 v[42:43], v9 offset:512
    v_mul_f32 v217, s48, v217
    v_mfma_f32_16x16x32_bf16 v[100:103], a[124:127], v[52:55], v[100:103]
    v_mul_f32 v218, s48, v218
    v_mul_f32 v219, s48, v219
    v_mfma_f32_16x16x32_bf16 v[100:103], a[120:123], v[48:51], v[100:103]
    v_cvt_pk_bf16_f32 v202, v216, v217
    v_cvt_pk_bf16_f32 v203, v218, v219
    v_mfma_f32_16x16x32_bf16 v[104:107], a[184:187], v[48:51], v[104:107]
    ds_read_b64_tr_b16 v[44:45], v9 offset:4096
    v_mfma_f32_16x16x32_bf16 v[104:107], a[188:191], v[52:55], v[104:107]
    ds_read_b64_tr_b16 v[46:47], v9 offset:4608
    buffer_store_dwordx4 v[200:203], v1, s[20:23], s51 offen offset:2048 sc0 sc1
    v_mfma_f32_16x16x32_bf16 v[108:111], a[252:255], v[52:55], v[108:111]
    v_mul_f32 v204, s48, v204
    v_mul_f32 v205, s48, v205
    v_mfma_f32_16x16x32_bf16 v[108:111], a[248:251], v[48:51], v[108:111]
    s_waitcnt lgkmcnt(8)
    v_mul_f32 v206, s48, v206
    v_mul_f32 v207, s48, v207
    v_mfma_f32_16x16x32_bf16 v[112:115], a[56:59], v[56:59], v[112:115]
    ds_read_b64_tr_b16 v[48:49], v10 offset:0
    v_cvt_pk_bf16_f32 v204, v204, v205
    v_mfma_f32_16x16x32_bf16 v[112:115], a[60:63], v[60:63], v[112:115]
    ds_read_b64_tr_b16 v[50:51], v10 offset:512
    v_cvt_pk_bf16_f32 v205, v206, v207
    v_mfma_f32_16x16x32_bf16 v[116:119], a[124:127], v[60:63], v[116:119]
    v_mul_f32 v220, s48, v220
    v_mul_f32 v221, s48, v221
    v_mfma_f32_16x16x32_bf16 v[116:119], a[120:123], v[56:59], v[116:119]
    v_mul_f32 v222, s48, v222
    v_mul_f32 v223, s48, v223
    v_mfma_f32_16x16x32_bf16 v[120:123], a[184:187], v[56:59], v[120:123]
    ds_read_b64_tr_b16 v[52:53], v10 offset:4096
    v_cvt_pk_bf16_f32 v206, v220, v221
    v_mfma_f32_16x16x32_bf16 v[120:123], a[188:191], v[60:63], v[120:123]
    ds_read_b64_tr_b16 v[54:55], v10 offset:4608
    v_cvt_pk_bf16_f32 v207, v222, v223
    v_mfma_f32_16x16x32_bf16 v[124:127], a[252:255], v[60:63], v[124:127]
    v_mfma_f32_16x16x32_bf16 v[124:127], a[248:251], v[56:59], v[124:127]
    s_waitcnt lgkmcnt(8)
    buffer_store_dwordx4 v[204:207], v1, s[20:23], s52 offen offset:2048 sc0 sc1
    v_mfma_f32_16x16x32_bf16 v[128:131], a[0:3], v[32:35], 0
    s_add_u32 m0, s44, 16384
    ds_read_b64_tr_b16 v[56:57], v11 offset:0
    s_mov_b32 s16, s82
    s_mov_b32 s17, s83
    s_mov_b32 s18, 3584
    s_add_u32 s24, s86, 35651584
    s_addc_u32 s25, s87, 0
    s_mov_b32 s26, 24117248
    s_mov_b32 s92, s32
    s_mov_b32 s93, s33
    s_mov_b32 s32, s24
    s_mov_b32 s33, s25
    s_bfe_u32 s3, s2, 0x20003
    s_cmp_lt_u32 s3, 3
    s_cselect_b32 s34, s26, 0
    s_mov_b32 s97, s26
    s_bitcmp1_b32 s2, 0
    s_cselect_b32 s97, s34, s97
    s_cselect_b32 s34, s26, s34
    s_lshr_b32 s3, s40, 1
    s_add_u32 s3, s3, s45
    s_add_u32 s3, s3, 0
    s_and_b32 s3, s3, 7
    s_lshl_b32 s3, s3, 19
    s_add_u32 s73, s3, s46
    s_lshr_b32 s3, s40, 1
    s_add_u32 s3, s3, s45
    s_add_u32 s3, s3, 2
    s_and_b32 s3, s3, 7
    s_lshl_b32 s3, s3, 19
    s_add_u32 s74, s3, s46
    s_lshr_b32 s3, s40, 1
    s_add_u32 s3, s3, s45
    s_add_u32 s3, s3, 4
    s_and_b32 s3, s3, 7
    s_lshl_b32 s3, s3, 19
    s_add_u32 s75, s3, s46
    s_lshr_b32 s3, s40, 1
    s_add_u32 s3, s3, s45
    s_add_u32 s3, s3, 6
    s_and_b32 s3, s3, 7
    s_lshl_b32 s3, s3, 19
    s_add_u32 s76, s3, s46
    s_lshl_b32 s3, s42, 3
    s_add_u32 s85, s3, s40
    s_sub_u32 s88, 127, s85
    s_sub_u32 s4, s3, s40
    s_add_u32 s86, s4, 7
    s_sub_u32 s87, 120, s4
    s_lshl_b32 s77, s85, 14
    s_lshl_b32 s78, s86, 14
    s_lshl_b32 s79, s87, 14
    s_lshl_b32 s80, s88, 14
    s_lshl_b32 s4, s41, 12
    s_lshl_b32 s5, s6, 10
    s_add_u32 s5, s5, 131072
    s_mul_i32 s3, s85, 188416
    s_add_u32 s81, s3, s4
    s_add_u32 s85, s3, s5
    s_mul_i32 s3, s86, 188416
    s_add_u32 s82, s3, s4
    s_add_u32 s86, s3, s5
    s_mul_i32 s3, s87, 188416
    s_add_u32 s83, s3, s4
    s_add_u32 s87, s3, s5
    s_mul_i32 s3, s88, 188416
    s_add_u32 s84, s3, s4
    s_add_u32 s88, s3, s5
    v_mfma_f32_16x16x32_bf16 v[128:131], a[4:7], v[36:39], v[128:131]
    s_mov_b32 s43, s58
    ds_read_b64_tr_b16 v[58:59], v11 offset:512
    buffer_load_dwordx4 v28, s[8:11], s43 offen offset:0 lds
    v_mfma_f32_16x16x32_bf16 v[132:135], a[68:71], v[36:39], 0
    buffer_load_dwordx2 v[20:21], v13, s[16:19], 0 offen offset:0
    v_mfma_f32_16x16x32_bf16 v[132:135], a[64:67], v[32:35], v[132:135]
    buffer_load_dwordx2 v[22:23], v13, s[16:19], 0 offen offset:32
    v_mfma_f32_16x16x32_bf16 v[136:139], a[128:131], v[32:35], 0
    ds_read_b64_tr_b16 v[60:61], v11 offset:4096
    v_mfma_f32_16x16x32_bf16 v[136:139], a[132:135], v[36:39], v[136:139]
    ds_read_b64_tr_b16 v[62:63], v11 offset:4608
    v_mfma_f32_16x16x32_bf16 v[140:143], a[196:199], v[36:39], 0
    buffer_load_dwordx2 v[24:25], v13, s[16:19], 0 offen offset:64
    v_mfma_f32_16x16x32_bf16 v[140:143], a[192:195], v[32:35], v[140:143]
    s_waitcnt lgkmcnt(8)
    buffer_load_dwordx2 v[26:27], v13, s[16:19], 0 offen offset:96
    v_mfma_f32_16x16x32_bf16 v[144:147], a[0:3], v[40:43], 0
    ds_read_b64_tr_b16 v[32:33], v8 offset:8192
    v_mul_f32 v224, s48, v224
    v_mfma_f32_16x16x32_bf16 v[144:147], a[4:7], v[44:47], v[144:147]
    ds_read_b64_tr_b16 v[34:35], v8 offset:8704
    v_mul_f32 v225, s48, v225
    v_mfma_f32_16x16x32_bf16 v[148:151], a[68:71], v[44:47], 0
    buffer_load_dword v15, v14, s[36:39], 0 offen offset:128 sc1
    v_mfma_f32_16x16x32_bf16 v[148:151], a[64:67], v[40:43], v[148:151]
    v_mul_f32 v226, s48, v226
    v_mul_f32 v227, s48, v227
    v_mfma_f32_16x16x32_bf16 v[152:155], a[128:131], v[40:43], 0
    ds_read_b64_tr_b16 v[36:37], v8 offset:12288
    v_cvt_pk_bf16_f32 v224, v224, v225
    v_mfma_f32_16x16x32_bf16 v[152:155], a[132:135], v[44:47], v[152:155]
    ds_read_b64_tr_b16 v[38:39], v8 offset:12800
    v_cvt_pk_bf16_f32 v225, v226, v227
    v_mfma_f32_16x16x32_bf16 v[156:159], a[196:199], v[44:47], 0
    v_mul_f32 v240, s48, v240
    v_mul_f32 v241, s48, v241
    v_mfma_f32_16x16x32_bf16 v[156:159], a[192:195], v[40:43], v[156:159]
    s_waitcnt lgkmcnt(8)
    v_mul_f32 v242, s48, v242
    v_mul_f32 v243, s48, v243
    v_mfma_f32_16x16x32_bf16 v[160:163], a[0:3], v[48:51], 0
    s_add_u32 s43, s43, s89
    ds_read_b64_tr_b16 v[40:41], v9 offset:8192
    buffer_load_dwordx4 v29, s[8:11], s43 offen offset:1024 lds
    v_mfma_f32_16x16x32_bf16 v[160:163], a[4:7], v[52:55], v[160:163]
    ds_read_b64_tr_b16 v[42:43], v9 offset:8704
    v_cvt_pk_bf16_f32 v226, v240, v241
    v_mfma_f32_16x16x32_bf16 v[164:167], a[68:71], v[52:55], 0
    v_cvt_pk_bf16_f32 v227, v242, v243
    v_mfma_f32_16x16x32_bf16 v[164:167], a[64:67], v[48:51], v[164:167]
    v_mfma_f32_16x16x32_bf16 v[168:171], a[128:131], v[48:51], 0
    ds_read_b64_tr_b16 v[44:45], v9 offset:12288
    v_mfma_f32_16x16x32_bf16 v[168:171], a[132:135], v[52:55], v[168:171]
    ds_read_b64_tr_b16 v[46:47], v9 offset:12800
    v_mfma_f32_16x16x32_bf16 v[172:175], a[196:199], v[52:55], 0
    v_mfma_f32_16x16x32_bf16 v[172:175], a[192:195], v[48:51], v[172:175]
    s_waitcnt lgkmcnt(8)
    v_mfma_f32_16x16x32_bf16 v[176:179], a[0:3], v[56:59], 0
    ds_read_b64_tr_b16 v[48:49], v10 offset:8192
    v_mfma_f32_16x16x32_bf16 v[176:179], a[4:7], v[60:63], v[176:179]
    ds_read_b64_tr_b16 v[50:51], v10 offset:8704
    v_mfma_f32_16x16x32_bf16 v[180:183], a[68:71], v[60:63], 0
    v_mfma_f32_16x16x32_bf16 v[180:183], a[64:67], v[56:59], v[180:183]
    v_mfma_f32_16x16x32_bf16 v[184:187], a[128:131], v[56:59], 0
    ds_read_b64_tr_b16 v[52:53], v10 offset:12288
    v_mfma_f32_16x16x32_bf16 v[184:187], a[132:135], v[60:63], v[184:187]
    ds_read_b64_tr_b16 v[54:55], v10 offset:12800
    v_mfma_f32_16x16x32_bf16 v[188:191], a[196:199], v[60:63], 0
    v_mfma_f32_16x16x32_bf16 v[188:191], a[192:195], v[56:59], v[188:191]
    s_waitcnt lgkmcnt(8)
    v_mfma_f32_16x16x32_bf16 v[128:131], a[8:11], v[32:35], v[128:131]
    s_add_u32 s43, s43, s89
    ds_read_b64_tr_b16 v[56:57], v11 offset:8192
    buffer_load_dwordx4 v28, s[8:11], s43 offen offset:2048 lds
    v_mfma_f32_16x16x32_bf16 v[128:131], a[12:15], v[36:39], v[128:131]
    ds_read_b64_tr_b16 v[58:59], v11 offset:8704
    v_mfma_f32_16x16x32_bf16 v[132:135], a[76:79], v[36:39], v[132:135]
    v_mfma_f32_16x16x32_bf16 v[132:135], a[72:75], v[32:35], v[132:135]
    v_mfma_f32_16x16x32_bf16 v[136:139], a[136:139], v[32:35], v[136:139]
    ds_read_b64_tr_b16 v[60:61], v11 offset:12288
    v_mfma_f32_16x16x32_bf16 v[136:139], a[140:143], v[36:39], v[136:139]
    ds_read_b64_tr_b16 v[62:63], v11 offset:12800
    v_mfma_f32_16x16x32_bf16 v[140:143], a[204:207], v[36:39], v[140:143]
    v_mfma_f32_16x16x32_bf16 v[140:143], a[200:203], v[32:35], v[140:143]
    s_waitcnt lgkmcnt(8)
    v_mfma_f32_16x16x32_bf16 v[144:147], a[8:11], v[40:43], v[144:147]
    s_waitcnt vmcnt(28)
    s_barrier
    ds_read_b64_tr_b16 v[32:33], v8 offset:16384
    v_mfma_f32_16x16x32_bf16 v[144:147], a[12:15], v[44:47], v[144:147]
    ds_read_b64_tr_b16 v[34:35], v8 offset:16896
    v_mfma_f32_16x16x32_bf16 v[148:151], a[76:79], v[44:47], v[148:151]
    buffer_store_dwordx4 v[224:227], v1, s[20:23], s49 offen offset:3072 sc0 sc1
    v_mfma_f32_16x16x32_bf16 v[148:151], a[72:75], v[40:43], v[148:151]
    v_mul_f32 v228, s48, v228
    v_mul_f32 v229, s48, v229
    v_mfma_f32_16x16x32_bf16 v[152:155], a[136:139], v[40:43], v[152:155]
    ds_read_b64_tr_b16 v[36:37], v8 offset:20480
    v_mul_f32 v230, s48, v230
    v_mfma_f32_16x16x32_bf16 v[152:155], a[140:143], v[44:47], v[152:155]
    ds_read_b64_tr_b16 v[38:39], v8 offset:20992
    v_mul_f32 v231, s48, v231
    v_mfma_f32_16x16x32_bf16 v[156:159], a[204:207], v[44:47], v[156:159]
    s_add_u32 s43, s43, s89
    buffer_load_dwordx4 v29, s[8:11], s43 offen offset:3072 lds
    v_mfma_f32_16x16x32_bf16 v[156:159], a[200:203], v[40:43], v[156:159]
    s_waitcnt lgkmcnt(8)
    v_cvt_pk_bf16_f32 v228, v228, v229
    v_cvt_pk_bf16_f32 v229, v230, v231
    v_mfma_f32_16x16x32_bf16 v[160:163], a[8:11], v[48:51], v[160:163]
    ds_read_b64_tr_b16 v[40:41], v9 offset:16384
    v_mul_f32 v244, s48, v244
    v_mfma_f32_16x16x32_bf16 v[160:163], a[12:15], v[52:55], v[160:163]
    ds_read_b64_tr_b16 v[42:43], v9 offset:16896
    v_mul_f32 v245, s48, v245
    v_mfma_f32_16x16x32_bf16 v[164:167], a[76:79], v[52:55], v[164:167]
    v_mul_f32 v246, s48, v246
    v_mul_f32 v247, s48, v247
    v_mfma_f32_16x16x32_bf16 v[164:167], a[72:75], v[48:51], v[164:167]
    v_cvt_pk_bf16_f32 v230, v244, v245
    v_cvt_pk_bf16_f32 v231, v246, v247
    v_mfma_f32_16x16x32_bf16 v[168:171], a[136:139], v[48:51], v[168:171]
    ds_read_b64_tr_b16 v[44:45], v9 offset:20480
    v_mfma_f32_16x16x32_bf16 v[168:171], a[140:143], v[52:55], v[168:171]
    ds_read_b64_tr_b16 v[46:47], v9 offset:20992
    buffer_store_dwordx4 v[228:231], v1, s[20:23], s50 offen offset:3072 sc0 sc1
    v_mfma_f32_16x16x32_bf16 v[172:175], a[204:207], v[52:55], v[172:175]
    v_mul_f32 v232, s48, v232
    v_mul_f32 v233, s48, v233
    v_mfma_f32_16x16x32_bf16 v[172:175], a[200:203], v[48:51], v[172:175]
    s_waitcnt lgkmcnt(8)
    v_mul_f32 v234, s48, v234
    v_mul_f32 v235, s48, v235
    v_mfma_f32_16x16x32_bf16 v[176:179], a[8:11], v[56:59], v[176:179]
    ds_read_b64_tr_b16 v[48:49], v10 offset:16384
    v_cvt_pk_bf16_f32 v232, v232, v233
    v_mfma_f32_16x16x32_bf16 v[176:179], a[12:15], v[60:63], v[176:179]
    ds_read_b64_tr_b16 v[50:51], v10 offset:16896
    v_cvt_pk_bf16_f32 v233, v234, v235
    v_mfma_f32_16x16x32_bf16 v[180:183], a[76:79], v[60:63], v[180:183]
    v_mul_f32 v248, s48, v248
    v_mul_f32 v249, s48, v249
    v_mfma_f32_16x16x32_bf16 v[180:183], a[72:75], v[56:59], v[180:183]
    v_mul_f32 v250, s48, v250
    v_mul_f32 v251, s48, v251
    v_mfma_f32_16x16x32_bf16 v[184:187], a[136:139], v[56:59], v[184:187]
    ds_read_b64_tr_b16 v[52:53], v10 offset:20480
    v_cvt_pk_bf16_f32 v234, v248, v249
    v_mfma_f32_16x16x32_bf16 v[184:187], a[140:143], v[60:63], v[184:187]
    ds_read_b64_tr_b16 v[54:55], v10 offset:20992
    v_cvt_pk_bf16_f32 v235, v250, v251
    v_mfma_f32_16x16x32_bf16 v[188:191], a[204:207], v[60:63], v[188:191]
    v_mfma_f32_16x16x32_bf16 v[188:191], a[200:203], v[56:59], v[188:191]
    s_waitcnt lgkmcnt(8)
    buffer_store_dwordx4 v[232:235], v1, s[20:23], s51 offen offset:3072 sc0 sc1
    v_mfma_f32_16x16x32_bf16 v[128:131], a[16:19], v[32:35], v[128:131]
    s_waitcnt vmcnt(6)
    ds_read_b64_tr_b16 v[56:57], v11 offset:16384
    v_mul_f32 v236, s48, v236
    v_mfma_f32_16x16x32_bf16 v[128:131], a[20:23], v[36:39], v[128:131]
    ds_read_b64_tr_b16 v[58:59], v11 offset:16896
    v_cmp_gt_u32 vcc, 16, v15
    s_nop 3
    s_cbranch_vccnz L_spin0
L_spun0:
    v_mfma_f32_16x16x32_bf16 v[132:135], a[84:87], v[36:39], v[132:135]
    v_mul_f32 v237, s48, v237
    v_mul_f32 v238, s48, v238
    v_mfma_f32_16x16x32_bf16 v[132:135], a[80:83], v[32:35], v[132:135]
    v_mul_f32 v239, s48, v239
    v_cvt_pk_bf16_f32 v236, v236, v237
    v_mfma_f32_16x16x32_bf16 v[136:139], a[144:147], v[32:35], v[136:139]
    ds_read_b64_tr_b16 v[60:61], v11 offset:20480
    v_cvt_pk_bf16_f32 v237, v238, v239
    v_mfma_f32_16x16x32_bf16 v[136:139], a[148:151], v[36:39], v[136:139]
    ds_read_b64_tr_b16 v[62:63], v11 offset:20992
    v_mul_f32 v252, s48, v252
    v_mfma_f32_16x16x32_bf16 v[140:143], a[212:215], v[36:39], v[140:143]
    v_mul_f32 v253, s48, v253
    v_mul_f32 v254, s48, v254
    v_mfma_f32_16x16x32_bf16 v[140:143], a[208:211], v[32:35], v[140:143]
    s_waitcnt lgkmcnt(8)
    v_mul_f32 v255, s48, v255
    v_cvt_pk_bf16_f32 v238, v252, v253
    v_mfma_f32_16x16x32_bf16 v[144:147], a[16:19], v[40:43], v[144:147]
    s_add_u32 s43, s77, s65
    ds_read_b64_tr_b16 v[32:33], v8 offset:24576
    v_cvt_pk_bf16_f32 v239, v254, v255
    v_mfma_f32_16x16x32_bf16 v[144:147], a[20:23], v[44:47], v[144:147]
    ds_read_b64_tr_b16 v[34:35], v8 offset:25088
    buffer_load_dwordx4 a[0:3], v1, s[28:31], s43 offen offset:0 sc1
    v_mfma_f32_16x16x32_bf16 v[148:151], a[84:87], v[44:47], v[148:151]
    v_mfma_f32_16x16x32_bf16 v[148:151], a[80:83], v[40:43], v[148:151]
    v_mfma_f32_16x16x32_bf16 v[152:155], a[144:147], v[40:43], v[152:155]
    ds_read_b64_tr_b16 v[36:37], v8 offset:28672
    v_mfma_f32_16x16x32_bf16 v[152:155], a[148:151], v[44:47], v[152:155]
    ds_read_b64_tr_b16 v[38:39], v8 offset:29184
    v_mfma_f32_16x16x32_bf16 v[156:159], a[212:215], v[44:47], v[156:159]
    v_mfma_f32_16x16x32_bf16 v[156:159], a[208:211], v[40:43], v[156:159]
    s_waitcnt lgkmcnt(8)
    v_mfma_f32_16x16x32_bf16 v[160:163], a[16:19], v[48:51], v[160:163]
    ds_read_b64_tr_b16 v[40:41], v9 offset:24576
    v_mfma_f32_16x16x32_bf16 v[160:163], a[20:23], v[52:55], v[160:163]
    ds_read_b64_tr_b16 v[42:43], v9 offset:25088
    v_mfma_f32_16x16x32_bf16 v[164:167], a[84:87], v[52:55], v[164:167]
    buffer_load_dwordx4 a[4:7], v1, s[28:31], s43 offen offset:1024 sc1
    v_mfma_f32_16x16x32_bf16 v[164:167], a[80:83], v[48:51], v[164:167]
    v_mfma_f32_16x16x32_bf16 v[168:171], a[144:147], v[48:51], v[168:171]
    ds_read_b64_tr_b16 v[44:45], v9 offset:28672
    v_mfma_f32_16x16x32_bf16 v[168:171], a[148:151], v[52:55], v[168:171]
    ds_read_b64_tr_b16 v[46:47], v9 offset:29184
    v_mfma_f32_16x16x32_bf16 v[172:175], a[212:215], v[52:55], v[172:175]
    v_mfma_f32_16x16x32_bf16 v[172:175], a[208:211], v[48:51], v[172:175]
    s_waitcnt lgkmcnt(8)
    v_mfma_f32_16x16x32_bf16 v[176:179], a[16:19], v[56:59], v[176:179]
    ds_read_b64_tr_b16 v[48:49], v10 offset:24576
    v_mfma_f32_16x16x32_bf16 v[176:179], a[20:23], v[60:63], v[176:179]
    ds_read_b64_tr_b16 v[50:51], v10 offset:25088
    v_mfma_f32_16x16x32_bf16 v[180:183], a[84:87], v[60:63], v[180:183]
    s_add_u32 s43, s78, s65
    buffer_load_dwordx4 a[64:67], v1, s[28:31], s43 offen offset:0 sc1
    v_mfma_f32_16x16x32_bf16 v[180:183], a[80:83], v[56:59], v[180:183]
    v_mfma_f32_16x16x32_bf16 v[184:187], a[144:147], v[56:59], v[184:187]
    ds_read_b64_tr_b16 v[52:53], v10 offset:28672
    v_mfma_f32_16x16x32_bf16 v[184:187], a[148:151], v[60:63], v[184:187]
    ds_read_b64_tr_b16 v[54:55], v10 offset:29184
    v_mfma_f32_16x16x32_bf16 v[188:191], a[212:215], v[60:63], v[188:191]
    v_mfma_f32_16x16x32_bf16 v[188:191], a[208:211], v[56:59], v[188:191]
    s_waitcnt lgkmcnt(8)
    v_mfma_f32_16x16x32_bf16 v[128:131], a[24:27], v[32:35], v[128:131]
    ds_read_b64_tr_b16 v[56:57], v11 offset:24576
    v_mfma_f32_16x16x32_bf16 v[128:131], a[28:31], v[36:39], v[128:131]
    ds_read_b64_tr_b16 v[58:59], v11 offset:25088
    v_mfma_f32_16x16x32_bf16 v[132:135], a[92:95], v[36:39], v[132:135]
    v_mfma_f32_16x16x32_bf16 v[132:135], a[88:91], v[32:35], v[132:135]
    buffer_load_dwordx4 a[68:71], v1, s[28:31], s43 offen offset:1024 sc1
    v_mfma_f32_16x16x32_bf16 v[136:139], a[152:155], v[32:35], v[136:139]
    ds_read_b64_tr_b16 v[60:61], v11 offset:28672
    v_mfma_f32_16x16x32_bf16 v[136:139], a[156:159], v[36:39], v[136:139]
    ds_read_b64_tr_b16 v[62:63], v11 offset:29184
    v_mfma_f32_16x16x32_bf16 v[140:143], a[220:223], v[36:39], v[140:143]
    v_mfma_f32_16x16x32_bf16 v[140:143], a[216:219], v[32:35], v[140:143]
    s_waitcnt lgkmcnt(8)
    v_mfma_f32_16x16x32_bf16 v[144:147], a[24:27], v[40:43], v[144:147]
    s_barrier
    ds_read_b64_tr_b16 v[32:33], v8 offset:32768
    v_mfma_f32_16x16x32_bf16 v[144:147], a[28:31], v[44:47], v[144:147]
    ds_read_b64_tr_b16 v[34:35], v8 offset:33280
    v_mfma_f32_16x16x32_bf16 v[148:151], a[92:95], v[44:47], v[148:151]
    v_mfma_f32_16x16x32_bf16 v[148:151], a[88:91], v[40:43], v[148:151]
    v_mfma_f32_16x16x32_bf16 v[152:155], a[152:155], v[40:43], v[152:155]
    s_add_u32 s43, s79, s65
    ds_read_b64_tr_b16 v[36:37], v8 offset:36864
    v_mfma_f32_16x16x32_bf16 v[152:155], a[156:159], v[44:47], v[152:155]
    ds_read_b64_tr_b16 v[38:39], v8 offset:37376
    buffer_load_dwordx4 a[128:131], v1, s[28:31], s43 offen offset:0 sc1
    v_mfma_f32_16x16x32_bf16 v[156:159], a[220:223], v[44:47], v[156:159]
    v_mfma_f32_16x16x32_bf16 v[156:159], a[216:219], v[40:43], v[156:159]
    s_waitcnt lgkmcnt(8)
    v_mfma_f32_16x16x32_bf16 v[160:163], a[24:27], v[48:51], v[160:163]
    ds_read_b64_tr_b16 v[40:41], v9 offset:32768
    v_mfma_f32_16x16x32_bf16 v[160:163], a[28:31], v[52:55], v[160:163]
    ds_read_b64_tr_b16 v[42:43], v9 offset:33280
    v_mfma_f32_16x16x32_bf16 v[164:167], a[92:95], v[52:55], v[164:167]
    v_mfma_f32_16x16x32_bf16 v[164:167], a[88:91], v[48:51], v[164:167]
    v_mfma_f32_16x16x32_bf16 v[168:171], a[152:155], v[48:51], v[168:171]
    ds_read_b64_tr_b16 v[44:45], v9 offset:36864
    buffer_store_dwordx4 v[236:239], v1, s[20:23], s52 offen offset:3072 sc0 sc1
    v_mfma_f32_16x16x32_bf16 v[168:171], a[156:159], v[52:55], v[168:171]
    ds_read_b64_tr_b16 v[46:47], v9 offset:37376
    v_cvt_pk_bf16_f32 v64, v64, v65
    v_mfma_f32_16x16x32_bf16 v[172:175], a[220:223], v[52:55], v[172:175]
    buffer_load_dwordx4 a[132:135], v1, s[28:31], s43 offen offset:1024 sc1
    v_mfma_f32_16x16x32_bf16 v[172:175], a[216:219], v[48:51], v[172:175]
    s_waitcnt lgkmcnt(8)
    v_cvt_pk_bf16_f32 v65, v66, v67
    v_cvt_pk_bf16_f32 v66, v68, v69
    v_mfma_f32_16x16x32_bf16 v[176:179], a[24:27], v[56:59], v[176:179]
    ds_read_b64_tr_b16 v[48:49], v10 offset:32768
    v_cvt_pk_bf16_f32 v67, v70, v71
    v_mfma_f32_16x16x32_bf16 v[176:179], a[28:31], v[60:63], v[176:179]
    ds_read_b64_tr_b16 v[50:51], v10 offset:33280
    v_mfma_f32_16x16x32_bf16 v[180:183], a[92:95], v[60:63], v[180:183]
    v_mfma_f32_16x16x32_bf16 v[180:183], a[88:91], v[56:59], v[180:183]
    buffer_store_dwordx4 v[64:67], v1, s[20:23], s53 offen offset:0 sc0 sc1
    v_mfma_f32_16x16x32_bf16 v[184:187], a[152:155], v[56:59], v[184:187]
    ds_read_b64_tr_b16 v[52:53], v10 offset:36864
    v_cvt_pk_bf16_f32 v80, v80, v81
    v_mfma_f32_16x16x32_bf16 v[184:187], a[156:159], v[60:63], v[184:187]
    ds_read_b64_tr_b16 v[54:55], v10 offset:37376
    v_cvt_pk_bf16_f32 v81, v82, v83
    v_mfma_f32_16x16x32_bf16 v[188:191], a[220:223], v[60:63], v[188:191]
    v_cvt_pk_bf16_f32 v82, v84, v85
    v_cvt_pk_bf16_f32 v83, v86, v87
    v_mfma_f32_16x16x32_bf16 v[188:191], a[216:219], v[56:59], v[188:191]
    s_waitcnt lgkmcnt(8)
    buffer_store_dwordx4 v[80:83], v1, s[20:23], s53 offen offset:1024 sc0 sc1
    v_mfma_f32_16x16x32_bf16 v[128:131], a[32:35], v[32:35], v[128:131]
    s_add_u32 s43, s80, s65
    ds_read_b64_tr_b16 v[56:57], v11 offset:32768
    v_cvt_pk_bf16_f32 v96, v96, v97
    v_mfma_f32_16x16x32_bf16 v[128:131], a[36:39], v[36:39], v[128:131]
    s_mov_b32 s36, s92
    ds_read_b64_tr_b16 v[58:59], v11 offset:33280
    buffer_load_dwordx4 a[192:195], v1, s[28:31], s43 offen offset:0 sc1
    v_mfma_f32_16x16x32_bf16 v[132:135], a[100:103], v[36:39], v[132:135]
    s_mov_b32 s37, s93
    v_cvt_pk_bf16_f32 v97, v98, v99
    v_cvt_pk_bf16_f32 v98, v100, v101
    v_mfma_f32_16x16x32_bf16 v[132:135], a[96:99], v[32:35], v[132:135]
    s_mov_b32 s38, 16384
    v_cvt_pk_bf16_f32 v99, v102, v103
    v_mfma_f32_16x16x32_bf16 v[136:139], a[160:163], v[32:35], v[136:139]
    ds_read_b64_tr_b16 v[60:61], v11 offset:36864
    v_mfma_f32_16x16x32_bf16 v[136:139], a[164:167], v[36:39], v[136:139]
    ds_read_b64_tr_b16 v[62:63], v11 offset:37376
    v_mfma_f32_16x16x32_bf16 v[140:143], a[228:231], v[36:39], v[140:143]
    v_mfma_f32_16x16x32_bf16 v[140:143], a[224:227], v[32:35], v[140:143]
    s_waitcnt lgkmcnt(8)
    v_mfma_f32_16x16x32_bf16 v[144:147], a[32:35], v[40:43], v[144:147]
    ds_read_b64_tr_b16 v[32:33], v8 offset:40960
    v_mfma_f32_16x16x32_bf16 v[144:147], a[36:39], v[44:47], v[144:147]
    ds_read_b64_tr_b16 v[34:35], v8 offset:41472
    v_mfma_f32_16x16x32_bf16 v[148:151], a[100:103], v[44:47], v[148:151]
    buffer_load_dwordx4 a[196:199], v1, s[28:31], s43 offen offset:1024 sc1
    v_mfma_f32_16x16x32_bf16 v[148:151], a[96:99], v[40:43], v[148:151]
    v_mfma_f32_16x16x32_bf16 v[152:155], a[160:163], v[40:43], v[152:155]
    ds_read_b64_tr_b16 v[36:37], v8 offset:45056
    v_mfma_f32_16x16x32_bf16 v[152:155], a[164:167], v[44:47], v[152:155]
    ds_read_b64_tr_b16 v[38:39], v8 offset:45568
    v_mfma_f32_16x16x32_bf16 v[156:159], a[228:231], v[44:47], v[156:159]
    v_mfma_f32_16x16x32_bf16 v[156:159], a[224:227], v[40:43], v[156:159]
    s_waitcnt lgkmcnt(8)
    v_mfma_f32_16x16x32_bf16 v[160:163], a[32:35], v[48:51], v[160:163]
    ds_read_b64_tr_b16 v[40:41], v9 offset:40960
    v_mfma_f32_16x16x32_bf16 v[160:163], a[36:39], v[52:55], v[160:163]
    ds_read_b64_tr_b16 v[42:43], v9 offset:41472
    v_mfma_f32_16x16x32_bf16 v[164:167], a[100:103], v[52:55], v[164:167]
    v_mfma_f32_16x16x32_bf16 v[164:167], a[96:99], v[48:51], v[164:167]
    v_mfma_f32_16x16x32_bf16 v[168:171], a[160:163], v[48:51], v[168:171]
    s_add_u32 s43, s77, s66
    ds_read_b64_tr_b16 v[44:45], v9 offset:45056
    v_mfma_f32_16x16x32_bf16 v[168:171], a[164:167], v[52:55], v[168:171]
    ds_read_b64_tr_b16 v[46:47], v9 offset:45568
    buffer_load_dwordx4 a[8:11], v1, s[28:31], s43 offen offset:0 sc1
    v_mfma_f32_16x16x32_bf16 v[172:175], a[228:231], v[52:55], v[172:175]
    v_mfma_f32_16x16x32_bf16 v[172:175], a[224:227], v[48:51], v[172:175]
    s_waitcnt lgkmcnt(8)
    v_mfma_f32_16x16x32_bf16 v[176:179], a[32:35], v[56:59], v[176:179]
    ds_read_b64_tr_b16 v[48:49], v10 offset:40960
    v_mfma_f32_16x16x32_bf16 v[176:179], a[36:39], v[60:63], v[176:179]
    ds_read_b64_tr_b16 v[50:51], v10 offset:41472
    v_mfma_f32_16x16x32_bf16 v[180:183], a[100:103], v[60:63], v[180:183]
    v_mfma_f32_16x16x32_bf16 v[180:183], a[96:99], v[56:59], v[180:183]
    v_mfma_f32_16x16x32_bf16 v[184:187], a[160:163], v[56:59], v[184:187]
    ds_read_b64_tr_b16 v[52:53], v10 offset:45056
    v_mfma_f32_16x16x32_bf16 v[184:187], a[164:167], v[60:63], v[184:187]
    ds_read_b64_tr_b16 v[54:55], v10 offset:45568
    v_mfma_f32_16x16x32_bf16 v[188:191], a[228:231], v[60:63], v[188:191]
    v_mfma_f32_16x16x32_bf16 v[188:191], a[224:227], v[56:59], v[188:191]
    s_waitcnt lgkmcnt(8)
    buffer_load_dwordx4 a[12:15], v1, s[28:31], s43 offen offset:1024 sc1
    v_mfma_f32_16x16x32_bf16 v[128:131], a[40:43], v[32:35], v[128:131]
    ds_read_b64_tr_b16 v[56:57], v11 offset:40960
    v_mfma_f32_16x16x32_bf16 v[128:131], a[44:47], v[36:39], v[128:131]
    ds_read_b64_tr_b16 v[58:59], v11 offset:41472
    v_mfma_f32_16x16x32_bf16 v[132:135], a[108:111], v[36:39], v[132:135]
    v_mfma_f32_16x16x32_bf16 v[132:135], a[104:107], v[32:35], v[132:135]
    v_mfma_f32_16x16x32_bf16 v[136:139], a[168:171], v[32:35], v[136:139]
    ds_read_b64_tr_b16 v[60:61], v11 offset:45056
    v_mfma_f32_16x16x32_bf16 v[136:139], a[172:175], v[36:39], v[136:139]
    ds_read_b64_tr_b16 v[62:63], v11 offset:45568
    v_mfma_f32_16x16x32_bf16 v[140:143], a[236:239], v[36:39], v[140:143]
    v_mfma_f32_16x16x32_bf16 v[140:143], a[232:235], v[32:35], v[140:143]
    s_waitcnt lgkmcnt(8)
    v_mfma_f32_16x16x32_bf16 v[144:147], a[40:43], v[40:43], v[144:147]
    s_barrier
    ds_read_b64_tr_b16 v[32:33], v8 offset:49152
    v_mfma_f32_16x16x32_bf16 v[144:147], a[44:47], v[44:47], v[144:147]
    s_add_u32 s43, s78, s66
    ds_read_b64_tr_b16 v[34:35], v8 offset:49664
    v_mfma_f32_16x16x32_bf16 v[148:151], a[108:111], v[44:47], v[148:151]
    buffer_load_dwordx4 a[72:75], v1, s[28:31], s43 offen offset:0 sc1
    v_mfma_f32_16x16x32_bf16 v[148:151], a[104:107], v[40:43], v[148:151]
    v_mfma_f32_16x16x32_bf16 v[152:155], a[168:171], v[40:43], v[152:155]
    ds_read_b64_tr_b16 v[36:37], v8 offset:53248
    v_mfma_f32_16x16x32_bf16 v[152:155], a[172:175], v[44:47], v[152:155]
    ds_read_b64_tr_b16 v[38:39], v8 offset:53760
    v_mfma_f32_16x16x32_bf16 v[156:159], a[236:239], v[44:47], v[156:159]
    v_mfma_f32_16x16x32_bf16 v[156:159], a[232:235], v[40:43], v[156:159]
    s_waitcnt lgkmcnt(8)
    v_mfma_f32_16x16x32_bf16 v[160:163], a[40:43], v[48:51], v[160:163]
    ds_read_b64_tr_b16 v[40:41], v9 offset:49152
    v_mfma_f32_16x16x32_bf16 v[160:163], a[44:47], v[52:55], v[160:163]
    ds_read_b64_tr_b16 v[42:43], v9 offset:49664
    v_mfma_f32_16x16x32_bf16 v[164:167], a[108:111], v[52:55], v[164:167]
    v_mfma_f32_16x16x32_bf16 v[164:167], a[104:107], v[48:51], v[164:167]
    buffer_load_dwordx4 a[76:79], v1, s[28:31], s43 offen offset:1024 sc1
    v_mfma_f32_16x16x32_bf16 v[168:171], a[168:171], v[48:51], v[168:171]
    ds_read_b64_tr_b16 v[44:45], v9 offset:53248
    v_mfma_f32_16x16x32_bf16 v[168:171], a[172:175], v[52:55], v[168:171]
    ds_read_b64_tr_b16 v[46:47], v9 offset:53760
    v_mfma_f32_16x16x32_bf16 v[172:175], a[236:239], v[52:55], v[172:175]
    buffer_store_dwordx4 v[96:99], v1, s[20:23], s53 offen offset:2048 sc0 sc1
    v_mfma_f32_16x16x32_bf16 v[172:175], a[232:235], v[48:51], v[172:175]
    s_waitcnt lgkmcnt(8)
    v_cvt_pk_bf16_f32 v112, v112, v113
    v_cvt_pk_bf16_f32 v113, v114, v115
    v_mfma_f32_16x16x32_bf16 v[176:179], a[40:43], v[56:59], v[176:179]
    ds_read_b64_tr_b16 v[48:49], v10 offset:49152
    v_cvt_pk_bf16_f32 v114, v116, v117
    v_mfma_f32_16x16x32_bf16 v[176:179], a[44:47], v[60:63], v[176:179]
    ds_read_b64_tr_b16 v[50:51], v10 offset:49664
    v_cvt_pk_bf16_f32 v115, v118, v119
    v_mfma_f32_16x16x32_bf16 v[180:183], a[108:111], v[60:63], v[180:183]
    v_mfma_f32_16x16x32_bf16 v[180:183], a[104:107], v[56:59], v[180:183]
    buffer_store_dwordx4 v[112:115], v1, s[20:23], s53 offen offset:3072 sc0 sc1
    v_mfma_f32_16x16x32_bf16 v[184:187], a[168:171], v[56:59], v[184:187]
    ds_read_b64_tr_b16 v[52:53], v10 offset:53248
    v_cvt_pk_bf16_f32 v72, v72, v73
    v_mfma_f32_16x16x32_bf16 v[184:187], a[172:175], v[60:63], v[184:187]
    ds_read_b64_tr_b16 v[54:55], v10 offset:53760
    v_cvt_pk_bf16_f32 v73, v74, v75
    v_mfma_f32_16x16x32_bf16 v[188:191], a[236:239], v[60:63], v[188:191]
    v_cvt_pk_bf16_f32 v74, v76, v77
    v_cvt_pk_bf16_f32 v75, v78, v79
    v_mfma_f32_16x16x32_bf16 v[188:191], a[232:235], v[56:59], v[188:191]
    s_waitcnt lgkmcnt(8)
    buffer_store_dwordx4 v[72:75], v1, s[20:23], s55 offen offset:0 sc0 sc1
    v_mfma_f32_16x16x32_bf16 v[128:131], a[48:51], v[32:35], v[128:131]
    s_add_u32 s43, s79, s66
    ds_read_b64_tr_b16 v[56:57], v11 offset:49152
    v_cvt_pk_bf16_f32 v88, v88, v89
    v_mfma_f32_16x16x32_bf16 v[128:131], a[52:55], v[36:39], v[128:131]
    ds_read_b64_tr_b16 v[58:59], v11 offset:49664
    buffer_load_dwordx4 a[136:139], v1, s[28:31], s43 offen offset:0 sc1
    v_mfma_f32_16x16x32_bf16 v[132:135], a[116:119], v[36:39], v[132:135]
    v_cvt_pk_bf16_f32 v89, v90, v91
    v_cvt_pk_bf16_f32 v90, v92, v93
    v_mfma_f32_16x16x32_bf16 v[132:135], a[112:115], v[32:35], v[132:135]
    v_cvt_pk_bf16_f32 v91, v94, v95
    v_mfma_f32_16x16x32_bf16 v[136:139], a[176:179], v[32:35], v[136:139]
    ds_read_b64_tr_b16 v[60:61], v11 offset:53248
    v_mfma_f32_16x16x32_bf16 v[136:139], a[180:183], v[36:39], v[136:139]
    ds_read_b64_tr_b16 v[62:63], v11 offset:53760
    v_mfma_f32_16x16x32_bf16 v[140:143], a[244:247], v[36:39], v[140:143]
    v_mfma_f32_16x16x32_bf16 v[140:143], a[240:243], v[32:35], v[140:143]
    s_waitcnt lgkmcnt(8)
    v_mfma_f32_16x16x32_bf16 v[144:147], a[48:51], v[40:43], v[144:147]
    ds_read_b64_tr_b16 v[32:33], v8 offset:57344
    v_mfma_f32_16x16x32_bf16 v[144:147], a[52:55], v[44:47], v[144:147]
    ds_read_b64_tr_b16 v[34:35], v8 offset:57856
    v_mfma_f32_16x16x32_bf16 v[148:151], a[116:119], v[44:47], v[148:151]
    v_mfma_f32_16x16x32_bf16 v[148:151], a[112:115], v[40:43], v[148:151]
    v_mfma_f32_16x16x32_bf16 v[152:155], a[176:179], v[40:43], v[152:155]
    ds_read_b64_tr_b16 v[36:37], v8 offset:61440
    v_mfma_f32_16x16x32_bf16 v[152:155], a[180:183], v[44:47], v[152:155]
    ds_read_b64_tr_b16 v[38:39], v8 offset:61952
    v_mfma_f32_16x16x32_bf16 v[156:159], a[244:247], v[44:47], v[156:159]
    v_mfma_f32_16x16x32_bf16 v[156:159], a[240:243], v[40:43], v[156:159]
    s_waitcnt lgkmcnt(8)
    buffer_load_dwordx4 a[140:143], v1, s[28:31], s43 offen offset:1024 sc1
    v_mfma_f32_16x16x32_bf16 v[160:163], a[48:51], v[48:51], v[160:163]
    ds_read_b64_tr_b16 v[40:41], v9 offset:57344
    v_mfma_f32_16x16x32_bf16 v[160:163], a[52:55], v[52:55], v[160:163]
    ds_read_b64_tr_b16 v[42:43], v9 offset:57856
    v_mfma_f32_16x16x32_bf16 v[164:167], a[116:119], v[52:55], v[164:167]
    v_mfma_f32_16x16x32_bf16 v[164:167], a[112:115], v[48:51], v[164:167]
    v_mfma_f32_16x16x32_bf16 v[168:171], a[176:179], v[48:51], v[168:171]
    ds_read_b64_tr_b16 v[44:45], v9 offset:61440
    v_lshlrev_b32 v12, 16, v20
    v_mfma_f32_16x16x32_bf16 v[168:171], a[180:183], v[52:55], v[168:171]
    ds_read_b64_tr_b16 v[46:47], v9 offset:61952
    v_and_b32 v13, 0xffff0000, v20
    v_mfma_f32_16x16x32_bf16 v[172:175], a[244:247], v[52:55], v[172:175]
    v_lshlrev_b32 v14, 16, v21
    v_and_b32 v15, 0xffff0000, v21
    v_mfma_f32_16x16x32_bf16 v[172:175], a[240:243], v[48:51], v[172:175]
    s_waitcnt lgkmcnt(8)
    v_lshlrev_b32 v16, 16, v22
    v_and_b32 v17, 0xffff0000, v22
    v_mfma_f32_16x16x32_bf16 v[176:179], a[48:51], v[56:59], v[176:179]
    ds_read_b64_tr_b16 v[48:49], v10 offset:57344
    v_lshlrev_b32 v18, 16, v23
    v_mfma_f32_16x16x32_bf16 v[176:179], a[52:55], v[60:63], v[176:179]
    ds_read_b64_tr_b16 v[50:51], v10 offset:57856
    v_and_b32 v19, 0xffff0000, v23
    v_mfma_f32_16x16x32_bf16 v[180:183], a[116:119], v[60:63], v[180:183]
    v_lshlrev_b32 v20, 16, v24
    v_and_b32 v21, 0xffff0000, v24
    v_mfma_f32_16x16x32_bf16 v[180:183], a[112:115], v[56:59], v[180:183]
    v_lshlrev_b32 v22, 16, v25
    v_and_b32 v23, 0xffff0000, v25
    v_mfma_f32_16x16x32_bf16 v[184:187], a[176:179], v[56:59], v[184:187]
    ds_read_b64_tr_b16 v[52:53], v10 offset:61440
    v_lshlrev_b32 v24, 16, v26
    v_mfma_f32_16x16x32_bf16 v[184:187], a[180:183], v[60:63], v[184:187]
    ds_read_b64_tr_b16 v[54:55], v10 offset:61952
    v_and_b32 v25, 0xffff0000, v26
    v_mfma_f32_16x16x32_bf16 v[188:191], a[244:247], v[60:63], v[188:191]
    v_lshlrev_b32 v26, 16, v27
    v_and_b32 v27, 0xffff0000, v27
    v_mfma_f32_16x16x32_bf16 v[188:191], a[240:243], v[56:59], v[188:191]
    s_waitcnt lgkmcnt(8)
    v_mfma_f32_16x16x32_bf16 v[128:131], a[56:59], v[32:35], v[128:131]
    s_add_u32 s43, s80, s66
    ds_read_b64_tr_b16 v[56:57], v11 offset:57344
    buffer_load_dwordx4 a[200:203], v1, s[28:31], s43 offen offset:0 sc1
    v_mfma_f32_16x16x32_bf16 v[128:131], a[60:63], v[36:39], v[128:131]
    ds_read_b64_tr_b16 v[58:59], v11 offset:57856
    v_mfma_f32_16x16x32_bf16 v[132:135], a[124:127], v[36:39], v[132:135]
    v_mfma_f32_16x16x32_bf16 v[132:135], a[120:123], v[32:35], v[132:135]
    v_mfma_f32_16x16x32_bf16 v[136:139], a[184:187], v[32:35], v[136:139]
    ds_read_b64_tr_b16 v[60:61], v11 offset:61440
    v_mfma_f32_16x16x32_bf16 v[136:139], a[188:191], v[36:39], v[136:139]
    ds_read_b64_tr_b16 v[62:63], v11 offset:61952
    v_mfma_f32_16x16x32_bf16 v[140:143], a[252:255], v[36:39], v[140:143]
    v_mfma_f32_16x16x32_bf16 v[140:143], a[248:251], v[32:35], v[140:143]
    s_waitcnt lgkmcnt(8)
    v_mfma_f32_16x16x32_bf16 v[144:147], a[56:59], v[40:43], v[144:147]
    s_barrier
    ds_read_b64_tr_b16 v[32:33], v4 offset:0
    v_mfma_f32_16x16x32_bf16 v[144:147], a[60:63], v[44:47], v[144:147]
    ds_read_b64_tr_b16 v[34:35], v4 offset:512
    v_mfma_f32_16x16x32_bf16 v[148:151], a[124:127], v[44:47], v[148:151]
    v_mfma_f32_16x16x32_bf16 v[148:151], a[120:123], v[40:43], v[148:151]
    v_mfma_f32_16x16x32_bf16 v[152:155], a[184:187], v[40:43], v[152:155]
    ds_read_b64_tr_b16 v[36:37], v4 offset:4096
    v_mfma_f32_16x16x32_bf16 v[152:155], a[188:191], v[44:47], v[152:155]
    ds_read_b64_tr_b16 v[38:39], v4 offset:4608
    v_mfma_f32_16x16x32_bf16 v[156:159], a[252:255], v[44:47], v[156:159]
    buffer_load_dwordx4 a[204:207], v1, s[28:31], s43 offen offset:1024 sc1
    v_mfma_f32_16x16x32_bf16 v[156:159], a[248:251], v[40:43], v[156:159]
    s_waitcnt lgkmcnt(8)
    v_mfma_f32_16x16x32_bf16 v[160:163], a[56:59], v[48:51], v[160:163]
    ds_read_b64_tr_b16 v[40:41], v5 offset:0
    v_mfma_f32_16x16x32_bf16 v[160:163], a[60:63], v[52:55], v[160:163]
    ds_read_b64_tr_b16 v[42:43], v5 offset:512
    v_mfma_f32_16x16x32_bf16 v[164:167], a[124:127], v[52:55], v[164:167]
    v_mfma_f32_16x16x32_bf16 v[164:167], a[120:123], v[48:51], v[164:167]
    v_mfma_f32_16x16x32_bf16 v[168:171], a[184:187], v[48:51], v[168:171]
    ds_read_b64_tr_b16 v[44:45], v5 offset:4096
    v_mfma_f32_16x16x32_bf16 v[168:171], a[188:191], v[52:55], v[168:171]
    ds_read_b64_tr_b16 v[46:47], v5 offset:4608
    buffer_store_dwordx4 v[88:91], v1, s[20:23], s55 offen offset:1024 sc0 sc1
    v_mfma_f32_16x16x32_bf16 v[172:175], a[252:255], v[52:55], v[172:175]
    v_cvt_pk_bf16_f32 v104, v104, v105
    v_cvt_pk_bf16_f32 v105, v106, v107
    v_mfma_f32_16x16x32_bf16 v[172:175], a[248:251], v[48:51], v[172:175]
    s_waitcnt lgkmcnt(8)
    v_cvt_pk_bf16_f32 v106, v108, v109
    v_cvt_pk_bf16_f32 v107, v110, v111
    v_mfma_f32_16x16x32_bf16 v[176:179], a[56:59], v[56:59], v[176:179]
    ds_read_b64_tr_b16 v[48:49], v6 offset:0
    v_mfma_f32_16x16x32_bf16 v[176:179], a[60:63], v[60:63], v[176:179]
    ds_read_b64_tr_b16 v[50:51], v6 offset:512
    v_mfma_f32_16x16x32_bf16 v[180:183], a[124:127], v[60:63], v[180:183]
    buffer_store_dwordx4 v[104:107], v1, s[20:23], s55 offen offset:2048 sc0 sc1
    v_mfma_f32_16x16x32_bf16 v[180:183], a[120:123], v[56:59], v[180:183]
    v_cvt_pk_bf16_f32 v120, v120, v121
    v_cvt_pk_bf16_f32 v121, v122, v123
    v_mfma_f32_16x16x32_bf16 v[184:187], a[184:187], v[56:59], v[184:187]
    ds_read_b64_tr_b16 v[52:53], v6 offset:4096
    v_cvt_pk_bf16_f32 v122, v124, v125
    v_mfma_f32_16x16x32_bf16 v[184:187], a[188:191], v[60:63], v[184:187]
    ds_read_b64_tr_b16 v[54:55], v6 offset:4608
    v_cvt_pk_bf16_f32 v123, v126, v127
    v_mfma_f32_16x16x32_bf16 v[188:191], a[252:255], v[60:63], v[188:191]
    v_mfma_f32_16x16x32_bf16 v[188:191], a[248:251], v[56:59], v[188:191]
    s_waitcnt lgkmcnt(8)
    s_waitcnt vmcnt(13)
    buffer_store_dwordx4 v[120:123], v1, s[20:23], s55 offen offset:3072 sc0 sc1
    v_mfma_f32_16x16x32_bf16 v[64:67], v[32:35], a[0:3], v[12:15]
    s_add_u32 m0, s44, 32768
    ds_read_b64_tr_b16 v[56:57], v7 offset:0
    v_mfma_f32_16x16x32_bf16 v[64:67], v[36:39], a[4:7], v[64:67]
    s_mov_b32 s43, s59
    ds_read_b64_tr_b16 v[58:59], v7 offset:512
    buffer_load_dwordx4 v28, s[8:11], s43 offen offset:0 lds
    v_mfma_f32_16x16x32_bf16 v[68:71], v[36:39], a[68:71], v[12:15]
    v_mfma_f32_16x16x32_bf16 v[68:71], v[32:35], a[64:67], v[68:71]
    v_mfma_f32_16x16x32_bf16 v[72:75], v[32:35], a[128:131], v[12:15]
    ds_read_b64_tr_b16 v[60:61], v7 offset:4096
    v_mfma_f32_16x16x32_bf16 v[72:75], v[36:39], a[132:135], v[72:75]
    s_add_u32 s43, s43, s89
    ds_read_b64_tr_b16 v[62:63], v7 offset:4608
    v_mfma_f32_16x16x32_bf16 v[76:79], v[36:39], a[196:199], v[12:15]
    buffer_load_dwordx4 v29, s[8:11], s43 offen offset:1024 lds
    v_mfma_f32_16x16x32_bf16 v[76:79], v[32:35], a[192:195], v[76:79]
    s_waitcnt lgkmcnt(8)
    v_mfma_f32_16x16x32_bf16 v[80:83], v[40:43], a[0:3], v[16:19]
    ds_read_b64_tr_b16 v[32:33], v4 offset:8192
    v_cvt_pk_bf16_f32 v128, v128, v129
    v_mfma_f32_16x16x32_bf16 v[80:83], v[44:47], a[4:7], v[80:83]
    ds_read_b64_tr_b16 v[34:35], v4 offset:8704
    v_cvt_pk_bf16_f32 v129, v130, v131
    v_mfma_f32_16x16x32_bf16 v[84:87], v[44:47], a[68:71], v[16:19]
    s_add_u32 s43, s43, s89
    buffer_load_dwordx4 v28, s[8:11], s43 offen offset:2048 lds
    v_mfma_f32_16x16x32_bf16 v[84:87], v[40:43], a[64:67], v[84:87]
    v_cvt_pk_bf16_f32 v130, v132, v133
    v_cvt_pk_bf16_f32 v131, v134, v135
    v_mfma_f32_16x16x32_bf16 v[88:91], v[40:43], a[128:131], v[16:19]
    ds_read_b64_tr_b16 v[36:37], v4 offset:12288
    v_mfma_f32_16x16x32_bf16 v[88:91], v[44:47], a[132:135], v[88:91]
    ds_read_b64_tr_b16 v[38:39], v4 offset:12800
    v_mfma_f32_16x16x32_bf16 v[92:95], v[44:47], a[196:199], v[16:19]
    v_mfma_f32_16x16x32_bf16 v[92:95], v[40:43], a[192:195], v[92:95]
    s_waitcnt lgkmcnt(8)
    v_mfma_f32_16x16x32_bf16 v[96:99], v[48:51], a[0:3], v[20:23]
    s_add_u32 s43, s43, s89
    ds_read_b64_tr_b16 v[40:41], v5 offset:8192
    buffer_load_dwordx4 v29, s[8:11], s43 offen offset:3072 lds
    v_mfma_f32_16x16x32_bf16 v[96:99], v[52:55], a[4:7], v[96:99]
    ds_read_b64_tr_b16 v[42:43], v5 offset:8704
    v_mfma_f32_16x16x32_bf16 v[100:103], v[52:55], a[68:71], v[20:23]
    v_mfma_f32_16x16x32_bf16 v[100:103], v[48:51], a[64:67], v[100:103]
    v_mfma_f32_16x16x32_bf16 v[104:107], v[48:51], a[128:131], v[20:23]
    s_add_u32 s43, s77, s67
    ds_read_b64_tr_b16 v[44:45], v5 offset:12288
    v_mfma_f32_16x16x32_bf16 v[104:107], v[52:55], a[132:135], v[104:107]
    ds_read_b64_tr_b16 v[46:47], v5 offset:12800
    buffer_load_dwordx4 a[16:19], v1, s[28:31], s43 offen offset:0 sc1
    v_mfma_f32_16x16x32_bf16 v[108:111], v[52:55], a[196:199], v[20:23]
    v_mfma_f32_16x16x32_bf16 v[108:111], v[48:51], a[192:195], v[108:111]
    s_waitcnt lgkmcnt(8)
    v_mfma_f32_16x16x32_bf16 v[112:115], v[56:59], a[0:3], v[24:27]
    ds_read_b64_tr_b16 v[48:49], v6 offset:8192
    v_mfma_f32_16x16x32_bf16 v[112:115], v[60:63], a[4:7], v[112:115]
    ds_read_b64_tr_b16 v[50:51], v6 offset:8704
    v_mfma_f32_16x16x32_bf16 v[116:119], v[60:63], a[68:71], v[24:27]
    buffer_load_dwordx4 a[20:23], v1, s[28:31], s43 offen offset:1024 sc1
    v_mfma_f32_16x16x32_bf16 v[116:119], v[56:59], a[64:67], v[116:119]
    v_mfma_f32_16x16x32_bf16 v[120:123], v[56:59], a[128:131], v[24:27]
    ds_read_b64_tr_b16 v[52:53], v6 offset:12288
    v_mfma_f32_16x16x32_bf16 v[120:123], v[60:63], a[132:135], v[120:123]
    ds_read_b64_tr_b16 v[54:55], v6 offset:12800
    v_mfma_f32_16x16x32_bf16 v[124:127], v[60:63], a[196:199], v[24:27]
    v_mfma_f32_16x16x32_bf16 v[124:127], v[56:59], a[192:195], v[124:127]
    s_waitcnt lgkmcnt(8)
    v_mfma_f32_16x16x32_bf16 v[192:195], v[32:35], a[0:3], 0
    s_add_u32 s43, s78, s67
    ds_read_b64_tr_b16 v[56:57], v7 offset:8192
    buffer_load_dwordx4 a[80:83], v1, s[28:31], s43 offen offset:0 sc1
    v_mfma_f32_16x16x32_bf16 v[192:195], v[36:39], a[4:7], v[192:195]
    ds_read_b64_tr_b16 v[58:59], v7 offset:8704
    v_mfma_f32_16x16x32_bf16 v[196:199], v[36:39], a[68:71], 0
    v_mfma_f32_16x16x32_bf16 v[196:199], v[32:35], a[64:67], v[196:199]
    v_mfma_f32_16x16x32_bf16 v[200:203], v[32:35], a[128:131], 0
    ds_read_b64_tr_b16 v[60:61], v7 offset:12288
    v_mfma_f32_16x16x32_bf16 v[200:203], v[36:39], a[132:135], v[200:203]
    ds_read_b64_tr_b16 v[62:63], v7 offset:12800
    buffer_load_dwordx4 a[84:87], v1, s[28:31], s43 offen offset:1024 sc1
    v_mfma_f32_16x16x32_bf16 v[204:207], v[36:39], a[196:199], 0
    v_mfma_f32_16x16x32_bf16 v[204:207], v[32:35], a[192:195], v[204:207]
    s_waitcnt lgkmcnt(8)
    v_mfma_f32_16x16x32_bf16 v[208:211], v[40:43], a[0:3], 0
    s_barrier
    ds_read_b64_tr_b16 v[32:33], v4 offset:16384
    v_mfma_f32_16x16x32_bf16 v[208:211], v[44:47], a[4:7], v[208:211]
    s_add_u32 s43, s79, s67
    ds_read_b64_tr_b16 v[34:35], v4 offset:16896
    v_mfma_f32_16x16x32_bf16 v[212:215], v[44:47], a[68:71], 0
    buffer_load_dwordx4 a[144:147], v1, s[28:31], s43 offen offset:0 sc1
    v_mfma_f32_16x16x32_bf16 v[212:215], v[40:43], a[64:67], v[212:215]
    v_mfma_f32_16x16x32_bf16 v[216:219], v[40:43], a[128:131], 0
    ds_read_b64_tr_b16 v[36:37], v4 offset:20480
    v_mfma_f32_16x16x32_bf16 v[216:219], v[44:47], a[132:135], v[216:219]
    ds_read_b64_tr_b16 v[38:39], v4 offset:20992
    v_mfma_f32_16x16x32_bf16 v[220:223], v[44:47], a[196:199], 0
    buffer_load_dwordx4 a[148:151], v1, s[28:31], s43 offen offset:1024 sc1
    v_mfma_f32_16x16x32_bf16 v[220:223], v[40:43], a[192:195], v[220:223]
    s_waitcnt lgkmcnt(8)
    v_mfma_f32_16x16x32_bf16 v[224:227], v[48:51], a[0:3], 0
    ds_read_b64_tr_b16 v[40:41], v5 offset:16384
    v_mfma_f32_16x16x32_bf16 v[224:227], v[52:55], a[4:7], v[224:227]
    ds_read_b64_tr_b16 v[42:43], v5 offset:16896
    v_mfma_f32_16x16x32_bf16 v[228:231], v[52:55], a[68:71], 0
    v_mfma_f32_16x16x32_bf16 v[228:231], v[48:51], a[64:67], v[228:231]
    s_add_u32 s43, s80, s67
    buffer_load_dwordx4 a[208:211], v1, s[28:31], s43 offen offset:0 sc1
    v_mfma_f32_16x16x32_bf16 v[232:235], v[48:51], a[128:131], 0
    ds_read_b64_tr_b16 v[44:45], v5 offset:20480
    v_mfma_f32_16x16x32_bf16 v[232:235], v[52:55], a[132:135], v[232:235]
    ds_read_b64_tr_b16 v[46:47], v5 offset:20992
    v_mfma_f32_16x16x32_bf16 v[236:239], v[52:55], a[196:199], 0
    v_mfma_f32_16x16x32_bf16 v[236:239], v[48:51], a[192:195], v[236:239]
    s_waitcnt lgkmcnt(8)
    v_mfma_f32_16x16x32_bf16 v[240:243], v[56:59], a[0:3], 0
    ds_read_b64_tr_b16 v[48:49], v6 offset:16384
    buffer_load_dwordx4 a[212:215], v1, s[28:31], s43 offen offset:1024 sc1
    v_mfma_f32_16x16x32_bf16 v[240:243], v[60:63], a[4:7], v[240:243]
    ds_read_b64_tr_b16 v[50:51], v6 offset:16896
    v_mfma_f32_16x16x32_bf16 v[244:247], v[60:63], a[68:71], 0
    buffer_store_dwordx4 v[128:131], v1, s[20:23], s54 offen offset:0 sc0 sc1
    v_mfma_f32_16x16x32_bf16 v[244:247], v[56:59], a[64:67], v[244:247]
    v_cvt_pk_bf16_f32 v144, v144, v145
    v_cvt_pk_bf16_f32 v145, v146, v147
    v_mfma_f32_16x16x32_bf16 v[248:251], v[56:59], a[128:131], 0
    ds_read_b64_tr_b16 v[52:53], v6 offset:20480
    v_cvt_pk_bf16_f32 v146, v148, v149
    v_mfma_f32_16x16x32_bf16 v[248:251], v[60:63], a[132:135], v[248:251]
    ds_read_b64_tr_b16 v[54:55], v6 offset:20992
    v_cvt_pk_bf16_f32 v147, v150, v151
    v_mfma_f32_16x16x32_bf16 v[252:255], v[60:63], a[196:199], 0
    v_mfma_f32_16x16x32_bf16 v[252:255], v[56:59], a[192:195], v[252:255]
    s_waitcnt lgkmcnt(8)
    s_waitcnt vmcnt(16)
    buffer_store_dwordx4 v[144:147], v1, s[20:23], s54 offen offset:1024 sc0 sc1
    v_mfma_f32_16x16x32_bf16 v[64:67], v[32:35], a[8:11], v[64:67]
    s_add_u32 m0, s44, 49152
    ds_read_b64_tr_b16 v[56:57], v7 offset:16384
    v_cvt_pk_bf16_f32 v160, v160, v161
    v_mfma_f32_16x16x32_bf16 v[64:67], v[36:39], a[12:15], v[64:67]
    s_mov_b32 s43, s60
    ds_read_b64_tr_b16 v[58:59], v7 offset:16896
    buffer_load_dwordx4 v28, s[8:11], s43 offen offset:0 lds
    v_mfma_f32_16x16x32_bf16 v[68:71], v[36:39], a[76:79], v[68:71]
    v_cvt_pk_bf16_f32 v161, v162, v163
    v_cvt_pk_bf16_f32 v162, v164, v165
    v_mfma_f32_16x16x32_bf16 v[68:71], v[32:35], a[72:75], v[68:71]
    v_cvt_pk_bf16_f32 v163, v166, v167
    v_mfma_f32_16x16x32_bf16 v[72:75], v[32:35], a[136:139], v[72:75]
    ds_read_b64_tr_b16 v[60:61], v7 offset:20480
    v_mfma_f32_16x16x32_bf16 v[72:75], v[36:39], a[140:143], v[72:75]
    s_add_u32 s43, s43, s89
    ds_read_b64_tr_b16 v[62:63], v7 offset:20992
    v_mfma_f32_16x16x32_bf16 v[76:79], v[36:39], a[204:207], v[76:79]
    buffer_load_dwordx4 v29, s[8:11], s43 offen offset:1024 lds
    v_mfma_f32_16x16x32_bf16 v[76:79], v[32:35], a[200:203], v[76:79]
    s_waitcnt lgkmcnt(8)
    v_mfma_f32_16x16x32_bf16 v[80:83], v[40:43], a[8:11], v[80:83]
    ds_read_b64_tr_b16 v[32:33], v4 offset:24576
    v_mfma_f32_16x16x32_bf16 v[80:83], v[44:47], a[12:15], v[80:83]
    ds_read_b64_tr_b16 v[34:35], v4 offset:25088
    v_mfma_f32_16x16x32_bf16 v[84:87], v[44:47], a[76:79], v[84:87]
    s_add_u32 s43, s43, s89
    buffer_load_dwordx4 v28, s[8:11], s43 offen offset:2048 lds
    v_mfma_f32_16x16x32_bf16 v[84:87], v[40:43], a[72:75], v[84:87]
    v_mfma_f32_16x16x32_bf16 v[88:91], v[40:43], a[136:139], v[88:91]
    ds_read_b64_tr_b16 v[36:37], v4 offset:28672
    v_mfma_f32_16x16x32_bf16 v[88:91], v[44:47], a[140:143], v[88:91]
    ds_read_b64_tr_b16 v[38:39], v4 offset:29184
    v_mfma_f32_16x16x32_bf16 v[92:95], v[44:47], a[204:207], v[92:95]
    v_mfma_f32_16x16x32_bf16 v[92:95], v[40:43], a[200:203], v[92:95]
    s_waitcnt lgkmcnt(8)
    v_mfma_f32_16x16x32_bf16 v[96:99], v[48:51], a[8:11], v[96:99]
    s_add_u32 s43, s43, s89
    ds_read_b64_tr_b16 v[40:41], v5 offset:24576
    buffer_load_dwordx4 v29, s[8:11], s43 offen offset:3072 lds
    v_mfma_f32_16x16x32_bf16 v[96:99], v[52:55], a[12:15], v[96:99]
    ds_read_b64_tr_b16 v[42:43], v5 offset:25088
    v_mfma_f32_16x16x32_bf16 v[100:103], v[52:55], a[76:79], v[100:103]
    v_mfma_f32_16x16x32_bf16 v[100:103], v[48:51], a[72:75], v[100:103]
    v_mfma_f32_16x16x32_bf16 v[104:107], v[48:51], a[136:139], v[104:107]
    s_add_u32 s43, s77, s68
    ds_read_b64_tr_b16 v[44:45], v5 offset:28672
    v_mfma_f32_16x16x32_bf16 v[104:107], v[52:55], a[140:143], v[104:107]
    ds_read_b64_tr_b16 v[46:47], v5 offset:29184
    buffer_load_dwordx4 a[24:27], v1, s[28:31], s43 offen offset:0 sc1
    v_mfma_f32_16x16x32_bf16 v[108:111], v[52:55], a[204:207], v[108:111]
    v_mfma_f32_16x16x32_bf16 v[108:111], v[48:51], a[200:203], v[108:111]
    s_waitcnt lgkmcnt(8)
    v_mfma_f32_16x16x32_bf16 v[112:115], v[56:59], a[8:11], v[112:115]
    ds_read_b64_tr_b16 v[48:49], v6 offset:24576
    v_mfma_f32_16x16x32_bf16 v[112:115], v[60:63], a[12:15], v[112:115]
    ds_read_b64_tr_b16 v[50:51], v6 offset:25088
    v_mfma_f32_16x16x32_bf16 v[116:119], v[60:63], a[76:79], v[116:119]
    buffer_load_dwordx4 a[28:31], v1, s[28:31], s43 offen offset:1024 sc1
    v_mfma_f32_16x16x32_bf16 v[116:119], v[56:59], a[72:75], v[116:119]
    v_mfma_f32_16x16x32_bf16 v[120:123], v[56:59], a[136:139], v[120:123]
    ds_read_b64_tr_b16 v[52:53], v6 offset:28672
    v_mfma_f32_16x16x32_bf16 v[120:123], v[60:63], a[140:143], v[120:123]
    ds_read_b64_tr_b16 v[54:55], v6 offset:29184
    v_mfma_f32_16x16x32_bf16 v[124:127], v[60:63], a[204:207], v[124:127]
    v_mfma_f32_16x16x32_bf16 v[124:127], v[56:59], a[200:203], v[124:127]
    s_waitcnt lgkmcnt(8)
    v_mfma_f32_16x16x32_bf16 v[192:195], v[32:35], a[8:11], v[192:195]
    s_add_u32 s43, s78, s68
    ds_read_b64_tr_b16 v[56:57], v7 offset:24576
    buffer_load_dwordx4 a[88:91], v1, s[28:31], s43 offen offset:0 sc1
    v_mfma_f32_16x16x32_bf16 v[192:195], v[36:39], a[12:15], v[192:195]
    ds_read_b64_tr_b16 v[58:59], v7 offset:25088
    v_mfma_f32_16x16x32_bf16 v[196:199], v[36:39], a[76:79], v[196:199]
    v_mfma_f32_16x16x32_bf16 v[196:199], v[32:35], a[72:75], v[196:199]
    v_mfma_f32_16x16x32_bf16 v[200:203], v[32:35], a[136:139], v[200:203]
    ds_read_b64_tr_b16 v[60:61], v7 offset:28672
    v_mfma_f32_16x16x32_bf16 v[200:203], v[36:39], a[140:143], v[200:203]
    ds_read_b64_tr_b16 v[62:63], v7 offset:29184
    buffer_load_dwordx4 a[92:95], v1, s[28:31], s43 offen offset:1024 sc1
    v_mfma_f32_16x16x32_bf16 v[204:207], v[36:39], a[204:207], v[204:207]
    v_mfma_f32_16x16x32_bf16 v[204:207], v[32:35], a[200:203], v[204:207]
    s_waitcnt lgkmcnt(8)
    v_mfma_f32_16x16x32_bf16 v[208:211], v[40:43], a[8:11], v[208:211]
    s_waitcnt vmcnt(18)
    s_barrier
    ds_read_b64_tr_b16 v[32:33], v4 offset:32768
    v_mfma_f32_16x16x32_bf16 v[208:211], v[44:47], a[12:15], v[208:211]
    s_add_u32 s43, s79, s68
    ds_read_b64_tr_b16 v[34:35], v4 offset:33280
    v_mfma_f32_16x16x32_bf16 v[212:215], v[44:47], a[76:79], v[212:215]
    buffer_load_dwordx4 a[152:155], v1, s[28:31], s43 offen offset:0 sc1
    v_mfma_f32_16x16x32_bf16 v[212:215], v[40:43], a[72:75], v[212:215]
    v_mfma_f32_16x16x32_bf16 v[216:219], v[40:43], a[136:139], v[216:219]
    ds_read_b64_tr_b16 v[36:37], v4 offset:36864
    v_mfma_f32_16x16x32_bf16 v[216:219], v[44:47], a[140:143], v[216:219]
    ds_read_b64_tr_b16 v[38:39], v4 offset:37376
    v_mfma_f32_16x16x32_bf16 v[220:223], v[44:47], a[204:207], v[220:223]
    buffer_load_dwordx4 a[156:159], v1, s[28:31], s43 offen offset:1024 sc1
    v_mfma_f32_16x16x32_bf16 v[220:223], v[40:43], a[200:203], v[220:223]
    s_waitcnt lgkmcnt(8)
    v_mfma_f32_16x16x32_bf16 v[224:227], v[48:51], a[8:11], v[224:227]
    ds_read_b64_tr_b16 v[40:41], v5 offset:32768
    v_mfma_f32_16x16x32_bf16 v[224:227], v[52:55], a[12:15], v[224:227]
    ds_read_b64_tr_b16 v[42:43], v5 offset:33280
    v_mfma_f32_16x16x32_bf16 v[228:231], v[52:55], a[76:79], v[228:231]
    v_mfma_f32_16x16x32_bf16 v[228:231], v[48:51], a[72:75], v[228:231]
    s_add_u32 s43, s80, s68
    buffer_load_dwordx4 a[216:219], v1, s[28:31], s43 offen offset:0 sc1
    v_mfma_f32_16x16x32_bf16 v[232:235], v[48:51], a[136:139], v[232:235]
    ds_read_b64_tr_b16 v[44:45], v5 offset:36864
    v_mfma_f32_16x16x32_bf16 v[232:235], v[52:55], a[140:143], v[232:235]
    ds_read_b64_tr_b16 v[46:47], v5 offset:37376
    v_mfma_f32_16x16x32_bf16 v[236:239], v[52:55], a[204:207], v[236:239]
    v_mfma_f32_16x16x32_bf16 v[236:239], v[48:51], a[200:203], v[236:239]
    s_waitcnt lgkmcnt(8)
    v_mfma_f32_16x16x32_bf16 v[240:243], v[56:59], a[8:11], v[240:243]
    ds_read_b64_tr_b16 v[48:49], v6 offset:32768
    buffer_load_dwordx4 a[220:223], v1, s[28:31], s43 offen offset:1024 sc1
    v_mfma_f32_16x16x32_bf16 v[240:243], v[60:63], a[12:15], v[240:243]
    ds_read_b64_tr_b16 v[50:51], v6 offset:33280
    v_mfma_f32_16x16x32_bf16 v[244:247], v[60:63], a[76:79], v[244:247]
    buffer_store_dwordx4 v[160:163], v1, s[20:23], s54 offen offset:2048 sc0 sc1
    v_mfma_f32_16x16x32_bf16 v[244:247], v[56:59], a[72:75], v[244:247]
    v_cvt_pk_bf16_f32 v176, v176, v177
    v_cvt_pk_bf16_f32 v177, v178, v179
    v_mfma_f32_16x16x32_bf16 v[248:251], v[56:59], a[136:139], v[248:251]
    ds_read_b64_tr_b16 v[52:53], v6 offset:36864
    v_cvt_pk_bf16_f32 v178, v180, v181
    v_mfma_f32_16x16x32_bf16 v[248:251], v[60:63], a[140:143], v[248:251]
    ds_read_b64_tr_b16 v[54:55], v6 offset:37376
    v_cvt_pk_bf16_f32 v179, v182, v183
    v_mfma_f32_16x16x32_bf16 v[252:255], v[60:63], a[204:207], v[252:255]
    v_mfma_f32_16x16x32_bf16 v[252:255], v[56:59], a[200:203], v[252:255]
    s_waitcnt lgkmcnt(8)
    s_waitcnt vmcnt(15)
    buffer_store_dwordx4 v[176:179], v1, s[20:23], s54 offen offset:3072 sc0 sc1
    v_mfma_f32_16x16x32_bf16 v[64:67], v[32:35], a[16:19], v[64:67]
    s_add_u32 m0, s44, 0
    ds_read_b64_tr_b16 v[56:57], v7 offset:32768
    v_cvt_pk_bf16_f32 v136, v136, v137
    v_mfma_f32_16x16x32_bf16 v[64:67], v[36:39], a[20:23], v[64:67]
    s_mov_b32 s43, s61
    ds_read_b64_tr_b16 v[58:59], v7 offset:33280
    buffer_load_dwordx4 v28, s[8:11], s43 offen offset:0 lds
    v_mfma_f32_16x16x32_bf16 v[68:71], v[36:39], a[84:87], v[68:71]
    v_cvt_pk_bf16_f32 v137, v138, v139
    v_cvt_pk_bf16_f32 v138, v140, v141
    v_mfma_f32_16x16x32_bf16 v[68:71], v[32:35], a[80:83], v[68:71]
    v_cvt_pk_bf16_f32 v139, v142, v143
    v_mfma_f32_16x16x32_bf16 v[72:75], v[32:35], a[144:147], v[72:75]
    ds_read_b64_tr_b16 v[60:61], v7 offset:36864
    v_mfma_f32_16x16x32_bf16 v[72:75], v[36:39], a[148:151], v[72:75]
    s_add_u32 s43, s43, s89
    ds_read_b64_tr_b16 v[62:63], v7 offset:37376
    v_mfma_f32_16x16x32_bf16 v[76:79], v[36:39], a[212:215], v[76:79]
    buffer_load_dwordx4 v29, s[8:11], s43 offen offset:1024 lds
    v_mfma_f32_16x16x32_bf16 v[76:79], v[32:35], a[208:211], v[76:79]
    s_waitcnt lgkmcnt(8)
    v_mfma_f32_16x16x32_bf16 v[80:83], v[40:43], a[16:19], v[80:83]
    ds_read_b64_tr_b16 v[32:33], v4 offset:40960
    v_mfma_f32_16x16x32_bf16 v[80:83], v[44:47], a[20:23], v[80:83]
    ds_read_b64_tr_b16 v[34:35], v4 offset:41472
    v_mfma_f32_16x16x32_bf16 v[84:87], v[44:47], a[84:87], v[84:87]
    s_add_u32 s43, s43, s89
    buffer_load_dwordx4 v28, s[8:11], s43 offen offset:2048 lds
    v_mfma_f32_16x16x32_bf16 v[84:87], v[40:43], a[80:83], v[84:87]
    v_mfma_f32_16x16x32_bf16 v[88:91], v[40:43], a[144:147], v[88:91]
    ds_read_b64_tr_b16 v[36:37], v4 offset:45056
    v_mfma_f32_16x16x32_bf16 v[88:91], v[44:47], a[148:151], v[88:91]
    ds_read_b64_tr_b16 v[38:39], v4 offset:45568
    v_mfma_f32_16x16x32_bf16 v[92:95], v[44:47], a[212:215], v[92:95]
    v_mfma_f32_16x16x32_bf16 v[92:95], v[40:43], a[208:211], v[92:95]
    s_waitcnt lgkmcnt(8)
    v_mfma_f32_16x16x32_bf16 v[96:99], v[48:51], a[16:19], v[96:99]
    s_add_u32 s43, s43, s89
    ds_read_b64_tr_b16 v[40:41], v5 offset:40960
    buffer_load_dwordx4 v29, s[8:11], s43 offen offset:3072 lds
    v_mfma_f32_16x16x32_bf16 v[96:99], v[52:55], a[20:23], v[96:99]
    ds_read_b64_tr_b16 v[42:43], v5 offset:41472
    v_mfma_f32_16x16x32_bf16 v[100:103], v[52:55], a[84:87], v[100:103]
    v_mfma_f32_16x16x32_bf16 v[100:103], v[48:51], a[80:83], v[100:103]
    v_mfma_f32_16x16x32_bf16 v[104:107], v[48:51], a[144:147], v[104:107]
    s_add_u32 s43, s77, s69
    ds_read_b64_tr_b16 v[44:45], v5 offset:45056
    v_mfma_f32_16x16x32_bf16 v[104:107], v[52:55], a[148:151], v[104:107]
    ds_read_b64_tr_b16 v[46:47], v5 offset:45568
    buffer_load_dwordx4 a[32:35], v1, s[28:31], s43 offen offset:0 sc1
    v_mfma_f32_16x16x32_bf16 v[108:111], v[52:55], a[212:215], v[108:111]
    v_mfma_f32_16x16x32_bf16 v[108:111], v[48:51], a[208:211], v[108:111]
    s_waitcnt lgkmcnt(8)
    v_mfma_f32_16x16x32_bf16 v[112:115], v[56:59], a[16:19], v[112:115]
    ds_read_b64_tr_b16 v[48:49], v6 offset:40960
    v_mfma_f32_16x16x32_bf16 v[112:115], v[60:63], a[20:23], v[112:115]
    ds_read_b64_tr_b16 v[50:51], v6 offset:41472
    v_mfma_f32_16x16x32_bf16 v[116:119], v[60:63], a[84:87], v[116:119]
    buffer_load_dwordx4 a[36:39], v1, s[28:31], s43 offen offset:1024 sc1
    v_mfma_f32_16x16x32_bf16 v[116:119], v[56:59], a[80:83], v[116:119]
    v_mfma_f32_16x16x32_bf16 v[120:123], v[56:59], a[144:147], v[120:123]
    ds_read_b64_tr_b16 v[52:53], v6 offset:45056
    v_mfma_f32_16x16x32_bf16 v[120:123], v[60:63], a[148:151], v[120:123]
    ds_read_b64_tr_b16 v[54:55], v6 offset:45568
    v_mfma_f32_16x16x32_bf16 v[124:127], v[60:63], a[212:215], v[124:127]
    v_mfma_f32_16x16x32_bf16 v[124:127], v[56:59], a[208:211], v[124:127]
    s_waitcnt lgkmcnt(8)
    v_mfma_f32_16x16x32_bf16 v[192:195], v[32:35], a[16:19], v[192:195]
    s_add_u32 s43, s78, s69
    ds_read_b64_tr_b16 v[56:57], v7 offset:40960
    buffer_load_dwordx4 a[96:99], v1, s[28:31], s43 offen offset:0 sc1
    v_mfma_f32_16x16x32_bf16 v[192:195], v[36:39], a[20:23], v[192:195]
    ds_read_b64_tr_b16 v[58:59], v7 offset:41472
    v_mfma_f32_16x16x32_bf16 v[196:199], v[36:39], a[84:87], v[196:199]
    v_mfma_f32_16x16x32_bf16 v[196:199], v[32:35], a[80:83], v[196:199]
    v_mfma_f32_16x16x32_bf16 v[200:203], v[32:35], a[144:147], v[200:203]
    ds_read_b64_tr_b16 v[60:61], v7 offset:45056
    v_mfma_f32_16x16x32_bf16 v[200:203], v[36:39], a[148:151], v[200:203]
    ds_read_b64_tr_b16 v[62:63], v7 offset:45568
    buffer_load_dwordx4 a[100:103], v1, s[28:31], s43 offen offset:1024 sc1
    v_mfma_f32_16x16x32_bf16 v[204:207], v[36:39], a[212:215], v[204:207]
    v_mfma_f32_16x16x32_bf16 v[204:207], v[32:35], a[208:211], v[204:207]
    s_waitcnt lgkmcnt(8)
    v_mfma_f32_16x16x32_bf16 v[208:211], v[40:43], a[16:19], v[208:211]
    s_waitcnt vmcnt(18)
    s_barrier
    ds_read_b64_tr_b16 v[32:33], v4 offset:49152
    v_mfma_f32_16x16x32_bf16 v[208:211], v[44:47], a[20:23], v[208:211]
    s_add_u32 s43, s79, s69
    ds_read_b64_tr_b16 v[34:35], v4 offset:49664
    v_mfma_f32_16x16x32_bf16 v[212:215], v[44:47], a[84:87], v[212:215]
    buffer_load_dwordx4 a[160:163], v1, s[28:31], s43 offen offset:0 sc1
    v_mfma_f32_16x16x32_bf16 v[212:215], v[40:43], a[80:83], v[212:215]
    v_mfma_f32_16x16x32_bf16 v[216:219], v[40:43], a[144:147], v[216:219]
    ds_read_b64_tr_b16 v[36:37], v4 offset:53248
    v_mfma_f32_16x16x32_bf16 v[216:219], v[44:47], a[148:151], v[216:219]
    ds_read_b64_tr_b16 v[38:39], v4 offset:53760
    v_mfma_f32_16x16x32_bf16 v[220:223], v[44:47], a[212:215], v[220:223]
    buffer_load_dwordx4 a[164:167], v1, s[28:31], s43 offen offset:1024 sc1
    v_mfma_f32_16x16x32_bf16 v[220:223], v[40:43], a[208:211], v[220:223]
    s_waitcnt lgkmcnt(8)
    v_mfma_f32_16x16x32_bf16 v[224:227], v[48:51], a[16:19], v[224:227]
    ds_read_b64_tr_b16 v[40:41], v5 offset:49152
    v_mfma_f32_16x16x32_bf16 v[224:227], v[52:55], a[20:23], v[224:227]
    ds_read_b64_tr_b16 v[42:43], v5 offset:49664
    v_mfma_f32_16x16x32_bf16 v[228:231], v[52:55], a[84:87], v[228:231]
    v_mfma_f32_16x16x32_bf16 v[228:231], v[48:51], a[80:83], v[228:231]
    s_add_u32 s43, s80, s69
    buffer_load_dwordx4 a[224:227], v1, s[28:31], s43 offen offset:0 sc1
    v_mfma_f32_16x16x32_bf16 v[232:235], v[48:51], a[144:147], v[232:235]
    ds_read_b64_tr_b16 v[44:45], v5 offset:53248
    v_mfma_f32_16x16x32_bf16 v[232:235], v[52:55], a[148:151], v[232:235]
    ds_read_b64_tr_b16 v[46:47], v5 offset:53760
    v_mfma_f32_16x16x32_bf16 v[236:239], v[52:55], a[212:215], v[236:239]
    v_mfma_f32_16x16x32_bf16 v[236:239], v[48:51], a[208:211], v[236:239]
    s_waitcnt lgkmcnt(8)
    v_mfma_f32_16x16x32_bf16 v[240:243], v[56:59], a[16:19], v[240:243]
    ds_read_b64_tr_b16 v[48:49], v6 offset:49152
    buffer_load_dwordx4 a[228:231], v1, s[28:31], s43 offen offset:1024 sc1
    v_mfma_f32_16x16x32_bf16 v[240:243], v[60:63], a[20:23], v[240:243]
    ds_read_b64_tr_b16 v[50:51], v6 offset:49664
    v_mfma_f32_16x16x32_bf16 v[244:247], v[60:63], a[84:87], v[244:247]
    buffer_store_dwordx4 v[136:139], v1, s[20:23], s56 offen offset:0 sc0 sc1
    v_mfma_f32_16x16x32_bf16 v[244:247], v[56:59], a[80:83], v[244:247]
    v_cvt_pk_bf16_f32 v152, v152, v153
    v_cvt_pk_bf16_f32 v153, v154, v155
    v_mfma_f32_16x16x32_bf16 v[248:251], v[56:59], a[144:147], v[248:251]
    ds_read_b64_tr_b16 v[52:53], v6 offset:53248
    v_cvt_pk_bf16_f32 v154, v156, v157
    v_mfma_f32_16x16x32_bf16 v[248:251], v[60:63], a[148:151], v[248:251]
    ds_read_b64_tr_b16 v[54:55], v6 offset:53760
    v_cvt_pk_bf16_f32 v155, v158, v159
    v_mfma_f32_16x16x32_bf16 v[252:255], v[60:63], a[212:215], v[252:255]
    v_mfma_f32_16x16x32_bf16 v[252:255], v[56:59], a[208:211], v[252:255]
    s_waitcnt lgkmcnt(8)
    s_waitcnt vmcnt(15)
    buffer_store_dwordx4 v[152:155], v1, s[20:23], s56 offen offset:1024 sc0 sc1
    v_mfma_f32_16x16x32_bf16 v[64:67], v[32:35], a[24:27], v[64:67]
    s_add_u32 m0, s44, 16384
    ds_read_b64_tr_b16 v[56:57], v7 offset:49152
    v_cvt_pk_bf16_f32 v168, v168, v169
    v_mfma_f32_16x16x32_bf16 v[64:67], v[36:39], a[28:31], v[64:67]
    s_mov_b32 s43, s62
    ds_read_b64_tr_b16 v[58:59], v7 offset:49664
    buffer_load_dwordx4 v28, s[8:11], s43 offen offset:0 lds
    v_mfma_f32_16x16x32_bf16 v[68:71], v[36:39], a[92:95], v[68:71]
    v_cvt_pk_bf16_f32 v169, v170, v171
    v_cvt_pk_bf16_f32 v170, v172, v173
    v_mfma_f32_16x16x32_bf16 v[68:71], v[32:35], a[88:91], v[68:71]
    v_cvt_pk_bf16_f32 v171, v174, v175
    v_mfma_f32_16x16x32_bf16 v[72:75], v[32:35], a[152:155], v[72:75]
    ds_read_b64_tr_b16 v[60:61], v7 offset:53248
    v_mfma_f32_16x16x32_bf16 v[72:75], v[36:39], a[156:159], v[72:75]
    s_add_u32 s43, s43, s89
    ds_read_b64_tr_b16 v[62:63], v7 offset:53760
    v_mfma_f32_16x16x32_bf16 v[76:79], v[36:39], a[220:223], v[76:79]
    buffer_load_dwordx4 v29, s[8:11], s43 offen offset:1024 lds
    v_mfma_f32_16x16x32_bf16 v[76:79], v[32:35], a[216:219], v[76:79]
    s_waitcnt lgkmcnt(8)
    v_mfma_f32_16x16x32_bf16 v[80:83], v[40:43], a[24:27], v[80:83]
    ds_read_b64_tr_b16 v[32:33], v4 offset:57344
    v_mfma_f32_16x16x32_bf16 v[80:83], v[44:47], a[28:31], v[80:83]
    ds_read_b64_tr_b16 v[34:35], v4 offset:57856
    v_mfma_f32_16x16x32_bf16 v[84:87], v[44:47], a[92:95], v[84:87]
    s_add_u32 s43, s43, s89
    buffer_load_dwordx4 v28, s[8:11], s43 offen offset:2048 lds
    v_mfma_f32_16x16x32_bf16 v[84:87], v[40:43], a[88:91], v[84:87]
    v_mfma_f32_16x16x32_bf16 v[88:91], v[40:43], a[152:155], v[88:91]
    ds_read_b64_tr_b16 v[36:37], v4 offset:61440
    v_mfma_f32_16x16x32_bf16 v[88:91], v[44:47], a[156:159], v[88:91]
    ds_read_b64_tr_b16 v[38:39], v4 offset:61952
    v_mfma_f32_16x16x32_bf16 v[92:95], v[44:47], a[220:223], v[92:95]
    v_mfma_f32_16x16x32_bf16 v[92:95], v[40:43], a[216:219], v[92:95]
    s_waitcnt lgkmcnt(8)
    v_mfma_f32_16x16x32_bf16 v[96:99], v[48:51], a[24:27], v[96:99]
    s_add_u32 s43, s43, s89
    ds_read_b64_tr_b16 v[40:41], v5 offset:57344
    buffer_load_dwordx4 v29, s[8:11], s43 offen offset:3072 lds
    v_mfma_f32_16x16x32_bf16 v[96:99], v[52:55], a[28:31], v[96:99]
    ds_read_b64_tr_b16 v[42:43], v5 offset:57856
    v_mfma_f32_16x16x32_bf16 v[100:103], v[52:55], a[92:95], v[100:103]
    v_mfma_f32_16x16x32_bf16 v[100:103], v[48:51], a[88:91], v[100:103]
    v_mfma_f32_16x16x32_bf16 v[104:107], v[48:51], a[152:155], v[104:107]
    s_add_u32 s43, s77, s70
    ds_read_b64_tr_b16 v[44:45], v5 offset:61440
    v_mfma_f32_16x16x32_bf16 v[104:107], v[52:55], a[156:159], v[104:107]
    ds_read_b64_tr_b16 v[46:47], v5 offset:61952
    buffer_load_dwordx4 a[40:43], v1, s[28:31], s43 offen offset:0 sc1
    v_mfma_f32_16x16x32_bf16 v[108:111], v[52:55], a[220:223], v[108:111]
    v_mfma_f32_16x16x32_bf16 v[108:111], v[48:51], a[216:219], v[108:111]
    s_waitcnt lgkmcnt(8)
    v_mfma_f32_16x16x32_bf16 v[112:115], v[56:59], a[24:27], v[112:115]
    ds_read_b64_tr_b16 v[48:49], v6 offset:57344
    v_mfma_f32_16x16x32_bf16 v[112:115], v[60:63], a[28:31], v[112:115]
    ds_read_b64_tr_b16 v[50:51], v6 offset:57856
    v_mfma_f32_16x16x32_bf16 v[116:119], v[60:63], a[92:95], v[116:119]
    buffer_load_dwordx4 a[44:47], v1, s[28:31], s43 offen offset:1024 sc1
    v_mfma_f32_16x16x32_bf16 v[116:119], v[56:59], a[88:91], v[116:119]
    v_mfma_f32_16x16x32_bf16 v[120:123], v[56:59], a[152:155], v[120:123]
    ds_read_b64_tr_b16 v[52:53], v6 offset:61440
    v_mfma_f32_16x16x32_bf16 v[120:123], v[60:63], a[156:159], v[120:123]
    ds_read_b64_tr_b16 v[54:55], v6 offset:61952
    v_mfma_f32_16x16x32_bf16 v[124:127], v[60:63], a[220:223], v[124:127]
    v_mfma_f32_16x16x32_bf16 v[124:127], v[56:59], a[216:219], v[124:127]
    s_waitcnt lgkmcnt(8)
    v_mfma_f32_16x16x32_bf16 v[192:195], v[32:35], a[24:27], v[192:195]
    s_add_u32 s43, s78, s70
    ds_read_b64_tr_b16 v[56:57], v7 offset:57344
    buffer_load_dwordx4 a[104:107], v1, s[28:31], s43 offen offset:0 sc1
    v_mfma_f32_16x16x32_bf16 v[192:195], v[36:39], a[28:31], v[192:195]
    ds_read_b64_tr_b16 v[58:59], v7 offset:57856
    v_mfma_f32_16x16x32_bf16 v[196:199], v[36:39], a[92:95], v[196:199]
    v_mfma_f32_16x16x32_bf16 v[196:199], v[32:35], a[88:91], v[196:199]
    v_mfma_f32_16x16x32_bf16 v[200:203], v[32:35], a[152:155], v[200:203]
    ds_read_b64_tr_b16 v[60:61], v7 offset:61440
    v_mfma_f32_16x16x32_bf16 v[200:203], v[36:39], a[156:159], v[200:203]
    ds_read_b64_tr_b16 v[62:63], v7 offset:61952
    buffer_load_dwordx4 a[108:111], v1, s[28:31], s43 offen offset:1024 sc1
    v_mfma_f32_16x16x32_bf16 v[204:207], v[36:39], a[220:223], v[204:207]
    v_mfma_f32_16x16x32_bf16 v[204:207], v[32:35], a[216:219], v[204:207]
    s_waitcnt lgkmcnt(8)
    v_mfma_f32_16x16x32_bf16 v[208:211], v[40:43], a[24:27], v[208:211]
    s_waitcnt vmcnt(18)
    s_barrier
    ds_read_b64_tr_b16 v[32:33], v4 offset:0
    v_mfma_f32_16x16x32_bf16 v[208:211], v[44:47], a[28:31], v[208:211]
    s_add_u32 s43, s79, s70
    ds_read_b64_tr_b16 v[34:35], v4 offset:512
    v_mfma_f32_16x16x32_bf16 v[212:215], v[44:47], a[92:95], v[212:215]
    buffer_load_dwordx4 a[168:171], v1, s[28:31], s43 offen offset:0 sc1
    v_mfma_f32_16x16x32_bf16 v[212:215], v[40:43], a[88:91], v[212:215]
    v_mfma_f32_16x16x32_bf16 v[216:219], v[40:43], a[152:155], v[216:219]
    ds_read_b64_tr_b16 v[36:37], v4 offset:4096
    v_mfma_f32_16x16x32_bf16 v[216:219], v[44:47], a[156:159], v[216:219]
    ds_read_b64_tr_b16 v[38:39], v4 offset:4608
    v_mfma_f32_16x16x32_bf16 v[220:223], v[44:47], a[220:223], v[220:223]
    buffer_load_dwordx4 a[172:175], v1, s[28:31], s43 offen offset:1024 sc1
    v_mfma_f32_16x16x32_bf16 v[220:223], v[40:43], a[216:219], v[220:223]
    s_waitcnt lgkmcnt(8)
    v_mfma_f32_16x16x32_bf16 v[224:227], v[48:51], a[24:27], v[224:227]
    ds_read_b64_tr_b16 v[40:41], v5 offset:0
    v_mfma_f32_16x16x32_bf16 v[224:227], v[52:55], a[28:31], v[224:227]
    ds_read_b64_tr_b16 v[42:43], v5 offset:512
    v_mfma_f32_16x16x32_bf16 v[228:231], v[52:55], a[92:95], v[228:231]
    v_mfma_f32_16x16x32_bf16 v[228:231], v[48:51], a[88:91], v[228:231]
    s_add_u32 s43, s80, s70
    buffer_load_dwordx4 a[232:235], v1, s[28:31], s43 offen offset:0 sc1
    v_mfma_f32_16x16x32_bf16 v[232:235], v[48:51], a[152:155], v[232:235]
    ds_read_b64_tr_b16 v[44:45], v5 offset:4096
    v_mfma_f32_16x16x32_bf16 v[232:235], v[52:55], a[156:159], v[232:235]
    ds_read_b64_tr_b16 v[46:47], v5 offset:4608
    v_mfma_f32_16x16x32_bf16 v[236:239], v[52:55], a[220:223], v[236:239]
    v_mfma_f32_16x16x32_bf16 v[236:239], v[48:51], a[216:219], v[236:239]
    s_waitcnt lgkmcnt(8)
    v_mfma_f32_16x16x32_bf16 v[240:243], v[56:59], a[24:27], v[240:243]
    ds_read_b64_tr_b16 v[48:49], v6 offset:0
    buffer_load_dwordx4 a[236:239], v1, s[28:31], s43 offen offset:1024 sc1
    v_mfma_f32_16x16x32_bf16 v[240:243], v[60:63], a[28:31], v[240:243]
    ds_read_b64_tr_b16 v[50:51], v6 offset:512
    v_mfma_f32_16x16x32_bf16 v[244:247], v[60:63], a[92:95], v[244:247]
    buffer_store_dwordx4 v[168:171], v1, s[20:23], s56 offen offset:2048 sc0 sc1
    v_mfma_f32_16x16x32_bf16 v[244:247], v[56:59], a[88:91], v[244:247]
    v_cvt_pk_bf16_f32 v184, v184, v185
    v_cvt_pk_bf16_f32 v185, v186, v187
    v_mfma_f32_16x16x32_bf16 v[248:251], v[56:59], a[152:155], v[248:251]
    ds_read_b64_tr_b16 v[52:53], v6 offset:4096
    v_cvt_pk_bf16_f32 v186, v188, v189
    v_mfma_f32_16x16x32_bf16 v[248:251], v[60:63], a[156:159], v[248:251]
    ds_read_b64_tr_b16 v[54:55], v6 offset:4608
    v_cvt_pk_bf16_f32 v187, v190, v191
    v_mfma_f32_16x16x32_bf16 v[252:255], v[60:63], a[220:223], v[252:255]
    v_mfma_f32_16x16x32_bf16 v[252:255], v[56:59], a[216:219], v[252:255]
    s_waitcnt lgkmcnt(8)
    s_waitcnt vmcnt(15)
    buffer_store_dwordx4 v[184:187], v1, s[20:23], s56 offen offset:3072 sc0 sc1
    v_mfma_f32_16x16x32_bf16 v[64:67], v[32:35], a[32:35], v[64:67]
    s_add_u32 m0, s44, 32768
    ds_read_b64_tr_b16 v[56:57], v7 offset:0
    v_mfma_f32_16x16x32_bf16 v[64:67], v[36:39], a[36:39], v[64:67]
    s_mov_b32 s43, s63
    ds_read_b64_tr_b16 v[58:59], v7 offset:512
    buffer_load_dwordx4 v28, s[8:11], s43 offen offset:0 lds
    v_mfma_f32_16x16x32_bf16 v[68:71], v[36:39], a[100:103], v[68:71]
    v_mfma_f32_16x16x32_bf16 v[68:71], v[32:35], a[96:99], v[68:71]
    s_add_u32 s43, s43, s89
    buffer_load_dwordx4 v29, s[8:11], s43 offen offset:1024 lds
    v_mfma_f32_16x16x32_bf16 v[72:75], v[32:35], a[160:163], v[72:75]
    ds_read_b64_tr_b16 v[60:61], v7 offset:4096
    v_mfma_f32_16x16x32_bf16 v[72:75], v[36:39], a[164:167], v[72:75]
    ds_read_b64_tr_b16 v[62:63], v7 offset:4608
    v_mfma_f32_16x16x32_bf16 v[76:79], v[36:39], a[228:231], v[76:79]
    v_mfma_f32_16x16x32_bf16 v[76:79], v[32:35], a[224:227], v[76:79]
    s_waitcnt lgkmcnt(8)
    v_mfma_f32_16x16x32_bf16 v[80:83], v[40:43], a[32:35], v[80:83]
    s_add_u32 s43, s43, s89
    ds_read_b64_tr_b16 v[32:33], v4 offset:8192
    buffer_load_dwordx4 v28, s[8:11], s43 offen offset:2048 lds
    v_mfma_f32_16x16x32_bf16 v[80:83], v[44:47], a[36:39], v[80:83]
    ds_read_b64_tr_b16 v[34:35], v4 offset:8704
    v_mfma_f32_16x16x32_bf16 v[84:87], v[44:47], a[100:103], v[84:87]
    s_add_u32 s43, s43, s89
    buffer_load_dwordx4 v29, s[8:11], s43 offen offset:3072 lds
    v_mfma_f32_16x16x32_bf16 v[84:87], v[40:43], a[96:99], v[84:87]
    v_mfma_f32_16x16x32_bf16 v[88:91], v[40:43], a[160:163], v[88:91]
    ds_read_b64_tr_b16 v[36:37], v4 offset:12288
    v_mfma_f32_16x16x32_bf16 v[88:91], v[44:47], a[164:167], v[88:91]
    ds_read_b64_tr_b16 v[38:39], v4 offset:12800
    v_mfma_f32_16x16x32_bf16 v[92:95], v[44:47], a[228:231], v[92:95]
    s_add_u32 s43, s77, s71
    buffer_load_dwordx4 a[48:51], v1, s[28:31], s43 offen offset:0 sc1
    v_mfma_f32_16x16x32_bf16 v[92:95], v[40:43], a[224:227], v[92:95]
    s_waitcnt lgkmcnt(8)
    v_mfma_f32_16x16x32_bf16 v[96:99], v[48:51], a[32:35], v[96:99]
    ds_read_b64_tr_b16 v[40:41], v5 offset:8192
    v_mfma_f32_16x16x32_bf16 v[96:99], v[52:55], a[36:39], v[96:99]
    ds_read_b64_tr_b16 v[42:43], v5 offset:8704
    v_mfma_f32_16x16x32_bf16 v[100:103], v[52:55], a[100:103], v[100:103]
    buffer_load_dwordx4 a[52:55], v1, s[28:31], s43 offen offset:1024 sc1
    v_mfma_f32_16x16x32_bf16 v[100:103], v[48:51], a[96:99], v[100:103]
    v_mfma_f32_16x16x32_bf16 v[104:107], v[48:51], a[160:163], v[104:107]
    ds_read_b64_tr_b16 v[44:45], v5 offset:12288
    v_mfma_f32_16x16x32_bf16 v[104:107], v[52:55], a[164:167], v[104:107]
    s_add_u32 s43, s78, s71
    ds_read_b64_tr_b16 v[46:47], v5 offset:12800
    v_mfma_f32_16x16x32_bf16 v[108:111], v[52:55], a[228:231], v[108:111]
    buffer_load_dwordx4 a[112:115], v1, s[28:31], s43 offen offset:0 sc1
    v_mfma_f32_16x16x32_bf16 v[108:111], v[48:51], a[224:227], v[108:111]
    s_waitcnt lgkmcnt(8)
    v_mfma_f32_16x16x32_bf16 v[112:115], v[56:59], a[32:35], v[112:115]
    ds_read_b64_tr_b16 v[48:49], v6 offset:8192
    v_mfma_f32_16x16x32_bf16 v[112:115], v[60:63], a[36:39], v[112:115]
    ds_read_b64_tr_b16 v[50:51], v6 offset:8704
    buffer_load_dwordx4 a[116:119], v1, s[28:31], s43 offen offset:1024 sc1
    v_mfma_f32_16x16x32_bf16 v[116:119], v[60:63], a[100:103], v[116:119]
    v_mfma_f32_16x16x32_bf16 v[116:119], v[56:59], a[96:99], v[116:119]
    v_mfma_f32_16x16x32_bf16 v[120:123], v[56:59], a[160:163], v[120:123]
    s_add_u32 s43, s79, s71
    ds_read_b64_tr_b16 v[52:53], v6 offset:12288
    v_mfma_f32_16x16x32_bf16 v[120:123], v[60:63], a[164:167], v[120:123]
    ds_read_b64_tr_b16 v[54:55], v6 offset:12800
    buffer_load_dwordx4 a[176:179], v1, s[28:31], s43 offen offset:0 sc1
    v_mfma_f32_16x16x32_bf16 v[124:127], v[60:63], a[228:231], v[124:127]
    v_mfma_f32_16x16x32_bf16 v[124:127], v[56:59], a[224:227], v[124:127]
    s_waitcnt lgkmcnt(8)
    buffer_load_dwordx4 a[180:183], v1, s[28:31], s43 offen offset:1024 sc1
    v_mfma_f32_16x16x32_bf16 v[192:195], v[32:35], a[32:35], v[192:195]
    ds_read_b64_tr_b16 v[56:57], v7 offset:8192
    v_mfma_f32_16x16x32_bf16 v[192:195], v[36:39], a[36:39], v[192:195]
    ds_read_b64_tr_b16 v[58:59], v7 offset:8704
    v_mfma_f32_16x16x32_bf16 v[196:199], v[36:39], a[100:103], v[196:199]
    v_mfma_f32_16x16x32_bf16 v[196:199], v[32:35], a[96:99], v[196:199]
    s_add_u32 s43, s80, s71
    buffer_load_dwordx4 a[240:243], v1, s[28:31], s43 offen offset:0 sc1
    v_mfma_f32_16x16x32_bf16 v[200:203], v[32:35], a[160:163], v[200:203]
    ds_read_b64_tr_b16 v[60:61], v7 offset:12288
    v_mfma_f32_16x16x32_bf16 v[200:203], v[36:39], a[164:167], v[200:203]
    ds_read_b64_tr_b16 v[62:63], v7 offset:12800
    v_mfma_f32_16x16x32_bf16 v[204:207], v[36:39], a[228:231], v[204:207]
    buffer_load_dwordx4 a[244:247], v1, s[28:31], s43 offen offset:1024 sc1
    v_mfma_f32_16x16x32_bf16 v[204:207], v[32:35], a[224:227], v[204:207]
    s_waitcnt lgkmcnt(8)
    v_mfma_f32_16x16x32_bf16 v[208:211], v[40:43], a[32:35], v[208:211]
    s_waitcnt vmcnt(12)
    s_barrier
    ds_read_b64_tr_b16 v[32:33], v4 offset:16384
    v_mfma_f32_16x16x32_bf16 v[208:211], v[44:47], a[36:39], v[208:211]
    ds_read_b64_tr_b16 v[34:35], v4 offset:16896
    v_mfma_f32_16x16x32_bf16 v[212:215], v[44:47], a[100:103], v[212:215]
    s_lshl_b32 s3, s41, 5
    s_add_u32 s3, s3, s42
    s_lshl_b32 s3, s3, 2
    s_add_u32 s3, s3, 12288
    buffer_store_dword v0, v30, s[36:39], s3 offen sc0 sc1
    v_mfma_f32_16x16x32_bf16 v[212:215], v[40:43], a[96:99], v[212:215]
    v_mfma_f32_16x16x32_bf16 v[216:219], v[40:43], a[160:163], v[216:219]
    s_add_u32 m0, s44, 49152
    ds_read_b64_tr_b16 v[36:37], v4 offset:20480
    v_mfma_f32_16x16x32_bf16 v[216:219], v[44:47], a[164:167], v[216:219]
    s_mov_b32 s43, s64
    ds_read_b64_tr_b16 v[38:39], v4 offset:20992
    buffer_load_dwordx4 v28, s[8:11], s43 offen offset:0 lds
    v_mfma_f32_16x16x32_bf16 v[220:223], v[44:47], a[228:231], v[220:223]
    v_mfma_f32_16x16x32_bf16 v[220:223], v[40:43], a[224:227], v[220:223]
    s_waitcnt lgkmcnt(8)
    v_mfma_f32_16x16x32_bf16 v[224:227], v[48:51], a[32:35], v[224:227]
    s_add_u32 s43, s43, s89
    ds_read_b64_tr_b16 v[40:41], v5 offset:16384
    v_mfma_f32_16x16x32_bf16 v[224:227], v[52:55], a[36:39], v[224:227]
    ds_read_b64_tr_b16 v[42:43], v5 offset:16896
    buffer_load_dwordx4 v29, s[8:11], s43 offen offset:1024 lds
    v_mfma_f32_16x16x32_bf16 v[228:231], v[52:55], a[100:103], v[228:231]
    v_mfma_f32_16x16x32_bf16 v[228:231], v[48:51], a[96:99], v[228:231]
    v_mfma_f32_16x16x32_bf16 v[232:235], v[48:51], a[160:163], v[232:235]
    s_add_u32 s43, s43, s89
    ds_read_b64_tr_b16 v[44:45], v5 offset:20480
    v_mfma_f32_16x16x32_bf16 v[232:235], v[52:55], a[164:167], v[232:235]
    ds_read_b64_tr_b16 v[46:47], v5 offset:20992
    buffer_load_dwordx4 v28, s[8:11], s43 offen offset:2048 lds
    v_mfma_f32_16x16x32_bf16 v[236:239], v[52:55], a[228:231], v[236:239]
    v_mfma_f32_16x16x32_bf16 v[236:239], v[48:51], a[224:227], v[236:239]
    s_waitcnt lgkmcnt(8)
    v_mfma_f32_16x16x32_bf16 v[240:243], v[56:59], a[32:35], v[240:243]
    s_add_u32 s43, s43, s89
    ds_read_b64_tr_b16 v[48:49], v6 offset:16384
    v_mfma_f32_16x16x32_bf16 v[240:243], v[60:63], a[36:39], v[240:243]
    ds_read_b64_tr_b16 v[50:51], v6 offset:16896
    buffer_load_dwordx4 v29, s[8:11], s43 offen offset:3072 lds
    v_mfma_f32_16x16x32_bf16 v[244:247], v[60:63], a[100:103], v[244:247]
    v_mfma_f32_16x16x32_bf16 v[244:247], v[56:59], a[96:99], v[244:247]
    v_mfma_f32_16x16x32_bf16 v[248:251], v[56:59], a[160:163], v[248:251]
    ds_read_b64_tr_b16 v[52:53], v6 offset:20480
    v_mfma_f32_16x16x32_bf16 v[248:251], v[60:63], a[164:167], v[248:251]
    ds_read_b64_tr_b16 v[54:55], v6 offset:20992
    v_mfma_f32_16x16x32_bf16 v[252:255], v[60:63], a[228:231], v[252:255]
    v_mfma_f32_16x16x32_bf16 v[252:255], v[56:59], a[224:227], v[252:255]
    s_waitcnt lgkmcnt(8)
    v_mfma_f32_16x16x32_bf16 v[64:67], v[32:35], a[40:43], v[64:67]
    s_add_u32 s43, s77, s72
    ds_read_b64_tr_b16 v[56:57], v7 offset:16384
    s_lshl_b32 s93, s40, 11
    v_mfma_f32_16x16x32_bf16 v[64:67], v[36:39], a[44:47], v[64:67]
    ds_read_b64_tr_b16 v[58:59], v7 offset:16896
    buffer_load_dwordx4 a[56:59], v1, s[28:31], s43 offen offset:0 sc1
    v_mfma_f32_16x16x32_bf16 v[68:71], v[36:39], a[108:111], v[68:71]
    v_add_u32 v13, s93, v1
    v_add_u32 v12, 0x20000, v1
    v_mfma_f32_16x16x32_bf16 v[68:71], v[32:35], a[104:107], v[68:71]
    s_mov_b32 s90, 0
    s_mov_b32 s91, 98304
    v_mfma_f32_16x16x32_bf16 v[72:75], v[32:35], a[168:171], v[72:75]
    ds_read_b64_tr_b16 v[60:61], v7 offset:20480
    s_mov_b32 s92, 131072
    v_mfma_f32_16x16x32_bf16 v[72:75], v[36:39], a[172:175], v[72:75]
    ds_read_b64_tr_b16 v[62:63], v7 offset:20992
    buffer_load_dwordx4 a[60:63], v1, s[28:31], s43 offen offset:1024 sc1
    v_mfma_f32_16x16x32_bf16 v[76:79], v[36:39], a[236:239], v[76:79]
    v_mfma_f32_16x16x32_bf16 v[76:79], v[32:35], a[232:235], v[76:79]
    s_waitcnt lgkmcnt(8)
    v_mfma_f32_16x16x32_bf16 v[80:83], v[40:43], a[40:43], v[80:83]
    s_waitcnt vmcnt(15)
    s_barrier
    ds_read_b64_tr_b16 v[32:33], v4 offset:32768
    v_mfma_f32_16x16x32_bf16 v[80:83], v[44:47], a[44:47], v[80:83]
    s_add_u32 s43, s78, s72
    ds_read_b64_tr_b16 v[34:35], v4 offset:33280
    buffer_load_dwordx4 a[120:123], v1, s[28:31], s43 offen offset:0 sc1
    v_mfma_f32_16x16x32_bf16 v[84:87], v[44:47], a[108:111], v[84:87]
    v_mfma_f32_16x16x32_bf16 v[84:87], v[40:43], a[104:107], v[84:87]
    v_mfma_f32_16x16x32_bf16 v[88:91], v[40:43], a[168:171], v[88:91]
    ds_read_b64_tr_b16 v[36:37], v4 offset:36864
    v_mfma_f32_16x16x32_bf16 v[88:91], v[44:47], a[172:175], v[88:91]
    ds_read_b64_tr_b16 v[38:39], v4 offset:37376
    buffer_load_dwordx4 a[124:127], v1, s[28:31], s43 offen offset:1024 sc1
    v_mfma_f32_16x16x32_bf16 v[92:95], v[44:47], a[236:239], v[92:95]
    v_mfma_f32_16x16x32_bf16 v[92:95], v[40:43], a[232:235], v[92:95]
    s_waitcnt lgkmcnt(8)
    v_mfma_f32_16x16x32_bf16 v[96:99], v[48:51], a[40:43], v[96:99]
    ds_read_b64_tr_b16 v[40:41], v5 offset:32768
    v_mfma_f32_16x16x32_bf16 v[96:99], v[52:55], a[44:47], v[96:99]
    s_add_u32 s43, s79, s72
    ds_read_b64_tr_b16 v[42:43], v5 offset:33280
    v_mfma_f32_16x16x32_bf16 v[100:103], v[52:55], a[108:111], v[100:103]
    buffer_load_dwordx4 a[184:187], v1, s[28:31], s43 offen offset:0 sc1
    v_mfma_f32_16x16x32_bf16 v[100:103], v[48:51], a[104:107], v[100:103]
    v_mfma_f32_16x16x32_bf16 v[104:107], v[48:51], a[168:171], v[104:107]
    ds_read_b64_tr_b16 v[44:45], v5 offset:36864
    v_mfma_f32_16x16x32_bf16 v[104:107], v[52:55], a[172:175], v[104:107]
    ds_read_b64_tr_b16 v[46:47], v5 offset:37376
    v_mfma_f32_16x16x32_bf16 v[108:111], v[52:55], a[236:239], v[108:111]
    buffer_load_dwordx4 a[188:191], v1, s[28:31], s43 offen offset:1024 sc1
    v_mfma_f32_16x16x32_bf16 v[108:111], v[48:51], a[232:235], v[108:111]
    s_waitcnt lgkmcnt(8)
    v_mfma_f32_16x16x32_bf16 v[112:115], v[56:59], a[40:43], v[112:115]
    ds_read_b64_tr_b16 v[48:49], v6 offset:32768
    v_mfma_f32_16x16x32_bf16 v[112:115], v[60:63], a[44:47], v[112:115]
    s_add_u32 s43, s80, s72
    ds_read_b64_tr_b16 v[50:51], v6 offset:33280
    v_mfma_f32_16x16x32_bf16 v[116:119], v[60:63], a[108:111], v[116:119]
    buffer_load_dwordx4 a[248:251], v1, s[28:31], s43 offen offset:0 sc1
    v_mfma_f32_16x16x32_bf16 v[116:119], v[56:59], a[104:107], v[116:119]
    v_mfma_f32_16x16x32_bf16 v[120:123], v[56:59], a[168:171], v[120:123]
    ds_read_b64_tr_b16 v[52:53], v6 offset:36864
    v_mfma_f32_16x16x32_bf16 v[120:123], v[60:63], a[172:175], v[120:123]
    ds_read_b64_tr_b16 v[54:55], v6 offset:37376
    v_mfma_f32_16x16x32_bf16 v[124:127], v[60:63], a[236:239], v[124:127]
    buffer_load_dwordx4 a[252:255], v1, s[28:31], s43 offen offset:1024 sc1
    v_mfma_f32_16x16x32_bf16 v[124:127], v[56:59], a[232:235], v[124:127]
    s_waitcnt lgkmcnt(8)
    s_waitcnt vmcnt(13)
    v_mfma_f32_16x16x32_bf16 v[64:67], v[32:35], a[48:51], v[64:67]
    ds_read_b64_tr_b16 v[56:57], v7 offset:32768
    v_mfma_f32_16x16x32_bf16 v[64:67], v[36:39], a[52:55], v[64:67]
    ds_read_b64_tr_b16 v[58:59], v7 offset:33280
    v_mfma_f32_16x16x32_bf16 v[68:71], v[36:39], a[116:119], v[68:71]
    v_mfma_f32_16x16x32_bf16 v[68:71], v[32:35], a[112:115], v[68:71]
    v_mfma_f32_16x16x32_bf16 v[72:75], v[32:35], a[176:179], v[72:75]
    s_add_u32 m0, s44, 65536
    ds_read_b64_tr_b16 v[60:61], v7 offset:36864
    v_mfma_f32_16x16x32_bf16 v[72:75], v[36:39], a[180:183], v[72:75]
    s_add_u32 s43, s73, 128
    ds_read_b64_tr_b16 v[62:63], v7 offset:37376
    buffer_load_dwordx4 v2, s[12:15], s43 offen offset:0 lds
    v_mfma_f32_16x16x32_bf16 v[76:79], v[36:39], a[244:247], v[76:79]
    v_mfma_f32_16x16x32_bf16 v[76:79], v[32:35], a[240:243], v[76:79]
    s_waitcnt lgkmcnt(8)
    v_mfma_f32_16x16x32_bf16 v[80:83], v[40:43], a[48:51], v[80:83]
    s_waitcnt vmcnt(9)
    s_barrier
    ds_read_b64_tr_b16 v[32:33], v4 offset:49152
    v_mfma_f32_16x16x32_bf16 v[80:83], v[44:47], a[52:55], v[80:83]
    ds_read_b64_tr_b16 v[34:35], v4 offset:49664
    v_mfma_f32_16x16x32_bf16 v[84:87], v[44:47], a[116:119], v[84:87]
    s_add_u32 s43, s73, 64640
    buffer_load_dwordx4 v3, s[12:15], s43 offen offset:1024 lds
    v_mfma_f32_16x16x32_bf16 v[84:87], v[40:43], a[112:115], v[84:87]
    v_mfma_f32_16x16x32_bf16 v[88:91], v[40:43], a[176:179], v[88:91]
    ds_read_b64_tr_b16 v[36:37], v4 offset:53248
    v_mfma_f32_16x16x32_bf16 v[88:91], v[44:47], a[180:183], v[88:91]
    ds_read_b64_tr_b16 v[38:39], v4 offset:53760
    v_mfma_f32_16x16x32_bf16 v[92:95], v[44:47], a[244:247], v[92:95]
    v_mfma_f32_16x16x32_bf16 v[92:95], v[40:43], a[240:243], v[92:95]
    s_waitcnt lgkmcnt(8)
    s_lshl_b32 s3, s41, 20
    s_add_u32 s3, s3, 2097152
    s_add_u32 s20, s28, s3
    s_addc_u32 s21, s29, 0
    v_mfma_f32_16x16x32_bf16 v[96:99], v[48:51], a[48:51], v[96:99]
    ds_read_b64_tr_b16 v[40:41], v5 offset:49152
    s_mov_b32 s16, s24
    v_mfma_f32_16x16x32_bf16 v[96:99], v[52:55], a[52:55], v[96:99]
    s_add_u32 s43, s73, 129152
    ds_read_b64_tr_b16 v[42:43], v5 offset:49664
    s_mov_b32 s17, s25
    v_mfma_f32_16x16x32_bf16 v[100:103], v[52:55], a[116:119], v[100:103]
    buffer_load_dwordx4 v2, s[12:15], s43 offen offset:2048 lds
    v_mfma_f32_16x16x32_bf16 v[100:103], v[48:51], a[112:115], v[100:103]
    s_mov_b32 s18, s97
    s_mov_b32 s95, 0x40004000
    v_mfma_f32_16x16x32_bf16 v[104:107], v[48:51], a[176:179], v[104:107]
    ds_read_b64_tr_b16 v[44:45], v5 offset:53248
    v_mov_b32 v14, 0
    v_mfma_f32_16x16x32_bf16 v[104:107], v[52:55], a[180:183], v[104:107]
    ds_read_b64_tr_b16 v[46:47], v5 offset:53760
    v_mov_b32 v15, 0
    v_mfma_f32_16x16x32_bf16 v[108:111], v[52:55], a[244:247], v[108:111]
    v_mov_b32 v16, 0
    v_mov_b32 v17, 0
    v_mfma_f32_16x16x32_bf16 v[108:111], v[48:51], a[240:243], v[108:111]
    s_waitcnt lgkmcnt(8)
    v_mov_b32 v18, 0xbdd2d3e8
    v_mov_b32 v19, 0xff800000
    v_mfma_f32_16x16x32_bf16 v[112:115], v[56:59], a[48:51], v[112:115]
    s_add_u32 s43, s73, 193664
    ds_read_b64_tr_b16 v[48:49], v6 offset:49152
    buffer_load_dwordx4 v3, s[12:15], s43 offen offset:3072 lds
    v_mfma_f32_16x16x32_bf16 v[112:115], v[60:63], a[52:55], v[112:115]
    ds_read_b64_tr_b16 v[50:51], v6 offset:49664
    v_mfma_f32_16x16x32_bf16 v[116:119], v[60:63], a[116:119], v[116:119]
    s_cmp_eq_u32 s42, 0
    s_cselect_b32 s60, 0, 1000
    v_mfma_f32_16x16x32_bf16 v[116:119], v[56:59], a[112:115], v[116:119]
    s_cmp_eq_u32 s42, 7
    s_cselect_b32 s61, 0, 1000
    v_mfma_f32_16x16x32_bf16 v[120:123], v[56:59], a[176:179], v[120:123]
    ds_read_b64_tr_b16 v[52:53], v6 offset:53248
    v_bfe_u32 v20, v1, 2, 5
    v_mfma_f32_16x16x32_bf16 v[120:123], v[60:63], a[180:183], v[120:123]
    ds_read_b64_tr_b16 v[54:55], v6 offset:53760
    v_and_b32 v20, 0x1c, v20
    v_mfma_f32_16x16x32_bf16 v[124:127], v[60:63], a[244:247], v[124:127]
    s_lshl_b32 s7, s41, 7
    s_add_u32 s7, s7, 12288
    v_mfma_f32_16x16x32_bf16 v[124:127], v[56:59], a[240:243], v[124:127]
    s_waitcnt lgkmcnt(8)
    s_waitcnt vmcnt(4)
    v_mfma_f32_16x16x32_bf16 v[64:67], v[32:35], a[56:59], v[64:67]
    s_add_u32 m0, s44, 81920
    ds_read_b64_tr_b16 v[56:57], v7 offset:49152
    v_mfma_f32_16x16x32_bf16 v[64:67], v[36:39], a[60:63], v[64:67]
    s_add_u32 s43, s74, 128
    ds_read_b64_tr_b16 v[58:59], v7 offset:49664
    buffer_load_dwordx4 v2, s[12:15], s43 offen offset:0 lds
    v_mfma_f32_16x16x32_bf16 v[68:71], v[36:39], a[124:127], v[68:71]
    v_mfma_f32_16x16x32_bf16 v[68:71], v[32:35], a[120:123], v[68:71]
    v_mfma_f32_16x16x32_bf16 v[72:75], v[32:35], a[184:187], v[72:75]
    ds_read_b64_tr_b16 v[60:61], v7 offset:53248
    v_mfma_f32_16x16x32_bf16 v[72:75], v[36:39], a[188:191], v[72:75]
    ds_read_b64_tr_b16 v[62:63], v7 offset:53760
    v_mfma_f32_16x16x32_bf16 v[76:79], v[36:39], a[252:255], v[76:79]
    v_mfma_f32_16x16x32_bf16 v[76:79], v[32:35], a[248:251], v[76:79]
    s_waitcnt lgkmcnt(8)
    v_mfma_f32_16x16x32_bf16 v[80:83], v[40:43], a[56:59], v[80:83]
    ds_read_b64_tr_b16 v[32:33], v4 offset:24576
    v_mfma_f32_16x16x32_bf16 v[80:83], v[44:47], a[60:63], v[80:83]
    ds_read_b64_tr_b16 v[34:35], v4 offset:25088
    v_mfma_f32_16x16x32_bf16 v[84:87], v[44:47], a[124:127], v[84:87]
    s_add_u32 s43, s74, 64640
    buffer_load_dwordx4 v3, s[12:15], s43 offen offset:1024 lds
    v_mfma_f32_16x16x32_bf16 v[84:87], v[40:43], a[120:123], v[84:87]
    v_mfma_f32_16x16x32_bf16 v[88:91], v[40:43], a[184:187], v[88:91]
    ds_read_b64_tr_b16 v[36:37], v4 offset:28672
    v_mfma_f32_16x16x32_bf16 v[88:91], v[44:47], a[188:191], v[88:91]
    ds_read_b64_tr_b16 v[38:39], v4 offset:29184
    v_mfma_f32_16x16x32_bf16 v[92:95], v[44:47], a[252:255], v[92:95]
    v_mfma_f32_16x16x32_bf16 v[92:95], v[40:43], a[248:251], v[92:95]
    s_waitcnt lgkmcnt(8)
    v_mfma_f32_16x16x32_bf16 v[96:99], v[48:51], a[56:59], v[96:99]
    ds_read_b64_tr_b16 v[40:41], v5 offset:24576
    v_mfma_f32_16x16x32_bf16 v[96:99], v[52:55], a[60:63], v[96:99]
    ds_read_b64_tr_b16 v[42:43], v5 offset:25088
    v_mfma_f32_16x16x32_bf16 v[100:103], v[52:55], a[124:127], v[100:103]
    v_mfma_f32_16x16x32_bf16 v[100:103], v[48:51], a[120:123], v[100:103]
    v_mfma_f32_16x16x32_bf16 v[104:107], v[48:51], a[184:187], v[104:107]
    s_add_u32 s43, s74, 129152
    ds_read_b64_tr_b16 v[44:45], v5 offset:28672
    buffer_load_dwordx4 v2, s[12:15], s43 offen offset:2048 lds
    v_mfma_f32_16x16x32_bf16 v[104:107], v[52:55], a[188:191], v[104:107]
    ds_read_b64_tr_b16 v[46:47], v5 offset:29184
    v_mfma_f32_16x16x32_bf16 v[108:111], v[52:55], a[252:255], v[108:111]
    v_mfma_f32_16x16x32_bf16 v[108:111], v[48:51], a[248:251], v[108:111]
    s_waitcnt lgkmcnt(8)
    v_mfma_f32_16x16x32_bf16 v[112:115], v[56:59], a[56:59], v[112:115]
    ds_read_b64_tr_b16 v[48:49], v6 offset:24576
    v_mfma_f32_16x16x32_bf16 v[112:115], v[60:63], a[60:63], v[112:115]
    ds_read_b64_tr_b16 v[50:51], v6 offset:25088
    v_mfma_f32_16x16x32_bf16 v[116:119], v[60:63], a[124:127], v[116:119]
    v_mfma_f32_16x16x32_bf16 v[116:119], v[56:59], a[120:123], v[116:119]
    v_mfma_f32_16x16x32_bf16 v[120:123], v[56:59], a[184:187], v[120:123]
    ds_read_b64_tr_b16 v[52:53], v6 offset:28672
    v_mfma_f32_16x16x32_bf16 v[120:123], v[60:63], a[188:191], v[120:123]
    ds_read_b64_tr_b16 v[54:55], v6 offset:29184
    v_mfma_f32_16x16x32_bf16 v[124:127], v[60:63], a[252:255], v[124:127]
    s_add_u32 s43, s74, 193664
    buffer_load_dwordx4 v3, s[12:15], s43 offen offset:3072 lds
    v_mfma_f32_16x16x32_bf16 v[124:127], v[56:59], a[248:251], v[124:127]
    s_waitcnt lgkmcnt(8)
    v_mfma_f32_16x16x32_bf16 v[192:195], v[32:35], a[40:43], v[192:195]
    ds_read_b64_tr_b16 v[56:57], v7 offset:24576
    v_mfma_f32_16x16x32_bf16 v[192:195], v[36:39], a[44:47], v[192:195]
    ds_read_b64_tr_b16 v[58:59], v7 offset:25088
    v_mfma_f32_16x16x32_bf16 v[196:199], v[36:39], a[108:111], v[196:199]
    v_mfma_f32_16x16x32_bf16 v[196:199], v[32:35], a[104:107], v[196:199]
    v_mfma_f32_16x16x32_bf16 v[200:203], v[32:35], a[168:171], v[200:203]
    ds_read_b64_tr_b16 v[60:61], v7 offset:28672
    v_mfma_f32_16x16x32_bf16 v[200:203], v[36:39], a[172:175], v[200:203]
    ds_read_b64_tr_b16 v[62:63], v7 offset:29184
    v_mfma_f32_16x16x32_bf16 v[204:207], v[36:39], a[236:239], v[204:207]
    v_mfma_f32_16x16x32_bf16 v[204:207], v[32:35], a[232:235], v[204:207]
    s_waitcnt lgkmcnt(8)
    v_mfma_f32_16x16x32_bf16 v[208:211], v[40:43], a[40:43], v[208:211]
    s_add_u32 m0, s44, 98304
    ds_read_b64_tr_b16 v[32:33], v4 offset:40960
    v_mfma_f32_16x16x32_bf16 v[208:211], v[44:47], a[44:47], v[208:211]
    s_add_u32 s43, s75, 128
    ds_read_b64_tr_b16 v[34:35], v4 offset:41472
    buffer_load_dwordx4 v2, s[12:15], s43 offen offset:0 lds
    v_mfma_f32_16x16x32_bf16 v[212:215], v[44:47], a[108:111], v[212:215]
    v_mul_f32 v23, v64, v64
    v_mul_f32 v24, v65, v65
    v_mfma_f32_16x16x32_bf16 v[212:215], v[40:43], a[104:107], v[212:215]
    v_mul_f32 v25, v66, v66
    v_mul_f32 v26, v67, v67
    v_mfma_f32_16x16x32_bf16 v[216:219], v[40:43], a[168:171], v[216:219]
    ds_read_b64_tr_b16 v[36:37], v4 offset:45056
    v_fmaak_f32 v23, v18, v23, 0xc0135761
    v_mfma_f32_16x16x32_bf16 v[216:219], v[44:47], a[172:175], v[216:219]
    ds_read_b64_tr_b16 v[38:39], v4 offset:45568
    v_fmaak_f32 v24, v18, v24, 0xc0135761
    v_mfma_f32_16x16x32_bf16 v[220:223], v[44:47], a[236:239], v[220:223]
    v_fmaak_f32 v25, v18, v25, 0xc0135761
    v_fmaak_f32 v26, v18, v26, 0xc0135761
    v_mfma_f32_16x16x32_bf16 v[220:223], v[40:43], a[232:235], v[220:223]
    s_waitcnt lgkmcnt(8)
    v_mul_f32 v23, v23, v64
    v_mul_f32 v24, v24, v65
    v_mfma_f32_16x16x32_bf16 v[224:227], v[48:51], a[40:43], v[224:227]
    ds_read_b64_tr_b16 v[40:41], v5 offset:40960
    v_mul_f32 v25, v25, v66
    v_mfma_f32_16x16x32_bf16 v[224:227], v[52:55], a[44:47], v[224:227]
    ds_read_b64_tr_b16 v[42:43], v5 offset:41472
    v_mul_f32 v26, v26, v67
    v_mfma_f32_16x16x32_bf16 v[228:231], v[52:55], a[108:111], v[228:231]
    s_add_u32 s43, s75, 64640
    buffer_load_dwordx4 v3, s[12:15], s43 offen offset:1024 lds
    v_mfma_f32_16x16x32_bf16 v[228:231], v[48:51], a[104:107], v[228:231]
    v_exp_f32 v23, v23
    v_mfma_f32_16x16x32_bf16 v[232:235], v[48:51], a[168:171], v[232:235]
    ds_read_b64_tr_b16 v[44:45], v5 offset:45056
    v_add_f32 v23, 1.0, v23
    v_mfma_f32_16x16x32_bf16 v[232:235], v[52:55], a[172:175], v[232:235]
    ds_read_b64_tr_b16 v[46:47], v5 offset:45568
    v_mul_f32 v27, v80, v80
    v_mfma_f32_16x16x32_bf16 v[236:239], v[52:55], a[236:239], v[236:239]
    v_exp_f32 v24, v24
    v_mfma_f32_16x16x32_bf16 v[236:239], v[48:51], a[232:235], v[236:239]
    s_waitcnt lgkmcnt(8)
    v_exp_f32 v25, v25
    v_mfma_f32_16x16x32_bf16 v[240:243], v[56:59], a[40:43], v[240:243]
    ds_read_b64_tr_b16 v[48:49], v6 offset:40960
    v_add_f32 v24, 1.0, v24
    v_mfma_f32_16x16x32_bf16 v[240:243], v[60:63], a[44:47], v[240:243]
    ds_read_b64_tr_b16 v[50:51], v6 offset:41472
    v_add_f32 v25, 1.0, v25
    v_mfma_f32_16x16x32_bf16 v[244:247], v[60:63], a[108:111], v[244:247]
    v_exp_f32 v26, v26
    v_mfma_f32_16x16x32_bf16 v[244:247], v[56:59], a[104:107], v[244:247]
    v_rcp_f32 v23, v23
    v_mfma_f32_16x16x32_bf16 v[248:251], v[56:59], a[168:171], v[248:251]
    s_add_u32 s43, s75, 129152
    ds_read_b64_tr_b16 v[52:53], v6 offset:45056
    v_add_f32 v26, 1.0, v26
    v_mfma_f32_16x16x32_bf16 v[248:251], v[60:63], a[172:175], v[248:251]
    ds_read_b64_tr_b16 v[54:55], v6 offset:45568
    buffer_load_dwordx4 v2, s[12:15], s43 offen offset:2048 lds
    v_mfma_f32_16x16x32_bf16 v[252:255], v[60:63], a[236:239], v[252:255]
    v_rcp_f32 v24, v24
    v_mfma_f32_16x16x32_bf16 v[252:255], v[56:59], a[232:235], v[252:255]
    s_waitcnt lgkmcnt(8)
    v_rcp_f32 v25, v25
    v_mfma_f32_16x16x32_bf16 v[192:195], v[32:35], a[48:51], v[192:195]
    ds_read_b64_tr_b16 v[56:57], v7 offset:40960
    v_mul_f32 v64, v64, v23
    v_mfma_f32_16x16x32_bf16 v[192:195], v[36:39], a[52:55], v[192:195]
    ds_read_b64_tr_b16 v[58:59], v7 offset:41472
    v_mul_f32 v65, v65, v24
    v_mfma_f32_16x16x32_bf16 v[196:199], v[36:39], a[116:119], v[196:199]
    v_rcp_f32 v26, v26
    v_mfma_f32_16x16x32_bf16 v[196:199], v[32:35], a[112:115], v[196:199]
    v_mul_f32 v66, v66, v25
    v_mul_f32 v67, v67, v26
    v_mfma_f32_16x16x32_bf16 v[200:203], v[32:35], a[176:179], v[200:203]
    ds_read_b64_tr_b16 v[60:61], v7 offset:45056
    v_mul_f32 v28, v81, v81
    v_mfma_f32_16x16x32_bf16 v[200:203], v[36:39], a[180:183], v[200:203]
    ds_read_b64_tr_b16 v[62:63], v7 offset:45568
    v_mul_f32 v29, v82, v82
    v_mfma_f32_16x16x32_bf16 v[204:207], v[36:39], a[244:247], v[204:207]
    s_add_u32 s43, s75, 193664
    buffer_load_dwordx4 v3, s[12:15], s43 offen offset:3072 lds
    v_mfma_f32_16x16x32_bf16 v[204:207], v[32:35], a[240:243], v[204:207]
    s_waitcnt lgkmcnt(8)
    v_mul_f32 v22, v83, v83
    v_fmaak_f32 v27, v18, v27, 0xc0135761
    v_mfma_f32_16x16x32_bf16 v[208:211], v[40:43], a[48:51], v[208:211]
    ds_read_b64_tr_b16 v[32:33], v4 offset:57344
    v_fmaak_f32 v28, v18, v28, 0xc0135761
    v_mfma_f32_16x16x32_bf16 v[208:211], v[44:47], a[52:55], v[208:211]
    ds_read_b64_tr_b16 v[34:35], v4 offset:57856
    v_fmaak_f32 v29, v18, v29, 0xc0135761
    v_mfma_f32_16x16x32_bf16 v[212:215], v[44:47], a[116:119], v[212:215]
    v_fmaak_f32 v22, v18, v22, 0xc0135761
    v_mul_f32 v27, v27, v80
    v_mfma_f32_16x16x32_bf16 v[212:215], v[40:43], a[112:115], v[212:215]
    v_exp_f32 v27, v27
    v_mfma_f32_16x16x32_bf16 v[216:219], v[40:43], a[176:179], v[216:219]
    ds_read_b64_tr_b16 v[36:37], v4 offset:61440
    v_mul_f32 v28, v28, v81
    v_mfma_f32_16x16x32_bf16 v[216:219], v[44:47], a[180:183], v[216:219]
    ds_read_b64_tr_b16 v[38:39], v4 offset:61952
    v_mul_f32 v29, v29, v82
    v_mfma_f32_16x16x32_bf16 v[220:223], v[44:47], a[244:247], v[220:223]
    v_exp_f32 v28, v28
    v_mfma_f32_16x16x32_bf16 v[220:223], v[40:43], a[240:243], v[220:223]
    s_waitcnt lgkmcnt(8)
    v_exp_f32 v29, v29
    v_mfma_f32_16x16x32_bf16 v[224:227], v[48:51], a[48:51], v[224:227]
    s_add_u32 m0, s44, 114688
    ds_read_b64_tr_b16 v[40:41], v5 offset:57344
    v_mul_f32 v22, v22, v83
    v_mfma_f32_16x16x32_bf16 v[224:227], v[52:55], a[52:55], v[224:227]
    s_add_u32 s43, s76, 128
    ds_read_b64_tr_b16 v[42:43], v5 offset:57856
    buffer_load_dwordx4 v2, s[12:15], s43 offen offset:0 lds
    v_mfma_f32_16x16x32_bf16 v[228:231], v[52:55], a[116:119], v[228:231]
    v_exp_f32 v22, v22
    v_mfma_f32_16x16x32_bf16 v[228:231], v[48:51], a[112:115], v[228:231]
    v_add_f32 v27, 1.0, v27
    v_add_f32 v28, 1.0, v28
    v_mfma_f32_16x16x32_bf16 v[232:235], v[48:51], a[176:179], v[232:235]
    ds_read_b64_tr_b16 v[44:45], v5 offset:61440
    v_add_f32 v29, 1.0, v29
    v_mfma_f32_16x16x32_bf16 v[232:235], v[52:55], a[180:183], v[232:235]
    ds_read_b64_tr_b16 v[46:47], v5 offset:61952
    v_add_f32 v22, 1.0, v22
    v_mfma_f32_16x16x32_bf16 v[236:239], v[52:55], a[244:247], v[236:239]
    v_rcp_f32 v27, v27
    v_mfma_f32_16x16x32_bf16 v[236:239], v[48:51], a[240:243], v[236:239]
    s_waitcnt lgkmcnt(8)
    v_rcp_f32 v28, v28
    v_mfma_f32_16x16x32_bf16 v[240:243], v[56:59], a[48:51], v[240:243]
    ds_read_b64_tr_b16 v[48:49], v6 offset:57344
    v_mul_f32 v80, v80, v27
    v_mfma_f32_16x16x32_bf16 v[240:243], v[60:63], a[52:55], v[240:243]
    ds_read_b64_tr_b16 v[50:51], v6 offset:57856
    v_mul_f32 v81, v81, v28
    v_mfma_f32_16x16x32_bf16 v[244:247], v[60:63], a[116:119], v[244:247]
    s_add_u32 s43, s76, 64640
    buffer_load_dwordx4 v3, s[12:15], s43 offen offset:1024 lds
    v_mfma_f32_16x16x32_bf16 v[244:247], v[56:59], a[112:115], v[244:247]
    v_rcp_f32 v29, v29
    v_mfma_f32_16x16x32_bf16 v[248:251], v[56:59], a[176:179], v[248:251]
    ds_read_b64_tr_b16 v[52:53], v6 offset:61440
    v_mul_f32 v82, v82, v29
    v_mfma_f32_16x16x32_bf16 v[248:251], v[60:63], a[180:183], v[248:251]
    ds_read_b64_tr_b16 v[54:55], v6 offset:61952
    v_cvt_pk_bf16_f32 v64, v64, v65
    v_mfma_f32_16x16x32_bf16 v[252:255], v[60:63], a[244:247], v[252:255]
    v_rcp_f32 v22, v22
    v_mfma_f32_16x16x32_bf16 v[252:255], v[56:59], a[240:243], v[252:255]
    s_waitcnt lgkmcnt(8)
    v_mul_f32 v83, v83, v22
    v_cvt_pk_bf16_f32 v65, v66, v67
    v_mfma_f32_16x16x32_bf16 v[192:195], v[32:35], a[56:59], v[192:195]
    ds_read_b64_tr_b16 v[56:57], v7 offset:57344
    v_cvt_pk_bf16_f32 v66, v80, v81
    v_mfma_f32_16x16x32_bf16 v[192:195], v[36:39], a[60:63], v[192:195]
    ds_read_b64_tr_b16 v[58:59], v7 offset:57856
    v_cvt_pk_bf16_f32 v67, v82, v83
    v_mfma_f32_16x16x32_bf16 v[196:199], v[36:39], a[124:127], v[196:199]
    buffer_store_dwordx4 v[64:67], v1, s[16:19], s85 offen offset:0 sc0 sc1
    v_mfma_f32_16x16x32_bf16 v[196:199], v[32:35], a[120:123], v[196:199]
    v_mul_f32 v23, v68, v68
    v_mul_f32 v24, v69, v69
    v_mfma_f32_16x16x32_bf16 v[200:203], v[32:35], a[184:187], v[200:203]
    s_add_u32 s43, s76, 129152
    ds_read_b64_tr_b16 v[60:61], v7 offset:61440
    v_mul_f32 v25, v70, v70
    v_mfma_f32_16x16x32_bf16 v[200:203], v[36:39], a[188:191], v[200:203]
    ds_read_b64_tr_b16 v[62:63], v7 offset:61952
    buffer_load_dwordx4 v2, s[12:15], s43 offen offset:2048 lds
    v_mfma_f32_16x16x32_bf16 v[204:207], v[36:39], a[252:255], v[204:207]
    v_mul_f32 v26, v71, v71
    v_fmaak_f32 v23, v18, v23, 0xc0135761
    v_mfma_f32_16x16x32_bf16 v[204:207], v[32:35], a[248:251], v[204:207]
    s_waitcnt lgkmcnt(8)
    v_fmaak_f32 v24, v18, v24, 0xc0135761
    v_fmaak_f32 v25, v18, v25, 0xc0135761
    v_mfma_f32_16x16x32_bf16 v[208:211], v[40:43], a[56:59], v[208:211]
    s_waitcnt vmcnt(12)
    s_barrier
    ds_read_b64_tr_b16 v[32:33], v8 offset:0
    v_mfma_f32_16x16x32_bf16 v[208:211], v[44:47], a[60:63], v[208:211]
    ds_read_b64_tr_b16 v[34:35], v8 offset:512
    v_fmaak_f32 v26, v18, v26, 0xc0135761
    v_mfma_f32_16x16x32_bf16 v[212:215], v[44:47], a[124:127], v[212:215]
    v_mul_f32 v23, v23, v68
    v_mul_f32 v24, v24, v69
    v_mfma_f32_16x16x32_bf16 v[212:215], v[40:43], a[120:123], v[212:215]
    v_exp_f32 v23, v23
    v_mfma_f32_16x16x32_bf16 v[216:219], v[40:43], a[184:187], v[216:219]
    ds_read_b64_tr_b16 v[36:37], v8 offset:4096
    v_mul_f32 v25, v25, v70
    v_mfma_f32_16x16x32_bf16 v[216:219], v[44:47], a[188:191], v[216:219]
    ds_read_b64_tr_b16 v[38:39], v8 offset:4608
    v_mul_f32 v26, v26, v71
    v_mfma_f32_16x16x32_bf16 v[220:223], v[44:47], a[252:255], v[220:223]
    s_add_u32 s43, s76, 193664
    buffer_load_dwordx4 v3, s[12:15], s43 offen offset:3072 lds
    v_mfma_f32_16x16x32_bf16 v[220:223], v[40:43], a[248:251], v[220:223]
    s_waitcnt lgkmcnt(8)
    v_exp_f32 v24, v24
    v_mfma_f32_16x16x32_bf16 v[224:227], v[48:51], a[56:59], v[224:227]
    ds_read_b64_tr_b16 v[40:41], v9 offset:0
    v_add_f32 v23, 1.0, v23
    v_mfma_f32_16x16x32_bf16 v[224:227], v[52:55], a[60:63], v[224:227]
    ds_read_b64_tr_b16 v[42:43], v9 offset:512
    v_add_f32 v24, 1.0, v24
    v_mfma_f32_16x16x32_bf16 v[228:231], v[52:55], a[124:127], v[228:231]
    v_exp_f32 v25, v25
    v_mfma_f32_16x16x32_bf16 v[228:231], v[48:51], a[120:123], v[228:231]
    v_exp_f32 v26, v26
    v_mfma_f32_16x16x32_bf16 v[232:235], v[48:51], a[184:187], v[232:235]
    ds_read_b64_tr_b16 v[44:45], v9 offset:4096
    v_add_f32 v25, 1.0, v25
    v_mfma_f32_16x16x32_bf16 v[232:235], v[52:55], a[188:191], v[232:235]
    ds_read_b64_tr_b16 v[46:47], v9 offset:4608
    v_add_f32 v26, 1.0, v26
    v_mfma_f32_16x16x32_bf16 v[236:239], v[52:55], a[252:255], v[236:239]
    v_rcp_f32 v23, v23
    v_mfma_f32_16x16x32_bf16 v[236:239], v[48:51], a[248:251], v[236:239]
    s_waitcnt lgkmcnt(8)
    v_rcp_f32 v24, v24
    v_mfma_f32_16x16x32_bf16 v[240:243], v[56:59], a[56:59], v[240:243]
    ds_read_b64_tr_b16 v[48:49], v10 offset:0
    v_mul_f32 v68, v68, v23
    v_mfma_f32_16x16x32_bf16 v[240:243], v[60:63], a[60:63], v[240:243]
    ds_read_b64_tr_b16 v[50:51], v10 offset:512
    v_mul_f32 v69, v69, v24
    v_mfma_f32_16x16x32_bf16 v[244:247], v[60:63], a[124:127], v[244:247]
    v_rcp_f32 v25, v25
    v_mfma_f32_16x16x32_bf16 v[244:247], v[56:59], a[120:123], v[244:247]
    v_rcp_f32 v26, v26
    v_mfma_f32_16x16x32_bf16 v[248:251], v[56:59], a[184:187], v[248:251]
    ds_read_b64_tr_b16 v[52:53], v10 offset:4096
    v_mul_f32 v70, v70, v25
    v_mfma_f32_16x16x32_bf16 v[248:251], v[60:63], a[188:191], v[248:251]
    ds_read_b64_tr_b16 v[54:55], v10 offset:4608
    v_mul_f32 v71, v71, v26
    v_mfma_f32_16x16x32_bf16 v[252:255], v[60:63], a[252:255], v[252:255]
    v_mul_f32 v27, v84, v84
    v_mul_f32 v28, v85, v85
    v_mfma_f32_16x16x32_bf16 v[252:255], v[56:59], a[248:251], v[252:255]
    s_waitcnt lgkmcnt(8)
    v_mul_f32 v29, v86, v86
    v_mul_f32 v22, v87, v87
    v_mfma_f32_16x16x32_bf16 v[128:131], v[32:35], a[0:3], 0
    ds_read_b64_tr_b16 v[56:57], v11 offset:0
    v_fmaak_f32 v27, v18, v27, 0xc0135761
    v_mfma_f32_16x16x32_bf16 v[128:131], v[36:39], a[4:7], v[128:131]
    ds_read_b64_tr_b16 v[58:59], v11 offset:512
    v_fmaak_f32 v28, v18, v28, 0xc0135761
    v_mfma_f32_16x16x32_bf16 v[132:135], v[36:39], a[68:71], 0
    v_fmaak_f32 v29, v18, v29, 0xc0135761
    v_fmaak_f32 v22, v18, v22, 0xc0135761
    v_mfma_f32_16x16x32_bf16 v[132:135], v[32:35], a[64:67], v[132:135]
    v_mul_f32 v27, v27, v84
    v_mul_f32 v28, v28, v85
    v_mfma_f32_16x16x32_bf16 v[136:139], v[32:35], a[128:131], 0
    ds_read_b64_tr_b16 v[60:61], v11 offset:4096
    v_mul_f32 v29, v29, v86
    v_mfma_f32_16x16x32_bf16 v[136:139], v[36:39], a[132:135], v[136:139]
    ds_read_b64_tr_b16 v[62:63], v11 offset:4608
    v_mul_f32 v22, v22, v87
    v_mfma_f32_16x16x32_bf16 v[140:143], v[36:39], a[196:199], 0
    v_exp_f32 v27, v27
    v_mfma_f32_16x16x32_bf16 v[140:143], v[32:35], a[192:195], v[140:143]
    s_waitcnt lgkmcnt(8)
    v_exp_f32 v28, v28
    v_mfma_f32_16x16x32_bf16 v[144:147], v[40:43], a[0:3], 0
    ds_read_b64_tr_b16 v[32:33], v8 offset:8192
    v_cvt_pk_bf16_f32 v64, v192, v193
    v_mfma_f32_16x16x32_bf16 v[144:147], v[44:47], a[4:7], v[144:147]
    ds_read_b64_tr_b16 v[34:35], v8 offset:8704
    v_cvt_pk_bf16_f32 v65, v194, v195
    v_mfma_f32_16x16x32_bf16 v[148:151], v[44:47], a[68:71], 0
    v_cvt_pk_bf16_f32 v66, v208, v209
    v_cvt_pk_bf16_f32 v67, v210, v211
    v_mfma_f32_16x16x32_bf16 v[148:151], v[40:43], a[64:67], v[148:151]
    v_cvt_pk_bf16_f32 v80, v224, v225
    v_cvt_pk_bf16_f32 v81, v226, v227
    v_mfma_f32_16x16x32_bf16 v[152:155], v[40:43], a[128:131], 0
    ds_read_b64_tr_b16 v[36:37], v8 offset:12288
    v_cvt_pk_bf16_f32 v82, v240, v241
    v_mfma_f32_16x16x32_bf16 v[152:155], v[44:47], a[132:135], v[152:155]
    ds_read_b64_tr_b16 v[38:39], v8 offset:12800
    v_cvt_pk_bf16_f32 v83, v242, v243
    v_mfma_f32_16x16x32_bf16 v[156:159], v[44:47], a[196:199], 0
    v_exp_f32 v29, v29
    v_mfma_f32_16x16x32_bf16 v[156:159], v[40:43], a[192:195], v[156:159]
    s_waitcnt lgkmcnt(8)
    v_exp_f32 v22, v22
    v_mfma_f32_16x16x32_bf16 v[160:163], v[48:51], a[0:3], 0
    ds_read_b64_tr_b16 v[40:41], v9 offset:8192
    v_add_f32 v27, 1.0, v27
    v_mfma_f32_16x16x32_bf16 v[160:163], v[52:55], a[4:7], v[160:163]
    ds_read_b64_tr_b16 v[42:43], v9 offset:8704
    v_add_f32 v28, 1.0, v28
    v_mfma_f32_16x16x32_bf16 v[164:167], v[52:55], a[68:71], 0
    v_rcp_f32 v27, v27
    v_mfma_f32_16x16x32_bf16 v[164:167], v[48:51], a[64:67], v[164:167]
    v_rcp_f32 v28, v28
    v_mfma_f32_16x16x32_bf16 v[168:171], v[48:51], a[128:131], 0
    ds_read_b64_tr_b16 v[44:45], v9 offset:12288
    v_add_f32 v29, 1.0, v29
    v_mfma_f32_16x16x32_bf16 v[168:171], v[52:55], a[132:135], v[168:171]
    ds_read_b64_tr_b16 v[46:47], v9 offset:12800
    v_add_f32 v22, 1.0, v22
    v_mfma_f32_16x16x32_bf16 v[172:175], v[52:55], a[196:199], 0
    buffer_load_dword v21, v20, s[36:39], s7 offen sc1
    v_mfma_f32_16x16x32_bf16 v[172:175], v[48:51], a[192:195], v[172:175]
    s_waitcnt lgkmcnt(8)
    v_rcp_f32 v29, v29
    v_mfma_f32_16x16x32_bf16 v[176:179], v[56:59], a[0:3], 0
    ds_read_b64_tr_b16 v[48:49], v10 offset:8192
    v_mul_f32 v84, v84, v27
    v_mfma_f32_16x16x32_bf16 v[176:179], v[60:63], a[4:7], v[176:179]
    ds_read_b64_tr_b16 v[50:51], v10 offset:8704
    v_mul_f32 v85, v85, v28
    v_mfma_f32_16x16x32_bf16 v[180:183], v[60:63], a[68:71], 0
    v_rcp_f32 v22, v22
    v_mfma_f32_16x16x32_bf16 v[180:183], v[56:59], a[64:67], v[180:183]
    v_mul_f32 v86, v86, v29
    v_mul_f32 v87, v87, v22
    v_mfma_f32_16x16x32_bf16 v[184:187], v[56:59], a[128:131], 0
    ds_read_b64_tr_b16 v[52:53], v10 offset:12288
    v_cvt_pk_bf16_f32 v68, v68, v69
    v_mfma_f32_16x16x32_bf16 v[184:187], v[60:63], a[132:135], v[184:187]
    ds_read_b64_tr_b16 v[54:55], v10 offset:12800
    v_cvt_pk_bf16_f32 v69, v70, v71
    v_mfma_f32_16x16x32_bf16 v[188:191], v[60:63], a[196:199], 0
    v_cvt_pk_bf16_f32 v70, v84, v85
    v_cvt_pk_bf16_f32 v71, v86, v87
    v_mfma_f32_16x16x32_bf16 v[188:191], v[56:59], a[192:195], v[188:191]
    s_waitcnt lgkmcnt(8)
    buffer_store_dwordx4 v[68:71], v1, s[16:19], s86 offen offset:0 sc0 sc1
    v_mfma_f32_16x16x32_bf16 v[128:131], v[32:35], a[8:11], v[128:131]
    ds_read_b64_tr_b16 v[56:57], v11 offset:8192
    v_mul_f32 v23, v72, v72
    v_mfma_f32_16x16x32_bf16 v[128:131], v[36:39], a[12:15], v[128:131]
    ds_read_b64_tr_b16 v[58:59], v11 offset:8704
    v_cvt_pk_bf16_f32 v68, v196, v197
    v_mfma_f32_16x16x32_bf16 v[132:135], v[36:39], a[76:79], v[132:135]
    v_cvt_pk_bf16_f32 v69, v198, v199
    v_cvt_pk_bf16_f32 v70, v212, v213
    v_mfma_f32_16x16x32_bf16 v[132:135], v[32:35], a[72:75], v[132:135]
    v_cvt_pk_bf16_f32 v71, v214, v215
    v_cvt_pk_bf16_f32 v84, v228, v229
    v_mfma_f32_16x16x32_bf16 v[136:139], v[32:35], a[136:139], v[136:139]
    ds_read_b64_tr_b16 v[60:61], v11 offset:12288
    v_cvt_pk_bf16_f32 v85, v230, v231
    v_mfma_f32_16x16x32_bf16 v[136:139], v[36:39], a[140:143], v[136:139]
    ds_read_b64_tr_b16 v[62:63], v11 offset:12800
    v_cvt_pk_bf16_f32 v86, v244, v245
    v_mfma_f32_16x16x32_bf16 v[140:143], v[36:39], a[204:207], v[140:143]
    v_cvt_pk_bf16_f32 v87, v246, v247
    v_mul_f32 v24, v73, v73
    v_mfma_f32_16x16x32_bf16 v[140:143], v[32:35], a[200:203], v[140:143]
    s_waitcnt lgkmcnt(8)
    v_mul_f32 v25, v74, v74
    v_mul_f32 v26, v75, v75
    v_mfma_f32_16x16x32_bf16 v[144:147], v[40:43], a[8:11], v[144:147]
    s_waitcnt vmcnt(11)
    s_barrier
    ds_read_b64_tr_b16 v[32:33], v8 offset:16384
    v_mfma_f32_16x16x32_bf16 v[144:147], v[44:47], a[12:15], v[144:147]
    ds_read_b64_tr_b16 v[34:35], v8 offset:16896
    v_fmaak_f32 v23, v18, v23, 0xc0135761
    v_mfma_f32_16x16x32_bf16 v[148:151], v[44:47], a[76:79], v[148:151]
    v_fmaak_f32 v24, v18, v24, 0xc0135761
    v_fmaak_f32 v25, v18, v25, 0xc0135761
    v_mfma_f32_16x16x32_bf16 v[148:151], v[40:43], a[72:75], v[148:151]
    v_fmaak_f32 v26, v18, v26, 0xc0135761
    v_mul_f32 v23, v23, v72
    v_mfma_f32_16x16x32_bf16 v[152:155], v[40:43], a[136:139], v[152:155]
    ds_read_b64_tr_b16 v[36:37], v8 offset:20480
    v_mul_f32 v24, v24, v73
    v_mfma_f32_16x16x32_bf16 v[152:155], v[44:47], a[140:143], v[152:155]
    ds_read_b64_tr_b16 v[38:39], v8 offset:20992
    v_mul_f32 v25, v25, v74
    v_mfma_f32_16x16x32_bf16 v[156:159], v[44:47], a[204:207], v[156:159]
    v_exp_f32 v23, v23
    v_mfma_f32_16x16x32_bf16 v[156:159], v[40:43], a[200:203], v[156:159]
    s_waitcnt lgkmcnt(8)
    v_exp_f32 v24, v24
    v_mfma_f32_16x16x32_bf16 v[160:163], v[48:51], a[8:11], v[160:163]
    ds_read_b64_tr_b16 v[40:41], v9 offset:16384
    v_mul_f32 v26, v26, v75
    v_mfma_f32_16x16x32_bf16 v[160:163], v[52:55], a[12:15], v[160:163]
    ds_read_b64_tr_b16 v[42:43], v9 offset:16896
    v_add_f32 v23, 1.0, v23
    v_mfma_f32_16x16x32_bf16 v[164:167], v[52:55], a[76:79], v[164:167]
    v_exp_f32 v25, v25
    v_mfma_f32_16x16x32_bf16 v[164:167], v[48:51], a[72:75], v[164:167]
    v_exp_f32 v26, v26
    v_mfma_f32_16x16x32_bf16 v[168:171], v[48:51], a[136:139], v[168:171]
    ds_read_b64_tr_b16 v[44:45], v9 offset:20480
    v_add_f32 v24, 1.0, v24
    v_mfma_f32_16x16x32_bf16 v[168:171], v[52:55], a[140:143], v[168:171]
    ds_read_b64_tr_b16 v[46:47], v9 offset:20992
    v_add_f32 v25, 1.0, v25
    v_mfma_f32_16x16x32_bf16 v[172:175], v[52:55], a[204:207], v[172:175]
    v_rcp_f32 v23, v23
    v_mfma_f32_16x16x32_bf16 v[172:175], v[48:51], a[200:203], v[172:175]
    s_waitcnt lgkmcnt(8)
    v_rcp_f32 v24, v24
    v_mfma_f32_16x16x32_bf16 v[176:179], v[56:59], a[8:11], v[176:179]
    ds_read_b64_tr_b16 v[48:49], v10 offset:16384
    v_add_f32 v26, 1.0, v26
    v_mfma_f32_16x16x32_bf16 v[176:179], v[60:63], a[12:15], v[176:179]
    ds_read_b64_tr_b16 v[50:51], v10 offset:16896
    v_mul_f32 v72, v72, v23
    v_mfma_f32_16x16x32_bf16 v[180:183], v[60:63], a[76:79], v[180:183]
    v_rcp_f32 v25, v25
    v_mfma_f32_16x16x32_bf16 v[180:183], v[56:59], a[72:75], v[180:183]
    v_rcp_f32 v26, v26
    v_mfma_f32_16x16x32_bf16 v[184:187], v[56:59], a[136:139], v[184:187]
    s_waitcnt vmcnt(1)
    ds_read_b64_tr_b16 v[52:53], v10 offset:20480
    v_mul_f32 v73, v73, v24
    v_mfma_f32_16x16x32_bf16 v[184:187], v[60:63], a[140:143], v[184:187]
    ds_read_b64_tr_b16 v[54:55], v10 offset:20992
    v_cmp_gt_u32 vcc, 1, v21
    s_nop 3
    s_cbranch_vccnz L_spin1
L_spun1:
    v_mfma_f32_16x16x32_bf16 v[188:191], v[60:63], a[204:207], v[188:191]
    v_mul_f32 v74, v74, v25
    v_mul_f32 v75, v75, v26
    v_mfma_f32_16x16x32_bf16 v[188:191], v[56:59], a[200:203], v[188:191]
    s_waitcnt lgkmcnt(8)
    v_mul_f32 v27, v88, v88
    v_mul_f32 v28, v89, v89
    v_mfma_f32_16x16x32_bf16 v[128:131], v[32:35], a[16:19], v[128:131]
    ds_read_b64_tr_b16 v[56:57], v11 offset:16384
    v_mul_f32 v29, v90, v90
    v_mfma_f32_16x16x32_bf16 v[128:131], v[36:39], a[20:23], v[128:131]
    ds_read_b64_tr_b16 v[58:59], v11 offset:16896
    v_mul_f32 v22, v91, v91
    v_mfma_f32_16x16x32_bf16 v[132:135], v[36:39], a[84:87], v[132:135]
    s_add_u32 m0, s93, 131072
    v_fmaak_f32 v27, v18, v27, 0xc0135761
    v_fmaak_f32 v28, v18, v28, 0xc0135761
    v_mfma_f32_16x16x32_bf16 v[132:135], v[32:35], a[80:83], v[132:135]
    s_mov_b32 s43, 0
    buffer_load_dwordx4 v13, s[20:23], s43 offen offset:0 sc1 lds
    v_mfma_f32_16x16x32_bf16 v[136:139], v[32:35], a[144:147], v[136:139]
    ds_read_b64_tr_b16 v[60:61], v11 offset:20480
    v_fmaak_f32 v29, v18, v29, 0xc0135761
    v_mfma_f32_16x16x32_bf16 v[136:139], v[36:39], a[148:151], v[136:139]
    ds_read_b64_tr_b16 v[62:63], v11 offset:20992
    v_fmaak_f32 v22, v18, v22, 0xc0135761
    v_mfma_f32_16x16x32_bf16 v[140:143], v[36:39], a[212:215], v[140:143]
    v_mul_f32 v27, v27, v88
    v_mul_f32 v28, v28, v89
    v_mfma_f32_16x16x32_bf16 v[140:143], v[32:35], a[208:211], v[140:143]
    s_waitcnt lgkmcnt(8)
    v_exp_f32 v27, v27
    v_mfma_f32_16x16x32_bf16 v[144:147], v[40:43], a[16:19], v[144:147]
    ds_read_b64_tr_b16 v[32:33], v8 offset:24576
    v_mul_f32 v29, v29, v90
    v_mfma_f32_16x16x32_bf16 v[144:147], v[44:47], a[20:23], v[144:147]
    ds_read_b64_tr_b16 v[34:35], v8 offset:25088
    buffer_load_dwordx4 v13, s[20:23], s43 offen offset:1024 sc1 lds
    v_mfma_f32_16x16x32_bf16 v[148:151], v[44:47], a[84:87], v[148:151]
    v_exp_f32 v28, v28
    v_mfma_f32_16x16x32_bf16 v[148:151], v[40:43], a[80:83], v[148:151]
    v_exp_f32 v29, v29
    v_mfma_f32_16x16x32_bf16 v[152:155], v[40:43], a[144:147], v[152:155]
    ds_read_b64_tr_b16 v[36:37], v8 offset:28672
    v_mul_f32 v22, v22, v91
    v_mfma_f32_16x16x32_bf16 v[152:155], v[44:47], a[148:151], v[152:155]
    ds_read_b64_tr_b16 v[38:39], v8 offset:29184
    v_add_f32 v27, 1.0, v27
    v_mfma_f32_16x16x32_bf16 v[156:159], v[44:47], a[212:215], v[156:159]
    s_add_u32 m0, s93, 147456
    v_exp_f32 v22, v22
    v_mfma_f32_16x16x32_bf16 v[156:159], v[40:43], a[208:211], v[156:159]
    s_waitcnt lgkmcnt(8)
    s_mov_b32 s43, 16384
    buffer_load_dwordx4 v13, s[20:23], s43 offen offset:0 sc1 lds
    v_mfma_f32_16x16x32_bf16 v[160:163], v[48:51], a[16:19], v[160:163]
    ds_read_b64_tr_b16 v[40:41], v9 offset:24576
    v_add_f32 v28, 1.0, v28
    v_mfma_f32_16x16x32_bf16 v[160:163], v[52:55], a[20:23], v[160:163]
    ds_read_b64_tr_b16 v[42:43], v9 offset:25088
    v_add_f32 v29, 1.0, v29
    v_mfma_f32_16x16x32_bf16 v[164:167], v[52:55], a[84:87], v[164:167]
    v_rcp_f32 v27, v27
    v_mfma_f32_16x16x32_bf16 v[164:167], v[48:51], a[80:83], v[164:167]
    v_rcp_f32 v28, v28
    v_mfma_f32_16x16x32_bf16 v[168:171], v[48:51], a[144:147], v[168:171]
    ds_read_b64_tr_b16 v[44:45], v9 offset:28672
    v_add_f32 v22, 1.0, v22
    v_mfma_f32_16x16x32_bf16 v[168:171], v[52:55], a[148:151], v[168:171]
    ds_read_b64_tr_b16 v[46:47], v9 offset:29184
    buffer_load_dwordx4 v13, s[20:23], s43 offen offset:1024 sc1 lds
    v_mfma_f32_16x16x32_bf16 v[172:175], v[52:55], a[212:215], v[172:175]
    v_rcp_f32 v29, v29
    v_mfma_f32_16x16x32_bf16 v[172:175], v[48:51], a[208:211], v[172:175]
    s_waitcnt lgkmcnt(8)
    v_rcp_f32 v22, v22
    v_mfma_f32_16x16x32_bf16 v[176:179], v[56:59], a[16:19], v[176:179]
    ds_read_b64_tr_b16 v[48:49], v10 offset:24576
    v_mul_f32 v88, v88, v27
    v_mfma_f32_16x16x32_bf16 v[176:179], v[60:63], a[20:23], v[176:179]
    ds_read_b64_tr_b16 v[50:51], v10 offset:25088
    v_mul_f32 v89, v89, v28
    v_mfma_f32_16x16x32_bf16 v[180:183], v[60:63], a[84:87], v[180:183]
    v_mul_f32 v90, v90, v29
    v_mul_f32 v91, v91, v22
    v_mfma_f32_16x16x32_bf16 v[180:183], v[56:59], a[80:83], v[180:183]
    v_cvt_pk_bf16_f32 v72, v72, v73
    v_cvt_pk_bf16_f32 v73, v74, v75
    v_mfma_f32_16x16x32_bf16 v[184:187], v[56:59], a[144:147], v[184:187]
    s_add_u32 m0, s93, 0
    ds_read_b64_tr_b16 v[52:53], v10 offset:28672
    v_cvt_pk_bf16_f32 v74, v88, v89
    v_mfma_f32_16x16x32_bf16 v[184:187], v[60:63], a[148:151], v[184:187]
    s_mov_b32 s43, 32768
    ds_read_b64_tr_b16 v[54:55], v10 offset:29184
    buffer_load_dwordx4 v13, s[20:23], s43 offen offset:0 sc1 lds
    v_mfma_f32_16x16x32_bf16 v[188:191], v[60:63], a[212:215], v[188:191]
    v_cvt_pk_bf16_f32 v75, v90, v91
    v_mul_f32 v23, v76, v76
    v_mfma_f32_16x16x32_bf16 v[188:191], v[56:59], a[208:211], v[188:191]
    s_waitcnt lgkmcnt(8)
    buffer_store_dwordx4 v[72:75], v1, s[16:19], s87 offen offset:0 sc0 sc1
    v_mfma_f32_16x16x32_bf16 v[128:131], v[32:35], a[24:27], v[128:131]
    ds_read_b64_tr_b16 v[56:57], v11 offset:24576
    v_mul_f32 v24, v77, v77
    v_mfma_f32_16x16x32_bf16 v[128:131], v[36:39], a[28:31], v[128:131]
    ds_read_b64_tr_b16 v[58:59], v11 offset:25088
    v_cvt_pk_bf16_f32 v72, v200, v201
    v_mfma_f32_16x16x32_bf16 v[132:135], v[36:39], a[92:95], v[132:135]
    v_cvt_pk_bf16_f32 v73, v202, v203
    v_cvt_pk_bf16_f32 v74, v216, v217
    v_mfma_f32_16x16x32_bf16 v[132:135], v[32:35], a[88:91], v[132:135]
    v_cvt_pk_bf16_f32 v75, v218, v219
    v_cvt_pk_bf16_f32 v88, v232, v233
    v_mfma_f32_16x16x32_bf16 v[136:139], v[32:35], a[152:155], v[136:139]
    ds_read_b64_tr_b16 v[60:61], v11 offset:28672
    v_cvt_pk_bf16_f32 v89, v234, v235
    v_mfma_f32_16x16x32_bf16 v[136:139], v[36:39], a[156:159], v[136:139]
    ds_read_b64_tr_b16 v[62:63], v11 offset:29184
    buffer_load_dwordx4 v13, s[20:23], s43 offen offset:1024 sc1 lds
    v_mfma_f32_16x16x32_bf16 v[140:143], v[36:39], a[220:223], v[140:143]
    v_cvt_pk_bf16_f32 v90, v248, v249
    v_cvt_pk_bf16_f32 v91, v250, v251
    v_mfma_f32_16x16x32_bf16 v[140:143], v[32:35], a[216:219], v[140:143]
    s_waitcnt lgkmcnt(8)
    v_mul_f32 v25, v78, v78
    v_mul_f32 v26, v79, v79
    v_mfma_f32_16x16x32_bf16 v[144:147], v[40:43], a[24:27], v[144:147]
    s_barrier
    ds_read_b64_tr_b16 v[32:33], v8 offset:32768
    v_mfma_f32_16x16x32_bf16 v[144:147], v[44:47], a[28:31], v[144:147]
    ds_read_b64_tr_b16 v[34:35], v8 offset:33280
    v_fmaak_f32 v23, v18, v23, 0xc0135761
    v_mfma_f32_16x16x32_bf16 v[148:151], v[44:47], a[92:95], v[148:151]
    v_fmaak_f32 v24, v18, v24, 0xc0135761
    v_fmaak_f32 v25, v18, v25, 0xc0135761
    v_mfma_f32_16x16x32_bf16 v[148:151], v[40:43], a[88:91], v[148:151]
    v_fmaak_f32 v26, v18, v26, 0xc0135761
    v_mul_f32 v23, v23, v76
    v_mfma_f32_16x16x32_bf16 v[152:155], v[40:43], a[152:155], v[152:155]
    ds_read_b64_tr_b16 v[36:37], v8 offset:36864
    v_mul_f32 v24, v24, v77
    v_mfma_f32_16x16x32_bf16 v[152:155], v[44:47], a[156:159], v[152:155]
    s_add_u32 m0, s93, 8192
    ds_read_b64_tr_b16 v[38:39], v8 offset:37376
    v_mul_f32 v25, v25, v78
    v_mfma_f32_16x16x32_bf16 v[156:159], v[44:47], a[220:223], v[156:159]
    s_mov_b32 s43, 8192
    buffer_load_dwordx4 v13, s[20:23], s43 offen offset:0 sc1 lds
    v_mfma_f32_16x16x32_bf16 v[156:159], v[40:43], a[216:219], v[156:159]
    s_waitcnt lgkmcnt(8)
    v_exp_f32 v23, v23
    v_mfma_f32_16x16x32_bf16 v[160:163], v[48:51], a[24:27], v[160:163]
    ds_read_b64_tr_b16 v[40:41], v9 offset:32768
    v_mul_f32 v26, v26, v79
    v_mfma_f32_16x16x32_bf16 v[160:163], v[52:55], a[28:31], v[160:163]
    ds_read_b64_tr_b16 v[42:43], v9 offset:33280
    v_add_f32 v23, 1.0, v23
    v_mfma_f32_16x16x32_bf16 v[164:167], v[52:55], a[92:95], v[164:167]
    v_exp_f32 v24, v24
    v_mfma_f32_16x16x32_bf16 v[164:167], v[48:51], a[88:91], v[164:167]
    v_exp_f32 v25, v25
    v_mfma_f32_16x16x32_bf16 v[168:171], v[48:51], a[152:155], v[168:171]
    ds_read_b64_tr_b16 v[44:45], v9 offset:36864
    v_add_f32 v24, 1.0, v24
    v_mfma_f32_16x16x32_bf16 v[168:171], v[52:55], a[156:159], v[168:171]
    ds_read_b64_tr_b16 v[46:47], v9 offset:37376
    v_add_f32 v25, 1.0, v25
    v_mfma_f32_16x16x32_bf16 v[172:175], v[52:55], a[220:223], v[172:175]
    buffer_load_dwordx4 v13, s[20:23], s43 offen offset:1024 sc1 lds
    v_mfma_f32_16x16x32_bf16 v[172:175], v[48:51], a[216:219], v[172:175]
    s_waitcnt lgkmcnt(8)
    v_exp_f32 v26, v26
    v_mfma_f32_16x16x32_bf16 v[176:179], v[56:59], a[24:27], v[176:179]
    ds_read_b64_tr_b16 v[48:49], v10 offset:32768
    v_add_f32 v26, 1.0, v26
    v_mfma_f32_16x16x32_bf16 v[176:179], v[60:63], a[28:31], v[176:179]
    ds_read_b64_tr_b16 v[50:51], v10 offset:33280
    v_mul_f32 v27, v92, v92
    v_mfma_f32_16x16x32_bf16 v[180:183], v[60:63], a[92:95], v[180:183]
    v_rcp_f32 v23, v23
    v_mfma_f32_16x16x32_bf16 v[180:183], v[56:59], a[88:91], v[180:183]
    v_rcp_f32 v24, v24
    v_mfma_f32_16x16x32_bf16 v[184:187], v[56:59], a[152:155], v[184:187]
    ds_read_b64_tr_b16 v[52:53], v10 offset:36864
    v_mul_f32 v76, v76, v23
    v_mfma_f32_16x16x32_bf16 v[184:187], v[60:63], a[156:159], v[184:187]
    ds_read_b64_tr_b16 v[54:55], v10 offset:37376
    v_mul_f32 v77, v77, v24
    v_mfma_f32_16x16x32_bf16 v[188:191], v[60:63], a[220:223], v[188:191]
    s_add_u32 m0, s93, 16384
    v_rcp_f32 v25, v25
    v_mfma_f32_16x16x32_bf16 v[188:191], v[56:59], a[216:219], v[188:191]
    s_waitcnt lgkmcnt(8)
    s_mov_b32 s43, 49152
    buffer_load_dwordx4 v13, s[20:23], s43 offen offset:0 sc1 lds
    v_mfma_f32_16x16x32_bf16 v[128:131], v[32:35], a[32:35], v[128:131]
    ds_read_b64_tr_b16 v[56:57], v11 offset:32768
    v_mul_f32 v78, v78, v25
    v_mfma_f32_16x16x32_bf16 v[128:131], v[36:39], a[36:39], v[128:131]
    ds_read_b64_tr_b16 v[58:59], v11 offset:33280
    v_mul_f32 v28, v93, v93
    v_mfma_f32_16x16x32_bf16 v[132:135], v[36:39], a[100:103], v[132:135]
    v_rcp_f32 v26, v26
    v_mfma_f32_16x16x32_bf16 v[132:135], v[32:35], a[96:99], v[132:135]
    v_mul_f32 v79, v79, v26
    v_mul_f32 v29, v94, v94
    v_mfma_f32_16x16x32_bf16 v[136:139], v[32:35], a[160:163], v[136:139]
    ds_read_b64_tr_b16 v[60:61], v11 offset:36864
    v_mul_f32 v22, v95, v95
    v_mfma_f32_16x16x32_bf16 v[136:139], v[36:39], a[164:167], v[136:139]
    ds_read_b64_tr_b16 v[62:63], v11 offset:37376
    v_fmaak_f32 v27, v18, v27, 0xc0135761
    v_mfma_f32_16x16x32_bf16 v[140:143], v[36:39], a[228:231], v[140:143]
    v_fmaak_f32 v28, v18, v28, 0xc0135761
    v_fmaak_f32 v29, v18, v29, 0xc0135761
    v_mfma_f32_16x16x32_bf16 v[140:143], v[32:35], a[224:227], v[140:143]
    s_waitcnt lgkmcnt(8)
    buffer_load_dwordx4 v13, s[20:23], s43 offen offset:1024 sc1 lds
    v_mfma_f32_16x16x32_bf16 v[144:147], v[40:43], a[32:35], v[144:147]
    ds_read_b64_tr_b16 v[32:33], v8 offset:40960
    v_fmaak_f32 v22, v18, v22, 0xc0135761
    v_mfma_f32_16x16x32_bf16 v[144:147], v[44:47], a[36:39], v[144:147]
    ds_read_b64_tr_b16 v[34:35], v8 offset:41472
    v_mul_f32 v27, v27, v92
    v_mfma_f32_16x16x32_bf16 v[148:151], v[44:47], a[100:103], v[148:151]
    v_exp_f32 v27, v27
    v_mfma_f32_16x16x32_bf16 v[148:151], v[40:43], a[96:99], v[148:151]
    v_mul_f32 v28, v28, v93
    v_mul_f32 v29, v29, v94
    v_mfma_f32_16x16x32_bf16 v[152:155], v[40:43], a[160:163], v[152:155]
    ds_read_b64_tr_b16 v[36:37], v8 offset:45056
    v_mul_f32 v22, v22, v95
    v_mfma_f32_16x16x32_bf16 v[152:155], v[44:47], a[164:167], v[152:155]
    ds_read_b64_tr_b16 v[38:39], v8 offset:45568
    v_add_f32 v27, 1.0, v27
    v_mfma_f32_16x16x32_bf16 v[156:159], v[44:47], a[228:231], v[156:159]
    v_exp_f32 v28, v28
    v_mfma_f32_16x16x32_bf16 v[156:159], v[40:43], a[224:227], v[156:159]
    s_waitcnt lgkmcnt(8)
    v_exp_f32 v29, v29
    v_mfma_f32_16x16x32_bf16 v[160:163], v[48:51], a[32:35], v[160:163]
    s_add_u32 m0, s93, 24576
    ds_read_b64_tr_b16 v[40:41], v9 offset:40960
    s_mov_b32 s43, 24576
    buffer_load_dwordx4 v13, s[20:23], s43 offen offset:0 sc1 lds
    v_mfma_f32_16x16x32_bf16 v[160:163], v[52:55], a[36:39], v[160:163]
    ds_read_b64_tr_b16 v[42:43], v9 offset:41472
    v_add_f32 v28, 1.0, v28
    v_mfma_f32_16x16x32_bf16 v[164:167], v[52:55], a[100:103], v[164:167]
    v_exp_f32 v22, v22
    v_mfma_f32_16x16x32_bf16 v[164:167], v[48:51], a[96:99], v[164:167]
    v_rcp_f32 v27, v27
    v_mfma_f32_16x16x32_bf16 v[168:171], v[48:51], a[160:163], v[168:171]
    ds_read_b64_tr_b16 v[44:45], v9 offset:45056
    v_add_f32 v29, 1.0, v29
    v_mfma_f32_16x16x32_bf16 v[168:171], v[52:55], a[164:167], v[168:171]
    ds_read_b64_tr_b16 v[46:47], v9 offset:45568
    v_add_f32 v22, 1.0, v22
    v_mfma_f32_16x16x32_bf16 v[172:175], v[52:55], a[228:231], v[172:175]
    v_rcp_f32 v28, v28
    v_mfma_f32_16x16x32_bf16 v[172:175], v[48:51], a[224:227], v[172:175]
    s_waitcnt lgkmcnt(8)
    v_rcp_f32 v29, v29
    v_mfma_f32_16x16x32_bf16 v[176:179], v[56:59], a[32:35], v[176:179]
    ds_read_b64_tr_b16 v[48:49], v10 offset:40960
    v_mul_f32 v92, v92, v27
    v_mfma_f32_16x16x32_bf16 v[176:179], v[60:63], a[36:39], v[176:179]
    ds_read_b64_tr_b16 v[50:51], v10 offset:41472
    buffer_load_dwordx4 v13, s[20:23], s43 offen offset:1024 sc1 lds
    v_mfma_f32_16x16x32_bf16 v[180:183], v[60:63], a[100:103], v[180:183]
    v_rcp_f32 v22, v22
    v_mfma_f32_16x16x32_bf16 v[180:183], v[56:59], a[96:99], v[180:183]
    v_mul_f32 v93, v93, v28
    v_mul_f32 v94, v94, v29
    v_mfma_f32_16x16x32_bf16 v[184:187], v[56:59], a[160:163], v[184:187]
    ds_read_b64_tr_b16 v[52:53], v10 offset:45056
    v_mul_f32 v95, v95, v22
    v_mfma_f32_16x16x32_bf16 v[184:187], v[60:63], a[164:167], v[184:187]
    ds_read_b64_tr_b16 v[54:55], v10 offset:45568
    v_cvt_pk_bf16_f32 v76, v76, v77
    v_mfma_f32_16x16x32_bf16 v[188:191], v[60:63], a[228:231], v[188:191]
    v_cvt_pk_bf16_f32 v77, v78, v79
    v_cvt_pk_bf16_f32 v78, v92, v93
    v_mfma_f32_16x16x32_bf16 v[188:191], v[56:59], a[224:227], v[188:191]
    s_waitcnt lgkmcnt(8)
    v_cvt_pk_bf16_f32 v79, v94, v95
    v_mul_f32 v23, v96, v96
    v_mfma_f32_16x16x32_bf16 v[128:131], v[32:35], a[40:43], v[128:131]
    ds_read_b64_tr_b16 v[56:57], v11 offset:40960
    v_mul_f32 v24, v97, v97
    v_mfma_f32_16x16x32_bf16 v[128:131], v[36:39], a[44:47], v[128:131]
    s_add_u32 m0, s93, 32768
    ds_read_b64_tr_b16 v[58:59], v11 offset:41472
    v_mul_f32 v25, v98, v98
    v_mfma_f32_16x16x32_bf16 v[132:135], v[36:39], a[108:111], v[132:135]
    s_mov_b32 s43, 65536
    buffer_load_dwordx4 v13, s[20:23], s43 offen offset:0 sc1 lds
    v_mfma_f32_16x16x32_bf16 v[132:135], v[32:35], a[104:107], v[132:135]
    buffer_store_dwordx4 v[76:79], v1, s[16:19], s88 offen offset:0 sc0 sc1
    v_mfma_f32_16x16x32_bf16 v[136:139], v[32:35], a[168:171], v[136:139]
    ds_read_b64_tr_b16 v[60:61], v11 offset:45056
    v_mul_f32 v26, v99, v99
    v_mfma_f32_16x16x32_bf16 v[136:139], v[36:39], a[172:175], v[136:139]
    ds_read_b64_tr_b16 v[62:63], v11 offset:45568
    v_cvt_pk_bf16_f32 v76, v204, v205
    v_mfma_f32_16x16x32_bf16 v[140:143], v[36:39], a[236:239], v[140:143]
    v_cvt_pk_bf16_f32 v77, v206, v207
    v_cvt_pk_bf16_f32 v78, v220, v221
    v_mfma_f32_16x16x32_bf16 v[140:143], v[32:35], a[232:235], v[140:143]
    s_waitcnt lgkmcnt(8)
    v_cvt_pk_bf16_f32 v79, v222, v223
    v_cvt_pk_bf16_f32 v92, v236, v237
    v_mfma_f32_16x16x32_bf16 v[144:147], v[40:43], a[40:43], v[144:147]
    s_waitcnt vmcnt(11)
    s_barrier
    ds_read_b64_tr_b16 v[32:33], v8 offset:49152
    v_mfma_f32_16x16x32_bf16 v[144:147], v[44:47], a[44:47], v[144:147]
    ds_read_b64_tr_b16 v[34:35], v8 offset:49664
    v_cvt_pk_bf16_f32 v93, v238, v239
    v_mfma_f32_16x16x32_bf16 v[148:151], v[44:47], a[108:111], v[148:151]
    buffer_load_dwordx4 v13, s[20:23], s43 offen offset:1024 sc1 lds
    v_mfma_f32_16x16x32_bf16 v[148:151], v[40:43], a[104:107], v[148:151]
    v_cvt_pk_bf16_f32 v94, v252, v253
    v_cvt_pk_bf16_f32 v95, v254, v255
    v_mfma_f32_16x16x32_bf16 v[152:155], v[40:43], a[168:171], v[152:155]
    ds_read_b64_tr_b16 v[36:37], v8 offset:53248
    v_fmaak_f32 v23, v18, v23, 0xc0135761
    v_mfma_f32_16x16x32_bf16 v[152:155], v[44:47], a[172:175], v[152:155]
    ds_read_b64_tr_b16 v[38:39], v8 offset:53760
    v_fmaak_f32 v24, v18, v24, 0xc0135761
    v_mfma_f32_16x16x32_bf16 v[156:159], v[44:47], a[236:239], v[156:159]
    v_fmaak_f32 v25, v18, v25, 0xc0135761
    v_fmaak_f32 v26, v18, v26, 0xc0135761
    v_mfma_f32_16x16x32_bf16 v[156:159], v[40:43], a[232:235], v[156:159]
    s_waitcnt lgkmcnt(8)
    v_mul_f32 v23, v23, v96
    v_mul_f32 v24, v24, v97
    v_mfma_f32_16x16x32_bf16 v[160:163], v[48:51], a[40:43], v[160:163]
    ds_read_b64_tr_b16 v[40:41], v9 offset:49152
    v_mul_f32 v25, v25, v98
    v_mfma_f32_16x16x32_bf16 v[160:163], v[52:55], a[44:47], v[160:163]
    ds_read_b64_tr_b16 v[42:43], v9 offset:49664
    v_mul_f32 v26, v26, v99
    v_mfma_f32_16x16x32_bf16 v[164:167], v[52:55], a[108:111], v[164:167]
    s_add_u32 m0, s93, 40960
    v_exp_f32 v23, v23
    v_mfma_f32_16x16x32_bf16 v[164:167], v[48:51], a[104:107], v[164:167]
    s_mov_b32 s43, 40960
    buffer_load_dwordx4 v13, s[20:23], s43 offen offset:0 sc1 lds
    v_mfma_f32_16x16x32_bf16 v[168:171], v[48:51], a[168:171], v[168:171]
    ds_read_b64_tr_b16 v[44:45], v9 offset:53248
    v_add_f32 v23, 1.0, v23
    v_mfma_f32_16x16x32_bf16 v[168:171], v[52:55], a[172:175], v[168:171]
    ds_read_b64_tr_b16 v[46:47], v9 offset:53760
    v_mul_f32 v27, v112, v112
    v_mfma_f32_16x16x32_bf16 v[172:175], v[52:55], a[236:239], v[172:175]
    v_exp_f32 v24, v24
    v_mfma_f32_16x16x32_bf16 v[172:175], v[48:51], a[232:235], v[172:175]
    s_waitcnt lgkmcnt(8)
    v_exp_f32 v25, v25
    v_mfma_f32_16x16x32_bf16 v[176:179], v[56:59], a[40:43], v[176:179]
    ds_read_b64_tr_b16 v[48:49], v10 offset:49152
    v_add_f32 v24, 1.0, v24
    v_mfma_f32_16x16x32_bf16 v[176:179], v[60:63], a[44:47], v[176:179]
    ds_read_b64_tr_b16 v[50:51], v10 offset:49664
    v_add_f32 v25, 1.0, v25
    v_mfma_f32_16x16x32_bf16 v[180:183], v[60:63], a[108:111], v[180:183]
    buffer_load_dwordx4 v13, s[20:23], s43 offen offset:1024 sc1 lds
    v_mfma_f32_16x16x32_bf16 v[180:183], v[56:59], a[104:107], v[180:183]
    v_exp_f32 v26, v26
    v_mfma_f32_16x16x32_bf16 v[184:187], v[56:59], a[168:171], v[184:187]
    ds_read_b64_tr_b16 v[52:53], v10 offset:53248
    v_add_f32 v26, 1.0, v26
    v_mfma_f32_16x16x32_bf16 v[184:187], v[60:63], a[172:175], v[184:187]
    ds_read_b64_tr_b16 v[54:55], v10 offset:53760
    v_mul_f32 v28, v113, v113
    v_mfma_f32_16x16x32_bf16 v[188:191], v[60:63], a[236:239], v[188:191]
    v_rcp_f32 v23, v23
    v_mfma_f32_16x16x32_bf16 v[188:191], v[56:59], a[232:235], v[188:191]
    s_waitcnt lgkmcnt(8)
    v_rcp_f32 v24, v24
    v_mfma_f32_16x16x32_bf16 v[128:131], v[32:35], a[48:51], v[128:131]
    ds_read_b64_tr_b16 v[56:57], v11 offset:49152
    v_mul_f32 v96, v96, v23
    v_mfma_f32_16x16x32_bf16 v[128:131], v[36:39], a[52:55], v[128:131]
    ds_read_b64_tr_b16 v[58:59], v11 offset:49664
    v_mul_f32 v97, v97, v24
    v_mfma_f32_16x16x32_bf16 v[132:135], v[36:39], a[116:119], v[132:135]
    v_rcp_f32 v25, v25
    v_mfma_f32_16x16x32_bf16 v[132:135], v[32:35], a[112:115], v[132:135]
    s_add_u32 m0, s93, 49152
    v_rcp_f32 v26, v26
    v_mfma_f32_16x16x32_bf16 v[136:139], v[32:35], a[176:179], v[136:139]
    s_mov_b32 s43, 81920
    ds_read_b64_tr_b16 v[60:61], v11 offset:53248
    buffer_load_dwordx4 v13, s[20:23], s43 offen offset:0 sc1 lds
    v_mfma_f32_16x16x32_bf16 v[136:139], v[36:39], a[180:183], v[136:139]
    ds_read_b64_tr_b16 v[62:63], v11 offset:53760
    ds_read_b128 a[32:35], v12 offset:0
    v_mfma_f32_16x16x32_bf16 v[140:143], v[36:39], a[244:247], v[140:143]
    v_mul_f32 v98, v98, v25
    v_mul_f32 v99, v99, v26
    v_mfma_f32_16x16x32_bf16 v[140:143], v[32:35], a[240:243], v[140:143]
    s_waitcnt lgkmcnt(9)
    v_mul_f32 v29, v114, v114
    v_mul_f32 v22, v115, v115
    v_mfma_f32_16x16x32_bf16 v[144:147], v[40:43], a[48:51], v[144:147]
    ds_read_b64_tr_b16 v[32:33], v8 offset:57344
    ds_read_b128 a[36:39], v12 offset:1024
    v_mfma_f32_16x16x32_bf16 v[144:147], v[44:47], a[52:55], v[144:147]
    ds_read_b64_tr_b16 v[34:35], v8 offset:57856
    v_fmaak_f32 v27, v18, v27, 0xc0135761
    v_mfma_f32_16x16x32_bf16 v[148:151], v[44:47], a[116:119], v[148:151]
    v_fmaak_f32 v28, v18, v28, 0xc0135761
    v_fmaak_f32 v29, v18, v29, 0xc0135761
    v_mfma_f32_16x16x32_bf16 v[148:151], v[40:43], a[112:115], v[148:151]
    v_fmaak_f32 v22, v18, v22, 0xc0135761
    v_mul_f32 v27, v27, v112
    v_mfma_f32_16x16x32_bf16 v[152:155], v[40:43], a[176:179], v[152:155]
    ds_read_b64_tr_b16 v[36:37], v8 offset:61440
    ds_read_b128 a[40:43], v12 offset:2048
    v_mfma_f32_16x16x32_bf16 v[152:155], v[44:47], a[180:183], v[152:155]
    ds_read_b64_tr_b16 v[38:39], v8 offset:61952
    buffer_load_dwordx4 v13, s[20:23], s43 offen offset:1024 sc1 lds
    v_mfma_f32_16x16x32_bf16 v[156:159], v[44:47], a[244:247], v[156:159]
    v_exp_f32 v27, v27
    v_mfma_f32_16x16x32_bf16 v[156:159], v[40:43], a[240:243], v[156:159]
    s_waitcnt lgkmcnt(11)
    v_mul_f32 v28, v28, v113
    v_mul_f32 v29, v29, v114
    v_mfma_f32_16x16x32_bf16 v[160:163], v[48:51], a[48:51], v[160:163]
    ds_read_b64_tr_b16 v[40:41], v9 offset:57344
    ds_read_b128 a[44:47], v12 offset:3072
    v_mfma_f32_16x16x32_bf16 v[160:163], v[52:55], a[52:55], v[160:163]
    ds_read_b64_tr_b16 v[42:43], v9 offset:57856
    v_mul_f32 v22, v22, v115
    v_mfma_f32_16x16x32_bf16 v[164:167], v[52:55], a[116:119], v[164:167]
    v_exp_f32 v28, v28
    v_mfma_f32_16x16x32_bf16 v[164:167], v[48:51], a[112:115], v[164:167]
    v_exp_f32 v29, v29
    v_mfma_f32_16x16x32_bf16 v[168:171], v[48:51], a[176:179], v[168:171]
    s_add_u32 m0, s93, 57344
    ds_read_b64_tr_b16 v[44:45], v9 offset:61440
    ds_read_b128 a[96:99], v12 offset:4096
    v_mfma_f32_16x16x32_bf16 v[168:171], v[52:55], a[180:183], v[168:171]
    s_mov_b32 s43, 57344
    ds_read_b64_tr_b16 v[46:47], v9 offset:61952
    buffer_load_dwordx4 v13, s[20:23], s43 offen offset:0 sc1 lds
    v_mfma_f32_16x16x32_bf16 v[172:175], v[52:55], a[244:247], v[172:175]
    v_exp_f32 v22, v22
    v_mfma_f32_16x16x32_bf16 v[172:175], v[48:51], a[240:243], v[172:175]
    s_waitcnt lgkmcnt(13)
    v_add_f32 v27, 1.0, v27
    v_add_f32 v28, 1.0, v28
    v_mfma_f32_16x16x32_bf16 v[176:179], v[56:59], a[48:51], v[176:179]
    ds_read_b64_tr_b16 v[48:49], v10 offset:57344
    ds_read_b128 a[100:103], v12 offset:5120
    v_mfma_f32_16x16x32_bf16 v[176:179], v[60:63], a[52:55], v[176:179]
    ds_read_b64_tr_b16 v[50:51], v10 offset:57856
    v_add_f32 v29, 1.0, v29
    v_mfma_f32_16x16x32_bf16 v[180:183], v[60:63], a[116:119], v[180:183]
    v_rcp_f32 v27, v27
    v_mfma_f32_16x16x32_bf16 v[180:183], v[56:59], a[112:115], v[180:183]
    v_rcp_f32 v28, v28
    v_mfma_f32_16x16x32_bf16 v[184:187], v[56:59], a[176:179], v[184:187]
    ds_read_b64_tr_b16 v[52:53], v10 offset:61440
    ds_read_b128 a[104:107], v12 offset:6144
    v_mfma_f32_16x16x32_bf16 v[184:187], v[60:63], a[180:183], v[184:187]
    ds_read_b64_tr_b16 v[54:55], v10 offset:61952
    v_add_f32 v22, 1.0, v22
    v_mfma_f32_16x16x32_bf16 v[188:191], v[60:63], a[244:247], v[188:191]
    buffer_load_dwordx4 v13, s[20:23], s43 offen offset:1024 sc1 lds
    v_mfma_f32_16x16x32_bf16 v[188:191], v[56:59], a[240:243], v[188:191]
    s_waitcnt lgkmcnt(12)
    v_rcp_f32 v29, v29
    v_mfma_f32_16x16x32_bf16 v[128:131], v[32:35], a[56:59], v[128:131]
    ds_read_b64_tr_b16 v[56:57], v11 offset:57344
    ds_read_b128 a[108:111], v12 offset:7168
    v_mfma_f32_16x16x32_bf16 v[128:131], v[36:39], a[60:63], v[128:131]
    ds_read_b64_tr_b16 v[58:59], v11 offset:57856
    v_mul_f32 v112, v112, v27
    v_mfma_f32_16x16x32_bf16 v[132:135], v[36:39], a[124:127], v[132:135]
    v_rcp_f32 v22, v22
    v_mfma_f32_16x16x32_bf16 v[132:135], v[32:35], a[120:123], v[132:135]
    v_mul_f32 v113, v113, v28
    v_mul_f32 v114, v114, v29
    v_mfma_f32_16x16x32_bf16 v[136:139], v[32:35], a[184:187], v[136:139]
    ds_read_b64_tr_b16 v[60:61], v11 offset:61440
    v_mul_f32 v115, v115, v22
    v_mfma_f32_16x16x32_bf16 v[136:139], v[36:39], a[188:191], v[136:139]
    ds_read_b64_tr_b16 v[62:63], v11 offset:61952
    v_cvt_pk_bf16_f32 v96, v96, v97
    v_mfma_f32_16x16x32_bf16 v[140:143], v[36:39], a[252:255], v[140:143]
    v_cvt_pk_bf16_f32 v97, v98, v99
    v_cvt_pk_bf16_f32 v98, v112, v113
    v_mfma_f32_16x16x32_bf16 v[140:143], v[32:35], a[248:251], v[140:143]
    s_waitcnt lgkmcnt(11)
    v_cvt_pk_bf16_f32 v99, v114, v115
    v_mul_f32 v23, v100, v100
    v_mfma_f32_16x16x32_bf16 v[144:147], v[40:43], a[56:59], v[144:147]
    s_add_u32 m0, s93, 65536
    buffer_store_dwordx4 v[96:99], v1, s[32:35], s85 offen offset:1024 sc0 sc1
    v_mfma_f32_16x16x32_bf16 v[144:147], v[44:47], a[60:63], v[144:147]
    s_mov_b32 s43, 98304
    buffer_load_dwordx4 v13, s[20:23], s43 offen offset:0 sc1 lds
    v_mfma_f32_16x16x32_bf16 v[148:151], v[44:47], a[124:127], v[148:151]
    v_mul_f32 v24, v101, v101
    v_mul_f32 v25, v102, v102
    v_mfma_f32_16x16x32_bf16 v[148:151], v[40:43], a[120:123], v[148:151]
    v_mul_f32 v26, v103, v103
    v_fmaak_f32 v23, v18, v23, 0xc0135761
    v_mfma_f32_16x16x32_bf16 v[152:155], v[40:43], a[184:187], v[152:155]
    v_fmaak_f32 v24, v18, v24, 0xc0135761
    v_fmaak_f32 v25, v18, v25, 0xc0135761
    v_mfma_f32_16x16x32_bf16 v[152:155], v[44:47], a[188:191], v[152:155]
    v_fmaak_f32 v26, v18, v26, 0xc0135761
    v_mul_f32 v23, v23, v100
    v_mfma_f32_16x16x32_bf16 v[156:159], v[44:47], a[252:255], v[156:159]
    v_exp_f32 v23, v23
    v_mfma_f32_16x16x32_bf16 v[156:159], v[40:43], a[248:251], v[156:159]
    s_waitcnt lgkmcnt(5)
    v_mul_f32 v24, v24, v101
    v_mul_f32 v25, v25, v102
    v_mfma_f32_16x16x32_bf16 v[160:163], v[48:51], a[56:59], v[160:163]
    buffer_load_dwordx4 v13, s[20:23], s43 offen offset:1024 sc1 lds
    v_mfma_f32_16x16x32_bf16 v[160:163], v[52:55], a[60:63], v[160:163]
    v_exp_f32 v24, v24
    v_mfma_f32_16x16x32_bf16 v[164:167], v[52:55], a[124:127], v[164:167]
    v_exp_f32 v25, v25
    v_mfma_f32_16x16x32_bf16 v[164:167], v[48:51], a[120:123], v[164:167]
    v_mul_f32 v26, v26, v103
    v_add_f32 v23, 1.0, v23
    v_mfma_f32_16x16x32_bf16 v[168:171], v[48:51], a[184:187], v[168:171]
    v_bfe_u32 v6, v1, 4, 4
    v_lshrrev_b32 v7, 8, v1
    v_mfma_f32_16x16x32_bf16 v[168:171], v[52:55], a[188:191], v[168:171]
    v_lshlrev_b32 v7, 2, v7
    v_sub_u32 v6, v6, v7
    v_mfma_f32_16x16x32_bf16 v[172:175], v[52:55], a[252:255], v[172:175]
    s_lshl_b32 s4, s40, 4
    v_add_u32 v20, s4, v6
    s_sub_u32 s4, 112, s4
    v_add_u32 v21, s4, v6
    v_mfma_f32_16x16x32_bf16 v[172:175], v[48:51], a[248:251], v[172:175]
    s_waitcnt lgkmcnt(0)
    v_exp_f32 v26, v26
    v_mfma_f32_16x16x32_bf16 v[176:179], v[56:59], a[56:59], v[176:179]
    v_rcp_f32 v23, v23
    v_mfma_f32_16x16x32_bf16 v[176:179], v[60:63], a[60:63], v[176:179]
    s_add_u32 m0, s93, 73728
    v_add_f32 v24, 1.0, v24
    v_add_f32 v25, 1.0, v25
    v_mfma_f32_16x16x32_bf16 v[180:183], v[60:63], a[124:127], v[180:183]
    s_mov_b32 s43, 73728
    buffer_load_dwordx4 v13, s[20:23], s43 offen offset:0 sc1 lds
    v_mfma_f32_16x16x32_bf16 v[180:183], v[56:59], a[120:123], v[180:183]
    v_rcp_f32 v24, v24
    v_mfma_f32_16x16x32_bf16 v[184:187], v[56:59], a[184:187], v[184:187]
    v_rcp_f32 v25, v25
    v_mfma_f32_16x16x32_bf16 v[184:187], v[60:63], a[188:191], v[184:187]
    v_add_f32 v26, 1.0, v26
    v_mul_f32 v100, v100, v23
    v_mfma_f32_16x16x32_bf16 v[188:191], v[60:63], a[252:255], v[188:191]
    v_rcp_f32 v26, v26
    v_mfma_f32_16x16x32_bf16 v[188:191], v[56:59], a[248:251], v[188:191]
    v_mul_f32 v101, v101, v24
    v_mul_f32 v102, v102, v25
    v_mfma_f32_16x16x32_bf16 a[0:3], v[14:17], v[14:17], 0
    v_mul_f32 v103, v103, v26
    v_mul_f32 v27, v116, v116
    v_mfma_f32_16x16x32_bf16 a[4:7], v[14:17], v[14:17], 0
    buffer_load_dwordx4 v13, s[20:23], s43 offen offset:1024 sc1 lds
    v_mfma_f32_16x16x32_bf16 a[8:11], v[14:17], v[14:17], 0
    v_mul_f32 v28, v117, v117
    v_mul_f32 v29, v118, v118
    v_mfma_f32_16x16x32_bf16 a[12:15], v[14:17], v[14:17], 0
    v_cvt_pk_bf16_f32 v192, v128, v129
    v_cvt_pk_bf16_f32 v193, v130, v131
    v_mfma_f32_16x16x32_bf16 a[16:19], v[14:17], v[14:17], 0
    v_cvt_pk_bf16_f32 v194, v144, v145
    v_cvt_pk_bf16_f32 v195, v146, v147
    v_mfma_f32_16x16x32_bf16 a[20:23], v[14:17], v[14:17], 0
    v_cvt_pk_bf16_f32 v196, v132, v133
    v_cvt_pk_bf16_f32 v197, v134, v135
    v_mfma_f32_16x16x32_bf16 a[24:27], v[14:17], v[14:17], 0
    v_cvt_pk_bf16_f32 v198, v148, v149
    v_cvt_pk_bf16_f32 v199, v150, v151
    v_mfma_f32_16x16x32_bf16 a[28:31], v[14:17], v[14:17], 0
    v_cvt_pk_bf16_f32 v200, v136, v137
    v_cvt_pk_bf16_f32 v201, v138, v139
    v_mfma_f32_16x16x32_bf16 a[64:67], v[14:17], v[14:17], 0
    v_cvt_pk_bf16_f32 v202, v152, v153
    v_cvt_pk_bf16_f32 v203, v154, v155
    v_mfma_f32_16x16x32_bf16 a[68:71], v[14:17], v[14:17], 0
    v_cvt_pk_bf16_f32 v204, v140, v141
    v_cvt_pk_bf16_f32 v205, v142, v143
    v_mfma_f32_16x16x32_bf16 a[72:75], v[14:17], v[14:17], 0
    s_add_u32 m0, s93, 81920
    v_cvt_pk_bf16_f32 v206, v156, v157
    v_cvt_pk_bf16_f32 v207, v158, v159
    v_mfma_f32_16x16x32_bf16 a[76:79], v[14:17], v[14:17], 0
    s_mov_b32 s43, 114688
    buffer_load_dwordx4 v13, s[20:23], s43 offen offset:0 sc1 lds
    v_mfma_f32_16x16x32_bf16 a[80:83], v[14:17], v[14:17], 0
    v_cvt_pk_bf16_f32 v208, v160, v161
    v_cvt_pk_bf16_f32 v209, v162, v163
    v_mfma_f32_16x16x32_bf16 a[84:87], v[14:17], v[14:17], 0
    v_cvt_pk_bf16_f32 v210, v176, v177
    v_cvt_pk_bf16_f32 v211, v178, v179
    v_mfma_f32_16x16x32_bf16 a[88:91], v[14:17], v[14:17], 0
    v_cvt_pk_bf16_f32 v212, v164, v165
    v_cvt_pk_bf16_f32 v213, v166, v167
    v_mfma_f32_16x16x32_bf16 a[92:95], v[14:17], v[14:17], 0
    v_cvt_pk_bf16_f32 v214, v180, v181
    v_cvt_pk_bf16_f32 v215, v182, v183
    v_mfma_f32_16x16x32_bf16 a[128:131], v[14:17], v[14:17], 0
    v_cvt_pk_bf16_f32 v216, v168, v169
    v_cvt_pk_bf16_f32 v217, v170, v171
    v_mfma_f32_16x16x32_bf16 a[132:135], v[14:17], v[14:17], 0
    v_cvt_pk_bf16_f32 v218, v184, v185
    v_cvt_pk_bf16_f32 v219, v186, v187
    v_mfma_f32_16x16x32_bf16 a[136:139], v[14:17], v[14:17], 0
    v_cvt_pk_bf16_f32 v220, v172, v173
    v_cvt_pk_bf16_f32 v221, v174, v175
    v_mfma_f32_16x16x32_bf16 a[140:143], v[14:17], v[14:17], 0
    buffer_load_dwordx4 v13, s[20:23], s43 offen offset:1024 sc1 lds
    v_mfma_f32_16x16x32_bf16 a[144:147], v[14:17], v[14:17], 0
    v_cvt_pk_bf16_f32 v222, v188, v189
    v_cvt_pk_bf16_f32 v223, v190, v191
    v_mfma_f32_16x16x32_bf16 a[148:151], v[14:17], v[14:17], 0
    v_add_u32 v4, s60, v20
    v_add_u32 v5, s60, v21
    v_mfma_f32_16x16x32_bf16 a[152:155], v[14:17], v[14:17], 0
    v_cmp_le_i32 s[50:51], 0, v4
    v_cmp_le_i32 s[52:53], 1, v4
    v_mfma_f32_16x16x32_bf16 a[156:159], v[14:17], v[14:17], 0
    v_cmp_le_i32 s[54:55], 2, v4
    v_cmp_le_i32 s[56:57], 3, v4
    v_mfma_f32_16x16x32_bf16 a[192:195], v[14:17], v[14:17], 0
    v_cndmask_b32 v32, v19, 0, s[50:51]
    v_cndmask_b32 v33, v19, 0, s[52:53]
    v_mfma_f32_16x16x32_bf16 a[196:199], v[14:17], v[14:17], 0
    v_cndmask_b32 v34, v19, 0, s[54:55]
    v_cndmask_b32 v35, v19, 0, s[56:57]
    v_mfma_f32_16x16x32_bf16 a[200:203], v[14:17], v[14:17], 0
    v_cmp_le_i32 s[50:51], 0, v5
    v_cmp_le_i32 s[52:53], 1, v5
    v_mfma_f32_16x16x32_bf16 a[204:207], v[14:17], v[14:17], 0
    s_add_u32 m0, s93, 90112
    v_cmp_le_i32 s[54:55], 2, v5
    v_cmp_le_i32 s[56:57], 3, v5
    v_mfma_f32_16x16x32_bf16 a[208:211], v[14:17], v[14:17], 0
    s_mov_b32 s43, 90112
    buffer_load_dwordx4 v13, s[20:23], s43 offen offset:0 sc1 lds
    v_mfma_f32_16x16x32_bf16 a[212:215], v[14:17], v[14:17], 0
    v_cndmask_b32 v40, v19, 0, s[50:51]
    v_cndmask_b32 v41, v19, 0, s[52:53]
    v_mfma_f32_16x16x32_bf16 a[216:219], v[14:17], v[14:17], 0
    v_cndmask_b32 v42, v19, 0, s[54:55]
    v_cndmask_b32 v43, v19, 0, s[56:57]
    v_cmp_le_i32 s[50:51], 16, v4
    v_cmp_le_i32 s[52:53], 17, v4
    v_cmp_le_i32 s[54:55], 18, v4
    v_cmp_le_i32 s[56:57], 19, v4
    v_mfma_f32_16x16x32_bf16 a[220:223], v[14:17], v[14:17], 0
    v_cndmask_b32 v36, v19, 0, s[50:51]
    v_cndmask_b32 v37, v19, 0, s[52:53]
    v_mfma_f32_16x16x32_bf16 a[48:51], v[14:17], v[14:17], 0
    v_cndmask_b32 v38, v19, 0, s[54:55]
    v_cndmask_b32 v39, v19, 0, s[56:57]
    v_cmp_le_i32 s[50:51], 16, v5
    v_cmp_le_i32 s[52:53], 17, v5
    v_cmp_le_i32 s[54:55], 18, v5
    v_cmp_le_i32 s[56:57], 19, v5
    v_mfma_f32_16x16x32_bf16 a[112:115], v[14:17], v[14:17], 0
    v_cndmask_b32 v44, v19, 0, s[50:51]
    v_cndmask_b32 v45, v19, 0, s[52:53]
    v_cndmask_b32 v46, v19, 0, s[54:55]
    v_cndmask_b32 v47, v19, 0, s[56:57]
    v_mfma_f32_16x16x32_bf16 a[176:179], v[14:17], v[14:17], 0
    v_mul_f32 v22, v119, v119
    v_fmaak_f32 v27, v18, v27, 0xc0135761
    v_mfma_f32_16x16x32_bf16 a[240:243], v[14:17], v[14:17], 0
    buffer_load_dwordx4 v13, s[20:23], s43 offen offset:1024 sc1 lds
    v_mfma_f32_16x16x32_bf16 v[224:227], a[32:35], v[64:67], v[32:35]
    v_fmaak_f32 v28, v18, v28, 0xc0135761
    v_fmaak_f32 v29, v18, v29, 0xc0135761
    v_mfma_f32_16x16x32_bf16 v[228:231], a[32:35], v[68:71], v[40:43]
    v_fmaak_f32 v22, v18, v22, 0xc0135761
    v_mul_f32 v27, v27, v116
    v_mfma_f32_16x16x32_bf16 v[232:235], a[32:35], v[72:75], 0
    v_exp_f32 v27, v27
    v_mfma_f32_16x16x32_bf16 v[236:239], a[32:35], v[76:79], 0
    ds_read_b128 a[32:35], v12 offset:16384
    v_mul_f32 v28, v28, v117
    v_mfma_f32_16x16x32_bf16 v[224:227], a[36:39], v[80:83], v[224:227]
    v_exp_f32 v28, v28
    v_mfma_f32_16x16x32_bf16 v[228:231], a[36:39], v[84:87], v[228:231]
    v_mul_f32 v29, v29, v118
    v_mul_f32 v22, v22, v119
    v_mfma_f32_16x16x32_bf16 v[232:235], a[36:39], v[88:91], v[232:235]
    v_exp_f32 v29, v29
    v_mfma_f32_16x16x32_bf16 v[236:239], a[36:39], v[92:95], v[236:239]
    ds_read_b128 a[36:39], v12 offset:17408
    v_add_f32 v27, 1.0, v27
    v_mfma_f32_16x16x32_bf16 v[224:227], a[40:43], v[192:195], v[224:227]
    v_exp_f32 v22, v22
    v_mfma_f32_16x16x32_bf16 v[228:231], a[40:43], v[196:199], v[228:231]
    v_rcp_f32 v27, v27
    v_mfma_f32_16x16x32_bf16 v[232:235], a[40:43], v[200:203], v[232:235]
    v_add_f32 v28, 1.0, v28
    v_add_f32 v29, 1.0, v29
    v_mfma_f32_16x16x32_bf16 v[236:239], a[40:43], v[204:207], v[236:239]
    ds_read_b128 a[40:43], v12 offset:18432
    v_add_f32 v22, 1.0, v22
    v_mfma_f32_16x16x32_bf16 v[224:227], a[44:47], v[208:211], v[224:227]
    v_rcp_f32 v28, v28
    v_mfma_f32_16x16x32_bf16 v[228:231], a[44:47], v[212:215], v[228:231]
    v_rcp_f32 v29, v29
    v_mfma_f32_16x16x32_bf16 v[232:235], a[44:47], v[216:219], v[232:235]
    v_rcp_f32 v22, v22
    v_mfma_f32_16x16x32_bf16 v[236:239], a[44:47], v[220:223], v[236:239]
    ds_read_b128 a[44:47], v12 offset:19456
    v_mul_f32 v116, v116, v27
    v_mfma_f32_16x16x32_bf16 v[240:243], a[96:99], v[64:67], v[36:39]
    v_mul_f32 v117, v117, v28
    v_mul_f32 v118, v118, v29
    v_mfma_f32_16x16x32_bf16 v[244:247], a[96:99], v[68:71], v[44:47]
    v_mul_f32 v119, v119, v22
    v_cvt_pk_bf16_f32 v100, v100, v101
    v_mfma_f32_16x16x32_bf16 v[248:251], a[96:99], v[72:75], 0
    v_cvt_pk_bf16_f32 v101, v102, v103
    v_cvt_pk_bf16_f32 v102, v116, v117
    v_mfma_f32_16x16x32_bf16 v[252:255], a[96:99], v[76:79], 0
    ds_read_b128 a[96:99], v12 offset:20480
    v_cvt_pk_bf16_f32 v103, v118, v119
    v_mfma_f32_16x16x32_bf16 v[240:243], a[100:103], v[80:83], v[240:243]
    buffer_store_dwordx4 v[100:103], v1, s[32:35], s86 offen offset:1024 sc0 sc1
    v_mfma_f32_16x16x32_bf16 v[244:247], a[100:103], v[84:87], v[244:247]
    v_mul_f32 v23, v104, v104
    v_mul_f32 v24, v105, v105
    v_mfma_f32_16x16x32_bf16 v[248:251], a[100:103], v[88:91], v[248:251]
    v_mul_f32 v25, v106, v106
    v_mul_f32 v26, v107, v107
    v_mfma_f32_16x16x32_bf16 v[252:255], a[100:103], v[92:95], v[252:255]
    ds_read_b128 a[100:103], v12 offset:21504
    v_fmaak_f32 v23, v18, v23, 0xc0135761
    v_mfma_f32_16x16x32_bf16 v[240:243], a[104:107], v[192:195], v[240:243]
    v_fmaak_f32 v24, v18, v24, 0xc0135761
    v_fmaak_f32 v25, v18, v25, 0xc0135761
    v_mfma_f32_16x16x32_bf16 v[244:247], a[104:107], v[196:199], v[244:247]
    v_fmaak_f32 v26, v18, v26, 0xc0135761
    v_mul_f32 v23, v23, v104
    v_mfma_f32_16x16x32_bf16 v[248:251], a[104:107], v[200:203], v[248:251]
    v_exp_f32 v23, v23
    v_mfma_f32_16x16x32_bf16 v[252:255], a[104:107], v[204:207], v[252:255]
    ds_read_b128 a[104:107], v12 offset:22528
    v_mul_f32 v24, v24, v105
    v_mfma_f32_16x16x32_bf16 v[240:243], a[108:111], v[208:211], v[240:243]
    v_exp_f32 v24, v24
    v_mfma_f32_16x16x32_bf16 v[244:247], a[108:111], v[212:215], v[244:247]
    v_mul_f32 v25, v25, v106
    v_mul_f32 v26, v26, v107
    v_mfma_f32_16x16x32_bf16 v[248:251], a[108:111], v[216:219], v[248:251]
    v_exp_f32 v25, v25
    v_mfma_f32_16x16x32_bf16 v[252:255], a[108:111], v[220:223], v[252:255]
    ds_read_b128 a[108:111], v12 offset:23552
    v_add_f32 v23, 1.0, v23
    v_exp_f32 v26, v26
    v_add_f32 v24, 1.0, v24
    v_add_f32 v25, 1.0, v25
    v_add_f32 v26, 1.0, v26
    v_rcp_f32 v23, v23
    v_rcp_f32 v24, v24
    v_rcp_f32 v25, v25
    v_rcp_f32 v26, v26
    v_mul_f32 v104, v104, v23
    v_mul_f32 v105, v105, v24
    v_mul_f32 v106, v106, v25
    v_mul_f32 v107, v107, v26
    v_mul_f32 v27, v120, v120
    v_mul_f32 v28, v121, v121
    v_mul_f32 v29, v122, v122
    v_mul_f32 v22, v123, v123
    v_fmaak_f32 v27, v18, v27, 0xc0135761
    v_fmaak_f32 v28, v18, v28, 0xc0135761
    v_fmaak_f32 v29, v18, v29, 0xc0135761
    v_fmaak_f32 v22, v18, v22, 0xc0135761
    v_mul_f32 v27, v27, v120
    v_mul_f32 v28, v28, v121
    v_mul_f32 v29, v29, v122
    v_mul_f32 v22, v22, v123
    v_exp_f32 v27, v27
    v_exp_f32 v28, v28
    v_exp_f32 v29, v29
    v_exp_f32 v22, v22
    v_add_f32 v27, 1.0, v27
    v_add_f32 v28, 1.0, v28
    v_add_f32 v29, 1.0, v29
    v_add_f32 v22, 1.0, v22
    v_rcp_f32 v27, v27
    v_rcp_f32 v28, v28
    v_rcp_f32 v29, v29
    v_rcp_f32 v22, v22
    v_mul_f32 v120, v120, v27
    v_mul_f32 v121, v121, v28
    v_mul_f32 v122, v122, v29
    v_mul_f32 v123, v123, v22
    v_cvt_pk_bf16_f32 v104, v104, v105
    v_cvt_pk_bf16_f32 v105, v106, v107
    v_cvt_pk_bf16_f32 v106, v120, v121
    v_cvt_pk_bf16_f32 v107, v122, v123
    buffer_store_dwordx4 v[104:107], v1, s[32:35], s87 offen offset:1024 sc0 sc1
    v_mul_f32 v23, v108, v108
    v_mul_f32 v24, v109, v109
    v_mul_f32 v25, v110, v110
    v_mul_f32 v26, v111, v111
    v_fmaak_f32 v23, v18, v23, 0xc0135761
    v_fmaak_f32 v24, v18, v24, 0xc0135761
    v_fmaak_f32 v25, v18, v25, 0xc0135761
    v_fmaak_f32 v26, v18, v26, 0xc0135761
    v_mul_f32 v23, v23, v108
    v_mul_f32 v24, v24, v109
    v_mul_f32 v25, v25, v110
    v_mul_f32 v26, v26, v111
    v_exp_f32 v23, v23
    v_exp_f32 v24, v24
    v_exp_f32 v25, v25
    v_exp_f32 v26, v26
    v_add_f32 v23, 1.0, v23
    v_add_f32 v24, 1.0, v24
    v_add_f32 v25, 1.0, v25
    v_add_f32 v26, 1.0, v26
    v_rcp_f32 v23, v23
    v_rcp_f32 v24, v24
    v_rcp_f32 v25, v25
    v_rcp_f32 v26, v26
    v_mul_f32 v108, v108, v23
    v_mul_f32 v109, v109, v24
    v_mul_f32 v110, v110, v25
    v_mul_f32 v111, v111, v26
    v_mul_f32 v27, v124, v124
    v_mul_f32 v28, v125, v125
    v_mul_f32 v29, v126, v126
    v_mul_f32 v22, v127, v127
    v_fmaak_f32 v27, v18, v27, 0xc0135761
    v_fmaak_f32 v28, v18, v28, 0xc0135761
    v_fmaak_f32 v29, v18, v29, 0xc0135761
    v_fmaak_f32 v22, v18, v22, 0xc0135761
    v_mul_f32 v27, v27, v124
    v_mul_f32 v28, v28, v125
    v_mul_f32 v29, v29, v126
    v_mul_f32 v22, v22, v127
    v_exp_f32 v27, v27
    v_exp_f32 v28, v28
    v_exp_f32 v29, v29
    v_exp_f32 v22, v22
    v_add_f32 v27, 1.0, v27
    v_add_f32 v28, 1.0, v28
    v_add_f32 v29, 1.0, v29
    v_add_f32 v22, 1.0, v22
    v_rcp_f32 v27, v27
    v_rcp_f32 v28, v28
    v_rcp_f32 v29, v29
    v_rcp_f32 v22, v22
    v_mul_f32 v124, v124, v27
    v_mul_f32 v125, v125, v28
    v_mul_f32 v126, v126, v29
    v_mul_f32 v127, v127, v22
    v_cvt_pk_bf16_f32 v108, v108, v109
    v_cvt_pk_bf16_f32 v109, v110, v111
    v_cvt_pk_bf16_f32 v110, v124, v125
    v_cvt_pk_bf16_f32 v111, v126, v127
    buffer_store_dwordx4 v[108:111], v1, s[32:35], s88 offen offset:1024 sc0 sc1
    v_mov_b32 v144, 0
    v_mov_b32 v145, 0
    v_mov_b32 v146, 0
    v_mov_b32 v147, 0
    v_mov_b32 v148, 0
    v_mov_b32 v149, 0
    v_mov_b32 v150, 0
    v_mov_b32 v151, 0
    v_mov_b32 v152, 0
    v_mov_b32 v153, 0
    v_mov_b32 v154, 0
    v_mov_b32 v155, 0
    v_mov_b32 v156, 0
    v_mov_b32 v157, 0
    v_mov_b32 v158, 0
    v_mov_b32 v159, 0
    v_subrev_u32 v22, 64, v21
    v_mov_b32 v14, 0x3f803f80
    v_mov_b32 v15, 0x3f803f80
    v_mov_b32 v16, 0x3f803f80
    v_mov_b32 v17, 0x3f803f80
    s_nop 3
    v_max3_f32 v48, v224, v225, v226
    v_max3_f32 v52, v240, v241, v242
    v_max3_f32 v48, v48, v227, v243
    v_max_f32 v48, v48, v52
    v_max3_f32 v49, v228, v229, v230
    v_max3_f32 v53, v244, v245, v246
    v_max3_f32 v49, v49, v231, v247
    v_max_f32 v49, v49, v53
    v_max3_f32 v50, v232, v233, v234
    v_max3_f32 v54, v248, v249, v250
    v_max3_f32 v50, v50, v235, v251
    v_max_f32 v50, v50, v54
    v_max3_f32 v51, v236, v237, v238
    v_max3_f32 v55, v252, v253, v254
    v_max3_f32 v51, v51, v239, v255
    v_max_f32 v51, v51, v55
    v_mov_b32 v52, v48
    v_mov_b32 v53, v49
    v_mov_b32 v54, v50
    v_mov_b32 v55, v51
    s_nop 0
    v_permlane16_swap_b32 v48, v52
    v_permlane16_swap_b32 v49, v53
    v_permlane16_swap_b32 v50, v54
    v_permlane16_swap_b32 v51, v55
    v_max_f32 v48, v48, v52
    v_max_f32 v49, v49, v53
    v_max_f32 v50, v50, v54
    v_max_f32 v51, v51, v55
    v_mov_b32 v52, v48
    v_mov_b32 v53, v49
    v_mov_b32 v54, v50
    v_mov_b32 v55, v51
    s_nop 0
    v_permlane32_swap_b32 v48, v52
    v_permlane32_swap_b32 v49, v53
    v_permlane32_swap_b32 v50, v54
    v_permlane32_swap_b32 v51, v55
    v_max_f32 v48, v48, v52
    v_max_f32 v49, v49, v53
    v_max_f32 v50, v50, v54
    v_max_f32 v51, v51, v55
    v_add_f32 v48, 0x42200000, v48
    v_add_f32 v49, 0x42200000, v49
    v_add_f32 v50, 0x42200000, v50
    v_add_f32 v51, 0x42200000, v51
    v_sub_f32 v160, 0, v48
    v_sub_f32 v161, 0, v48
    v_sub_f32 v162, 0, v48
    v_sub_f32 v163, 0, v48
    v_sub_f32 v164, 0, v49
    v_sub_f32 v165, 0, v49
    v_sub_f32 v166, 0, v49
    v_sub_f32 v167, 0, v49
    v_sub_f32 v168, 0, v50
    v_sub_f32 v169, 0, v50
    v_sub_f32 v170, 0, v50
    v_sub_f32 v171, 0, v50
    v_sub_f32 v172, 0, v51
    v_sub_f32 v173, 0, v51
    v_sub_f32 v174, 0, v51
    v_sub_f32 v175, 0, v51
    v_sub_f32 v224, v224, v48
    v_sub_f32 v225, v225, v48
    v_sub_f32 v226, v226, v48
    v_sub_f32 v227, v227, v48
    v_sub_f32 v240, v240, v48
    v_sub_f32 v241, v241, v48
    v_sub_f32 v242, v242, v48
    v_sub_f32 v243, v243, v48
    v_sub_f32 v228, v228, v49
    v_sub_f32 v229, v229, v49
    v_sub_f32 v230, v230, v49
    v_sub_f32 v231, v231, v49
    v_sub_f32 v244, v244, v49
    v_sub_f32 v245, v245, v49
    v_sub_f32 v246, v246, v49
    v_sub_f32 v247, v247, v49
    v_sub_f32 v232, v232, v50
    v_sub_f32 v233, v233, v50
    v_sub_f32 v234, v234, v50
    v_sub_f32 v235, v235, v50
    v_sub_f32 v248, v248, v50
    v_sub_f32 v249, v249, v50
    v_sub_f32 v250, v250, v50
    v_sub_f32 v251, v251, v50
    v_sub_f32 v236, v236, v51
    v_sub_f32 v237, v237, v51
    v_sub_f32 v238, v238, v51
    v_sub_f32 v239, v239, v51
    v_sub_f32 v252, v252, v51
    v_sub_f32 v253, v253, v51
    v_sub_f32 v254, v254, v51
    v_sub_f32 v255, v255, v51
    s_waitcnt lgkmcnt(0)
    s_cmp_eq_u32 s42, 0
    s_cbranch_scc1 k2_X2
    s_lshl_b32 s94, s42, 1
    s_sub_u32 s94, s94, 1
.p2align 6
k2_D:
    v_mfma_f32_16x16x32_bf16 v[96:99], a[32:35], v[64:67], v[160:163]
    s_waitcnt vmcnt(16)
    s_barrier
    v_add_u32 v12, s90, v1
    v_mfma_f32_16x16x32_bf16 v[96:99], a[36:39], v[80:83], v[96:99]
    s_add_u32 m0, s91, s93
    v_exp_f32 v32, v224
    v_mfma_f32_16x16x32_bf16 v[96:99], a[40:43], v[192:195], v[96:99]
    s_add_u32 s43, s92, 0
    v_exp_f32 v33, v225
    v_mfma_f32_16x16x32_bf16 v[96:99], a[44:47], v[208:211], v[96:99]
    s_waitcnt lgkmcnt(8)
    v_exp_f32 v34, v226
    v_mfma_f32_16x16x32_bf16 a[0:3], a[160:163], v[144:147], a[0:3]
    s_add_u32 s90, s90, 0x8000
    v_exp_f32 v35, v227
    v_mfma_f32_16x16x32_bf16 a[64:67], a[160:163], v[148:151], a[64:67]
    s_sub_u32 s3, s90, 163840
    v_exp_f32 v36, v240
    v_mfma_f32_16x16x32_bf16 a[128:131], a[160:163], v[152:155], a[128:131]
    s_min_u32 s90, s90, s3
    v_exp_f32 v37, v241
    v_mfma_f32_16x16x32_bf16 a[192:195], a[160:163], v[156:159], a[192:195]
    ds_read_b128 a[160:163], v12 offset:8192
    v_cvt_pk_bf16_f32 v128, v32, v33
    v_mfma_f32_16x16x32_bf16 v[100:103], a[32:35], v[68:71], v[164:167]
    buffer_load_dwordx4 v13, s[20:23], s43 offen offset:0 sc1 lds
    v_mfma_f32_16x16x32_bf16 v[100:103], a[36:39], v[84:87], v[100:103]
    v_exp_f32 v38, v242
    v_mfma_f32_16x16x32_bf16 v[100:103], a[40:43], v[196:199], v[100:103]
    v_exp_f32 v39, v243
    v_mfma_f32_16x16x32_bf16 v[100:103], a[44:47], v[212:215], v[100:103]
    v_exp_f32 v40, v228
    v_mfma_f32_16x16x32_bf16 a[4:7], a[164:167], v[144:147], a[4:7]
    v_exp_f32 v41, v229
    v_mfma_f32_16x16x32_bf16 a[68:71], a[164:167], v[148:151], a[68:71]
    v_exp_f32 v42, v230
    v_mfma_f32_16x16x32_bf16 a[132:135], a[164:167], v[152:155], a[132:135]
    v_exp_f32 v43, v231
    v_mfma_f32_16x16x32_bf16 a[196:199], a[164:167], v[156:159], a[196:199]
    ds_read_b128 a[164:167], v12 offset:9216
    v_cvt_pk_bf16_f32 v129, v34, v35
    v_mfma_f32_16x16x32_bf16 a[48:51], v[14:17], v[144:147], a[48:51]
    v_exp_f32 v44, v244
    v_mfma_f32_16x16x32_bf16 a[176:179], v[14:17], v[152:155], a[176:179]
    v_exp_f32 v45, v245
    v_mfma_f32_16x16x32_bf16 v[104:107], a[32:35], v[72:75], v[168:171]
    v_exp_f32 v46, v246
    v_mfma_f32_16x16x32_bf16 v[104:107], a[36:39], v[88:91], v[104:107]
    v_exp_f32 v47, v247
    v_mfma_f32_16x16x32_bf16 v[104:107], a[40:43], v[200:203], v[104:107]
    v_exp_f32 v32, v232
    v_mfma_f32_16x16x32_bf16 v[104:107], a[44:47], v[216:219], v[104:107]
    buffer_load_dwordx4 v13, s[20:23], s43 offen offset:1024 sc1 lds
    v_mfma_f32_16x16x32_bf16 a[8:11], a[168:171], v[144:147], a[8:11]
    s_add_u32 m0, m0, 0x2000
    v_exp_f32 v33, v233
    v_mfma_f32_16x16x32_bf16 a[72:75], a[168:171], v[148:151], a[72:75]
    s_add_u32 s43, s92, 4294942720
    v_exp_f32 v34, v234
    v_mfma_f32_16x16x32_bf16 a[136:139], a[168:171], v[152:155], a[136:139]
    v_exp_f32 v35, v235
    v_mfma_f32_16x16x32_bf16 a[200:203], a[168:171], v[156:159], a[200:203]
    ds_read_b128 a[168:171], v12 offset:10240
    v_cvt_pk_bf16_f32 v130, v36, v37
    v_mfma_f32_16x16x32_bf16 v[108:111], a[32:35], v[76:79], v[172:175]
    v_exp_f32 v36, v248
    v_mfma_f32_16x16x32_bf16 v[108:111], a[36:39], v[92:95], v[108:111]
    ds_read_b128 a[32:35], v12 offset:0
    ds_read_b128 a[36:39], v12 offset:1024
    v_mfma_f32_16x16x32_bf16 v[108:111], a[40:43], v[204:207], v[108:111]
    v_exp_f32 v37, v249
    v_mfma_f32_16x16x32_bf16 v[108:111], a[44:47], v[220:223], v[108:111]
    ds_read_b128 a[40:43], v12 offset:2048
    ds_read_b128 a[44:47], v12 offset:3072
    v_mfma_f32_16x16x32_bf16 a[12:15], a[172:175], v[144:147], a[12:15]
    v_or3_b32 v10, v128, v129, v130
    v_cvt_pk_bf16_f32 v131, v38, v39
    v_mfma_f32_16x16x32_bf16 a[76:79], a[172:175], v[148:151], a[76:79]
    v_exp_f32 v38, v250
    v_mfma_f32_16x16x32_bf16 a[140:143], a[172:175], v[152:155], a[140:143]
    v_exp_f32 v39, v251
    v_mfma_f32_16x16x32_bf16 a[204:207], a[172:175], v[156:159], a[204:207]
    s_waitcnt lgkmcnt(8)
    ds_read_b128 a[172:175], v12 offset:11264
    v_cvt_pk_bf16_f32 v132, v40, v41
    v_mfma_f32_16x16x32_bf16 v[112:115], a[96:99], v[64:67], v[160:163]
    buffer_load_dwordx4 v13, s[20:23], s43 offen offset:0 sc1 lds
    v_mfma_f32_16x16x32_bf16 v[112:115], a[100:103], v[80:83], v[112:115]
    v_exp_f32 v40, v236
    v_mfma_f32_16x16x32_bf16 v[112:115], a[104:107], v[192:195], v[112:115]
    v_exp_f32 v41, v237
    v_mfma_f32_16x16x32_bf16 v[112:115], a[108:111], v[208:211], v[112:115]
    s_waitcnt lgkmcnt(8)
    v_or3_b32 v10, v10, v131, v132
    v_cvt_pk_bf16_f32 v133, v42, v43
    v_mfma_f32_16x16x32_bf16 a[16:19], a[224:227], v[144:147], a[16:19]
    v_exp_f32 v42, v238
    v_mfma_f32_16x16x32_bf16 a[80:83], a[224:227], v[148:151], a[80:83]
    v_exp_f32 v43, v239
    v_mfma_f32_16x16x32_bf16 a[144:147], a[224:227], v[152:155], a[144:147]
    v_cvt_pk_bf16_f32 v134, v44, v45
    v_or3_b32 v10, v10, v133, v134
    v_mfma_f32_16x16x32_bf16 a[208:211], a[224:227], v[156:159], a[208:211]
    ds_read_b128 a[224:227], v12 offset:12288
    v_cvt_pk_bf16_f32 v135, v46, v47
    v_mfma_f32_16x16x32_bf16 v[116:119], a[96:99], v[68:71], v[164:167]
    v_exp_f32 v44, v252
    v_mfma_f32_16x16x32_bf16 v[116:119], a[100:103], v[84:87], v[116:119]
    v_exp_f32 v45, v253
    v_mfma_f32_16x16x32_bf16 v[116:119], a[104:107], v[196:199], v[116:119]
    v_exp_f32 v46, v254
    v_mfma_f32_16x16x32_bf16 v[116:119], a[108:111], v[212:215], v[116:119]
    v_exp_f32 v47, v255
    v_mfma_f32_16x16x32_bf16 a[20:23], a[228:231], v[144:147], a[20:23]
    v_cvt_pk_bf16_f32 v136, v32, v33
    v_or3_b32 v10, v10, v135, v136
    v_mfma_f32_16x16x32_bf16 a[84:87], a[228:231], v[148:151], a[84:87]
    v_cvt_pk_bf16_f32 v137, v34, v35
    v_cvt_pk_bf16_f32 v138, v36, v37
    v_mfma_f32_16x16x32_bf16 a[148:151], a[228:231], v[152:155], a[148:151]
    v_or3_b32 v10, v10, v137, v138
    v_cvt_pk_bf16_f32 v139, v38, v39
    v_mfma_f32_16x16x32_bf16 a[212:215], a[228:231], v[156:159], a[212:215]
    ds_read_b128 a[228:231], v12 offset:13312
    v_cvt_pk_bf16_f32 v140, v40, v41
    v_mfma_f32_16x16x32_bf16 a[112:115], v[14:17], v[148:151], a[112:115]
    v_or3_b32 v10, v10, v139, v140
    v_cvt_pk_bf16_f32 v141, v42, v43
    v_mfma_f32_16x16x32_bf16 a[240:243], v[14:17], v[156:159], a[240:243]
    v_cvt_pk_bf16_f32 v142, v44, v45
    v_or3_b32 v10, v10, v141, v142
    v_mfma_f32_16x16x32_bf16 v[120:123], a[96:99], v[72:75], v[168:171]
    v_cvt_pk_bf16_f32 v143, v46, v47
    v_bitop3_b32 v10, v10, v143, s95 bitop3:0xa8
    v_mfma_f32_16x16x32_bf16 v[120:123], a[100:103], v[88:91], v[120:123]
    v_cmp_ne_u32 vcc, 0, v10
    v_mfma_f32_16x16x32_bf16 v[120:123], a[104:107], v[200:203], v[120:123]
    v_mfma_f32_16x16x32_bf16 v[120:123], a[108:111], v[216:219], v[120:123]
    v_mfma_f32_16x16x32_bf16 a[24:27], a[232:235], v[144:147], a[24:27]
    v_mfma_f32_16x16x32_bf16 a[88:91], a[232:235], v[148:151], a[88:91]
    v_mfma_f32_16x16x32_bf16 a[152:155], a[232:235], v[152:155], a[152:155]
    v_mfma_f32_16x16x32_bf16 a[216:219], a[232:235], v[156:159], a[216:219]
    ds_read_b128 a[232:235], v12 offset:14336
    v_mfma_f32_16x16x32_bf16 v[124:127], a[96:99], v[76:79], v[172:175]
    v_mfma_f32_16x16x32_bf16 v[124:127], a[100:103], v[92:95], v[124:127]
    ds_read_b128 a[96:99], v12 offset:4096
    ds_read_b128 a[100:103], v12 offset:5120
    v_mfma_f32_16x16x32_bf16 v[124:127], a[104:107], v[204:207], v[124:127]
    v_mfma_f32_16x16x32_bf16 v[124:127], a[108:111], v[220:223], v[124:127]
    ds_read_b128 a[104:107], v12 offset:6144
    ds_read_b128 a[108:111], v12 offset:7168
    v_mfma_f32_16x16x32_bf16 a[28:31], a[236:239], v[144:147], a[28:31]
    v_mfma_f32_16x16x32_bf16 a[92:95], a[236:239], v[148:151], a[92:95]
    v_mfma_f32_16x16x32_bf16 a[156:159], a[236:239], v[152:155], a[156:159]
    s_waitcnt lgkmcnt(8)
    buffer_load_dwordx4 v13, s[20:23], s43 offen offset:1024 sc1 lds
    v_mfma_f32_16x16x32_bf16 a[220:223], a[236:239], v[156:159], a[220:223]
    ds_read_b128 a[236:239], v12 offset:15360
    s_cbranch_vccnz k2_fb0
k2_r0:
    v_mfma_f32_16x16x32_bf16 v[224:227], a[32:35], v[64:67], v[160:163]
    v_exp_f32 v32, v96
    v_mfma_f32_16x16x32_bf16 v[224:227], a[36:39], v[80:83], v[224:227]
    s_add_u32 m0, m0, 0x2000
    v_exp_f32 v33, v97
    v_mfma_f32_16x16x32_bf16 v[224:227], a[40:43], v[192:195], v[224:227]
    s_add_u32 s43, s92, 16384
    v_exp_f32 v34, v98
    v_mfma_f32_16x16x32_bf16 v[224:227], a[44:47], v[208:211], v[224:227]
    s_waitcnt lgkmcnt(8)
    v_exp_f32 v35, v99
    v_mfma_f32_16x16x32_bf16 a[0:3], a[160:163], v[128:131], a[0:3]
    s_add_u32 s91, s91, 0x8000
    v_exp_f32 v36, v112
    v_mfma_f32_16x16x32_bf16 a[64:67], a[160:163], v[132:135], a[64:67]
    s_sub_u32 s3, s91, 163840
    v_exp_f32 v37, v113
    v_mfma_f32_16x16x32_bf16 a[128:131], a[160:163], v[136:139], a[128:131]
    s_min_u32 s91, s91, s3
    v_exp_f32 v38, v114
    v_mfma_f32_16x16x32_bf16 a[192:195], a[160:163], v[140:143], a[192:195]
    s_sub_u32 s94, s94, 1
    ds_read_b128 a[160:163], v12 offset:24576
    v_cvt_pk_bf16_f32 v144, v32, v33
    v_mfma_f32_16x16x32_bf16 v[228:231], a[32:35], v[68:71], v[164:167]
    buffer_load_dwordx4 v13, s[20:23], s43 offen offset:0 sc1 lds
    v_mfma_f32_16x16x32_bf16 v[228:231], a[36:39], v[84:87], v[228:231]
    v_exp_f32 v39, v115
    v_mfma_f32_16x16x32_bf16 v[228:231], a[40:43], v[196:199], v[228:231]
    v_exp_f32 v40, v100
    v_mfma_f32_16x16x32_bf16 v[228:231], a[44:47], v[212:215], v[228:231]
    v_exp_f32 v41, v101
    v_mfma_f32_16x16x32_bf16 a[4:7], a[164:167], v[128:131], a[4:7]
    v_exp_f32 v42, v102
    v_mfma_f32_16x16x32_bf16 a[68:71], a[164:167], v[132:135], a[68:71]
    v_exp_f32 v43, v103
    v_mfma_f32_16x16x32_bf16 a[132:135], a[164:167], v[136:139], a[132:135]
    v_exp_f32 v44, v116
    v_mfma_f32_16x16x32_bf16 a[196:199], a[164:167], v[140:143], a[196:199]
    ds_read_b128 a[164:167], v12 offset:25600
    v_cvt_pk_bf16_f32 v145, v34, v35
    v_mfma_f32_16x16x32_bf16 a[48:51], v[14:17], v[128:131], a[48:51]
    v_exp_f32 v45, v117
    v_mfma_f32_16x16x32_bf16 a[176:179], v[14:17], v[136:139], a[176:179]
    v_exp_f32 v46, v118
    v_mfma_f32_16x16x32_bf16 v[232:235], a[32:35], v[72:75], v[168:171]
    v_exp_f32 v47, v119
    v_mfma_f32_16x16x32_bf16 v[232:235], a[36:39], v[88:91], v[232:235]
    v_exp_f32 v32, v104
    v_mfma_f32_16x16x32_bf16 v[232:235], a[40:43], v[200:203], v[232:235]
    v_exp_f32 v33, v105
    v_mfma_f32_16x16x32_bf16 v[232:235], a[44:47], v[216:219], v[232:235]
    buffer_load_dwordx4 v13, s[20:23], s43 offen offset:1024 sc1 lds
    v_mfma_f32_16x16x32_bf16 a[8:11], a[168:171], v[128:131], a[8:11]
    s_add_u32 m0, m0, 0x2000
    v_exp_f32 v34, v106
    v_mfma_f32_16x16x32_bf16 a[72:75], a[168:171], v[132:135], a[72:75]
    s_add_u32 s43, s92, 4294959104
    v_exp_f32 v35, v107
    v_mfma_f32_16x16x32_bf16 a[136:139], a[168:171], v[136:139], a[136:139]
    v_cvt_pk_bf16_f32 v146, v36, v37
    v_or3_b32 v10, v144, v145, v146
    v_mfma_f32_16x16x32_bf16 a[200:203], a[168:171], v[140:143], a[200:203]
    ds_read_b128 a[168:171], v12 offset:26624
    v_cvt_pk_bf16_f32 v147, v38, v39
    v_mfma_f32_16x16x32_bf16 v[236:239], a[32:35], v[76:79], v[172:175]
    v_exp_f32 v36, v120
    v_mfma_f32_16x16x32_bf16 v[236:239], a[36:39], v[92:95], v[236:239]
    ds_read_b128 a[32:35], v12 offset:16384
    ds_read_b128 a[36:39], v12 offset:17408
    v_mfma_f32_16x16x32_bf16 v[236:239], a[40:43], v[204:207], v[236:239]
    v_exp_f32 v37, v121
    v_mfma_f32_16x16x32_bf16 v[236:239], a[44:47], v[220:223], v[236:239]
    ds_read_b128 a[40:43], v12 offset:18432
    ds_read_b128 a[44:47], v12 offset:19456
    v_mfma_f32_16x16x32_bf16 a[12:15], a[172:175], v[128:131], a[12:15]
    v_exp_f32 v38, v122
    v_mfma_f32_16x16x32_bf16 a[76:79], a[172:175], v[132:135], a[76:79]
    v_exp_f32 v39, v123
    v_mfma_f32_16x16x32_bf16 a[140:143], a[172:175], v[136:139], a[140:143]
    v_cvt_pk_bf16_f32 v148, v40, v41
    v_or3_b32 v10, v10, v147, v148
    v_mfma_f32_16x16x32_bf16 a[204:207], a[172:175], v[140:143], a[204:207]
    s_waitcnt lgkmcnt(8)
    ds_read_b128 a[172:175], v12 offset:27648
    v_cvt_pk_bf16_f32 v149, v42, v43
    v_mfma_f32_16x16x32_bf16 v[240:243], a[96:99], v[64:67], v[160:163]
    buffer_load_dwordx4 v13, s[20:23], s43 offen offset:0 sc1 lds
    v_mfma_f32_16x16x32_bf16 v[240:243], a[100:103], v[80:83], v[240:243]
    v_exp_f32 v40, v108
    v_mfma_f32_16x16x32_bf16 v[240:243], a[104:107], v[192:195], v[240:243]
    v_exp_f32 v41, v109
    v_mfma_f32_16x16x32_bf16 v[240:243], a[108:111], v[208:211], v[240:243]
    s_waitcnt lgkmcnt(8)
    v_exp_f32 v42, v110
    v_mfma_f32_16x16x32_bf16 a[16:19], a[224:227], v[128:131], a[16:19]
    v_exp_f32 v43, v111
    v_mfma_f32_16x16x32_bf16 a[80:83], a[224:227], v[132:135], a[80:83]
    v_cvt_pk_bf16_f32 v150, v44, v45
    v_or3_b32 v10, v10, v149, v150
    v_mfma_f32_16x16x32_bf16 a[144:147], a[224:227], v[136:139], a[144:147]
    v_exp_f32 v44, v124
    v_mfma_f32_16x16x32_bf16 a[208:211], a[224:227], v[140:143], a[208:211]
    ds_read_b128 a[224:227], v12 offset:28672
    v_cvt_pk_bf16_f32 v151, v46, v47
    v_mfma_f32_16x16x32_bf16 v[244:247], a[96:99], v[68:71], v[164:167]
    v_exp_f32 v45, v125
    v_mfma_f32_16x16x32_bf16 v[244:247], a[100:103], v[84:87], v[244:247]
    v_exp_f32 v46, v126
    v_mfma_f32_16x16x32_bf16 v[244:247], a[104:107], v[196:199], v[244:247]
    v_exp_f32 v47, v127
    v_mfma_f32_16x16x32_bf16 v[244:247], a[108:111], v[212:215], v[244:247]
    v_cvt_pk_bf16_f32 v152, v32, v33
    v_or3_b32 v10, v10, v151, v152
    v_mfma_f32_16x16x32_bf16 a[20:23], a[228:231], v[128:131], a[20:23]
    v_cvt_pk_bf16_f32 v153, v34, v35
    v_cvt_pk_bf16_f32 v154, v36, v37
    v_mfma_f32_16x16x32_bf16 a[84:87], a[228:231], v[132:135], a[84:87]
    v_or3_b32 v10, v10, v153, v154
    v_cvt_pk_bf16_f32 v155, v38, v39
    v_mfma_f32_16x16x32_bf16 a[148:151], a[228:231], v[136:139], a[148:151]
    v_cvt_pk_bf16_f32 v156, v40, v41
    v_or3_b32 v10, v10, v155, v156
    v_mfma_f32_16x16x32_bf16 a[212:215], a[228:231], v[140:143], a[212:215]
    ds_read_b128 a[228:231], v12 offset:29696
    v_cvt_pk_bf16_f32 v157, v42, v43
    v_mfma_f32_16x16x32_bf16 a[112:115], v[14:17], v[132:135], a[112:115]
    v_cvt_pk_bf16_f32 v158, v44, v45
    v_or3_b32 v10, v10, v157, v158
    v_mfma_f32_16x16x32_bf16 a[240:243], v[14:17], v[140:143], a[240:243]
    v_cvt_pk_bf16_f32 v159, v46, v47
    v_bitop3_b32 v10, v10, v159, s95 bitop3:0xa8
    v_mfma_f32_16x16x32_bf16 v[248:251], a[96:99], v[72:75], v[168:171]
    v_cmp_ne_u32 vcc, 0, v10
    v_mfma_f32_16x16x32_bf16 v[248:251], a[100:103], v[88:91], v[248:251]
    v_mfma_f32_16x16x32_bf16 v[248:251], a[104:107], v[200:203], v[248:251]
    v_mfma_f32_16x16x32_bf16 v[248:251], a[108:111], v[216:219], v[248:251]
    v_mfma_f32_16x16x32_bf16 a[24:27], a[232:235], v[128:131], a[24:27]
    v_mfma_f32_16x16x32_bf16 a[88:91], a[232:235], v[132:135], a[88:91]
    v_mfma_f32_16x16x32_bf16 a[152:155], a[232:235], v[136:139], a[152:155]
    v_mfma_f32_16x16x32_bf16 a[216:219], a[232:235], v[140:143], a[216:219]
    ds_read_b128 a[232:235], v12 offset:30720
    v_mfma_f32_16x16x32_bf16 v[252:255], a[96:99], v[76:79], v[172:175]
    v_mfma_f32_16x16x32_bf16 v[252:255], a[100:103], v[92:95], v[252:255]
    ds_read_b128 a[96:99], v12 offset:20480
    ds_read_b128 a[100:103], v12 offset:21504
    v_mfma_f32_16x16x32_bf16 v[252:255], a[104:107], v[204:207], v[252:255]
    v_mfma_f32_16x16x32_bf16 v[252:255], a[108:111], v[220:223], v[252:255]
    ds_read_b128 a[104:107], v12 offset:22528
    ds_read_b128 a[108:111], v12 offset:23552
    v_mfma_f32_16x16x32_bf16 a[28:31], a[236:239], v[128:131], a[28:31]
    v_mfma_f32_16x16x32_bf16 a[92:95], a[236:239], v[132:135], a[92:95]
    v_mfma_f32_16x16x32_bf16 a[156:159], a[236:239], v[136:139], a[156:159]
    s_waitcnt lgkmcnt(8)
    buffer_load_dwordx4 v13, s[20:23], s43 offen offset:1024 sc1 lds
    v_mfma_f32_16x16x32_bf16 a[220:223], a[236:239], v[140:143], a[220:223]
    s_add_u32 s92, s92, 0x8000
    ds_read_b128 a[236:239], v12 offset:31744
    s_cmp_lg_u32 s94, 0
    s_cbranch_vccnz k2_fb1
k2_r1:
    s_cbranch_scc1 k2_D
k2_X1:
    v_mfma_f32_16x16x32_bf16 v[96:99], a[32:35], v[64:67], v[160:163]
    s_waitcnt vmcnt(16)
    s_barrier
    v_add_u32 v12, s90, v1
    v_mfma_f32_16x16x32_bf16 v[96:99], a[36:39], v[80:83], v[96:99]
    s_add_u32 m0, s91, s93
    v_exp_f32 v32, v224
    v_mfma_f32_16x16x32_bf16 v[96:99], a[40:43], v[192:195], v[96:99]
    s_add_u32 s43, s92, 0
    v_exp_f32 v33, v225
    v_mfma_f32_16x16x32_bf16 v[96:99], a[44:47], v[208:211], v[96:99]
    s_waitcnt lgkmcnt(8)
    v_exp_f32 v34, v226
    v_mfma_f32_16x16x32_bf16 a[0:3], a[160:163], v[144:147], a[0:3]
    s_add_u32 s90, s90, 0x8000
    v_exp_f32 v35, v227
    v_mfma_f32_16x16x32_bf16 a[64:67], a[160:163], v[148:151], a[64:67]
    s_sub_u32 s3, s90, 163840
    v_exp_f32 v36, v240
    v_mfma_f32_16x16x32_bf16 a[128:131], a[160:163], v[152:155], a[128:131]
    s_min_u32 s90, s90, s3
    v_exp_f32 v37, v241
    v_mfma_f32_16x16x32_bf16 a[192:195], a[160:163], v[156:159], a[192:195]
    ds_read_b128 a[160:163], v12 offset:8192
    v_cvt_pk_bf16_f32 v128, v32, v33
    v_mfma_f32_16x16x32_bf16 v[100:103], a[32:35], v[68:71], v[164:167]
    buffer_load_dwordx4 v13, s[20:23], s43 offen offset:0 sc1 lds
    v_mfma_f32_16x16x32_bf16 v[100:103], a[36:39], v[84:87], v[100:103]
    v_exp_f32 v38, v242
    v_mfma_f32_16x16x32_bf16 v[100:103], a[40:43], v[196:199], v[100:103]
    v_exp_f32 v39, v243
    v_mfma_f32_16x16x32_bf16 v[100:103], a[44:47], v[212:215], v[100:103]
    v_exp_f32 v40, v228
    v_mfma_f32_16x16x32_bf16 a[4:7], a[164:167], v[144:147], a[4:7]
    v_exp_f32 v41, v229
    v_mfma_f32_16x16x32_bf16 a[68:71], a[164:167], v[148:151], a[68:71]
    v_exp_f32 v42, v230
    v_mfma_f32_16x16x32_bf16 a[132:135], a[164:167], v[152:155], a[132:135]
    v_exp_f32 v43, v231
    v_mfma_f32_16x16x32_bf16 a[196:199], a[164:167], v[156:159], a[196:199]
    ds_read_b128 a[164:167], v12 offset:9216
    v_cvt_pk_bf16_f32 v129, v34, v35
    v_mfma_f32_16x16x32_bf16 a[48:51], v[14:17], v[144:147], a[48:51]
    v_exp_f32 v44, v244
    v_mfma_f32_16x16x32_bf16 a[176:179], v[14:17], v[152:155], a[176:179]
    v_exp_f32 v45, v245
    v_mfma_f32_16x16x32_bf16 v[104:107], a[32:35], v[72:75], v[168:171]
    v_exp_f32 v46, v246
    v_mfma_f32_16x16x32_bf16 v[104:107], a[36:39], v[88:91], v[104:107]
    v_exp_f32 v47, v247
    v_mfma_f32_16x16x32_bf16 v[104:107], a[40:43], v[200:203], v[104:107]
    v_exp_f32 v32, v232
    v_mfma_f32_16x16x32_bf16 v[104:107], a[44:47], v[216:219], v[104:107]
    buffer_load_dwordx4 v13, s[20:23], s43 offen offset:1024 sc1 lds
    v_mfma_f32_16x16x32_bf16 a[8:11], a[168:171], v[144:147], a[8:11]
    s_add_u32 m0, m0, 0x2000
    v_exp_f32 v33, v233
    v_mfma_f32_16x16x32_bf16 a[72:75], a[168:171], v[148:151], a[72:75]
    s_add_u32 s43, s92, 4294942720
    v_exp_f32 v34, v234
    v_mfma_f32_16x16x32_bf16 a[136:139], a[168:171], v[152:155], a[136:139]
    v_exp_f32 v35, v235
    v_mfma_f32_16x16x32_bf16 a[200:203], a[168:171], v[156:159], a[200:203]
    ds_read_b128 a[168:171], v12 offset:10240
    v_cvt_pk_bf16_f32 v130, v36, v37
    v_mfma_f32_16x16x32_bf16 v[108:111], a[32:35], v[76:79], v[172:175]
    v_exp_f32 v36, v248
    v_mfma_f32_16x16x32_bf16 v[108:111], a[36:39], v[92:95], v[108:111]
    ds_read_b128 a[32:35], v12 offset:0
    ds_read_b128 a[36:39], v12 offset:1024
    v_mfma_f32_16x16x32_bf16 v[108:111], a[40:43], v[204:207], v[108:111]
    v_exp_f32 v37, v249
    v_mfma_f32_16x16x32_bf16 v[108:111], a[44:47], v[220:223], v[108:111]
    ds_read_b128 a[40:43], v12 offset:2048
    ds_read_b128 a[44:47], v12 offset:3072
    v_mfma_f32_16x16x32_bf16 a[12:15], a[172:175], v[144:147], a[12:15]
    v_or3_b32 v10, v128, v129, v130
    v_cvt_pk_bf16_f32 v131, v38, v39
    v_mfma_f32_16x16x32_bf16 a[76:79], a[172:175], v[148:151], a[76:79]
    v_exp_f32 v38, v250
    v_mfma_f32_16x16x32_bf16 a[140:143], a[172:175], v[152:155], a[140:143]
    v_exp_f32 v39, v251
    v_mfma_f32_16x16x32_bf16 a[204:207], a[172:175], v[156:159], a[204:207]
    s_waitcnt lgkmcnt(8)
    ds_read_b128 a[172:175], v12 offset:11264
    v_cvt_pk_bf16_f32 v132, v40, v41
    v_mfma_f32_16x16x32_bf16 v[112:115], a[96:99], v[64:67], v[160:163]
    buffer_load_dwordx4 v13, s[20:23], s43 offen offset:0 sc1 lds
    v_mfma_f32_16x16x32_bf16 v[112:115], a[100:103], v[80:83], v[112:115]
    v_exp_f32 v40, v236
    v_mfma_f32_16x16x32_bf16 v[112:115], a[104:107], v[192:195], v[112:115]
    v_exp_f32 v41, v237
    v_mfma_f32_16x16x32_bf16 v[112:115], a[108:111], v[208:211], v[112:115]
    s_waitcnt lgkmcnt(8)
    v_or3_b32 v10, v10, v131, v132
    v_cvt_pk_bf16_f32 v133, v42, v43
    v_mfma_f32_16x16x32_bf16 a[16:19], a[224:227], v[144:147], a[16:19]
    v_exp_f32 v42, v238
    v_mfma_f32_16x16x32_bf16 a[80:83], a[224:227], v[148:151], a[80:83]
    v_exp_f32 v43, v239
    v_mfma_f32_16x16x32_bf16 a[144:147], a[224:227], v[152:155], a[144:147]
    v_cvt_pk_bf16_f32 v134, v44, v45
    v_or3_b32 v10, v10, v133, v134
    v_mfma_f32_16x16x32_bf16 a[208:211], a[224:227], v[156:159], a[208:211]
    ds_read_b128 a[224:227], v12 offset:12288
    v_cvt_pk_bf16_f32 v135, v46, v47
    v_mfma_f32_16x16x32_bf16 v[116:119], a[96:99], v[68:71], v[164:167]
    v_exp_f32 v44, v252
    v_mfma_f32_16x16x32_bf16 v[116:119], a[100:103], v[84:87], v[116:119]
    v_exp_f32 v45, v253
    v_mfma_f32_16x16x32_bf16 v[116:119], a[104:107], v[196:199], v[116:119]
    v_exp_f32 v46, v254
    v_mfma_f32_16x16x32_bf16 v[116:119], a[108:111], v[212:215], v[116:119]
    v_exp_f32 v47, v255
    v_mfma_f32_16x16x32_bf16 a[20:23], a[228:231], v[144:147], a[20:23]
    v_cvt_pk_bf16_f32 v136, v32, v33
    v_or3_b32 v10, v10, v135, v136
    v_mfma_f32_16x16x32_bf16 a[84:87], a[228:231], v[148:151], a[84:87]
    v_cvt_pk_bf16_f32 v137, v34, v35
    v_cvt_pk_bf16_f32 v138, v36, v37
    v_mfma_f32_16x16x32_bf16 a[148:151], a[228:231], v[152:155], a[148:151]
    v_or3_b32 v10, v10, v137, v138
    v_cvt_pk_bf16_f32 v139, v38, v39
    v_mfma_f32_16x16x32_bf16 a[212:215], a[228:231], v[156:159], a[212:215]
    ds_read_b128 a[228:231], v12 offset:13312
    v_cvt_pk_bf16_f32 v140, v40, v41
    v_mfma_f32_16x16x32_bf16 a[112:115], v[14:17], v[148:151], a[112:115]
    v_or3_b32 v10, v10, v139, v140
    v_cvt_pk_bf16_f32 v141, v42, v43
    v_mfma_f32_16x16x32_bf16 a[240:243], v[14:17], v[156:159], a[240:243]
    v_cvt_pk_bf16_f32 v142, v44, v45
    v_or3_b32 v10, v10, v141, v142
    v_mfma_f32_16x16x32_bf16 v[120:123], a[96:99], v[72:75], v[168:171]
    v_cvt_pk_bf16_f32 v143, v46, v47
    v_bitop3_b32 v10, v10, v143, s95 bitop3:0xa8
    v_mfma_f32_16x16x32_bf16 v[120:123], a[100:103], v[88:91], v[120:123]
    v_cmp_ne_u32 vcc, 0, v10
    v_mfma_f32_16x16x32_bf16 v[120:123], a[104:107], v[200:203], v[120:123]
    v_mfma_f32_16x16x32_bf16 v[120:123], a[108:111], v[216:219], v[120:123]
    v_mfma_f32_16x16x32_bf16 a[24:27], a[232:235], v[144:147], a[24:27]
    v_mfma_f32_16x16x32_bf16 a[88:91], a[232:235], v[148:151], a[88:91]
    v_mfma_f32_16x16x32_bf16 a[152:155], a[232:235], v[152:155], a[152:155]
    v_mfma_f32_16x16x32_bf16 a[216:219], a[232:235], v[156:159], a[216:219]
    ds_read_b128 a[232:235], v12 offset:14336
    v_mfma_f32_16x16x32_bf16 v[124:127], a[96:99], v[76:79], v[172:175]
    v_mfma_f32_16x16x32_bf16 v[124:127], a[100:103], v[92:95], v[124:127]
    ds_read_b128 a[96:99], v12 offset:4096
    ds_read_b128 a[100:103], v12 offset:5120
    v_mfma_f32_16x16x32_bf16 v[124:127], a[104:107], v[204:207], v[124:127]
    v_mfma_f32_16x16x32_bf16 v[124:127], a[108:111], v[220:223], v[124:127]
    ds_read_b128 a[104:107], v12 offset:6144
    ds_read_b128 a[108:111], v12 offset:7168
    v_mfma_f32_16x16x32_bf16 a[28:31], a[236:239], v[144:147], a[28:31]
    v_mfma_f32_16x16x32_bf16 a[92:95], a[236:239], v[148:151], a[92:95]
    v_mfma_f32_16x16x32_bf16 a[156:159], a[236:239], v[152:155], a[156:159]
    s_waitcnt lgkmcnt(8)
    buffer_load_dwordx4 v13, s[20:23], s43 offen offset:1024 sc1 lds
    v_mfma_f32_16x16x32_bf16 a[220:223], a[236:239], v[156:159], a[220:223]
    ds_read_b128 a[236:239], v12 offset:15360
    s_cbranch_vccnz k2_fb2
k2_r2:
    v_mfma_f32_16x16x32_bf16 v[232:235], a[32:35], v[72:75], v[168:171]
    v_cmp_le_i32 s[50:51], 0, v20
    v_cmp_le_i32 s[52:53], 1, v20
    v_mfma_f32_16x16x32_bf16 v[232:235], a[36:39], v[88:91], v[232:235]
    s_add_u32 m0, m0, 0x2000
    v_cmp_le_i32 s[54:55], 2, v20
    v_cmp_le_i32 s[56:57], 3, v20
    v_mfma_f32_16x16x32_bf16 v[232:235], a[40:43], v[200:203], v[232:235]
    s_add_u32 s43, s92, 16384
    v_cndmask_b32 v176, v19, v160, s[50:51]
    v_cndmask_b32 v177, v19, v160, s[52:53]
    v_mfma_f32_16x16x32_bf16 v[232:235], a[44:47], v[216:219], v[232:235]
    s_waitcnt lgkmcnt(8)
    v_cndmask_b32 v178, v19, v160, s[54:55]
    v_cndmask_b32 v179, v19, v160, s[56:57]
    v_mfma_f32_16x16x32_bf16 a[0:3], a[160:163], v[128:131], a[0:3]
    s_add_u32 s91, s91, 0x8000
    v_cmp_le_i32 s[50:51], 0, v21
    v_cmp_le_i32 s[52:53], 1, v21
    v_mfma_f32_16x16x32_bf16 a[64:67], a[160:163], v[132:135], a[64:67]
    s_sub_u32 s3, s91, 163840
    v_cmp_le_i32 s[54:55], 2, v21
    v_cmp_le_i32 s[56:57], 3, v21
    v_mfma_f32_16x16x32_bf16 a[128:131], a[160:163], v[136:139], a[128:131]
    s_min_u32 s91, s91, s3
    v_cndmask_b32 v184, v19, v164, s[50:51]
    v_cndmask_b32 v185, v19, v164, s[52:53]
    v_mfma_f32_16x16x32_bf16 a[192:195], a[160:163], v[140:143], a[192:195]
    ds_read_b128 a[160:163], v12 offset:24576
    v_cndmask_b32 v186, v19, v164, s[54:55]
    v_mfma_f32_16x16x32_bf16 v[236:239], a[32:35], v[76:79], v[172:175]
    v_cndmask_b32 v187, v19, v164, s[56:57]
    v_cmp_le_i32 s[50:51], 16, v20
    v_mfma_f32_16x16x32_bf16 v[236:239], a[36:39], v[92:95], v[236:239]
    v_cmp_le_i32 s[52:53], 17, v20
    v_cmp_le_i32 s[54:55], 18, v20
    v_mfma_f32_16x16x32_bf16 v[236:239], a[40:43], v[204:207], v[236:239]
    v_cmp_le_i32 s[56:57], 19, v20
    buffer_load_dwordx4 v13, s[20:23], s43 offen offset:0 sc1 lds
    v_mfma_f32_16x16x32_bf16 v[236:239], a[44:47], v[220:223], v[236:239]
    v_cndmask_b32 v180, v19, v160, s[50:51]
    v_cndmask_b32 v181, v19, v160, s[52:53]
    v_mfma_f32_16x16x32_bf16 a[4:7], a[164:167], v[128:131], a[4:7]
    v_cndmask_b32 v182, v19, v160, s[54:55]
    v_cndmask_b32 v183, v19, v160, s[56:57]
    v_mfma_f32_16x16x32_bf16 a[68:71], a[164:167], v[132:135], a[68:71]
    v_cmp_le_i32 s[50:51], 16, v21
    v_cmp_le_i32 s[52:53], 17, v21
    v_mfma_f32_16x16x32_bf16 a[132:135], a[164:167], v[136:139], a[132:135]
    v_cmp_le_i32 s[54:55], 18, v21
    v_cmp_le_i32 s[56:57], 19, v21
    v_mfma_f32_16x16x32_bf16 a[196:199], a[164:167], v[140:143], a[196:199]
    ds_read_b128 a[164:167], v12 offset:25600
    v_cndmask_b32 v188, v19, v164, s[50:51]
    v_mfma_f32_16x16x32_bf16 a[48:51], v[14:17], v[128:131], a[48:51]
    v_cndmask_b32 v189, v19, v164, s[52:53]
    v_cndmask_b32 v190, v19, v164, s[54:55]
    v_mfma_f32_16x16x32_bf16 a[176:179], v[14:17], v[136:139], a[176:179]
    v_cndmask_b32 v191, v19, v164, s[56:57]
    v_exp_f32 v32, v96
    v_mfma_f32_16x16x32_bf16 v[224:227], a[32:35], v[64:67], v[176:179]
    v_exp_f32 v33, v97
    v_mfma_f32_16x16x32_bf16 v[224:227], a[36:39], v[80:83], v[224:227]
    v_exp_f32 v34, v98
    v_mfma_f32_16x16x32_bf16 v[224:227], a[40:43], v[192:195], v[224:227]
    v_exp_f32 v35, v99
    v_mfma_f32_16x16x32_bf16 v[224:227], a[44:47], v[208:211], v[224:227]
    buffer_load_dwordx4 v13, s[20:23], s43 offen offset:1024 sc1 lds
    v_mfma_f32_16x16x32_bf16 a[8:11], a[168:171], v[128:131], a[8:11]
    s_add_u32 m0, m0, 0x2000
    v_exp_f32 v36, v112
    v_mfma_f32_16x16x32_bf16 a[72:75], a[168:171], v[132:135], a[72:75]
    s_add_u32 s43, s92, 4294959104
    v_exp_f32 v37, v113
    v_mfma_f32_16x16x32_bf16 a[136:139], a[168:171], v[136:139], a[136:139]
    v_exp_f32 v38, v114
    v_mfma_f32_16x16x32_bf16 a[200:203], a[168:171], v[140:143], a[200:203]
    ds_read_b128 a[168:171], v12 offset:26624
    v_cvt_pk_bf16_f32 v144, v32, v33
    v_mfma_f32_16x16x32_bf16 v[228:231], a[32:35], v[68:71], v[184:187]
    v_exp_f32 v39, v115
    v_mfma_f32_16x16x32_bf16 v[228:231], a[36:39], v[84:87], v[228:231]
    ds_read_b128 a[32:35], v12 offset:16384
    ds_read_b128 a[36:39], v12 offset:17408
    v_mfma_f32_16x16x32_bf16 v[228:231], a[40:43], v[196:199], v[228:231]
    v_exp_f32 v40, v100
    v_mfma_f32_16x16x32_bf16 v[228:231], a[44:47], v[212:215], v[228:231]
    ds_read_b128 a[40:43], v12 offset:18432
    ds_read_b128 a[44:47], v12 offset:19456
    v_mfma_f32_16x16x32_bf16 a[12:15], a[172:175], v[128:131], a[12:15]
    v_exp_f32 v41, v101
    v_mfma_f32_16x16x32_bf16 a[76:79], a[172:175], v[132:135], a[76:79]
    v_exp_f32 v42, v102
    v_mfma_f32_16x16x32_bf16 a[140:143], a[172:175], v[136:139], a[140:143]
    v_exp_f32 v43, v103
    v_mfma_f32_16x16x32_bf16 a[204:207], a[172:175], v[140:143], a[204:207]
    s_waitcnt lgkmcnt(8)
    ds_read_b128 a[172:175], v12 offset:27648
    v_cvt_pk_bf16_f32 v145, v34, v35
    v_mfma_f32_16x16x32_bf16 v[248:251], a[96:99], v[72:75], v[168:171]
    buffer_load_dwordx4 v13, s[20:23], s43 offen offset:0 sc1 lds
    v_mfma_f32_16x16x32_bf16 v[248:251], a[100:103], v[88:91], v[248:251]
    v_exp_f32 v44, v116
    v_mfma_f32_16x16x32_bf16 v[248:251], a[104:107], v[200:203], v[248:251]
    v_exp_f32 v45, v117
    v_mfma_f32_16x16x32_bf16 v[248:251], a[108:111], v[216:219], v[248:251]
    s_waitcnt lgkmcnt(8)
    v_exp_f32 v46, v118
    v_mfma_f32_16x16x32_bf16 a[16:19], a[224:227], v[128:131], a[16:19]
    v_exp_f32 v47, v119
    v_mfma_f32_16x16x32_bf16 a[80:83], a[224:227], v[132:135], a[80:83]
    v_exp_f32 v32, v104
    v_mfma_f32_16x16x32_bf16 a[144:147], a[224:227], v[136:139], a[144:147]
    v_exp_f32 v33, v105
    v_mfma_f32_16x16x32_bf16 a[208:211], a[224:227], v[140:143], a[208:211]
    ds_read_b128 a[224:227], v12 offset:28672
    v_cvt_pk_bf16_f32 v146, v36, v37
    v_mfma_f32_16x16x32_bf16 v[252:255], a[96:99], v[76:79], v[172:175]
    v_exp_f32 v34, v106
    v_mfma_f32_16x16x32_bf16 v[252:255], a[100:103], v[92:95], v[252:255]
    v_exp_f32 v35, v107
    v_mfma_f32_16x16x32_bf16 v[252:255], a[104:107], v[204:207], v[252:255]
    v_exp_f32 v36, v120
    v_mfma_f32_16x16x32_bf16 v[252:255], a[108:111], v[220:223], v[252:255]
    v_exp_f32 v37, v121
    v_mfma_f32_16x16x32_bf16 a[20:23], a[228:231], v[128:131], a[20:23]
    v_or3_b32 v10, v144, v145, v146
    v_cvt_pk_bf16_f32 v147, v38, v39
    v_mfma_f32_16x16x32_bf16 a[84:87], a[228:231], v[132:135], a[84:87]
    v_exp_f32 v38, v122
    v_mfma_f32_16x16x32_bf16 a[148:151], a[228:231], v[136:139], a[148:151]
    v_exp_f32 v39, v123
    v_mfma_f32_16x16x32_bf16 a[212:215], a[228:231], v[140:143], a[212:215]
    ds_read_b128 a[228:231], v12 offset:29696
    v_cvt_pk_bf16_f32 v148, v40, v41
    v_mfma_f32_16x16x32_bf16 a[112:115], v[14:17], v[132:135], a[112:115]
    v_exp_f32 v40, v108
    v_mfma_f32_16x16x32_bf16 a[240:243], v[14:17], v[140:143], a[240:243]
    v_exp_f32 v41, v109
    v_mfma_f32_16x16x32_bf16 v[240:243], a[96:99], v[64:67], v[180:183]
    v_or3_b32 v10, v10, v147, v148
    v_cvt_pk_bf16_f32 v149, v42, v43
    v_mfma_f32_16x16x32_bf16 v[240:243], a[100:103], v[80:83], v[240:243]
    v_exp_f32 v42, v110
    v_mfma_f32_16x16x32_bf16 v[240:243], a[104:107], v[192:195], v[240:243]
    v_exp_f32 v43, v111
    v_mfma_f32_16x16x32_bf16 v[240:243], a[108:111], v[208:211], v[240:243]
    v_cvt_pk_bf16_f32 v150, v44, v45
    v_or3_b32 v10, v10, v149, v150
    v_mfma_f32_16x16x32_bf16 a[24:27], a[232:235], v[128:131], a[24:27]
    v_exp_f32 v44, v124
    v_mfma_f32_16x16x32_bf16 a[88:91], a[232:235], v[132:135], a[88:91]
    v_exp_f32 v45, v125
    v_mfma_f32_16x16x32_bf16 a[152:155], a[232:235], v[136:139], a[152:155]
    v_cvt_pk_bf16_f32 v151, v46, v47
    v_cvt_pk_bf16_f32 v152, v32, v33
    v_mfma_f32_16x16x32_bf16 a[216:219], a[232:235], v[140:143], a[216:219]
    ds_read_b128 a[232:235], v12 offset:30720
    v_or3_b32 v10, v10, v151, v152
    v_mfma_f32_16x16x32_bf16 v[244:247], a[96:99], v[68:71], v[188:191]
    v_exp_f32 v46, v126
    v_mfma_f32_16x16x32_bf16 v[244:247], a[100:103], v[84:87], v[244:247]
    ds_read_b128 a[96:99], v12 offset:20480
    ds_read_b128 a[100:103], v12 offset:21504
    v_mfma_f32_16x16x32_bf16 v[244:247], a[104:107], v[196:199], v[244:247]
    v_exp_f32 v47, v127
    v_mfma_f32_16x16x32_bf16 v[244:247], a[108:111], v[212:215], v[244:247]
    ds_read_b128 a[104:107], v12 offset:22528
    ds_read_b128 a[108:111], v12 offset:23552
    v_mfma_f32_16x16x32_bf16 a[28:31], a[236:239], v[128:131], a[28:31]
    v_cvt_pk_bf16_f32 v153, v34, v35
    v_cvt_pk_bf16_f32 v154, v36, v37
    v_mfma_f32_16x16x32_bf16 a[92:95], a[236:239], v[132:135], a[92:95]
    v_or3_b32 v10, v10, v153, v154
    v_cvt_pk_bf16_f32 v155, v38, v39
    v_cvt_pk_bf16_f32 v156, v40, v41
    v_or3_b32 v10, v10, v155, v156
    v_cvt_pk_bf16_f32 v157, v42, v43
    v_cvt_pk_bf16_f32 v158, v44, v45
    v_or3_b32 v10, v10, v157, v158
    v_cvt_pk_bf16_f32 v159, v46, v47
    v_bitop3_b32 v10, v10, v159, s95 bitop3:0xa8
    v_cmp_ne_u32 vcc, 0, v10
    v_mfma_f32_16x16x32_bf16 a[156:159], a[236:239], v[136:139], a[156:159]
    s_waitcnt lgkmcnt(8)
    buffer_load_dwordx4 v13, s[20:23], s43 offen offset:1024 sc1 lds
    v_mfma_f32_16x16x32_bf16 a[220:223], a[236:239], v[140:143], a[220:223]
    s_add_u32 s92, s92, 0x8000
    ds_read_b128 a[236:239], v12 offset:31744
    s_cbranch_vccnz k2_fb3
k2_r3:
k2_X2:
    v_mfma_f32_16x16x32_bf16 v[104:107], a[32:35], v[72:75], v[168:171]
    s_waitcnt vmcnt(16)
    s_barrier
    v_add_u32 v12, s90, v1
    v_mfma_f32_16x16x32_bf16 v[104:107], a[36:39], v[88:91], v[104:107]
    s_add_u32 m0, s91, s93
    v_cmp_le_i32 s[50:51], 32, v20
    v_cmp_le_i32 s[52:53], 33, v20
    v_mfma_f32_16x16x32_bf16 v[104:107], a[40:43], v[200:203], v[104:107]
    s_add_u32 s43, s92, 0
    v_cmp_le_i32 s[54:55], 34, v20
    v_cmp_le_i32 s[56:57], 35, v20
    v_mfma_f32_16x16x32_bf16 v[104:107], a[44:47], v[216:219], v[104:107]
    s_waitcnt lgkmcnt(8)
    v_cndmask_b32 v176, v19, v160, s[50:51]
    v_cndmask_b32 v177, v19, v160, s[52:53]
    v_mfma_f32_16x16x32_bf16 a[0:3], a[160:163], v[144:147], a[0:3]
    s_add_u32 s90, s90, 0x8000
    v_cndmask_b32 v178, v19, v160, s[54:55]
    v_cndmask_b32 v179, v19, v160, s[56:57]
    v_mfma_f32_16x16x32_bf16 a[64:67], a[160:163], v[148:151], a[64:67]
    s_sub_u32 s3, s90, 163840
    v_cmp_le_i32 s[50:51], 32, v21
    v_cmp_le_i32 s[52:53], 33, v21
    v_mfma_f32_16x16x32_bf16 a[128:131], a[160:163], v[152:155], a[128:131]
    s_min_u32 s90, s90, s3
    v_cmp_le_i32 s[54:55], 34, v21
    v_cmp_le_i32 s[56:57], 35, v21
    v_mfma_f32_16x16x32_bf16 a[192:195], a[160:163], v[156:159], a[192:195]
    ds_read_b128 a[160:163], v12 offset:8192
    v_cndmask_b32 v184, v19, v164, s[50:51]
    v_mfma_f32_16x16x32_bf16 v[108:111], a[32:35], v[76:79], v[172:175]
    v_cndmask_b32 v185, v19, v164, s[52:53]
    v_cndmask_b32 v186, v19, v164, s[54:55]
    v_mfma_f32_16x16x32_bf16 v[108:111], a[36:39], v[92:95], v[108:111]
    v_cndmask_b32 v187, v19, v164, s[56:57]
    v_cmp_le_i32 s[50:51], 48, v20
    v_mfma_f32_16x16x32_bf16 v[108:111], a[40:43], v[204:207], v[108:111]
    v_cmp_le_i32 s[52:53], 49, v20
    v_cmp_le_i32 s[54:55], 50, v20
    v_mfma_f32_16x16x32_bf16 v[108:111], a[44:47], v[220:223], v[108:111]
    v_cmp_le_i32 s[56:57], 51, v20
    buffer_load_dwordx4 v13, s[20:23], s43 offen offset:0 sc1 lds
    v_mfma_f32_16x16x32_bf16 a[4:7], a[164:167], v[144:147], a[4:7]
    v_cndmask_b32 v180, v19, v160, s[50:51]
    v_cndmask_b32 v181, v19, v160, s[52:53]
    v_mfma_f32_16x16x32_bf16 a[68:71], a[164:167], v[148:151], a[68:71]
    v_cndmask_b32 v182, v19, v160, s[54:55]
    v_cndmask_b32 v183, v19, v160, s[56:57]
    v_mfma_f32_16x16x32_bf16 a[132:135], a[164:167], v[152:155], a[132:135]
    v_cmp_le_i32 s[50:51], 48, v21
    v_cmp_le_i32 s[52:53], 49, v21
    v_mfma_f32_16x16x32_bf16 a[196:199], a[164:167], v[156:159], a[196:199]
    ds_read_b128 a[164:167], v12 offset:9216
    v_cmp_le_i32 s[54:55], 50, v21
    v_mfma_f32_16x16x32_bf16 a[48:51], v[14:17], v[144:147], a[48:51]
    v_cmp_le_i32 s[56:57], 51, v21
    v_exp_f32 v32, v224
    v_mfma_f32_16x16x32_bf16 a[176:179], v[14:17], v[152:155], a[176:179]
    v_cndmask_b32 v188, v19, v164, s[50:51]
    v_cndmask_b32 v189, v19, v164, s[52:53]
    v_mfma_f32_16x16x32_bf16 v[96:99], a[32:35], v[64:67], v[176:179]
    v_cndmask_b32 v190, v19, v164, s[54:55]
    v_cndmask_b32 v191, v19, v164, s[56:57]
    v_mfma_f32_16x16x32_bf16 v[96:99], a[36:39], v[80:83], v[96:99]
    v_exp_f32 v33, v225
    v_mfma_f32_16x16x32_bf16 v[96:99], a[40:43], v[192:195], v[96:99]
    v_exp_f32 v34, v226
    v_mfma_f32_16x16x32_bf16 v[96:99], a[44:47], v[208:211], v[96:99]
    buffer_load_dwordx4 v13, s[20:23], s43 offen offset:1024 sc1 lds
    v_mfma_f32_16x16x32_bf16 a[8:11], a[168:171], v[144:147], a[8:11]
    s_add_u32 m0, m0, 0x2000
    v_exp_f32 v35, v227
    v_mfma_f32_16x16x32_bf16 a[72:75], a[168:171], v[148:151], a[72:75]
    s_add_u32 s43, s92, 4294942720
    v_exp_f32 v36, v240
    v_mfma_f32_16x16x32_bf16 a[136:139], a[168:171], v[152:155], a[136:139]
    v_exp_f32 v37, v241
    v_mfma_f32_16x16x32_bf16 a[200:203], a[168:171], v[156:159], a[200:203]
    ds_read_b128 a[168:171], v12 offset:10240
    v_cvt_pk_bf16_f32 v128, v32, v33
    v_mfma_f32_16x16x32_bf16 v[100:103], a[32:35], v[68:71], v[184:187]
    v_exp_f32 v38, v242
    v_mfma_f32_16x16x32_bf16 v[100:103], a[36:39], v[84:87], v[100:103]
    ds_read_b128 a[32:35], v12 offset:0
    ds_read_b128 a[36:39], v12 offset:1024
    v_mfma_f32_16x16x32_bf16 v[100:103], a[40:43], v[196:199], v[100:103]
    v_exp_f32 v39, v243
    v_mfma_f32_16x16x32_bf16 v[100:103], a[44:47], v[212:215], v[100:103]
    ds_read_b128 a[40:43], v12 offset:2048
    ds_read_b128 a[44:47], v12 offset:3072
    v_mfma_f32_16x16x32_bf16 a[12:15], a[172:175], v[144:147], a[12:15]
    v_exp_f32 v40, v228
    v_mfma_f32_16x16x32_bf16 a[76:79], a[172:175], v[148:151], a[76:79]
    v_exp_f32 v41, v229
    v_mfma_f32_16x16x32_bf16 a[140:143], a[172:175], v[152:155], a[140:143]
    v_exp_f32 v42, v230
    v_mfma_f32_16x16x32_bf16 a[204:207], a[172:175], v[156:159], a[204:207]
    s_waitcnt lgkmcnt(8)
    ds_read_b128 a[172:175], v12 offset:11264
    v_cvt_pk_bf16_f32 v129, v34, v35
    v_mfma_f32_16x16x32_bf16 v[120:123], a[96:99], v[72:75], v[168:171]
    buffer_load_dwordx4 v13, s[20:23], s43 offen offset:0 sc1 lds
    v_mfma_f32_16x16x32_bf16 v[120:123], a[100:103], v[88:91], v[120:123]
    v_exp_f32 v43, v231
    v_mfma_f32_16x16x32_bf16 v[120:123], a[104:107], v[200:203], v[120:123]
    v_exp_f32 v44, v244
    v_mfma_f32_16x16x32_bf16 v[120:123], a[108:111], v[216:219], v[120:123]
    s_waitcnt lgkmcnt(8)
    v_exp_f32 v45, v245
    v_mfma_f32_16x16x32_bf16 a[16:19], a[224:227], v[144:147], a[16:19]
    v_exp_f32 v46, v246
    v_mfma_f32_16x16x32_bf16 a[80:83], a[224:227], v[148:151], a[80:83]
    v_exp_f32 v47, v247
    v_mfma_f32_16x16x32_bf16 a[144:147], a[224:227], v[152:155], a[144:147]
    v_exp_f32 v32, v232
    v_mfma_f32_16x16x32_bf16 a[208:211], a[224:227], v[156:159], a[208:211]
    ds_read_b128 a[224:227], v12 offset:12288
    v_cvt_pk_bf16_f32 v130, v36, v37
    v_mfma_f32_16x16x32_bf16 v[124:127], a[96:99], v[76:79], v[172:175]
    v_exp_f32 v33, v233
    v_mfma_f32_16x16x32_bf16 v[124:127], a[100:103], v[92:95], v[124:127]
    v_exp_f32 v34, v234
    v_mfma_f32_16x16x32_bf16 v[124:127], a[104:107], v[204:207], v[124:127]
    v_exp_f32 v35, v235
    v_mfma_f32_16x16x32_bf16 v[124:127], a[108:111], v[220:223], v[124:127]
    v_exp_f32 v36, v248
    v_mfma_f32_16x16x32_bf16 a[20:23], a[228:231], v[144:147], a[20:23]
    v_exp_f32 v37, v249
    v_mfma_f32_16x16x32_bf16 a[84:87], a[228:231], v[148:151], a[84:87]
    v_or3_b32 v10, v128, v129, v130
    v_cvt_pk_bf16_f32 v131, v38, v39
    v_mfma_f32_16x16x32_bf16 a[148:151], a[228:231], v[152:155], a[148:151]
    v_exp_f32 v38, v250
    v_mfma_f32_16x16x32_bf16 a[212:215], a[228:231], v[156:159], a[212:215]
    ds_read_b128 a[228:231], v12 offset:13312
    v_cvt_pk_bf16_f32 v132, v40, v41
    v_mfma_f32_16x16x32_bf16 a[112:115], v[14:17], v[148:151], a[112:115]
    v_exp_f32 v39, v251
    v_mfma_f32_16x16x32_bf16 a[240:243], v[14:17], v[156:159], a[240:243]
    v_exp_f32 v40, v236
    v_mfma_f32_16x16x32_bf16 v[112:115], a[96:99], v[64:67], v[180:183]
    v_exp_f32 v41, v237
    v_mfma_f32_16x16x32_bf16 v[112:115], a[100:103], v[80:83], v[112:115]
    v_or3_b32 v10, v10, v131, v132
    v_cvt_pk_bf16_f32 v133, v42, v43
    v_mfma_f32_16x16x32_bf16 v[112:115], a[104:107], v[192:195], v[112:115]
    v_exp_f32 v42, v238
    v_mfma_f32_16x16x32_bf16 v[112:115], a[108:111], v[208:211], v[112:115]
    v_exp_f32 v43, v239
    v_mfma_f32_16x16x32_bf16 a[24:27], a[232:235], v[144:147], a[24:27]
    v_cvt_pk_bf16_f32 v134, v44, v45
    v_or3_b32 v10, v10, v133, v134
    v_mfma_f32_16x16x32_bf16 a[88:91], a[232:235], v[148:151], a[88:91]
    v_exp_f32 v44, v252
    v_mfma_f32_16x16x32_bf16 a[152:155], a[232:235], v[152:155], a[152:155]
    v_exp_f32 v45, v253
    v_mfma_f32_16x16x32_bf16 a[216:219], a[232:235], v[156:159], a[216:219]
    ds_read_b128 a[232:235], v12 offset:14336
    v_cvt_pk_bf16_f32 v135, v46, v47
    v_mfma_f32_16x16x32_bf16 v[116:119], a[96:99], v[68:71], v[188:191]
    v_exp_f32 v46, v254
    v_mfma_f32_16x16x32_bf16 v[116:119], a[100:103], v[84:87], v[116:119]
    ds_read_b128 a[96:99], v12 offset:4096
    ds_read_b128 a[100:103], v12 offset:5120
    v_mfma_f32_16x16x32_bf16 v[116:119], a[104:107], v[196:199], v[116:119]
    v_exp_f32 v47, v255
    v_mfma_f32_16x16x32_bf16 v[116:119], a[108:111], v[212:215], v[116:119]
    ds_read_b128 a[104:107], v12 offset:6144
    ds_read_b128 a[108:111], v12 offset:7168
    v_mfma_f32_16x16x32_bf16 a[28:31], a[236:239], v[144:147], a[28:31]
    v_cvt_pk_bf16_f32 v136, v32, v33
    v_or3_b32 v10, v10, v135, v136
    v_mfma_f32_16x16x32_bf16 a[92:95], a[236:239], v[148:151], a[92:95]
    v_cvt_pk_bf16_f32 v137, v34, v35
    v_cvt_pk_bf16_f32 v138, v36, v37
    v_or3_b32 v10, v10, v137, v138
    v_cvt_pk_bf16_f32 v139, v38, v39
    v_cvt_pk_bf16_f32 v140, v40, v41
    v_or3_b32 v10, v10, v139, v140
    v_cvt_pk_bf16_f32 v141, v42, v43
    v_cvt_pk_bf16_f32 v142, v44, v45
    v_or3_b32 v10, v10, v141, v142
    v_cvt_pk_bf16_f32 v143, v46, v47
    v_bitop3_b32 v10, v10, v143, s95 bitop3:0xa8
    v_cmp_ne_u32 vcc, 0, v10
    v_mfma_f32_16x16x32_bf16 a[156:159], a[236:239], v[152:155], a[156:159]
    s_waitcnt lgkmcnt(8)
    buffer_load_dwordx4 v13, s[20:23], s43 offen offset:1024 sc1 lds
    v_mfma_f32_16x16x32_bf16 a[220:223], a[236:239], v[156:159], a[220:223]
    ds_read_b128 a[236:239], v12 offset:15360
    s_cbranch_vccnz k2_fb4
k2_r4:
    v_mfma_f32_16x16x32_bf16 v[232:235], a[32:35], v[72:75], v[168:171]
    v_cmp_le_i32 s[50:51], 0, v22
    v_cmp_le_i32 s[52:53], 1, v22
    v_mfma_f32_16x16x32_bf16 v[232:235], a[36:39], v[88:91], v[232:235]
    s_add_u32 m0, m0, 0x2000
    v_cmp_le_i32 s[54:55], 2, v22
    v_cmp_le_i32 s[56:57], 3, v22
    v_mfma_f32_16x16x32_bf16 v[232:235], a[40:43], v[200:203], v[232:235]
    s_add_u32 s43, s92, 16384
    v_cndmask_b32 v176, v19, v164, s[50:51]
    v_cndmask_b32 v177, v19, v164, s[52:53]
    v_mfma_f32_16x16x32_bf16 v[232:235], a[44:47], v[216:219], v[232:235]
    s_waitcnt lgkmcnt(8)
    v_cndmask_b32 v178, v19, v164, s[54:55]
    v_cndmask_b32 v179, v19, v164, s[56:57]
    v_mfma_f32_16x16x32_bf16 a[0:3], a[160:163], v[128:131], a[0:3]
    s_add_u32 s91, s91, 0x8000
    v_cmp_le_i32 s[50:51], 16, v22
    v_cmp_le_i32 s[52:53], 17, v22
    v_mfma_f32_16x16x32_bf16 a[64:67], a[160:163], v[132:135], a[64:67]
    s_sub_u32 s3, s91, 163840
    v_cmp_le_i32 s[54:55], 18, v22
    v_cmp_le_i32 s[56:57], 19, v22
    v_mfma_f32_16x16x32_bf16 a[128:131], a[160:163], v[136:139], a[128:131]
    s_min_u32 s91, s91, s3
    v_cndmask_b32 v180, v19, v164, s[50:51]
    v_cndmask_b32 v181, v19, v164, s[52:53]
    v_mfma_f32_16x16x32_bf16 a[192:195], a[160:163], v[140:143], a[192:195]
    ds_read_b128 a[160:163], v12 offset:24576
    v_cndmask_b32 v182, v19, v164, s[54:55]
    v_mfma_f32_16x16x32_bf16 a[4:7], a[164:167], v[128:131], a[4:7]
    v_cndmask_b32 v183, v19, v164, s[56:57]
    buffer_load_dwordx4 v13, s[20:23], s43 offen offset:0 sc1 lds
    v_mfma_f32_16x16x32_bf16 a[68:71], a[164:167], v[132:135], a[68:71]
    v_exp_f32 v32, v96
    v_mfma_f32_16x16x32_bf16 a[132:135], a[164:167], v[136:139], a[132:135]
    v_exp_f32 v33, v97
    v_mfma_f32_16x16x32_bf16 a[196:199], a[164:167], v[140:143], a[196:199]
    ds_read_b128 a[164:167], v12 offset:25600
    v_cvt_pk_bf16_f32 v144, v32, v33
    v_mfma_f32_16x16x32_bf16 a[48:51], v[14:17], v[128:131], a[48:51]
    v_exp_f32 v34, v98
    v_mfma_f32_16x16x32_bf16 a[176:179], v[14:17], v[136:139], a[176:179]
    v_exp_f32 v35, v99
    v_mfma_f32_16x16x32_bf16 v[236:239], a[32:35], v[76:79], v[172:175]
    v_exp_f32 v36, v112
    v_mfma_f32_16x16x32_bf16 v[236:239], a[36:39], v[92:95], v[236:239]
    v_exp_f32 v37, v113
    v_mfma_f32_16x16x32_bf16 v[236:239], a[40:43], v[204:207], v[236:239]
    v_exp_f32 v38, v114
    v_mfma_f32_16x16x32_bf16 v[236:239], a[44:47], v[220:223], v[236:239]
    v_exp_f32 v39, v115
    v_mfma_f32_16x16x32_bf16 a[8:11], a[168:171], v[128:131], a[8:11]
    buffer_load_dwordx4 v13, s[20:23], s43 offen offset:1024 sc1 lds
    v_mfma_f32_16x16x32_bf16 a[72:75], a[168:171], v[132:135], a[72:75]
    s_add_u32 m0, m0, 0x2000
    v_exp_f32 v40, v100
    v_mfma_f32_16x16x32_bf16 a[136:139], a[168:171], v[136:139], a[136:139]
    s_add_u32 s43, s92, 4294959104
    v_exp_f32 v41, v101
    v_mfma_f32_16x16x32_bf16 a[200:203], a[168:171], v[140:143], a[200:203]
    ds_read_b128 a[168:171], v12 offset:26624
    v_cvt_pk_bf16_f32 v145, v34, v35
    v_mfma_f32_16x16x32_bf16 v[228:231], a[32:35], v[68:71], v[176:179]
    v_exp_f32 v42, v102
    v_mfma_f32_16x16x32_bf16 v[228:231], a[36:39], v[84:87], v[228:231]
    ds_read_b128 a[32:35], v12 offset:16384
    ds_read_b128 a[36:39], v12 offset:17408
    v_mfma_f32_16x16x32_bf16 v[228:231], a[40:43], v[196:199], v[228:231]
    v_exp_f32 v43, v103
    v_mfma_f32_16x16x32_bf16 v[228:231], a[44:47], v[212:215], v[228:231]
    ds_read_b128 a[40:43], v12 offset:18432
    ds_read_b128 a[44:47], v12 offset:19456
    v_mfma_f32_16x16x32_bf16 a[12:15], a[172:175], v[128:131], a[12:15]
    v_exp_f32 v44, v116
    v_mfma_f32_16x16x32_bf16 a[76:79], a[172:175], v[132:135], a[76:79]
    v_exp_f32 v45, v117
    v_mfma_f32_16x16x32_bf16 a[140:143], a[172:175], v[136:139], a[140:143]
    v_exp_f32 v46, v118
    v_mfma_f32_16x16x32_bf16 a[204:207], a[172:175], v[140:143], a[204:207]
    s_waitcnt lgkmcnt(8)
    ds_read_b128 a[172:175], v12 offset:27648
    v_cvt_pk_bf16_f32 v146, v36, v37
    v_mfma_f32_16x16x32_bf16 v[248:251], a[96:99], v[72:75], v[168:171]
    buffer_load_dwordx4 v13, s[20:23], s43 offen offset:0 sc1 lds
    v_mfma_f32_16x16x32_bf16 v[248:251], a[100:103], v[88:91], v[248:251]
    v_exp_f32 v47, v119
    v_mfma_f32_16x16x32_bf16 v[248:251], a[104:107], v[200:203], v[248:251]
    v_exp_f32 v32, v104
    v_mfma_f32_16x16x32_bf16 v[248:251], a[108:111], v[216:219], v[248:251]
    s_waitcnt lgkmcnt(8)
    v_exp_f32 v33, v105
    v_mfma_f32_16x16x32_bf16 a[16:19], a[224:227], v[128:131], a[16:19]
    v_exp_f32 v34, v106
    v_mfma_f32_16x16x32_bf16 a[80:83], a[224:227], v[132:135], a[80:83]
    v_exp_f32 v35, v107
    v_mfma_f32_16x16x32_bf16 a[144:147], a[224:227], v[136:139], a[144:147]
    v_exp_f32 v36, v120
    v_mfma_f32_16x16x32_bf16 a[208:211], a[224:227], v[140:143], a[208:211]
    ds_read_b128 a[224:227], v12 offset:28672
    v_or3_b32 v10, v144, v145, v146
    v_mfma_f32_16x16x32_bf16 a[20:23], a[228:231], v[128:131], a[20:23]
    v_exp_f32 v37, v121
    v_mfma_f32_16x16x32_bf16 a[84:87], a[228:231], v[132:135], a[84:87]
    v_cvt_pk_bf16_f32 v147, v38, v39
    v_cvt_pk_bf16_f32 v148, v40, v41
    v_mfma_f32_16x16x32_bf16 a[148:151], a[228:231], v[136:139], a[148:151]
    v_exp_f32 v38, v122
    v_mfma_f32_16x16x32_bf16 a[212:215], a[228:231], v[140:143], a[212:215]
    ds_read_b128 a[228:231], v12 offset:29696
    v_or3_b32 v10, v10, v147, v148
    v_mfma_f32_16x16x32_bf16 a[112:115], v[14:17], v[132:135], a[112:115]
    v_exp_f32 v39, v123
    v_mfma_f32_16x16x32_bf16 a[240:243], v[14:17], v[140:143], a[240:243]
    v_exp_f32 v40, v108
    v_mfma_f32_16x16x32_bf16 v[252:255], a[96:99], v[76:79], v[172:175]
    v_exp_f32 v41, v109
    v_mfma_f32_16x16x32_bf16 v[252:255], a[100:103], v[92:95], v[252:255]
    v_cvt_pk_bf16_f32 v149, v42, v43
    v_cvt_pk_bf16_f32 v150, v44, v45
    v_mfma_f32_16x16x32_bf16 v[252:255], a[104:107], v[204:207], v[252:255]
    v_exp_f32 v42, v110
    v_mfma_f32_16x16x32_bf16 v[252:255], a[108:111], v[220:223], v[252:255]
    v_exp_f32 v43, v111
    v_mfma_f32_16x16x32_bf16 a[24:27], a[232:235], v[128:131], a[24:27]
    v_exp_f32 v44, v124
    v_mfma_f32_16x16x32_bf16 a[88:91], a[232:235], v[132:135], a[88:91]
    v_exp_f32 v45, v125
    v_mfma_f32_16x16x32_bf16 a[152:155], a[232:235], v[136:139], a[152:155]
    v_or3_b32 v10, v10, v149, v150
    v_cvt_pk_bf16_f32 v151, v46, v47
    v_mfma_f32_16x16x32_bf16 a[216:219], a[232:235], v[140:143], a[216:219]
    ds_read_b128 a[232:235], v12 offset:30720
    v_cvt_pk_bf16_f32 v152, v32, v33
    v_mfma_f32_16x16x32_bf16 v[244:247], a[96:99], v[68:71], v[180:183]
    v_exp_f32 v46, v126
    v_mfma_f32_16x16x32_bf16 v[244:247], a[100:103], v[84:87], v[244:247]
    ds_read_b128 a[96:99], v12 offset:20480
    ds_read_b128 a[100:103], v12 offset:21504
    v_mfma_f32_16x16x32_bf16 v[244:247], a[104:107], v[196:199], v[244:247]
    v_exp_f32 v47, v127
    v_mfma_f32_16x16x32_bf16 v[244:247], a[108:111], v[212:215], v[244:247]
    ds_read_b128 a[104:107], v12 offset:22528
    ds_read_b128 a[108:111], v12 offset:23552
    v_mfma_f32_16x16x32_bf16 a[28:31], a[236:239], v[128:131], a[28:31]
    v_or3_b32 v10, v10, v151, v152
    v_cvt_pk_bf16_f32 v153, v34, v35
    v_mfma_f32_16x16x32_bf16 a[92:95], a[236:239], v[132:135], a[92:95]
    v_cvt_pk_bf16_f32 v154, v36, v37
    v_or3_b32 v10, v10, v153, v154
    v_cvt_pk_bf16_f32 v155, v38, v39
    v_cvt_pk_bf16_f32 v156, v40, v41
    v_or3_b32 v10, v10, v155, v156
    v_cvt_pk_bf16_f32 v157, v42, v43
    v_cvt_pk_bf16_f32 v158, v44, v45
    v_or3_b32 v10, v10, v157, v158
    v_cvt_pk_bf16_f32 v159, v46, v47
    v_bitop3_b32 v10, v10, v159, s95 bitop3:0xa8
    v_cmp_ne_u32 vcc, 0, v10
    v_mfma_f32_16x16x32_bf16 a[156:159], a[236:239], v[136:139], a[156:159]
    s_waitcnt lgkmcnt(8)
    buffer_load_dwordx4 v13, s[20:23], s43 offen offset:1024 sc1 lds
    v_mfma_f32_16x16x32_bf16 a[220:223], a[236:239], v[140:143], a[220:223]
    s_add_u32 s92, s92, 0x8000
    ds_read_b128 a[236:239], v12 offset:31744
    s_cbranch_vccnz k2_fb5
k2_r5:
k2_X3:
    v_lshlrev_b32 v56, 3, v1
    s_lshl_b32 s3, s40, 13
    v_add_u32 v56, s3, v56
    s_getpc_b64 s[4:5]
L_pc1:
    s_add_u32 s4, s4, k2_Y1-L_pc1+4096
    s_addc_u32 s5, s5, 0
    v_min_u32 v56, CODE_B-4, v56
    v_mov_b32 v57, s5
    v_add_co_u32 v56, vcc, s4, v56
    s_nop 1
    v_addc_co_u32 v57, vcc, 0, v57, vcc
    global_load_dword v58, v[56:57], off offset:-4096
    v_mfma_f32_16x16x32_bf16 v[104:107], a[32:35], v[72:75], v[168:171]
    s_waitcnt vmcnt(16)
    s_barrier
    v_add_u32 v12, s90, v1
    v_mfma_f32_16x16x32_bf16 v[104:107], a[36:39], v[88:91], v[104:107]
    s_add_u32 m0, s91, s93
    v_cmp_le_i32 s[50:51], 32, v22
    v_cmp_le_i32 s[52:53], 33, v22
    v_mfma_f32_16x16x32_bf16 v[104:107], a[40:43], v[200:203], v[104:107]
    s_add_u32 s43, s92, 0
    v_cmp_le_i32 s[54:55], 34, v22
    v_cmp_le_i32 s[56:57], 35, v22
    v_mfma_f32_16x16x32_bf16 v[104:107], a[44:47], v[216:219], v[104:107]
    s_waitcnt lgkmcnt(8)
    v_cndmask_b32 v176, v19, v164, s[50:51]
    v_cndmask_b32 v177, v19, v164, s[52:53]
    v_mfma_f32_16x16x32_bf16 a[0:3], a[160:163], v[144:147], a[0:3]
    s_add_u32 s90, s90, 0x8000
    v_cndmask_b32 v178, v19, v164, s[54:55]
    v_cndmask_b32 v179, v19, v164, s[56:57]
    v_mfma_f32_16x16x32_bf16 a[64:67], a[160:163], v[148:151], a[64:67]
    s_sub_u32 s3, s90, 163840
    v_cmp_le_i32 s[50:51], 48, v22
    v_cmp_le_i32 s[52:53], 49, v22
    v_mfma_f32_16x16x32_bf16 a[128:131], a[160:163], v[152:155], a[128:131]
    s_min_u32 s90, s90, s3
    v_cmp_le_i32 s[54:55], 50, v22
    v_cmp_le_i32 s[56:57], 51, v22
    v_mfma_f32_16x16x32_bf16 a[192:195], a[160:163], v[156:159], a[192:195]
    ds_read_b128 a[160:163], v12 offset:8192
    v_cndmask_b32 v180, v19, v164, s[50:51]
    v_mfma_f32_16x16x32_bf16 a[4:7], a[164:167], v[144:147], a[4:7]
    v_cndmask_b32 v181, v19, v164, s[52:53]
    v_cndmask_b32 v182, v19, v164, s[54:55]
    v_mfma_f32_16x16x32_bf16 a[68:71], a[164:167], v[148:151], a[68:71]
    v_cndmask_b32 v183, v19, v164, s[56:57]
    v_mfma_f32_16x16x32_bf16 a[132:135], a[164:167], v[152:155], a[132:135]
    buffer_load_dwordx4 v13, s[20:23], s43 offen offset:0 sc1 lds
    v_mfma_f32_16x16x32_bf16 a[196:199], a[164:167], v[156:159], a[196:199]
    ds_read_b128 a[164:167], v12 offset:9216
    v_mfma_f32_16x16x32_bf16 a[48:51], v[14:17], v[144:147], a[48:51]
    v_exp_f32 v32, v228
    v_mfma_f32_16x16x32_bf16 a[176:179], v[14:17], v[152:155], a[176:179]
    v_exp_f32 v33, v229
    v_mfma_f32_16x16x32_bf16 v[108:111], a[32:35], v[76:79], v[172:175]
    v_exp_f32 v34, v230
    v_mfma_f32_16x16x32_bf16 v[108:111], a[36:39], v[92:95], v[108:111]
    v_exp_f32 v35, v231
    v_mfma_f32_16x16x32_bf16 v[108:111], a[40:43], v[204:207], v[108:111]
    v_exp_f32 v36, v244
    v_mfma_f32_16x16x32_bf16 v[108:111], a[44:47], v[220:223], v[108:111]
    v_exp_f32 v37, v245
    v_mfma_f32_16x16x32_bf16 a[8:11], a[168:171], v[144:147], a[8:11]
    buffer_load_dwordx4 v13, s[20:23], s43 offen offset:1024 sc1 lds
    v_mfma_f32_16x16x32_bf16 a[72:75], a[168:171], v[148:151], a[72:75]
    s_add_u32 m0, m0, 0x2000
    v_exp_f32 v38, v246
    v_mfma_f32_16x16x32_bf16 a[136:139], a[168:171], v[152:155], a[136:139]
    s_add_u32 s43, s92, 4294942720
    v_exp_f32 v39, v247
    v_mfma_f32_16x16x32_bf16 a[200:203], a[168:171], v[156:159], a[200:203]
    ds_read_b128 a[168:171], v12 offset:10240
    v_cvt_pk_bf16_f32 v132, v32, v33
    v_mfma_f32_16x16x32_bf16 v[100:103], a[32:35], v[68:71], v[176:179]
    v_exp_f32 v40, v232
    v_mfma_f32_16x16x32_bf16 v[100:103], a[36:39], v[84:87], v[100:103]
    ds_read_b128 a[32:35], v12 offset:0
    ds_read_b128 a[36:39], v12 offset:1024
    v_mfma_f32_16x16x32_bf16 v[100:103], a[40:43], v[196:199], v[100:103]
    v_exp_f32 v41, v233
    v_mfma_f32_16x16x32_bf16 v[100:103], a[44:47], v[212:215], v[100:103]
    ds_read_b128 a[40:43], v12 offset:2048
    ds_read_b128 a[44:47], v12 offset:3072
    v_mfma_f32_16x16x32_bf16 a[12:15], a[172:175], v[144:147], a[12:15]
    v_exp_f32 v42, v234
    v_mfma_f32_16x16x32_bf16 a[76:79], a[172:175], v[148:151], a[76:79]
    v_exp_f32 v43, v235
    v_mfma_f32_16x16x32_bf16 a[140:143], a[172:175], v[152:155], a[140:143]
    v_exp_f32 v44, v248
    v_mfma_f32_16x16x32_bf16 a[204:207], a[172:175], v[156:159], a[204:207]
    s_waitcnt lgkmcnt(8)
    ds_read_b128 a[172:175], v12 offset:11264
    v_cvt_pk_bf16_f32 v133, v34, v35
    v_mfma_f32_16x16x32_bf16 v[120:123], a[96:99], v[72:75], v[168:171]
    buffer_load_dwordx4 v13, s[20:23], s43 offen offset:0 sc1 lds
    v_mfma_f32_16x16x32_bf16 v[120:123], a[100:103], v[88:91], v[120:123]
    v_exp_f32 v45, v249
    v_mfma_f32_16x16x32_bf16 v[120:123], a[104:107], v[200:203], v[120:123]
    v_exp_f32 v46, v250
    v_mfma_f32_16x16x32_bf16 v[120:123], a[108:111], v[216:219], v[120:123]
    s_waitcnt lgkmcnt(8)
    v_exp_f32 v47, v251
    v_mfma_f32_16x16x32_bf16 a[16:19], a[224:227], v[144:147], a[16:19]
    v_exp_f32 v32, v236
    v_mfma_f32_16x16x32_bf16 a[80:83], a[224:227], v[148:151], a[80:83]
    v_exp_f32 v33, v237
    v_mfma_f32_16x16x32_bf16 a[144:147], a[224:227], v[152:155], a[144:147]
    v_exp_f32 v34, v238
    v_mfma_f32_16x16x32_bf16 a[208:211], a[224:227], v[156:159], a[208:211]
    ds_read_b128 a[224:227], v12 offset:12288
    v_cvt_pk_bf16_f32 v134, v36, v37
    v_mfma_f32_16x16x32_bf16 a[20:23], a[228:231], v[144:147], a[20:23]
    v_exp_f32 v35, v239
    v_mfma_f32_16x16x32_bf16 a[84:87], a[228:231], v[148:151], a[84:87]
    v_exp_f32 v36, v252
    v_mfma_f32_16x16x32_bf16 a[148:151], a[228:231], v[152:155], a[148:151]
    v_exp_f32 v37, v253
    v_mfma_f32_16x16x32_bf16 a[212:215], a[228:231], v[156:159], a[212:215]
    ds_read_b128 a[228:231], v12 offset:13312
    v_or3_b32 v10, v132, v133, v134
    v_mfma_f32_16x16x32_bf16 a[112:115], v[14:17], v[148:151], a[112:115]
    v_cvt_pk_bf16_f32 v135, v38, v39
    v_cvt_pk_bf16_f32 v136, v40, v41
    v_mfma_f32_16x16x32_bf16 a[240:243], v[14:17], v[156:159], a[240:243]
    v_exp_f32 v38, v254
    v_mfma_f32_16x16x32_bf16 v[124:127], a[96:99], v[76:79], v[172:175]
    v_exp_f32 v39, v255
    v_mfma_f32_16x16x32_bf16 v[124:127], a[100:103], v[92:95], v[124:127]
    v_or3_b32 v10, v10, v135, v136
    v_cvt_pk_bf16_f32 v137, v42, v43
    v_mfma_f32_16x16x32_bf16 v[124:127], a[104:107], v[204:207], v[124:127]
    v_cvt_pk_bf16_f32 v138, v44, v45
    v_or3_b32 v10, v10, v137, v138
    v_mfma_f32_16x16x32_bf16 v[124:127], a[108:111], v[220:223], v[124:127]
    v_cvt_pk_bf16_f32 v139, v46, v47
    v_cvt_pk_bf16_f32 v140, v32, v33
    v_mfma_f32_16x16x32_bf16 a[24:27], a[232:235], v[144:147], a[24:27]
    v_or3_b32 v10, v10, v139, v140
    v_cvt_pk_bf16_f32 v141, v34, v35
    v_mfma_f32_16x16x32_bf16 a[88:91], a[232:235], v[148:151], a[88:91]
    v_cvt_pk_bf16_f32 v142, v36, v37
    v_or3_b32 v10, v10, v141, v142
    v_mfma_f32_16x16x32_bf16 a[152:155], a[232:235], v[152:155], a[152:155]
    v_cvt_pk_bf16_f32 v143, v38, v39
    v_bitop3_b32 v10, v10, v143, s95 bitop3:0xa8
    v_mfma_f32_16x16x32_bf16 a[216:219], a[232:235], v[156:159], a[216:219]
    ds_read_b128 a[232:235], v12 offset:14336
    v_cmp_ne_u32 vcc, 0, v10
    v_mfma_f32_16x16x32_bf16 v[116:119], a[96:99], v[68:71], v[180:183]
    v_mfma_f32_16x16x32_bf16 v[116:119], a[100:103], v[84:87], v[116:119]
    ds_read_b128 a[96:99], v12 offset:4096
    ds_read_b128 a[100:103], v12 offset:5120
    v_mfma_f32_16x16x32_bf16 v[116:119], a[104:107], v[196:199], v[116:119]
    v_mfma_f32_16x16x32_bf16 v[116:119], a[108:111], v[212:215], v[116:119]
    ds_read_b128 a[104:107], v12 offset:6144
    ds_read_b128 a[108:111], v12 offset:7168
    v_mfma_f32_16x16x32_bf16 a[28:31], a[236:239], v[144:147], a[28:31]
    v_mfma_f32_16x16x32_bf16 a[92:95], a[236:239], v[148:151], a[92:95]
    v_mfma_f32_16x16x32_bf16 a[156:159], a[236:239], v[152:155], a[156:159]
    s_waitcnt lgkmcnt(8)
    buffer_load_dwordx4 v13, s[20:23], s43 offen offset:1024 sc1 lds
    v_mfma_f32_16x16x32_bf16 a[220:223], a[236:239], v[156:159], a[220:223]
    ds_read_b128 a[236:239], v12 offset:15360
    s_cbranch_vccnz k2_fb6
k2_r6:
    v_add_u32 v23, s61, v20
    v_add_u32 v24, s61, v21
    v_mfma_f32_16x16x32_bf16 a[64:67], a[160:163], v[132:135], a[64:67]
    v_cmp_le_i32 s[50:51], 0, v23
    v_cmp_le_i32 s[52:53], 1, v23
    v_mfma_f32_16x16x32_bf16 a[128:131], a[160:163], v[136:139], a[128:131]
    s_add_u32 m0, m0, 0x2000
    v_cmp_le_i32 s[54:55], 2, v23
    v_cmp_le_i32 s[56:57], 3, v23
    v_mfma_f32_16x16x32_bf16 a[192:195], a[160:163], v[140:143], a[192:195]
    s_add_u32 s43, s92, 16384
    ds_read_b128 a[160:163], v12 offset:24576
    v_cndmask_b32 v176, v19, v168, s[50:51]
    v_mfma_f32_16x16x32_bf16 a[68:71], a[164:167], v[132:135], a[68:71]
    s_add_u32 s91, s91, 0x8000
    v_cndmask_b32 v177, v19, v168, s[52:53]
    v_cndmask_b32 v178, v19, v168, s[54:55]
    v_mfma_f32_16x16x32_bf16 a[132:135], a[164:167], v[136:139], a[132:135]
    s_sub_u32 s3, s91, 163840
    v_cndmask_b32 v179, v19, v168, s[56:57]
    v_cmp_le_i32 s[50:51], 0, v24
    v_mfma_f32_16x16x32_bf16 a[196:199], a[164:167], v[140:143], a[196:199]
    s_min_u32 s91, s91, s3
    ds_read_b128 a[164:167], v12 offset:25600
    v_cmp_le_i32 s[52:53], 1, v24
    v_mfma_f32_16x16x32_bf16 a[112:115], v[14:17], v[132:135], a[112:115]
    v_cmp_le_i32 s[54:55], 2, v24
    v_cmp_le_i32 s[56:57], 3, v24
    v_mfma_f32_16x16x32_bf16 a[240:243], v[14:17], v[140:143], a[240:243]
    v_cndmask_b32 v184, v19, v172, s[50:51]
    v_cndmask_b32 v185, v19, v172, s[52:53]
    v_mfma_f32_16x16x32_bf16 v[232:235], a[32:35], v[72:75], v[176:179]
    v_cndmask_b32 v186, v19, v172, s[54:55]
    v_cndmask_b32 v187, v19, v172, s[56:57]
    v_mfma_f32_16x16x32_bf16 v[232:235], a[36:39], v[88:91], v[232:235]
    s_waitcnt lgkmcnt(10)
    v_cmp_le_i32 s[50:51], 16, v23
    v_cmp_le_i32 s[52:53], 17, v23
    v_mfma_f32_16x16x32_bf16 v[232:235], a[40:43], v[200:203], v[232:235]
    v_cmp_le_i32 s[54:55], 18, v23
    v_cmp_le_i32 s[56:57], 19, v23
    v_mfma_f32_16x16x32_bf16 v[232:235], a[44:47], v[216:219], v[232:235]
    v_cndmask_b32 v180, v19, v168, s[50:51]
    v_cndmask_b32 v181, v19, v168, s[52:53]
    v_mfma_f32_16x16x32_bf16 a[72:75], a[168:171], v[132:135], a[72:75]
    v_cndmask_b32 v182, v19, v168, s[54:55]
    v_cndmask_b32 v183, v19, v168, s[56:57]
    v_mfma_f32_16x16x32_bf16 a[136:139], a[168:171], v[136:139], a[136:139]
    v_cmp_le_i32 s[50:51], 16, v24
    v_cmp_le_i32 s[52:53], 17, v24
    v_mfma_f32_16x16x32_bf16 a[200:203], a[168:171], v[140:143], a[200:203]
    ds_read_b128 a[168:171], v12 offset:26624
    v_cmp_le_i32 s[54:55], 18, v24
    v_mfma_f32_16x16x32_bf16 a[76:79], a[172:175], v[132:135], a[76:79]
    v_cmp_le_i32 s[56:57], 19, v24
    buffer_load_dwordx4 v13, s[20:23], s43 offen offset:0 sc1 lds
    v_mfma_f32_16x16x32_bf16 a[140:143], a[172:175], v[136:139], a[140:143]
    v_cndmask_b32 v188, v19, v172, s[50:51]
    v_cndmask_b32 v189, v19, v172, s[52:53]
    v_mfma_f32_16x16x32_bf16 a[204:207], a[172:175], v[140:143], a[204:207]
    ds_read_b128 a[172:175], v12 offset:27648
    v_cndmask_b32 v190, v19, v172, s[54:55]
    v_mfma_f32_16x16x32_bf16 v[236:239], a[32:35], v[76:79], v[184:187]
    v_cndmask_b32 v191, v19, v172, s[56:57]
    buffer_load_dwordx4 v13, s[20:23], s43 offen offset:1024 sc1 lds
    v_mfma_f32_16x16x32_bf16 v[236:239], a[36:39], v[92:95], v[236:239]
    s_add_u32 m0, m0, 0x2000
    ds_read_b128 a[32:35], v12 offset:16384
    ds_read_b128 a[36:39], v12 offset:17408
    v_mfma_f32_16x16x32_bf16 v[236:239], a[40:43], v[204:207], v[236:239]
    s_add_u32 s43, s92, 4294959104
    v_exp_f32 v32, v100
    v_mfma_f32_16x16x32_bf16 v[236:239], a[44:47], v[220:223], v[236:239]
    s_waitcnt lgkmcnt(8)
    ds_read_b128 a[40:43], v12 offset:18432
    ds_read_b128 a[44:47], v12 offset:19456
    v_mfma_f32_16x16x32_bf16 a[80:83], a[224:227], v[132:135], a[80:83]
    buffer_load_dwordx4 v13, s[20:23], s43 offen offset:0 sc1 lds
    v_mfma_f32_16x16x32_bf16 a[144:147], a[224:227], v[136:139], a[144:147]
    v_exp_f32 v33, v101
    v_mfma_f32_16x16x32_bf16 a[208:211], a[224:227], v[140:143], a[208:211]
    ds_read_b128 a[224:227], v12 offset:28672
    v_cvt_pk_bf16_f32 v148, v32, v33
    v_mfma_f32_16x16x32_bf16 v[248:251], a[96:99], v[72:75], v[180:183]
    v_exp_f32 v34, v102
    v_mfma_f32_16x16x32_bf16 v[248:251], a[100:103], v[88:91], v[248:251]
    v_exp_f32 v35, v103
    v_mfma_f32_16x16x32_bf16 v[248:251], a[104:107], v[200:203], v[248:251]
    s_waitcnt lgkmcnt(9)
    v_exp_f32 v36, v116
    v_mfma_f32_16x16x32_bf16 v[248:251], a[108:111], v[216:219], v[248:251]
    v_exp_f32 v37, v117
    v_mfma_f32_16x16x32_bf16 a[84:87], a[228:231], v[132:135], a[84:87]
    v_exp_f32 v38, v118
    v_mfma_f32_16x16x32_bf16 a[148:151], a[228:231], v[136:139], a[148:151]
    v_exp_f32 v39, v119
    v_mfma_f32_16x16x32_bf16 a[212:215], a[228:231], v[140:143], a[212:215]
    ds_read_b128 a[228:231], v12 offset:29696
    v_cvt_pk_bf16_f32 v149, v34, v35
    v_mfma_f32_16x16x32_bf16 a[176:179], v[14:17], v[136:139], a[176:179]
    v_exp_f32 v40, v104
    v_mfma_f32_16x16x32_bf16 a[88:91], a[232:235], v[132:135], a[88:91]
    v_exp_f32 v41, v105
    v_mfma_f32_16x16x32_bf16 a[152:155], a[232:235], v[136:139], a[152:155]
    v_exp_f32 v42, v106
    v_mfma_f32_16x16x32_bf16 a[216:219], a[232:235], v[140:143], a[216:219]
    ds_read_b128 a[232:235], v12 offset:30720
    v_cvt_pk_bf16_f32 v150, v36, v37
    v_mfma_f32_16x16x32_bf16 v[252:255], a[96:99], v[76:79], v[188:191]
    v_exp_f32 v43, v107
    v_mfma_f32_16x16x32_bf16 v[252:255], a[100:103], v[92:95], v[252:255]
    ds_read_b128 a[96:99], v12 offset:20480
    ds_read_b128 a[100:103], v12 offset:21504
    v_mfma_f32_16x16x32_bf16 v[252:255], a[104:107], v[204:207], v[252:255]
    v_exp_f32 v44, v120
    v_mfma_f32_16x16x32_bf16 v[252:255], a[108:111], v[220:223], v[252:255]
    ds_read_b128 a[104:107], v12 offset:22528
    ds_read_b128 a[108:111], v12 offset:23552
    v_mfma_f32_16x16x32_bf16 a[92:95], a[236:239], v[132:135], a[92:95]
    v_exp_f32 v45, v121
    v_or3_b32 v10, v148, v149, v150
    v_cvt_pk_bf16_f32 v151, v38, v39
    v_cvt_pk_bf16_f32 v152, v40, v41
    v_or3_b32 v10, v10, v151, v152
    v_cvt_pk_bf16_f32 v153, v42, v43
    v_cvt_pk_bf16_f32 v154, v44, v45
    v_or3_b32 v10, v10, v153, v154
    v_exp_f32 v46, v122
    v_exp_f32 v47, v123
    v_exp_f32 v32, v108
    v_cvt_pk_bf16_f32 v155, v46, v47
    v_exp_f32 v33, v109
    v_exp_f32 v34, v110
    v_cvt_pk_bf16_f32 v156, v32, v33
    v_or3_b32 v10, v10, v155, v156
    v_exp_f32 v35, v111
    v_exp_f32 v36, v124
    v_cvt_pk_bf16_f32 v157, v34, v35
    v_exp_f32 v37, v125
    v_exp_f32 v38, v126
    v_cvt_pk_bf16_f32 v158, v36, v37
    v_or3_b32 v10, v10, v157, v158
    v_exp_f32 v39, v127
    s_nop 0
    v_cvt_pk_bf16_f32 v159, v38, v39
    v_bitop3_b32 v10, v10, v159, s95 bitop3:0xa8
    v_cmp_ne_u32 vcc, 0, v10
    v_mfma_f32_16x16x32_bf16 a[156:159], a[236:239], v[136:139], a[156:159]
    s_waitcnt lgkmcnt(7)
    buffer_load_dwordx4 v13, s[20:23], s43 offen offset:1024 sc1 lds
    v_mfma_f32_16x16x32_bf16 a[220:223], a[236:239], v[140:143], a[220:223]
    s_add_u32 s92, s92, 0x8000
    ds_read_b128 a[236:239], v12 offset:31744
    s_cbranch_vccnz k2_fb7
k2_r7:
    s_waitcnt lgkmcnt(0)
    v_mfma_f32_16x16x32_bf16 a[64:67], a[160:163], v[148:151], a[64:67]
    v_accvgpr_read_b32 v2, a48
    v_rcp_f32 v2, v2
    v_mfma_f32_16x16x32_bf16 a[68:71], a[164:167], v[148:151], a[68:71]
    v_accvgpr_read_b32 v32, a0
    v_accvgpr_read_b32 v33, a1
    v_accvgpr_read_b32 v34, a2
    v_mfma_f32_16x16x32_bf16 a[72:75], a[168:171], v[148:151], a[72:75]
    v_accvgpr_read_b32 v35, a3
    v_accvgpr_read_b32 v36, a4
    v_accvgpr_read_b32 v37, a5
    v_mfma_f32_16x16x32_bf16 a[76:79], a[172:175], v[148:151], a[76:79]
    v_accvgpr_read_b32 v38, a6
    v_accvgpr_read_b32 v39, a7
    v_mfma_f32_16x16x32_bf16 a[80:83], a[224:227], v[148:151], a[80:83]
    v_mul_f32 v32, v32, v2
    v_mul_f32 v33, v33, v2
    v_mfma_f32_16x16x32_bf16 a[84:87], a[228:231], v[148:151], a[84:87]
    v_mul_f32 v34, v34, v2
    v_mul_f32 v35, v35, v2
    v_mfma_f32_16x16x32_bf16 a[88:91], a[232:235], v[148:151], a[88:91]
    v_mul_f32 v36, v36, v2
    v_mul_f32 v37, v37, v2
    v_mfma_f32_16x16x32_bf16 a[92:95], a[236:239], v[148:151], a[92:95]
    v_mul_f32 v38, v38, v2
    v_mul_f32 v39, v39, v2
    v_mfma_f32_16x16x32_bf16 a[112:115], v[14:17], v[148:151], a[112:115]
    v_cvt_pk_bf16_f32 v48, v32, v33
    v_cvt_pk_bf16_f32 v49, v34, v35
    v_cvt_pk_bf16_f32 v50, v36, v37
    v_cvt_pk_bf16_f32 v51, v38, v39
    buffer_store_dwordx4 v[48:51], v1, s[24:27], s81 offen offset:0 sc0 sc1
    v_accvgpr_read_b32 v40, a8
    v_accvgpr_read_b32 v41, a9
    v_accvgpr_read_b32 v42, a10
    v_accvgpr_read_b32 v43, a11
    v_accvgpr_read_b32 v44, a12
    v_accvgpr_read_b32 v45, a13
    v_accvgpr_read_b32 v46, a14
    v_accvgpr_read_b32 v47, a15
    v_mul_f32 v40, v40, v2
    v_mul_f32 v41, v41, v2
    v_mul_f32 v42, v42, v2
    v_mul_f32 v43, v43, v2
    v_mul_f32 v44, v44, v2
    v_mul_f32 v45, v45, v2
    v_mul_f32 v46, v46, v2
    v_mul_f32 v47, v47, v2
    v_cvt_pk_bf16_f32 v52, v40, v41
    v_cvt_pk_bf16_f32 v53, v42, v43
    v_cvt_pk_bf16_f32 v54, v44, v45
    v_cvt_pk_bf16_f32 v55, v46, v47
    buffer_store_dwordx4 v[52:55], v1, s[24:27], s81 offen offset:1024 sc0 sc1
    v_accvgpr_read_b32 v32, a16
    v_accvgpr_read_b32 v33, a17
    v_accvgpr_read_b32 v34, a18
    v_accvgpr_read_b32 v35, a19
    v_accvgpr_read_b32 v36, a20
    v_accvgpr_read_b32 v37, a21
    v_accvgpr_read_b32 v38, a22
    v_accvgpr_read_b32 v39, a23
    v_mul_f32 v32, v32, v2
    v_mul_f32 v33, v33, v2
    v_mul_f32 v34, v34, v2
    v_mul_f32 v35, v35, v2
    v_mul_f32 v36, v36, v2
    v_mul_f32 v37, v37, v2
    v_mul_f32 v38, v38, v2
    v_mul_f32 v39, v39, v2
    v_cvt_pk_bf16_f32 v48, v32, v33
    v_cvt_pk_bf16_f32 v49, v34, v35
    v_cvt_pk_bf16_f32 v50, v36, v37
    v_cvt_pk_bf16_f32 v51, v38, v39
    buffer_store_dwordx4 v[48:51], v1, s[24:27], s81 offen offset:2048 sc0 sc1
    v_accvgpr_read_b32 v40, a24
    v_accvgpr_read_b32 v41, a25
    v_accvgpr_read_b32 v42, a26
    v_accvgpr_read_b32 v43, a27
    v_accvgpr_read_b32 v44, a28
    v_accvgpr_read_b32 v45, a29
    v_accvgpr_read_b32 v46, a30
    v_accvgpr_read_b32 v47, a31
    v_mul_f32 v40, v40, v2
    v_mul_f32 v41, v41, v2
    v_mul_f32 v42, v42, v2
    v_mul_f32 v43, v43, v2
    v_mul_f32 v44, v44, v2
    v_mul_f32 v45, v45, v2
    v_mul_f32 v46, v46, v2
    v_mul_f32 v47, v47, v2
    v_cvt_pk_bf16_f32 v52, v40, v41
    v_cvt_pk_bf16_f32 v53, v42, v43
    v_cvt_pk_bf16_f32 v54, v44, v45
    v_cvt_pk_bf16_f32 v55, v46, v47
    buffer_store_dwordx4 v[52:55], v1, s[24:27], s81 offen offset:3072 sc0 sc1
    v_accvgpr_read_b32 v3, a112
    v_rcp_f32 v3, v3
    v_accvgpr_read_b32 v32, a64
    v_accvgpr_read_b32 v33, a65
    v_accvgpr_read_b32 v34, a66
    v_accvgpr_read_b32 v35, a67
    v_accvgpr_read_b32 v36, a68
    v_accvgpr_read_b32 v37, a69
    v_accvgpr_read_b32 v38, a70
    v_accvgpr_read_b32 v39, a71
    v_mul_f32 v32, v32, v3
    v_mul_f32 v33, v33, v3
    v_mul_f32 v34, v34, v3
    v_mul_f32 v35, v35, v3
    v_mul_f32 v36, v36, v3
    v_mul_f32 v37, v37, v3
    v_mul_f32 v38, v38, v3
    v_mul_f32 v39, v39, v3
    v_cvt_pk_bf16_f32 v48, v32, v33
    v_cvt_pk_bf16_f32 v49, v34, v35
    v_cvt_pk_bf16_f32 v50, v36, v37
    v_cvt_pk_bf16_f32 v51, v38, v39
    buffer_store_dwordx4 v[48:51], v1, s[24:27], s82 offen offset:0 sc0 sc1
    v_accvgpr_read_b32 v40, a72
    v_accvgpr_read_b32 v41, a73
    v_accvgpr_read_b32 v42, a74
    v_accvgpr_read_b32 v43, a75
    v_accvgpr_read_b32 v44, a76
    v_accvgpr_read_b32 v45, a77
    v_accvgpr_read_b32 v46, a78
    v_accvgpr_read_b32 v47, a79
    v_mul_f32 v40, v40, v3
    v_mul_f32 v41, v41, v3
    v_mul_f32 v42, v42, v3
    v_mul_f32 v43, v43, v3
    v_mul_f32 v44, v44, v3
    v_mul_f32 v45, v45, v3
    v_mul_f32 v46, v46, v3
    v_mul_f32 v47, v47, v3
    v_cvt_pk_bf16_f32 v52, v40, v41
    v_cvt_pk_bf16_f32 v53, v42, v43
    v_cvt_pk_bf16_f32 v54, v44, v45
    v_cvt_pk_bf16_f32 v55, v46, v47
    buffer_store_dwordx4 v[52:55], v1, s[24:27], s82 offen offset:1024 sc0 sc1
    v_accvgpr_read_b32 v32, a80
    v_accvgpr_read_b32 v33, a81
    v_accvgpr_read_b32 v34, a82
    v_accvgpr_read_b32 v35, a83
    v_accvgpr_read_b32 v36, a84
    v_accvgpr_read_b32 v37, a85
    v_accvgpr_read_b32 v38, a86
    v_accvgpr_read_b32 v39, a87
    v_mul_f32 v32, v32, v3
    v_mul_f32 v33, v33, v3
    v_mul_f32 v34, v34, v3
    v_mul_f32 v35, v35, v3
    v_mul_f32 v36, v36, v3
    v_mul_f32 v37, v37, v3
    v_mul_f32 v38, v38, v3
    v_mul_f32 v39, v39, v3
    v_cvt_pk_bf16_f32 v48, v32, v33
    v_cvt_pk_bf16_f32 v49, v34, v35
    v_cvt_pk_bf16_f32 v50, v36, v37
    v_cvt_pk_bf16_f32 v51, v38, v39
    buffer_store_dwordx4 v[48:51], v1, s[24:27], s82 offen offset:2048 sc0 sc1
    v_accvgpr_read_b32 v40, a88
    v_accvgpr_read_b32 v41, a89
    v_accvgpr_read_b32 v42, a90
    v_accvgpr_read_b32 v43, a91
    v_accvgpr_read_b32 v44, a92
    v_accvgpr_read_b32 v45, a93
    v_accvgpr_read_b32 v46, a94
    v_accvgpr_read_b32 v47, a95
    v_mul_f32 v40, v40, v3
    v_mul_f32 v41, v41, v3
    v_mul_f32 v42, v42, v3
    v_mul_f32 v43, v43, v3
    v_mul_f32 v44, v44, v3
    v_mul_f32 v45, v45, v3
    v_mul_f32 v46, v46, v3
    v_mul_f32 v47, v47, v3
    v_cvt_pk_bf16_f32 v52, v40, v41
    v_cvt_pk_bf16_f32 v53, v42, v43
    v_cvt_pk_bf16_f32 v54, v44, v45
    v_cvt_pk_bf16_f32 v55, v46, v47
    buffer_store_dwordx4 v[52:55], v1, s[24:27], s82 offen offset:3072 sc0 sc1
    s_cmp_lg_u32 s42, 7
    s_cbranch_scc1 k2_X4
    s_waitcnt vmcnt(0)
    s_barrier
    s_and_b32 s3, s2, 7
    s_lshl_b32 s4, s42, 3
    s_add_u32 s3, s3, s4
    s_lshl_b32 s3, s3, 5
    s_bfe_u32 s4, s2, 0x20003
    s_add_u32 s3, s3, s4
    s_lshl_b32 s4, s3, 2
    s_add_u32 s5, s4, 16
    v_lshlrev_b32 v27, 3, v1
    v_lshlrev_b32 v28, 19, v1
    v_and_b32 v29, 0x18000000, v28
    v_and_b32 v28, 0x10000000, v28
    v_lshl_add_u32 v29, v29, 2, v27
    v_lshl_add_u32 v27, v28, 2, v27
    buffer_store_dword v0, v30, s[36:39], s4 offen sc0 sc1
    s_branch k2_Y2
k2_X4:
    s_lshl_b32 s94, s42, 2
    s_sub_u32 s94, 27, s94
.p2align 6
k2_S:
    v_mfma_f32_16x16x32_bf16 v[104:107], a[32:35], v[72:75], v[168:171]
    s_waitcnt vmcnt(16)
    s_barrier
    v_add_u32 v12, s90, v1
    v_mfma_f32_16x16x32_bf16 v[104:107], a[36:39], v[88:91], v[104:107]
    s_add_u32 m0, s91, s93
    v_exp_f32 v32, v232
    v_mfma_f32_16x16x32_bf16 v[104:107], a[40:43], v[200:203], v[104:107]
    s_add_u32 s43, s92, 0
    v_exp_f32 v33, v233
    v_mfma_f32_16x16x32_bf16 v[104:107], a[44:47], v[216:219], v[104:107]
    s_waitcnt lgkmcnt(8)
    v_exp_f32 v34, v234
    v_mfma_f32_16x16x32_bf16 a[128:131], a[160:163], v[152:155], a[128:131]
    s_add_u32 s90, s90, 0x8000
    buffer_load_dwordx4 v13, s[20:23], s43 offen offset:0 sc1 lds
    v_mfma_f32_16x16x32_bf16 a[192:195], a[160:163], v[156:159], a[192:195]
    s_sub_u32 s3, s90, 163840
    ds_read_b128 a[160:163], v12 offset:8192
    v_cvt_pk_bf16_f32 v136, v32, v33
    v_mfma_f32_16x16x32_bf16 a[132:135], a[164:167], v[152:155], a[132:135]
    s_min_u32 s90, s90, s3
    v_exp_f32 v35, v235
    v_mfma_f32_16x16x32_bf16 a[196:199], a[164:167], v[156:159], a[196:199]
    ds_read_b128 a[164:167], v12 offset:9216
    v_cvt_pk_bf16_f32 v137, v34, v35
    v_mfma_f32_16x16x32_bf16 a[176:179], v[14:17], v[152:155], a[176:179]
    v_exp_f32 v36, v248
    v_mfma_f32_16x16x32_bf16 v[108:111], a[32:35], v[76:79], v[172:175]
    v_exp_f32 v37, v249
    v_mfma_f32_16x16x32_bf16 v[108:111], a[36:39], v[92:95], v[108:111]
    ds_read_b128 a[32:35], v12 offset:0
    ds_read_b128 a[36:39], v12 offset:1024
    v_mfma_f32_16x16x32_bf16 v[108:111], a[40:43], v[204:207], v[108:111]
    buffer_load_dwordx4 v13, s[20:23], s43 offen offset:1024 sc1 lds
    v_mfma_f32_16x16x32_bf16 v[108:111], a[44:47], v[220:223], v[108:111]
    s_add_u32 m0, m0, 0x2000
    ds_read_b128 a[40:43], v12 offset:2048
    ds_read_b128 a[44:47], v12 offset:3072
    v_mfma_f32_16x16x32_bf16 a[136:139], a[168:171], v[152:155], a[136:139]
    s_add_u32 s43, s92, 4294942720
    v_exp_f32 v38, v250
    v_mfma_f32_16x16x32_bf16 a[200:203], a[168:171], v[156:159], a[200:203]
    ds_read_b128 a[168:171], v12 offset:10240
    v_cvt_pk_bf16_f32 v138, v36, v37
    v_mfma_f32_16x16x32_bf16 a[140:143], a[172:175], v[152:155], a[140:143]
    v_exp_f32 v39, v251
    v_mfma_f32_16x16x32_bf16 a[204:207], a[172:175], v[156:159], a[204:207]
    s_waitcnt lgkmcnt(9)
    ds_read_b128 a[172:175], v12 offset:11264
    v_or3_b32 v10, v136, v137, v138
    v_mfma_f32_16x16x32_bf16 v[120:123], a[96:99], v[72:75], v[168:171]
    buffer_load_dwordx4 v13, s[20:23], s43 offen offset:0 sc1 lds
    v_mfma_f32_16x16x32_bf16 v[120:123], a[100:103], v[88:91], v[120:123]
    v_exp_f32 v40, v236
    v_mfma_f32_16x16x32_bf16 v[120:123], a[104:107], v[200:203], v[120:123]
    v_exp_f32 v41, v237
    v_mfma_f32_16x16x32_bf16 v[120:123], a[108:111], v[216:219], v[120:123]
    s_waitcnt lgkmcnt(8)
    v_exp_f32 v42, v238
    v_mfma_f32_16x16x32_bf16 a[144:147], a[224:227], v[152:155], a[144:147]
    v_exp_f32 v43, v239
    v_mfma_f32_16x16x32_bf16 a[208:211], a[224:227], v[156:159], a[208:211]
    ds_read_b128 a[224:227], v12 offset:12288
    v_cvt_pk_bf16_f32 v139, v38, v39
    v_mfma_f32_16x16x32_bf16 a[148:151], a[228:231], v[152:155], a[148:151]
    v_exp_f32 v44, v252
    v_mfma_f32_16x16x32_bf16 a[212:215], a[228:231], v[156:159], a[212:215]
    ds_read_b128 a[228:231], v12 offset:13312
    v_cvt_pk_bf16_f32 v140, v40, v41
    v_mfma_f32_16x16x32_bf16 a[240:243], v[14:17], v[156:159], a[240:243]
    v_exp_f32 v45, v253
    v_mfma_f32_16x16x32_bf16 v[124:127], a[96:99], v[76:79], v[172:175]
    v_exp_f32 v46, v254
    v_mfma_f32_16x16x32_bf16 v[124:127], a[100:103], v[92:95], v[124:127]
    ds_read_b128 a[96:99], v12 offset:4096
    ds_read_b128 a[100:103], v12 offset:5120
    v_mfma_f32_16x16x32_bf16 v[124:127], a[104:107], v[204:207], v[124:127]
    v_exp_f32 v47, v255
    v_mfma_f32_16x16x32_bf16 v[124:127], a[108:111], v[220:223], v[124:127]
    ds_read_b128 a[104:107], v12 offset:6144
    ds_read_b128 a[108:111], v12 offset:7168
    v_mfma_f32_16x16x32_bf16 a[152:155], a[232:235], v[152:155], a[152:155]
    v_or3_b32 v10, v10, v139, v140
    v_cvt_pk_bf16_f32 v141, v42, v43
    v_mfma_f32_16x16x32_bf16 a[216:219], a[232:235], v[156:159], a[216:219]
    ds_read_b128 a[232:235], v12 offset:14336
    v_cvt_pk_bf16_f32 v142, v44, v45
    v_or3_b32 v10, v10, v141, v142
    v_cvt_pk_bf16_f32 v143, v46, v47
    v_bitop3_b32 v10, v10, v143, s95 bitop3:0xa8
    v_cmp_ne_u32 vcc, 0, v10
    v_mfma_f32_16x16x32_bf16 a[156:159], a[236:239], v[152:155], a[156:159]
    s_waitcnt lgkmcnt(9)
    buffer_load_dwordx4 v13, s[20:23], s43 offen offset:1024 sc1 lds
    v_mfma_f32_16x16x32_bf16 a[220:223], a[236:239], v[156:159], a[220:223]
    ds_read_b128 a[236:239], v12 offset:15360
    s_cbranch_vccnz k2_fb8
k2_r8:
    v_mfma_f32_16x16x32_bf16 v[232:235], a[32:35], v[72:75], v[168:171]
    v_exp_f32 v32, v104
    v_mfma_f32_16x16x32_bf16 v[232:235], a[36:39], v[88:91], v[232:235]
    s_add_u32 m0, m0, 0x2000
    v_exp_f32 v33, v105
    v_mfma_f32_16x16x32_bf16 v[232:235], a[40:43], v[200:203], v[232:235]
    s_add_u32 s43, s92, 16384
    v_exp_f32 v34, v106
    v_mfma_f32_16x16x32_bf16 v[232:235], a[44:47], v[216:219], v[232:235]
    s_waitcnt lgkmcnt(8)
    v_exp_f32 v35, v107
    v_mfma_f32_16x16x32_bf16 a[128:131], a[160:163], v[136:139], a[128:131]
    s_add_u32 s91, s91, 0x8000
    buffer_load_dwordx4 v13, s[20:23], s43 offen offset:0 sc1 lds
    v_mfma_f32_16x16x32_bf16 a[192:195], a[160:163], v[140:143], a[192:195]
    s_sub_u32 s3, s91, 163840
    ds_read_b128 a[160:163], v12 offset:24576
    v_cvt_pk_bf16_f32 v152, v32, v33
    v_mfma_f32_16x16x32_bf16 a[132:135], a[164:167], v[136:139], a[132:135]
    s_min_u32 s91, s91, s3
    v_exp_f32 v36, v120
    v_mfma_f32_16x16x32_bf16 a[196:199], a[164:167], v[140:143], a[196:199]
    s_sub_u32 s94, s94, 1
    ds_read_b128 a[164:167], v12 offset:25600
    v_cvt_pk_bf16_f32 v153, v34, v35
    v_mfma_f32_16x16x32_bf16 a[176:179], v[14:17], v[136:139], a[176:179]
    v_exp_f32 v37, v121
    v_mfma_f32_16x16x32_bf16 v[236:239], a[32:35], v[76:79], v[172:175]
    v_exp_f32 v38, v122
    v_mfma_f32_16x16x32_bf16 v[236:239], a[36:39], v[92:95], v[236:239]
    ds_read_b128 a[32:35], v12 offset:16384
    ds_read_b128 a[36:39], v12 offset:17408
    v_mfma_f32_16x16x32_bf16 v[236:239], a[40:43], v[204:207], v[236:239]
    buffer_load_dwordx4 v13, s[20:23], s43 offen offset:1024 sc1 lds
    v_mfma_f32_16x16x32_bf16 v[236:239], a[44:47], v[220:223], v[236:239]
    s_add_u32 m0, m0, 0x2000
    ds_read_b128 a[40:43], v12 offset:18432
    ds_read_b128 a[44:47], v12 offset:19456
    v_mfma_f32_16x16x32_bf16 a[136:139], a[168:171], v[136:139], a[136:139]
    s_add_u32 s43, s92, 4294959104
    v_exp_f32 v39, v123
    v_mfma_f32_16x16x32_bf16 a[200:203], a[168:171], v[140:143], a[200:203]
    ds_read_b128 a[168:171], v12 offset:26624
    v_cvt_pk_bf16_f32 v154, v36, v37
    v_mfma_f32_16x16x32_bf16 a[140:143], a[172:175], v[136:139], a[140:143]
    v_exp_f32 v40, v108
    v_mfma_f32_16x16x32_bf16 a[204:207], a[172:175], v[140:143], a[204:207]
    s_waitcnt lgkmcnt(9)
    ds_read_b128 a[172:175], v12 offset:27648
    v_or3_b32 v10, v152, v153, v154
    v_mfma_f32_16x16x32_bf16 v[248:251], a[96:99], v[72:75], v[168:171]
    buffer_load_dwordx4 v13, s[20:23], s43 offen offset:0 sc1 lds
    v_mfma_f32_16x16x32_bf16 v[248:251], a[100:103], v[88:91], v[248:251]
    v_exp_f32 v41, v109
    v_mfma_f32_16x16x32_bf16 v[248:251], a[104:107], v[200:203], v[248:251]
    v_exp_f32 v42, v110
    v_mfma_f32_16x16x32_bf16 v[248:251], a[108:111], v[216:219], v[248:251]
    s_waitcnt lgkmcnt(8)
    v_exp_f32 v43, v111
    v_mfma_f32_16x16x32_bf16 a[144:147], a[224:227], v[136:139], a[144:147]
    v_exp_f32 v44, v124
    v_mfma_f32_16x16x32_bf16 a[208:211], a[224:227], v[140:143], a[208:211]
    ds_read_b128 a[224:227], v12 offset:28672
    v_cvt_pk_bf16_f32 v155, v38, v39
    v_mfma_f32_16x16x32_bf16 a[148:151], a[228:231], v[136:139], a[148:151]
    v_exp_f32 v45, v125
    v_mfma_f32_16x16x32_bf16 a[212:215], a[228:231], v[140:143], a[212:215]
    ds_read_b128 a[228:231], v12 offset:29696
    v_cvt_pk_bf16_f32 v156, v40, v41
    v_mfma_f32_16x16x32_bf16 a[240:243], v[14:17], v[140:143], a[240:243]
    v_exp_f32 v46, v126
    v_mfma_f32_16x16x32_bf16 v[252:255], a[96:99], v[76:79], v[172:175]
    v_exp_f32 v47, v127
    v_mfma_f32_16x16x32_bf16 v[252:255], a[100:103], v[92:95], v[252:255]
    ds_read_b128 a[96:99], v12 offset:20480
    ds_read_b128 a[100:103], v12 offset:21504
    v_mfma_f32_16x16x32_bf16 v[252:255], a[104:107], v[204:207], v[252:255]
    v_or3_b32 v10, v10, v155, v156
    v_cvt_pk_bf16_f32 v157, v42, v43
    v_mfma_f32_16x16x32_bf16 v[252:255], a[108:111], v[220:223], v[252:255]
    ds_read_b128 a[104:107], v12 offset:22528
    ds_read_b128 a[108:111], v12 offset:23552
    v_mfma_f32_16x16x32_bf16 a[152:155], a[232:235], v[136:139], a[152:155]
    v_cvt_pk_bf16_f32 v158, v44, v45
    v_or3_b32 v10, v10, v157, v158
    v_mfma_f32_16x16x32_bf16 a[216:219], a[232:235], v[140:143], a[216:219]
    ds_read_b128 a[232:235], v12 offset:30720
    v_cvt_pk_bf16_f32 v159, v46, v47
    v_bitop3_b32 v10, v10, v159, s95 bitop3:0xa8
    v_cmp_ne_u32 vcc, 0, v10
    v_mfma_f32_16x16x32_bf16 a[156:159], a[236:239], v[136:139], a[156:159]
    s_waitcnt lgkmcnt(9)
    buffer_load_dwordx4 v13, s[20:23], s43 offen offset:1024 sc1 lds
    v_mfma_f32_16x16x32_bf16 a[220:223], a[236:239], v[140:143], a[220:223]
    s_add_u32 s92, s92, 0x8000
    ds_read_b128 a[236:239], v12 offset:31744
    s_cmp_lg_u32 s94, 0
    s_cbranch_vccnz k2_fb9
k2_r9:
    s_cbranch_scc1 k2_S
k2_Y1:
    s_and_b32 s3, s2, 7
    s_lshl_b32 s4, s42, 3
    s_add_u32 s3, s3, s4
    s_lshl_b32 s3, s3, 5
    s_bfe_u32 s4, s2, 0x20003
    s_add_u32 s3, s3, s4
    s_lshl_b32 s4, s3, 2
    s_add_u32 s5, s4, 16
    v_lshlrev_b32 v27, 3, v1
    v_lshlrev_b32 v28, 19, v1
    v_and_b32 v29, 0x18000000, v28
    v_and_b32 v28, 0x10000000, v28
    v_lshl_add_u32 v29, v29, 2, v27
    v_lshl_add_u32 v27, v28, 2, v27
    v_mfma_f32_16x16x32_bf16 v[104:107], a[32:35], v[72:75], v[168:171]
    s_waitcnt vmcnt(16)
    s_barrier
    v_add_u32 v12, s90, v1
    v_mfma_f32_16x16x32_bf16 v[104:107], a[36:39], v[88:91], v[104:107]
    buffer_store_dword v0, v30, s[36:39], s4 offen sc0 sc1
    v_mfma_f32_16x16x32_bf16 v[104:107], a[40:43], v[200:203], v[104:107]
    s_add_u32 s90, s90, 0x8000
    v_exp_f32 v32, v232
    v_mfma_f32_16x16x32_bf16 v[104:107], a[44:47], v[216:219], v[104:107]
    s_waitcnt lgkmcnt(8)
    v_exp_f32 v33, v233
    v_mfma_f32_16x16x32_bf16 a[128:131], a[160:163], v[152:155], a[128:131]
    s_sub_u32 s3, s90, 163840
    v_exp_f32 v34, v234
    v_mfma_f32_16x16x32_bf16 a[192:195], a[160:163], v[156:159], a[192:195]
    s_min_u32 s90, s90, s3
    ds_read_b128 a[160:163], v12 offset:8192
    v_cvt_pk_bf16_f32 v136, v32, v33
    v_mfma_f32_16x16x32_bf16 a[132:135], a[164:167], v[152:155], a[132:135]
    v_exp_f32 v35, v235
    v_mfma_f32_16x16x32_bf16 a[196:199], a[164:167], v[156:159], a[196:199]
    ds_read_b128 a[164:167], v12 offset:9216
    v_cvt_pk_bf16_f32 v137, v34, v35
    v_mfma_f32_16x16x32_bf16 a[176:179], v[14:17], v[152:155], a[176:179]
    v_exp_f32 v36, v248
    v_mfma_f32_16x16x32_bf16 v[108:111], a[32:35], v[76:79], v[172:175]
    v_exp_f32 v37, v249
    v_mfma_f32_16x16x32_bf16 v[108:111], a[36:39], v[92:95], v[108:111]
    ds_read_b128 a[32:35], v12 offset:0
    ds_read_b128 a[36:39], v12 offset:1024
    v_mfma_f32_16x16x32_bf16 v[108:111], a[40:43], v[204:207], v[108:111]
    v_exp_f32 v38, v250
    v_mfma_f32_16x16x32_bf16 v[108:111], a[44:47], v[220:223], v[108:111]
    ds_read_b128 a[40:43], v12 offset:2048
    ds_read_b128 a[44:47], v12 offset:3072
    v_mfma_f32_16x16x32_bf16 a[136:139], a[168:171], v[152:155], a[136:139]
    v_exp_f32 v39, v251
    v_mfma_f32_16x16x32_bf16 a[200:203], a[168:171], v[156:159], a[200:203]
    ds_read_b128 a[168:171], v12 offset:10240
    v_cvt_pk_bf16_f32 v138, v36, v37
    v_mfma_f32_16x16x32_bf16 a[140:143], a[172:175], v[152:155], a[140:143]
    v_exp_f32 v40, v236
    v_mfma_f32_16x16x32_bf16 a[204:207], a[172:175], v[156:159], a[204:207]
    s_waitcnt lgkmcnt(9)
    ds_read_b128 a[172:175], v12 offset:11264
    v_or3_b32 v10, v136, v137, v138
    v_mfma_f32_16x16x32_bf16 v[120:123], a[96:99], v[72:75], v[168:171]
    v_exp_f32 v41, v237
    v_mfma_f32_16x16x32_bf16 v[120:123], a[100:103], v[88:91], v[120:123]
    v_exp_f32 v42, v238
    v_mfma_f32_16x16x32_bf16 v[120:123], a[104:107], v[200:203], v[120:123]
    v_exp_f32 v43, v239
    v_mfma_f32_16x16x32_bf16 v[120:123], a[108:111], v[216:219], v[120:123]
    s_waitcnt lgkmcnt(8)
    v_exp_f32 v44, v252
    v_mfma_f32_16x16x32_bf16 a[144:147], a[224:227], v[152:155], a[144:147]
    v_exp_f32 v45, v253
    v_mfma_f32_16x16x32_bf16 a[208:211], a[224:227], v[156:159], a[208:211]
    ds_read_b128 a[224:227], v12 offset:12288
    v_cvt_pk_bf16_f32 v139, v38, v39
    v_mfma_f32_16x16x32_bf16 a[148:151], a[228:231], v[152:155], a[148:151]
    v_exp_f32 v46, v254
    v_mfma_f32_16x16x32_bf16 a[212:215], a[228:231], v[156:159], a[212:215]
    ds_read_b128 a[228:231], v12 offset:13312
    v_cvt_pk_bf16_f32 v140, v40, v41
    v_mfma_f32_16x16x32_bf16 a[240:243], v[14:17], v[156:159], a[240:243]
    v_exp_f32 v47, v255
    v_mfma_f32_16x16x32_bf16 v[124:127], a[96:99], v[76:79], v[172:175]
    v_or3_b32 v10, v10, v139, v140
    v_cvt_pk_bf16_f32 v141, v42, v43
    v_mfma_f32_16x16x32_bf16 v[124:127], a[100:103], v[92:95], v[124:127]
    ds_read_b128 a[96:99], v12 offset:4096
    ds_read_b128 a[100:103], v12 offset:5120
    v_mfma_f32_16x16x32_bf16 v[124:127], a[104:107], v[204:207], v[124:127]
    v_cvt_pk_bf16_f32 v142, v44, v45
    v_or3_b32 v10, v10, v141, v142
    v_mfma_f32_16x16x32_bf16 v[124:127], a[108:111], v[220:223], v[124:127]
    ds_read_b128 a[104:107], v12 offset:6144
    ds_read_b128 a[108:111], v12 offset:7168
    v_mfma_f32_16x16x32_bf16 a[152:155], a[232:235], v[152:155], a[152:155]
    v_cvt_pk_bf16_f32 v143, v46, v47
    v_bitop3_b32 v10, v10, v143, s95 bitop3:0xa8
    v_mfma_f32_16x16x32_bf16 a[216:219], a[232:235], v[156:159], a[216:219]
    ds_read_b128 a[232:235], v12 offset:14336
    v_cmp_ne_u32 vcc, 0, v10
    v_mfma_f32_16x16x32_bf16 a[156:159], a[236:239], v[152:155], a[156:159]
    s_waitcnt lgkmcnt(9)
    v_mfma_f32_16x16x32_bf16 a[220:223], a[236:239], v[156:159], a[220:223]
    ds_read_b128 a[236:239], v12 offset:15360
    s_cbranch_vccnz k2_fb10
k2_r10:
    v_mfma_f32_16x16x32_bf16 a[128:131], a[160:163], v[136:139], a[128:131]
    v_cmp_le_i32 s[50:51], 0, v20
    v_cmp_le_i32 s[52:53], 1, v20
    v_mfma_f32_16x16x32_bf16 a[192:195], a[160:163], v[140:143], a[192:195]
    ds_read_b128 a[160:163], v12 offset:24576
    v_cmp_le_i32 s[54:55], 2, v20
    v_cmp_le_i32 s[56:57], 3, v20
    v_mfma_f32_16x16x32_bf16 a[132:135], a[164:167], v[136:139], a[132:135]
    v_cndmask_b32 v176, v19, v168, s[50:51]
    v_cndmask_b32 v177, v19, v168, s[52:53]
    v_mfma_f32_16x16x32_bf16 a[196:199], a[164:167], v[140:143], a[196:199]
    ds_read_b128 a[164:167], v12 offset:25600
    v_cndmask_b32 v178, v19, v168, s[54:55]
    v_cndmask_b32 v179, v19, v168, s[56:57]
    v_mfma_f32_16x16x32_bf16 a[176:179], v[14:17], v[136:139], a[176:179]
    v_cmp_le_i32 s[50:51], 0, v21
    v_cmp_le_i32 s[52:53], 1, v21
    v_mfma_f32_16x16x32_bf16 v[232:235], a[32:35], v[72:75], v[176:179]
    v_cmp_le_i32 s[54:55], 2, v21
    v_cmp_le_i32 s[56:57], 3, v21
    v_mfma_f32_16x16x32_bf16 v[232:235], a[36:39], v[88:91], v[232:235]
    s_waitcnt lgkmcnt(10)
    v_cndmask_b32 v184, v19, v172, s[50:51]
    v_cndmask_b32 v185, v19, v172, s[52:53]
    v_mfma_f32_16x16x32_bf16 v[232:235], a[40:43], v[200:203], v[232:235]
    v_cndmask_b32 v186, v19, v172, s[54:55]
    v_cndmask_b32 v187, v19, v172, s[56:57]
    v_mfma_f32_16x16x32_bf16 v[232:235], a[44:47], v[216:219], v[232:235]
    v_cmp_le_i32 s[50:51], 16, v20
    v_cmp_le_i32 s[52:53], 17, v20
    v_mfma_f32_16x16x32_bf16 a[136:139], a[168:171], v[136:139], a[136:139]
    v_cmp_le_i32 s[54:55], 18, v20
    v_cmp_le_i32 s[56:57], 19, v20
    v_mfma_f32_16x16x32_bf16 a[200:203], a[168:171], v[140:143], a[200:203]
    ds_read_b128 a[168:171], v12 offset:26624
    v_cndmask_b32 v180, v19, v168, s[50:51]
    v_mfma_f32_16x16x32_bf16 a[140:143], a[172:175], v[136:139], a[140:143]
    v_cndmask_b32 v181, v19, v168, s[52:53]
    v_cndmask_b32 v182, v19, v168, s[54:55]
    v_mfma_f32_16x16x32_bf16 a[204:207], a[172:175], v[140:143], a[204:207]
    ds_read_b128 a[172:175], v12 offset:27648
    v_cndmask_b32 v183, v19, v168, s[56:57]
    v_mfma_f32_16x16x32_bf16 v[236:239], a[32:35], v[76:79], v[184:187]
    v_cmp_le_i32 s[50:51], 16, v21
    v_cmp_le_i32 s[52:53], 17, v21
    v_mfma_f32_16x16x32_bf16 v[236:239], a[36:39], v[92:95], v[236:239]
    ds_read_b128 a[32:35], v12 offset:16384
    ds_read_b128 a[36:39], v12 offset:17408
    v_mfma_f32_16x16x32_bf16 v[236:239], a[40:43], v[204:207], v[236:239]
    v_cmp_le_i32 s[54:55], 18, v21
    v_cmp_le_i32 s[56:57], 19, v21
    v_mfma_f32_16x16x32_bf16 v[236:239], a[44:47], v[220:223], v[236:239]
    s_waitcnt lgkmcnt(9)
    ds_read_b128 a[40:43], v12 offset:18432
    ds_read_b128 a[44:47], v12 offset:19456
    v_mfma_f32_16x16x32_bf16 a[144:147], a[224:227], v[136:139], a[144:147]
    v_cndmask_b32 v188, v19, v172, s[50:51]
    v_cndmask_b32 v189, v19, v172, s[52:53]
    v_mfma_f32_16x16x32_bf16 a[208:211], a[224:227], v[140:143], a[208:211]
    ds_read_b128 a[224:227], v12 offset:28672
    v_cndmask_b32 v190, v19, v172, s[54:55]
    v_mfma_f32_16x16x32_bf16 v[248:251], a[96:99], v[72:75], v[180:183]
    v_cndmask_b32 v191, v19, v172, s[56:57]
    v_exp_f32 v32, v104
    v_mfma_f32_16x16x32_bf16 v[248:251], a[100:103], v[88:91], v[248:251]
    v_exp_f32 v33, v105
    v_mfma_f32_16x16x32_bf16 v[248:251], a[104:107], v[200:203], v[248:251]
    s_waitcnt lgkmcnt(9)
    v_exp_f32 v34, v106
    v_mfma_f32_16x16x32_bf16 v[248:251], a[108:111], v[216:219], v[248:251]
    v_exp_f32 v35, v107
    v_mfma_f32_16x16x32_bf16 a[148:151], a[228:231], v[136:139], a[148:151]
    v_exp_f32 v36, v120
    v_mfma_f32_16x16x32_bf16 a[212:215], a[228:231], v[140:143], a[212:215]
    ds_read_b128 a[228:231], v12 offset:29696
    v_cvt_pk_bf16_f32 v152, v32, v33
    v_mfma_f32_16x16x32_bf16 a[240:243], v[14:17], v[140:143], a[240:243]
    v_exp_f32 v37, v121
    v_mfma_f32_16x16x32_bf16 a[152:155], a[232:235], v[136:139], a[152:155]
    v_exp_f32 v38, v122
    v_mfma_f32_16x16x32_bf16 a[216:219], a[232:235], v[140:143], a[216:219]
    ds_read_b128 a[232:235], v12 offset:30720
    v_cvt_pk_bf16_f32 v153, v34, v35
    v_mfma_f32_16x16x32_bf16 v[252:255], a[96:99], v[76:79], v[188:191]
    v_exp_f32 v39, v123
    v_mfma_f32_16x16x32_bf16 v[252:255], a[100:103], v[92:95], v[252:255]
    ds_read_b128 a[96:99], v12 offset:20480
    ds_read_b128 a[100:103], v12 offset:21504
    v_mfma_f32_16x16x32_bf16 v[252:255], a[104:107], v[204:207], v[252:255]
    v_exp_f32 v40, v108
    v_mfma_f32_16x16x32_bf16 v[252:255], a[108:111], v[220:223], v[252:255]
    ds_read_b128 a[104:107], v12 offset:22528
    ds_read_b128 a[108:111], v12 offset:23552
    v_cvt_pk_bf16_f32 v154, v36, v37
    v_or3_b32 v10, v152, v153, v154
    v_cvt_pk_bf16_f32 v155, v38, v39
    v_exp_f32 v41, v109
    v_exp_f32 v42, v110
    v_cvt_pk_bf16_f32 v156, v40, v41
    v_or3_b32 v10, v10, v155, v156
    v_exp_f32 v43, v111
    v_exp_f32 v44, v124
    v_cvt_pk_bf16_f32 v157, v42, v43
    v_exp_f32 v45, v125
    v_exp_f32 v46, v126
    v_cvt_pk_bf16_f32 v158, v44, v45
    v_or3_b32 v10, v10, v157, v158
    v_exp_f32 v47, v127
    s_nop 0
    v_cvt_pk_bf16_f32 v159, v46, v47
    v_bitop3_b32 v10, v10, v159, s95 bitop3:0xa8
    v_cmp_ne_u32 vcc, 0, v10
    v_mfma_f32_16x16x32_bf16 a[156:159], a[236:239], v[136:139], a[156:159]
    s_waitcnt lgkmcnt(7)
    v_mfma_f32_16x16x32_bf16 a[220:223], a[236:239], v[140:143], a[220:223]
    ds_read_b128 a[236:239], v12 offset:31744
    s_cbranch_vccnz k2_fb11
k2_r11:
k2_Y2:
    s_and_b32 s6, s4, 0xffffff80
    v_bfe_u32 v25, v1, 2, 4
    v_and_b32 v25, 12, v25
    v_mfma_f32_16x16x32_bf16 a[128:131], a[160:163], v[152:155], a[128:131]
    s_waitcnt vmcnt(9)
    s_barrier
    v_add_u32 v12, s90, v1
    v_mfma_f32_16x16x32_bf16 a[192:195], a[160:163], v[156:159], a[192:195]
    ds_read_b128 a[160:163], v12 offset:8192
    v_cmp_le_i32 s[50:51], 32, v20
    v_cmp_le_i32 s[52:53], 33, v20
    v_cmp_le_i32 s[54:55], 34, v20
    v_cmp_le_i32 s[56:57], 35, v20
    v_mfma_f32_16x16x32_bf16 a[132:135], a[164:167], v[152:155], a[132:135]
    s_add_u32 s90, s90, 0x8000
    v_cndmask_b32 v176, v19, v168, s[50:51]
    v_cndmask_b32 v177, v19, v168, s[52:53]
    v_mfma_f32_16x16x32_bf16 a[196:199], a[164:167], v[156:159], a[196:199]
    s_sub_u32 s3, s90, 163840
    ds_read_b128 a[164:167], v12 offset:9216
    v_cndmask_b32 v178, v19, v168, s[54:55]
    v_cndmask_b32 v179, v19, v168, s[56:57]
    v_mfma_f32_16x16x32_bf16 a[176:179], v[14:17], v[152:155], a[176:179]
    s_min_u32 s90, s90, s3
    v_cmp_le_i32 s[50:51], 32, v21
    v_cmp_le_i32 s[52:53], 33, v21
    v_mfma_f32_16x16x32_bf16 v[104:107], a[32:35], v[72:75], v[176:179]
    v_cmp_le_i32 s[54:55], 34, v21
    v_cmp_le_i32 s[56:57], 35, v21
    v_mfma_f32_16x16x32_bf16 v[104:107], a[36:39], v[88:91], v[104:107]
    v_cndmask_b32 v184, v19, v172, s[50:51]
    v_cndmask_b32 v185, v19, v172, s[52:53]
    v_mfma_f32_16x16x32_bf16 v[104:107], a[40:43], v[200:203], v[104:107]
    v_cndmask_b32 v186, v19, v172, s[54:55]
    v_cndmask_b32 v187, v19, v172, s[56:57]
    v_mfma_f32_16x16x32_bf16 v[104:107], a[44:47], v[216:219], v[104:107]
    v_cmp_le_i32 s[50:51], 48, v20
    v_cmp_le_i32 s[52:53], 49, v20
    v_mfma_f32_16x16x32_bf16 a[136:139], a[168:171], v[152:155], a[136:139]
    v_cmp_le_i32 s[54:55], 50, v20
    v_cmp_le_i32 s[56:57], 51, v20
    v_mfma_f32_16x16x32_bf16 a[200:203], a[168:171], v[156:159], a[200:203]
    ds_read_b128 a[168:171], v12 offset:10240
    v_cndmask_b32 v180, v19, v168, s[50:51]
    v_mfma_f32_16x16x32_bf16 a[140:143], a[172:175], v[152:155], a[140:143]
    v_cndmask_b32 v181, v19, v168, s[52:53]
    v_cndmask_b32 v182, v19, v168, s[54:55]
    v_mfma_f32_16x16x32_bf16 a[204:207], a[172:175], v[156:159], a[204:207]
    ds_read_b128 a[172:175], v12 offset:11264
    v_cndmask_b32 v183, v19, v168, s[56:57]
    v_mfma_f32_16x16x32_bf16 v[108:111], a[32:35], v[76:79], v[184:187]
    v_cmp_le_i32 s[50:51], 48, v21
    v_cmp_le_i32 s[52:53], 49, v21
    v_mfma_f32_16x16x32_bf16 v[108:111], a[36:39], v[92:95], v[108:111]
    ds_read_b128 a[32:35], v12 offset:0
    ds_read_b128 a[36:39], v12 offset:1024
    v_mfma_f32_16x16x32_bf16 v[108:111], a[40:43], v[204:207], v[108:111]
    v_cmp_le_i32 s[54:55], 50, v21
    v_cmp_le_i32 s[56:57], 51, v21
    v_mfma_f32_16x16x32_bf16 v[108:111], a[44:47], v[220:223], v[108:111]
    s_waitcnt lgkmcnt(8)
    ds_read_b128 a[40:43], v12 offset:2048
    ds_read_b128 a[44:47], v12 offset:3072
    v_mfma_f32_16x16x32_bf16 a[144:147], a[224:227], v[152:155], a[144:147]
    v_cndmask_b32 v188, v19, v172, s[50:51]
    v_cndmask_b32 v189, v19, v172, s[52:53]
    v_mfma_f32_16x16x32_bf16 a[208:211], a[224:227], v[156:159], a[208:211]
    ds_read_b128 a[224:227], v12 offset:12288
    v_cndmask_b32 v190, v19, v172, s[54:55]
    v_mfma_f32_16x16x32_bf16 v[120:123], a[96:99], v[72:75], v[180:183]
    v_cndmask_b32 v191, v19, v172, s[56:57]
    v_exp_f32 v32, v232
    v_mfma_f32_16x16x32_bf16 v[120:123], a[100:103], v[88:91], v[120:123]
    v_exp_f32 v33, v233
    v_mfma_f32_16x16x32_bf16 v[120:123], a[104:107], v[200:203], v[120:123]
    s_waitcnt lgkmcnt(9)
    v_exp_f32 v34, v234
    v_mfma_f32_16x16x32_bf16 v[120:123], a[108:111], v[216:219], v[120:123]
    v_exp_f32 v35, v235
    v_mfma_f32_16x16x32_bf16 a[148:151], a[228:231], v[152:155], a[148:151]
    v_exp_f32 v36, v248
    v_mfma_f32_16x16x32_bf16 a[212:215], a[228:231], v[156:159], a[212:215]
    ds_read_b128 a[228:231], v12 offset:13312
    v_cvt_pk_bf16_f32 v136, v32, v33
    v_mfma_f32_16x16x32_bf16 a[240:243], v[14:17], v[156:159], a[240:243]
    v_exp_f32 v37, v249
    v_mfma_f32_16x16x32_bf16 a[152:155], a[232:235], v[152:155], a[152:155]
    v_exp_f32 v38, v250
    v_mfma_f32_16x16x32_bf16 a[216:219], a[232:235], v[156:159], a[216:219]
    ds_read_b128 a[232:235], v12 offset:14336
    v_cvt_pk_bf16_f32 v137, v34, v35
    v_mfma_f32_16x16x32_bf16 v[124:127], a[96:99], v[76:79], v[188:191]
    v_exp_f32 v39, v251
    v_mfma_f32_16x16x32_bf16 v[124:127], a[100:103], v[92:95], v[124:127]
    ds_read_b128 a[96:99], v12 offset:4096
    ds_read_b128 a[100:103], v12 offset:5120
    v_mfma_f32_16x16x32_bf16 v[124:127], a[104:107], v[204:207], v[124:127]
    v_exp_f32 v40, v236
    v_mfma_f32_16x16x32_bf16 v[124:127], a[108:111], v[220:223], v[124:127]
    ds_read_b128 a[104:107], v12 offset:6144
    ds_read_b128 a[108:111], v12 offset:7168
    v_cvt_pk_bf16_f32 v138, v36, v37
    v_or3_b32 v10, v136, v137, v138
    v_cvt_pk_bf16_f32 v139, v38, v39
    v_exp_f32 v41, v237
    v_exp_f32 v42, v238
    v_cvt_pk_bf16_f32 v140, v40, v41
    v_or3_b32 v10, v10, v139, v140
    v_exp_f32 v43, v239
    v_exp_f32 v44, v252
    v_cvt_pk_bf16_f32 v141, v42, v43
    v_exp_f32 v45, v253
    v_exp_f32 v46, v254
    v_cvt_pk_bf16_f32 v142, v44, v45
    v_or3_b32 v10, v10, v141, v142
    v_exp_f32 v47, v255
    s_nop 0
    v_cvt_pk_bf16_f32 v143, v46, v47
    v_bitop3_b32 v10, v10, v143, s95 bitop3:0xa8
    v_cmp_ne_u32 vcc, 0, v10
    v_mfma_f32_16x16x32_bf16 a[156:159], a[236:239], v[152:155], a[156:159]
    s_waitcnt lgkmcnt(7)
    v_mfma_f32_16x16x32_bf16 a[220:223], a[236:239], v[156:159], a[220:223]
    ds_read_b128 a[236:239], v12 offset:15360
    s_cbranch_vccnz k2_fb12
k2_r12:
    v_mfma_f32_16x16x32_bf16 a[128:131], a[160:163], v[136:139], a[128:131]
    v_cmp_le_i32 s[50:51], 0, v22
    v_cmp_le_i32 s[52:53], 1, v22
    v_mfma_f32_16x16x32_bf16 a[192:195], a[160:163], v[140:143], a[192:195]
    ds_read_b128 a[160:163], v12 offset:24576
    v_cmp_le_i32 s[54:55], 2, v22
    v_cmp_le_i32 s[56:57], 3, v22
    v_mfma_f32_16x16x32_bf16 a[132:135], a[164:167], v[136:139], a[132:135]
    v_cndmask_b32 v176, v19, v172, s[50:51]
    v_cndmask_b32 v177, v19, v172, s[52:53]
    v_mfma_f32_16x16x32_bf16 a[196:199], a[164:167], v[140:143], a[196:199]
    ds_read_b128 a[164:167], v12 offset:25600
    v_cndmask_b32 v178, v19, v172, s[54:55]
    v_cndmask_b32 v179, v19, v172, s[56:57]
    v_mfma_f32_16x16x32_bf16 a[176:179], v[14:17], v[136:139], a[176:179]
    v_cmp_le_i32 s[50:51], 16, v22
    v_cmp_le_i32 s[52:53], 17, v22
    v_mfma_f32_16x16x32_bf16 v[236:239], a[32:35], v[76:79], v[176:179]
    v_cmp_le_i32 s[54:55], 18, v22
    v_cmp_le_i32 s[56:57], 19, v22
    v_mfma_f32_16x16x32_bf16 v[236:239], a[36:39], v[92:95], v[236:239]
    ds_read_b128 a[32:35], v12 offset:16384
    ds_read_b128 a[36:39], v12 offset:17408
    v_mfma_f32_16x16x32_bf16 v[236:239], a[40:43], v[204:207], v[236:239]
    v_cndmask_b32 v180, v19, v172, s[50:51]
    v_cndmask_b32 v181, v19, v172, s[52:53]
    v_mfma_f32_16x16x32_bf16 v[236:239], a[44:47], v[220:223], v[236:239]
    ds_read_b128 a[40:43], v12 offset:18432
    ds_read_b128 a[44:47], v12 offset:19456
    v_mfma_f32_16x16x32_bf16 a[136:139], a[168:171], v[136:139], a[136:139]
    v_cndmask_b32 v182, v19, v172, s[54:55]
    v_cndmask_b32 v183, v19, v172, s[56:57]
    v_mfma_f32_16x16x32_bf16 a[200:203], a[168:171], v[140:143], a[200:203]
    ds_read_b128 a[168:171], v12 offset:26624
    buffer_load_dword v26, v25, s[36:39], s6 offen sc1
    v_mfma_f32_16x16x32_bf16 a[140:143], a[172:175], v[136:139], a[140:143]
    v_exp_f32 v32, v104
    v_mfma_f32_16x16x32_bf16 a[204:207], a[172:175], v[140:143], a[204:207]
    s_waitcnt lgkmcnt(9)
    ds_read_b128 a[172:175], v12 offset:27648
    v_exp_f32 v33, v105
    v_mfma_f32_16x16x32_bf16 a[144:147], a[224:227], v[136:139], a[144:147]
    v_exp_f32 v34, v106
    v_mfma_f32_16x16x32_bf16 a[208:211], a[224:227], v[140:143], a[208:211]
    ds_read_b128 a[224:227], v12 offset:28672
    v_cvt_pk_bf16_f32 v152, v32, v33
    v_mfma_f32_16x16x32_bf16 v[252:255], a[96:99], v[76:79], v[180:183]
    v_exp_f32 v35, v107
    v_mfma_f32_16x16x32_bf16 v[252:255], a[100:103], v[92:95], v[252:255]
    ds_read_b128 a[96:99], v12 offset:20480
    ds_read_b128 a[100:103], v12 offset:21504
    v_mfma_f32_16x16x32_bf16 v[252:255], a[104:107], v[204:207], v[252:255]
    s_waitcnt lgkmcnt(11)
    v_exp_f32 v36, v120
    v_mfma_f32_16x16x32_bf16 v[252:255], a[108:111], v[220:223], v[252:255]
    ds_read_b128 a[104:107], v12 offset:22528
    ds_read_b128 a[108:111], v12 offset:23552
    v_mfma_f32_16x16x32_bf16 a[148:151], a[228:231], v[136:139], a[148:151]
    v_exp_f32 v37, v121
    v_mfma_f32_16x16x32_bf16 a[212:215], a[228:231], v[140:143], a[212:215]
    ds_read_b128 a[228:231], v12 offset:29696
    v_cvt_pk_bf16_f32 v153, v34, v35
    v_mfma_f32_16x16x32_bf16 a[240:243], v[14:17], v[140:143], a[240:243]
    v_exp_f32 v38, v122
    v_mfma_f32_16x16x32_bf16 a[152:155], a[232:235], v[136:139], a[152:155]
    v_exp_f32 v39, v123
    v_mfma_f32_16x16x32_bf16 a[216:219], a[232:235], v[140:143], a[216:219]
    ds_read_b128 a[232:235], v12 offset:30720
    v_cvt_pk_bf16_f32 v154, v36, v37
    v_or3_b32 v10, v152, v153, v154
    v_cvt_pk_bf16_f32 v155, v38, v39
    v_exp_f32 v40, v108
    v_exp_f32 v41, v109
    v_exp_f32 v42, v110
    v_cvt_pk_bf16_f32 v156, v40, v41
    v_or3_b32 v10, v10, v155, v156
    v_exp_f32 v43, v111
    v_exp_f32 v44, v124
    v_cvt_pk_bf16_f32 v157, v42, v43
    v_exp_f32 v45, v125
    v_exp_f32 v46, v126
    v_cvt_pk_bf16_f32 v158, v44, v45
    v_or3_b32 v10, v10, v157, v158
    v_exp_f32 v47, v127
    s_nop 0
    v_cvt_pk_bf16_f32 v159, v46, v47
    v_bitop3_b32 v10, v10, v159, s95 bitop3:0xa8
    v_cmp_ne_u32 vcc, 0, v10
    v_mfma_f32_16x16x32_bf16 a[156:159], a[236:239], v[136:139], a[156:159]
    s_waitcnt lgkmcnt(9)
    v_mfma_f32_16x16x32_bf16 a[220:223], a[236:239], v[140:143], a[220:223]
    ds_read_b128 a[236:239], v12 offset:31744
    s_cbranch_vccnz k2_fb13
k2_r13:
k2_Y3:
    v_mfma_f32_16x16x32_bf16 a[128:131], a[160:163], v[152:155], a[128:131]
    s_waitcnt vmcnt(2)
    s_barrier
    v_add_u32 v12, s90, v1
    v_mfma_f32_16x16x32_bf16 a[192:195], a[160:163], v[156:159], a[192:195]
    ds_read_b128 a[160:163], v12 offset:8192
    v_cmp_le_i32 s[50:51], 32, v22
    v_cmp_le_i32 s[52:53], 33, v22
    v_cmp_le_i32 s[54:55], 34, v22
    v_cmp_le_i32 s[56:57], 35, v22
    v_mfma_f32_16x16x32_bf16 a[132:135], a[164:167], v[152:155], a[132:135]
    s_add_u32 s90, s90, 0x8000
    v_cndmask_b32 v176, v19, v172, s[50:51]
    v_cndmask_b32 v177, v19, v172, s[52:53]
    v_mfma_f32_16x16x32_bf16 a[196:199], a[164:167], v[156:159], a[196:199]
    s_sub_u32 s3, s90, 163840
    ds_read_b128 a[164:167], v12 offset:9216
    v_cndmask_b32 v178, v19, v172, s[54:55]
    v_cndmask_b32 v179, v19, v172, s[56:57]
    v_mfma_f32_16x16x32_bf16 a[176:179], v[14:17], v[152:155], a[176:179]
    s_min_u32 s90, s90, s3
    v_cmp_le_i32 s[50:51], 48, v22
    v_cmp_le_i32 s[52:53], 49, v22
    v_mfma_f32_16x16x32_bf16 v[108:111], a[32:35], v[76:79], v[176:179]
    v_cmp_le_i32 s[54:55], 50, v22
    v_cmp_le_i32 s[56:57], 51, v22
    v_mfma_f32_16x16x32_bf16 v[108:111], a[36:39], v[92:95], v[108:111]
    s_waitcnt lgkmcnt(10)
    ds_read_b128 a[32:35], v12 offset:0
    ds_read_b128 a[36:39], v12 offset:1024
    v_mfma_f32_16x16x32_bf16 v[108:111], a[40:43], v[204:207], v[108:111]
    v_cndmask_b32 v180, v19, v172, s[50:51]
    v_cndmask_b32 v181, v19, v172, s[52:53]
    v_mfma_f32_16x16x32_bf16 v[108:111], a[44:47], v[220:223], v[108:111]
    ds_read_b128 a[40:43], v12 offset:2048
    ds_read_b128 a[44:47], v12 offset:3072
    v_mfma_f32_16x16x32_bf16 a[136:139], a[168:171], v[152:155], a[136:139]
    v_cndmask_b32 v182, v19, v172, s[54:55]
    v_cndmask_b32 v183, v19, v172, s[56:57]
    v_mfma_f32_16x16x32_bf16 a[200:203], a[168:171], v[156:159], a[200:203]
    ds_read_b128 a[168:171], v12 offset:10240
    v_exp_f32 v32, v236
    v_mfma_f32_16x16x32_bf16 a[140:143], a[172:175], v[152:155], a[140:143]
    v_exp_f32 v33, v237
    v_mfma_f32_16x16x32_bf16 a[204:207], a[172:175], v[156:159], a[204:207]
    s_waitcnt lgkmcnt(11)
    ds_read_b128 a[172:175], v12 offset:11264
    v_cvt_pk_bf16_f32 v140, v32, v33
    v_mfma_f32_16x16x32_bf16 a[144:147], a[224:227], v[152:155], a[144:147]
    v_exp_f32 v34, v238
    v_mfma_f32_16x16x32_bf16 a[208:211], a[224:227], v[156:159], a[208:211]
    ds_read_b128 a[224:227], v12 offset:12288
    v_exp_f32 v35, v239
    v_mfma_f32_16x16x32_bf16 v[124:127], a[96:99], v[76:79], v[180:183]
    v_exp_f32 v36, v252
    v_mfma_f32_16x16x32_bf16 v[124:127], a[100:103], v[92:95], v[124:127]
    ds_read_b128 a[96:99], v12 offset:4096
    ds_read_b128 a[100:103], v12 offset:5120
    v_mfma_f32_16x16x32_bf16 v[124:127], a[104:107], v[204:207], v[124:127]
    s_waitcnt lgkmcnt(11)
    v_exp_f32 v37, v253
    v_mfma_f32_16x16x32_bf16 v[124:127], a[108:111], v[220:223], v[124:127]
    ds_read_b128 a[104:107], v12 offset:6144
    ds_read_b128 a[108:111], v12 offset:7168
    v_mfma_f32_16x16x32_bf16 a[148:151], a[228:231], v[152:155], a[148:151]
    v_exp_f32 v38, v254
    v_mfma_f32_16x16x32_bf16 a[212:215], a[228:231], v[156:159], a[212:215]
    ds_read_b128 a[228:231], v12 offset:13312
    v_cvt_pk_bf16_f32 v141, v34, v35
    v_mfma_f32_16x16x32_bf16 a[240:243], v[14:17], v[156:159], a[240:243]
    v_exp_f32 v39, v255
    v_mfma_f32_16x16x32_bf16 a[152:155], a[232:235], v[152:155], a[152:155]
    v_cvt_pk_bf16_f32 v142, v36, v37
    v_or3_b32 v10, v140, v141, v142
    v_mfma_f32_16x16x32_bf16 a[216:219], a[232:235], v[156:159], a[216:219]
    ds_read_b128 a[232:235], v12 offset:14336
    v_cvt_pk_bf16_f32 v143, v38, v39
    v_bitop3_b32 v10, v10, v143, s95 bitop3:0xa8
    v_cmp_ne_u32 vcc, 0, v10
    v_mfma_f32_16x16x32_bf16 a[156:159], a[236:239], v[152:155], a[156:159]
    s_waitcnt lgkmcnt(9)
    v_mfma_f32_16x16x32_bf16 a[220:223], a[236:239], v[156:159], a[220:223]
    ds_read_b128 a[236:239], v12 offset:15360
    s_cbranch_vccnz k2_fb14
k2_r14:
    s_waitcnt lgkmcnt(8)
    v_mfma_f32_16x16x32_bf16 a[192:195], a[160:163], v[140:143], a[192:195]
    ds_read_b128 a[160:163], v12 offset:24576
    v_exp_f32 v32, v108
    v_mfma_f32_16x16x32_bf16 a[196:199], a[164:167], v[140:143], a[196:199]
    ds_read_b128 a[164:167], v12 offset:25600
    v_exp_f32 v33, v109
    v_mfma_f32_16x16x32_bf16 a[240:243], v[14:17], v[140:143], a[240:243]
    v_exp_f32 v34, v110
    v_mfma_f32_16x16x32_bf16 a[200:203], a[168:171], v[140:143], a[200:203]
    ds_read_b128 a[168:171], v12 offset:26624
    v_cvt_pk_bf16_f32 v156, v32, v33
    v_mfma_f32_16x16x32_bf16 a[204:207], a[172:175], v[140:143], a[204:207]
    s_waitcnt lgkmcnt(3)
    ds_read_b128 a[172:175], v12 offset:27648
    v_exp_f32 v35, v111
    v_mfma_f32_16x16x32_bf16 a[208:211], a[224:227], v[140:143], a[208:211]
    ds_read_b128 a[224:227], v12 offset:28672
    v_cvt_pk_bf16_f32 v157, v34, v35
    v_mfma_f32_16x16x32_bf16 a[212:215], a[228:231], v[140:143], a[212:215]
    ds_read_b128 a[228:231], v12 offset:29696
    v_exp_f32 v36, v124
    v_exp_f32 v37, v125
    v_exp_f32 v38, v126
    v_cvt_pk_bf16_f32 v158, v36, v37
    v_or3_b32 v10, v156, v157, v158
    v_exp_f32 v39, v127
    s_nop 0
    v_cvt_pk_bf16_f32 v159, v38, v39
    v_bitop3_b32 v10, v10, v159, s95 bitop3:0xa8
    v_cmp_ne_u32 vcc, 0, v10
    v_mfma_f32_16x16x32_bf16 a[216:219], a[232:235], v[140:143], a[216:219]
    ds_read_b128 a[232:235], v12 offset:30720
    v_mfma_f32_16x16x32_bf16 a[220:223], a[236:239], v[140:143], a[220:223]
    ds_read_b128 a[236:239], v12 offset:31744
    s_cbranch_vccnz k2_fb15
k2_r15:
    s_waitcnt lgkmcnt(0)
    s_load_dwordx2 s[48:49], s[0:1], 40
    s_load_dwordx4 s[52:55], s[0:1], 72
    s_load_dwordx2 s[50:51], s[0:1], 88
    s_load_dwordx2 s[56:57], s[0:1], 104
    s_load_dwordx2 s[58:59], s[0:1], 0
    v_mov_b32 v255, v30
    v_mov_b32 v253, v25
    s_and_b32 s68, s2, 7
    s_bfe_u32 s69, s2, 0x20003
    s_mul_i32 s77, s68, 7
    s_add_u32 s77, s77, 128
    s_lshl_b32 s3, s69, 1
    s_add_u32 s3, s3, s42
    s_lshl_b32 s79, s3, 1
    s_and_b32 s79, s79, 15
    s_cmp_ge_u32 s3, 7
    s_cselect_b32 s4, 7, 0
    s_sub_u32 s3, s3, s4
    s_add_u32 s70, s77, s3
    s_lshl_b32 s80, s68, 4
    s_add_u32 s79, s79, s80
    s_lshl_b32 s3, s42, 3
    s_sub_u32 s4, 120, s3
    s_cmp_lt_u32 s40, 2
    s_cselect_b32 s89, s3, s4
    s_and_b32 s7, s40, 1
    s_lshl_b32 s3, s7, 2
    s_add_u32 s3, s3, s68
    s_add_u32 s3, s3, 0
    s_and_b32 s3, s3, 7
    s_add_u32 s3, s3, s89
    s_mul_i32 s3, s3, 188416
    s_sub_u32 s90, s3, 0
    s_lshl_b32 s3, s7, 2
    s_add_u32 s3, s3, s68
    s_add_u32 s3, s3, 1
    s_and_b32 s3, s3, 7
    s_add_u32 s3, s3, s89
    s_mul_i32 s3, s3, 188416
    s_sub_u32 s91, s3, 1024
    s_lshl_b32 s3, s7, 2
    s_add_u32 s3, s3, s68
    s_add_u32 s3, s3, 2
    s_and_b32 s3, s3, 7
    s_add_u32 s3, s3, s89
    s_mul_i32 s3, s3, 188416
    s_sub_u32 s92, s3, 2048
    s_lshl_b32 s3, s7, 2
    s_add_u32 s3, s3, s68
    s_add_u32 s3, s3, 3
    s_and_b32 s3, s3, 7
    s_add_u32 s3, s3, s89
    s_mul_i32 s3, s3, 188416
    s_sub_u32 s93, s3, 3072
    v_lshrrev_b32 v248, 4, v1
    v_lshrrev_b32 v249, 3, v248
    v_lshlrev_b32 v249, 10, v249
    v_lshrrev_b32 v250, 4, v248
    v_lshlrev_b32 v250, 1, v250
    v_and_b32 v251, 7, v248
    v_xor_b32 v250, v250, v251
    v_lshl_add_u32 v2, v250, 4, v249
    s_lshl_b32 s3, s7, 7
    s_lshl_b32 s4, s69, 8
    s_add_u32 s47, s3, s4
    s_lshr_b32 s4, s40, 1
    s_lshl_b32 s3, s4, 14
    s_add_u32 s3, s3, s47
    v_add_u32 v2, s3, v2
    s_lshl_b32 s87, s7, 12
    s_lshl_b32 s4, s4, 11
    s_add_u32 s87, s87, s4
    s_add_u32 s88, s44, 8192
    s_mov_b32 s71, 23
    s_bitcmp1_b32 s2, 0
    s_mov_b32 s73, 0
    s_cselect_b32 s73, 0, s73
    s_mov_b32 s72, s73
    s_mov_b32 s75, 24117248
    s_waitcnt lgkmcnt(0)
    s_mov_b32 s8, s48
    s_mov_b32 s9, s49
    s_mov_b32 s10, 4194304
    s_mov_b32 s11, 0x20000
    s_mov_b32 s12, s52
    s_mov_b32 s13, s53
    s_mov_b32 s14, 1835008
    s_mov_b32 s15, 0x20000
    s_mov_b32 s19, 0x20000
    s_barrier
    s_waitcnt vmcnt(0)
    v_cmp_gt_u32 vcc, 1, v26
    s_nop 3
    s_cbranch_vccnz L_spin2
L_spun2:
    s_cmp_eq_u32 s71, 16
    s_cselect_b32 s70, s79, s70
    s_cselect_b32 s77, s80, s77
    s_cmp_lt_u32 s70, 128
    s_cselect_b64 s[16:17], s[8:9], s[12:13]
    s_cselect_b32 s18, s10, s14
    s_cselect_b32 s78, 16, 7
    s_add_u32 s78, s78, s77
    s_and_b32 s43, s70, 127
    s_lshl_b32 s43, s43, 15
    s_lshl_b32 s76, s70, 10
    s_sub_u32 s71, s71, 1
    s_cselect_b32 s18, 0, s18
    s_cselect_b32 s26, 0, s75
    s_cselect_b32 s71, 0, s71
    s_add_u32 s70, s70, 1
    s_cmp_eq_u32 s70, s78
    s_cselect_b32 s70, s77, s70
    s_add_u32 m0, s73, s87
    s_add_u32 s3, s43, 7168
    buffer_load_dwordx4 v2, s[16:19], s43 offen lds
    buffer_load_dwordx4 v2, s[16:19], s3 offen offset:1024 lds
    s_add_u32 m0, s73, s88
    s_add_u32 s43, s76, s90
    buffer_load_dwordx4 v1, s[24:27], s43 offen offset:0 sc1 lds
    s_add_u32 s43, s76, s91
    buffer_load_dwordx4 v1, s[24:27], s43 offen offset:1024 sc1 lds
    s_add_u32 s43, s76, s92
    buffer_load_dwordx4 v1, s[24:27], s43 offen offset:2048 sc1 lds
    s_add_u32 s43, s76, s93
    buffer_load_dwordx4 v1, s[24:27], s43 offen offset:3072 sc1 lds
    s_add_u32 s73, s73, 24576
    s_cmp_eq_u32 s73, 147456
    s_cselect_b32 s73, 0, s73
    s_cmp_eq_u32 s71, 16
    s_cselect_b32 s70, s79, s70
    s_cselect_b32 s77, s80, s77
    s_cmp_lt_u32 s70, 128
    s_cselect_b64 s[16:17], s[8:9], s[12:13]
    s_cselect_b32 s18, s10, s14
    s_cselect_b32 s78, 16, 7
    s_add_u32 s78, s78, s77
    s_and_b32 s43, s70, 127
    s_lshl_b32 s43, s43, 15
    s_lshl_b32 s76, s70, 10
    s_sub_u32 s71, s71, 1
    s_cselect_b32 s18, 0, s18
    s_cselect_b32 s26, 0, s75
    s_cselect_b32 s71, 0, s71
    s_add_u32 s70, s70, 1
    s_cmp_eq_u32 s70, s78
    s_cselect_b32 s70, s77, s70
    s_add_u32 m0, s73, s87
    s_add_u32 s3, s43, 7168
    buffer_load_dwordx4 v2, s[16:19], s43 offen lds
    buffer_load_dwordx4 v2, s[16:19], s3 offen offset:1024 lds
    s_add_u32 m0, s73, s88
    s_add_u32 s43, s76, s90
    buffer_load_dwordx4 v1, s[24:27], s43 offen offset:0 sc1 lds
    s_add_u32 s43, s76, s91
    buffer_load_dwordx4 v1, s[24:27], s43 offen offset:1024 sc1 lds
    s_add_u32 s43, s76, s92
    buffer_load_dwordx4 v1, s[24:27], s43 offen offset:2048 sc1 lds
    s_add_u32 s43, s76, s93
    buffer_load_dwordx4 v1, s[24:27], s43 offen offset:3072 sc1 lds
    s_add_u32 s73, s73, 24576
    s_cmp_eq_u32 s73, 147456
    s_cselect_b32 s73, 0, s73
    s_waitcnt lgkmcnt(0)
    v_mfma_f32_16x16x32_bf16 a[192:195], a[160:163], v[156:159], a[192:195]
    v_accvgpr_read_b32 v4, a176
    v_rcp_f32 v4, v4
    v_mfma_f32_16x16x32_bf16 a[196:199], a[164:167], v[156:159], a[196:199]
    v_accvgpr_read_b32 v32, a128
    v_accvgpr_read_b32 v33, a129
    v_accvgpr_read_b32 v34, a130
    v_mfma_f32_16x16x32_bf16 a[200:203], a[168:171], v[156:159], a[200:203]
    v_accvgpr_read_b32 v35, a131
    v_accvgpr_read_b32 v36, a132
    v_accvgpr_read_b32 v37, a133
    v_mfma_f32_16x16x32_bf16 a[204:207], a[172:175], v[156:159], a[204:207]
    v_accvgpr_read_b32 v38, a134
    v_accvgpr_read_b32 v39, a135
    v_mfma_f32_16x16x32_bf16 a[208:211], a[224:227], v[156:159], a[208:211]
    v_mul_f32 v32, v32, v4
    v_mul_f32 v33, v33, v4
    v_mfma_f32_16x16x32_bf16 a[212:215], a[228:231], v[156:159], a[212:215]
    v_mul_f32 v34, v34, v4
    v_mul_f32 v35, v35, v4
    v_mfma_f32_16x16x32_bf16 a[216:219], a[232:235], v[156:159], a[216:219]
    v_mul_f32 v36, v36, v4
    v_mul_f32 v37, v37, v4
    v_mfma_f32_16x16x32_bf16 a[220:223], a[236:239], v[156:159], a[220:223]
    v_mul_f32 v38, v38, v4
    v_mul_f32 v39, v39, v4
    v_mfma_f32_16x16x32_bf16 a[240:243], v[14:17], v[156:159], a[240:243]
    v_cvt_pk_bf16_f32 v48, v32, v33
    v_cvt_pk_bf16_f32 v49, v34, v35
    v_cvt_pk_bf16_f32 v50, v36, v37
    v_cvt_pk_bf16_f32 v51, v38, v39
    buffer_store_dwordx4 v[48:51], v1, s[24:27], s83 offen offset:0 sc0 sc1
    v_accvgpr_read_b32 v40, a136
    v_accvgpr_read_b32 v41, a137
    v_accvgpr_read_b32 v42, a138
    v_accvgpr_read_b32 v43, a139
    v_accvgpr_read_b32 v44, a140
    v_accvgpr_read_b32 v45, a141
    v_accvgpr_read_b32 v46, a142
    v_accvgpr_read_b32 v47, a143
    v_mul_f32 v40, v40, v4
    v_mul_f32 v41, v41, v4
    v_mul_f32 v42, v42, v4
    v_mul_f32 v43, v43, v4
    v_mul_f32 v44, v44, v4
    v_mul_f32 v45, v45, v4
    v_mul_f32 v46, v46, v4
    v_mul_f32 v47, v47, v4
    v_cvt_pk_bf16_f32 v52, v40, v41
    v_cvt_pk_bf16_f32 v53, v42, v43
    v_cvt_pk_bf16_f32 v54, v44, v45
    v_cvt_pk_bf16_f32 v55, v46, v47
    buffer_store_dwordx4 v[52:55], v1, s[24:27], s83 offen offset:1024 sc0 sc1
    v_accvgpr_read_b32 v32, a144
    v_accvgpr_read_b32 v33, a145
    v_accvgpr_read_b32 v34, a146
    v_accvgpr_read_b32 v35, a147
    v_accvgpr_read_b32 v36, a148
    v_accvgpr_read_b32 v37, a149
    v_accvgpr_read_b32 v38, a150
    v_accvgpr_read_b32 v39, a151
    v_mul_f32 v32, v32, v4
    v_mul_f32 v33, v33, v4
    v_mul_f32 v34, v34, v4
    v_mul_f32 v35, v35, v4
    v_mul_f32 v36, v36, v4
    v_mul_f32 v37, v37, v4
    v_mul_f32 v38, v38, v4
    v_mul_f32 v39, v39, v4
    v_cvt_pk_bf16_f32 v48, v32, v33
    v_cvt_pk_bf16_f32 v49, v34, v35
    v_cvt_pk_bf16_f32 v50, v36, v37
    v_cvt_pk_bf16_f32 v51, v38, v39
    buffer_store_dwordx4 v[48:51], v1, s[24:27], s83 offen offset:2048 sc0 sc1
    v_accvgpr_read_b32 v40, a152
    v_accvgpr_read_b32 v41, a153
    v_accvgpr_read_b32 v42, a154
    v_accvgpr_read_b32 v43, a155
    v_accvgpr_read_b32 v44, a156
    v_accvgpr_read_b32 v45, a157
    v_accvgpr_read_b32 v46, a158
    v_accvgpr_read_b32 v47, a159
    v_mul_f32 v40, v40, v4
    v_mul_f32 v41, v41, v4
    v_mul_f32 v42, v42, v4
    v_mul_f32 v43, v43, v4
    v_mul_f32 v44, v44, v4
    v_mul_f32 v45, v45, v4
    v_mul_f32 v46, v46, v4
    v_mul_f32 v47, v47, v4
    v_cvt_pk_bf16_f32 v52, v40, v41
    v_cvt_pk_bf16_f32 v53, v42, v43
    v_cvt_pk_bf16_f32 v54, v44, v45
    v_cvt_pk_bf16_f32 v55, v46, v47
    buffer_store_dwordx4 v[52:55], v1, s[24:27], s83 offen offset:3072 sc0 sc1
    v_accvgpr_read_b32 v5, a240
    v_rcp_f32 v5, v5
    v_accvgpr_read_b32 v32, a192
    v_accvgpr_read_b32 v33, a193
    v_accvgpr_read_b32 v34, a194
    v_accvgpr_read_b32 v35, a195
    v_accvgpr_read_b32 v36, a196
    v_accvgpr_read_b32 v37, a197
    v_accvgpr_read_b32 v38, a198
    v_accvgpr_read_b32 v39, a199
    v_mul_f32 v32, v32, v5
    v_mul_f32 v33, v33, v5
    v_mul_f32 v34, v34, v5
    v_mul_f32 v35, v35, v5
    v_mul_f32 v36, v36, v5
    v_mul_f32 v37, v37, v5
    v_mul_f32 v38, v38, v5
    v_mul_f32 v39, v39, v5
    v_cvt_pk_bf16_f32 v48, v32, v33
    v_cvt_pk_bf16_f32 v49, v34, v35
    v_cvt_pk_bf16_f32 v50, v36, v37
    v_cvt_pk_bf16_f32 v51, v38, v39
    buffer_store_dwordx4 v[48:51], v1, s[24:27], s84 offen offset:0 sc0 sc1
    v_accvgpr_read_b32 v40, a200
    v_accvgpr_read_b32 v41, a201
    v_accvgpr_read_b32 v42, a202
    v_accvgpr_read_b32 v43, a203
    v_accvgpr_read_b32 v44, a204
    v_accvgpr_read_b32 v45, a205
    v_accvgpr_read_b32 v46, a206
    v_accvgpr_read_b32 v47, a207
    v_mul_f32 v40, v40, v5
    v_mul_f32 v41, v41, v5
    v_mul_f32 v42, v42, v5
    v_mul_f32 v43, v43, v5
    v_mul_f32 v44, v44, v5
    v_mul_f32 v45, v45, v5
    v_mul_f32 v46, v46, v5
    v_mul_f32 v47, v47, v5
    v_cvt_pk_bf16_f32 v52, v40, v41
    v_cvt_pk_bf16_f32 v53, v42, v43
    v_cvt_pk_bf16_f32 v54, v44, v45
    v_cvt_pk_bf16_f32 v55, v46, v47
    buffer_store_dwordx4 v[52:55], v1, s[24:27], s84 offen offset:1024 sc0 sc1
    v_accvgpr_read_b32 v32, a208
    v_accvgpr_read_b32 v33, a209
    v_accvgpr_read_b32 v34, a210
    v_accvgpr_read_b32 v35, a211
    v_accvgpr_read_b32 v36, a212
    v_accvgpr_read_b32 v37, a213
    v_accvgpr_read_b32 v38, a214
    v_accvgpr_read_b32 v39, a215
    v_mul_f32 v32, v32, v5
    v_mul_f32 v33, v33, v5
    v_mul_f32 v34, v34, v5
    v_mul_f32 v35, v35, v5
    v_mul_f32 v36, v36, v5
    v_mul_f32 v37, v37, v5
    v_mul_f32 v38, v38, v5
    v_mul_f32 v39, v39, v5
    v_cvt_pk_bf16_f32 v48, v32, v33
    v_cvt_pk_bf16_f32 v49, v34, v35
    v_cvt_pk_bf16_f32 v50, v36, v37
    v_cvt_pk_bf16_f32 v51, v38, v39
    buffer_store_dwordx4 v[48:51], v1, s[24:27], s84 offen offset:2048 sc0 sc1
    v_accvgpr_read_b32 v40, a216
    v_accvgpr_read_b32 v41, a217
    v_accvgpr_read_b32 v42, a218
    v_accvgpr_read_b32 v43, a219
    v_accvgpr_read_b32 v44, a220
    v_accvgpr_read_b32 v45, a221
    v_accvgpr_read_b32 v46, a222
    v_accvgpr_read_b32 v47, a223
    v_mul_f32 v40, v40, v5
    v_mul_f32 v41, v41, v5
    v_mul_f32 v42, v42, v5
    v_mul_f32 v43, v43, v5
    v_mul_f32 v44, v44, v5
    v_mul_f32 v45, v45, v5
    v_mul_f32 v46, v46, v5
    v_mul_f32 v47, v47, v5
    v_cvt_pk_bf16_f32 v52, v40, v41
    v_cvt_pk_bf16_f32 v53, v42, v43
    v_cvt_pk_bf16_f32 v54, v44, v45
    v_cvt_pk_bf16_f32 v55, v46, v47
    buffer_store_dwordx4 v[52:55], v1, s[24:27], s84 offen offset:3072 sc0 sc1
    s_cmp_eq_u32 s71, 16
    s_cselect_b32 s70, s79, s70
    s_cselect_b32 s77, s80, s77
    s_cmp_lt_u32 s70, 128
    s_cselect_b64 s[16:17], s[8:9], s[12:13]
    s_cselect_b32 s18, s10, s14
    s_cselect_b32 s78, 16, 7
    s_add_u32 s78, s78, s77
    s_and_b32 s43, s70, 127
    s_lshl_b32 s43, s43, 15
    s_lshl_b32 s76, s70, 10
    s_sub_u32 s71, s71, 1
    s_cselect_b32 s18, 0, s18
    s_cselect_b32 s26, 0, s75
    s_cselect_b32 s71, 0, s71
    s_add_u32 s70, s70, 1
    s_cmp_eq_u32 s70, s78
    s_cselect_b32 s70, s77, s70
    s_add_u32 m0, s73, s87
    s_add_u32 s3, s43, 7168
    buffer_load_dwordx4 v2, s[16:19], s43 offen lds
    buffer_load_dwordx4 v2, s[16:19], s3 offen offset:1024 lds
    s_add_u32 m0, s73, s88
    s_add_u32 s43, s76, s90
    buffer_load_dwordx4 v1, s[24:27], s43 offen offset:0 sc1 lds
    s_add_u32 s43, s76, s91
    buffer_load_dwordx4 v1, s[24:27], s43 offen offset:1024 sc1 lds
    s_add_u32 s43, s76, s92
    buffer_load_dwordx4 v1, s[24:27], s43 offen offset:2048 sc1 lds
    s_add_u32 s43, s76, s93
    buffer_load_dwordx4 v1, s[24:27], s43 offen offset:3072 sc1 lds
    s_add_u32 s73, s73, 24576
    s_cmp_eq_u32 s73, 147456
    s_cselect_b32 s73, 0, s73
    s_cmp_eq_u32 s71, 16
    s_cselect_b32 s70, s79, s70
    s_cselect_b32 s77, s80, s77
    s_cmp_lt_u32 s70, 128
    s_cselect_b64 s[16:17], s[8:9], s[12:13]
    s_cselect_b32 s18, s10, s14
    s_cselect_b32 s78, 16, 7
    s_add_u32 s78, s78, s77
    s_and_b32 s43, s70, 127
    s_lshl_b32 s43, s43, 15
    s_lshl_b32 s76, s70, 10
    s_sub_u32 s71, s71, 1
    s_cselect_b32 s18, 0, s18
    s_cselect_b32 s26, 0, s75
    s_cselect_b32 s71, 0, s71
    s_add_u32 s70, s70, 1
    s_cmp_eq_u32 s70, s78
    s_cselect_b32 s70, s77, s70
    s_add_u32 m0, s73, s87
    s_add_u32 s3, s43, 7168
    buffer_load_dwordx4 v2, s[16:19], s43 offen lds
    buffer_load_dwordx4 v2, s[16:19], s3 offen offset:1024 lds
    s_add_u32 m0, s73, s88
    s_add_u32 s43, s76, s90
    buffer_load_dwordx4 v1, s[24:27], s43 offen offset:0 sc1 lds
    s_add_u32 s43, s76, s91
    buffer_load_dwordx4 v1, s[24:27], s43 offen offset:1024 sc1 lds
    s_add_u32 s43, s76, s92
    buffer_load_dwordx4 v1, s[24:27], s43 offen offset:2048 sc1 lds
    s_add_u32 s43, s76, s93
    buffer_load_dwordx4 v1, s[24:27], s43 offen offset:3072 sc1 lds
    s_add_u32 s73, s73, 24576
    s_cmp_eq_u32 s73, 147456
    s_cselect_b32 s73, 0, s73
    s_mov_b32 s28, s58
    s_mov_b32 s29, s59
    s_mov_b32 s30, 2097152
    s_mov_b32 s31, 0x20000
    s_mov_b32 s32, s54
    s_mov_b32 s33, s55
    s_mov_b32 s34, 1024
    s_mov_b32 s35, 0x20000
    s_mov_b32 s64, s50
    s_mov_b32 s65, s51
    s_mov_b32 s66, 2097152
    s_mov_b32 s67, 0x20000
    s_lshr_b32 s3, s2, 3
    s_lshl_b32 s3, s3, 19
    s_add_u32 s3, s3, 67108864
    s_add_u32 s20, s56, s3
    s_addc_u32 s21, s57, 0
    s_mov_b32 s22, 524288
    s_mov_b32 s23, 0x20000
    v_lshrrev_b32 v249, 2, v248
    v_lshlrev_b32 v251, 7, v249
    v_and_b32 v252, 3, v248
    v_lshl_add_u32 v251, v252, 3, v251
    s_lshl_b32 s3, s7, 12
    v_add_u32 v251, s3, v251
    v_bfe_u32 v250, v248, 3, 2
    v_xor_b32 v252, 0, v250
    v_lshl_add_u32 v4, v252, 5, v251
    v_add_u32 v10, s72, v4
    v_xor_b32 v252, 1, v250
    v_lshl_add_u32 v5, v252, 5, v251
    v_add_u32 v11, s72, v5
    v_xor_b32 v252, 2, v250
    v_lshl_add_u32 v6, v252, 5, v251
    v_add_u32 v12, s72, v6
    v_xor_b32 v252, 3, v250
    v_lshl_add_u32 v7, v252, 5, v251
    v_add_u32 v13, s72, v7
    s_lshr_b32 s3, s40, 1
    s_lshl_b32 s3, s3, 13
    s_add_u32 s3, s3, 8192
    v_add_u32 v8, s3, v1
    v_add_u32 v14, s72, v8
    s_add_u32 s3, s89, s68
    s_lshl_b32 s3, s3, 14
    v_bfe_u32 v249, v248, 4, 1
    v_lshlrev_b32 v249, 5, v249
    v_lshrrev_b32 v250, 5, v248
    v_lshl_add_u32 v249, v250, 4, v249
    v_add_u32 v9, s47, v249
    v_and_b32 v250, 15, v248
    v_lshl_add_u32 v15, v250, 10, v9
    v_add_u32 v15, s3, v15
    s_lshl_b32 s3, s40, 11
    s_lshl_b32 s4, s68, 16
    s_add_u32 s4, s4, s3
    s_add_u32 s3, s68, 1
    s_and_b32 s3, s3, 7
    s_lshl_b32 s3, s3, 13
    s_add_u32 s49, s3, s4
    s_add_u32 s3, s68, 2
    s_and_b32 s3, s3, 7
    s_lshl_b32 s3, s3, 13
    s_add_u32 s50, s3, s4
    s_add_u32 s3, s68, 3
    s_and_b32 s3, s3, 7
    s_lshl_b32 s3, s3, 13
    s_add_u32 s51, s3, s4
    s_add_u32 s3, s68, 4
    s_and_b32 s3, s3, 7
    s_lshl_b32 s3, s3, 13
    s_add_u32 s52, s3, s4
    s_add_u32 s3, s68, 5
    s_and_b32 s3, s3, 7
    s_lshl_b32 s3, s3, 13
    s_add_u32 s53, s3, s4
    s_add_u32 s3, s68, 6
    s_and_b32 s3, s3, 7
    s_lshl_b32 s3, s3, 13
    s_add_u32 s54, s3, s4
    s_add_u32 s3, s68, 7
    s_and_b32 s3, s3, 7
    s_lshl_b32 s3, s3, 13
    s_add_u32 s55, s3, s4
    s_add_u32 s86, s6, 16
    s_mov_b32 s74, 1
    s_mov_b32 s85, 0
    s_waitcnt vmcnt(12)
    s_barrier
    buffer_store_dword v0, v255, s[36:39], s5 offen sc0 sc1
    ds_read_b64_tr_b16 v[16:17], v10 offset:0
    ds_read_b64_tr_b16 v[18:19], v10 offset:2048
    ds_read_b128 a[0:3], v14 offset:0
    ds_read_b128 a[4:7], v14 offset:1024
    ds_read_b128 a[8:11], v14 offset:2048
    ds_read_b128 a[12:15], v14 offset:3072
    ds_read_b128 a[16:19], v14 offset:4096
    ds_read_b128 a[20:23], v14 offset:5120
    ds_read_b128 a[24:27], v14 offset:6144
    ds_read_b128 a[28:31], v14 offset:7168
    ds_read_b64_tr_b16 v[20:21], v11 offset:0
    ds_read_b64_tr_b16 v[22:23], v11 offset:2048
    ds_read_b64_tr_b16 v[24:25], v12 offset:0
    ds_read_b64_tr_b16 v[26:27], v12 offset:2048
    ds_read_b64_tr_b16 v[28:29], v13 offset:0
    ds_read_b64_tr_b16 v[30:31], v13 offset:2048
    s_waitcnt lgkmcnt(12)
    v_mfma_f32_16x16x32_bf16 v[64:67], v[16:19], a[0:3], 0
    s_add_u32 s72, s72, 24576
    v_mfma_f32_16x16x32_bf16 v[80:83], v[16:19], a[4:7], 0
    s_waitcnt lgkmcnt(6)
    v_mfma_f32_16x16x32_bf16 v[96:99], v[16:19], a[8:11], 0
    s_cmp_eq_u32 s72, 147456
    v_mfma_f32_16x16x32_bf16 v[112:115], v[16:19], a[12:15], 0
    s_cselect_b32 s72, 0, s72
    v_mfma_f32_16x16x32_bf16 v[128:131], v[16:19], a[16:19], 0
    s_barrier
    v_add_u32 v10, s72, v4
    v_mfma_f32_16x16x32_bf16 v[144:147], v[16:19], a[20:23], 0
    s_cmp_eq_u32 s71, 16
    v_add_u32 v14, s72, v8
    v_add_u32 v11, s72, v5
    s_cselect_b32 s70, s79, s70
    v_mfma_f32_16x16x32_bf16 v[160:163], v[16:19], a[24:27], 0
    s_cselect_b32 s77, s80, s77
    v_add_u32 v12, s72, v6
    v_add_u32 v13, s72, v7
    s_cmp_lt_u32 s70, 128
    v_mfma_f32_16x16x32_bf16 v[176:179], v[16:19], a[28:31], 0
    s_waitcnt lgkmcnt(4)
    ds_read_b64_tr_b16 v[32:33], v10 offset:0
    s_cselect_b64 s[16:17], s[8:9], s[12:13]
    s_cselect_b32 s18, s10, s14
    v_mfma_f32_16x16x32_bf16 v[68:71], v[20:23], a[0:3], 0
    s_cselect_b32 s78, 16, 7
    ds_read_b64_tr_b16 v[34:35], v10 offset:2048
    s_add_u32 s78, s78, s77
    v_mfma_f32_16x16x32_bf16 v[84:87], v[20:23], a[4:7], 0
    s_and_b32 s43, s70, 127
    ds_read_b128 a[32:35], v14 offset:0
    s_lshl_b32 s43, s43, 15
    v_mfma_f32_16x16x32_bf16 v[100:103], v[20:23], a[8:11], 0
    s_lshl_b32 s76, s70, 10
    ds_read_b128 a[36:39], v14 offset:1024
    s_sub_u32 s71, s71, 1
    v_mfma_f32_16x16x32_bf16 v[116:119], v[20:23], a[12:15], 0
    s_cselect_b32 s18, 0, s18
    ds_read_b128 a[40:43], v14 offset:2048
    s_cselect_b32 s26, 0, s75
    v_mfma_f32_16x16x32_bf16 v[132:135], v[20:23], a[16:19], 0
    s_cselect_b32 s71, 0, s71
    ds_read_b128 a[44:47], v14 offset:3072
    s_add_u32 s70, s70, 1
    v_mfma_f32_16x16x32_bf16 v[148:151], v[20:23], a[20:23], 0
    s_cmp_eq_u32 s70, s78
    ds_read_b128 a[48:51], v14 offset:4096
    s_cselect_b32 s70, s77, s70
    v_mfma_f32_16x16x32_bf16 v[164:167], v[20:23], a[24:27], 0
    ds_read_b128 a[52:55], v14 offset:5120
    v_mfma_f32_16x16x32_bf16 v[180:183], v[20:23], a[28:31], 0
    s_waitcnt lgkmcnt(10)
    ds_read_b128 a[56:59], v14 offset:6144
    v_mfma_f32_16x16x32_bf16 v[72:75], v[24:27], a[0:3], 0
    s_add_u32 m0, s73, s87
    ds_read_b128 a[60:63], v14 offset:7168
    s_add_u32 s3, s43, 7168
    buffer_load_dwordx4 v2, s[16:19], s43 offen lds
    v_mfma_f32_16x16x32_bf16 v[88:91], v[24:27], a[4:7], 0
    ds_read_b64_tr_b16 v[36:37], v11 offset:0
    buffer_load_dwordx4 v2, s[16:19], s3 offen offset:1024 lds
    v_mfma_f32_16x16x32_bf16 v[104:107], v[24:27], a[8:11], 0
    s_add_u32 m0, s73, s88
    ds_read_b64_tr_b16 v[38:39], v11 offset:2048
    v_mfma_f32_16x16x32_bf16 v[120:123], v[24:27], a[12:15], 0
    s_add_u32 s43, s76, s90
    ds_read_b64_tr_b16 v[40:41], v12 offset:0
    buffer_load_dwordx4 v1, s[24:27], s43 offen offset:0 sc1 lds
    v_mfma_f32_16x16x32_bf16 v[136:139], v[24:27], a[16:19], 0
    s_add_u32 s43, s76, s91
    ds_read_b64_tr_b16 v[42:43], v12 offset:2048
    buffer_load_dwordx4 v1, s[24:27], s43 offen offset:1024 sc1 lds
    v_mfma_f32_16x16x32_bf16 v[152:155], v[24:27], a[20:23], 0
    s_add_u32 s43, s76, s92
    ds_read_b64_tr_b16 v[44:45], v13 offset:0
    v_mfma_f32_16x16x32_bf16 v[168:171], v[24:27], a[24:27], 0
    ds_read_b64_tr_b16 v[46:47], v13 offset:2048
    buffer_load_dwordx4 v1, s[24:27], s43 offen offset:2048 sc1 lds
    v_mfma_f32_16x16x32_bf16 v[184:187], v[24:27], a[28:31], 0
    s_waitcnt lgkmcnt(15)
    s_add_u32 s43, s76, s93
    buffer_load_dwordx4 v1, s[24:27], s43 offen offset:3072 sc1 lds
    v_mfma_f32_16x16x32_bf16 v[76:79], v[28:31], a[0:3], 0
    s_add_u32 s73, s73, 24576
    v_mfma_f32_16x16x32_bf16 v[92:95], v[28:31], a[4:7], 0
    s_cmp_eq_u32 s73, 147456
    s_cselect_b32 s73, 0, s73
    buffer_load_dwordx4 v[56:59], v9, s[32:35], 0 offen offset:0
    v_mfma_f32_16x16x32_bf16 v[108:111], v[28:31], a[8:11], 0
    buffer_load_dwordx4 v[48:51], v15, s[28:31], 0 offen offset:0
    v_mfma_f32_16x16x32_bf16 v[124:127], v[28:31], a[12:15], 0
    buffer_load_dwordx4 v[60:63], v9, s[32:35], 0 offen offset:64
    v_mfma_f32_16x16x32_bf16 v[140:143], v[28:31], a[16:19], 0
    buffer_load_dwordx4 v[52:55], v15, s[28:31], 0 offen offset:64
    v_mfma_f32_16x16x32_bf16 v[156:159], v[28:31], a[20:23], 0
    v_mfma_f32_16x16x32_bf16 v[172:175], v[28:31], a[24:27], 0
    v_mfma_f32_16x16x32_bf16 v[188:191], v[28:31], a[28:31], 0
    s_waitcnt lgkmcnt(12)
    v_mfma_f32_16x16x32_bf16 v[64:67], v[32:35], a[32:35], v[64:67]
    s_add_u32 s72, s72, 24576
    v_mfma_f32_16x16x32_bf16 v[80:83], v[32:35], a[36:39], v[80:83]
    s_waitcnt lgkmcnt(6)
    v_mfma_f32_16x16x32_bf16 v[96:99], v[32:35], a[40:43], v[96:99]
    s_cmp_eq_u32 s72, 147456
    v_mfma_f32_16x16x32_bf16 v[112:115], v[32:35], a[44:47], v[112:115]
    s_cselect_b32 s72, 0, s72
    v_mfma_f32_16x16x32_bf16 v[128:131], v[32:35], a[48:51], v[128:131]
    s_waitcnt vmcnt(17)
    s_barrier
    v_add_u32 v10, s72, v4
    v_mfma_f32_16x16x32_bf16 v[144:147], v[32:35], a[52:55], v[144:147]
    s_cmp_eq_u32 s71, 16
    v_add_u32 v14, s72, v8
    v_add_u32 v11, s72, v5
    s_cselect_b32 s70, s79, s70
    v_mfma_f32_16x16x32_bf16 v[160:163], v[32:35], a[56:59], v[160:163]
    s_cselect_b32 s77, s80, s77
    v_add_u32 v12, s72, v6
    v_add_u32 v13, s72, v7
    s_cmp_lt_u32 s70, 128
    v_mfma_f32_16x16x32_bf16 v[176:179], v[32:35], a[60:63], v[176:179]
    s_waitcnt lgkmcnt(4)
    ds_read_b64_tr_b16 v[16:17], v10 offset:0
    s_cselect_b64 s[16:17], s[8:9], s[12:13]
    s_cselect_b32 s18, s10, s14
    v_mfma_f32_16x16x32_bf16 v[68:71], v[36:39], a[32:35], v[68:71]
    s_cselect_b32 s78, 16, 7
    ds_read_b64_tr_b16 v[18:19], v10 offset:2048
    s_add_u32 s78, s78, s77
    v_mfma_f32_16x16x32_bf16 v[84:87], v[36:39], a[36:39], v[84:87]
    s_and_b32 s43, s70, 127
    ds_read_b128 a[0:3], v14 offset:0
    s_lshl_b32 s43, s43, 15
    v_mfma_f32_16x16x32_bf16 v[100:103], v[36:39], a[40:43], v[100:103]
    s_lshl_b32 s76, s70, 10
    ds_read_b128 a[4:7], v14 offset:1024
    s_sub_u32 s71, s71, 1
    v_mfma_f32_16x16x32_bf16 v[116:119], v[36:39], a[44:47], v[116:119]
    s_cselect_b32 s18, 0, s18
    ds_read_b128 a[8:11], v14 offset:2048
    s_cselect_b32 s26, 0, s75
    v_mfma_f32_16x16x32_bf16 v[132:135], v[36:39], a[48:51], v[132:135]
    s_cselect_b32 s71, 0, s71
    ds_read_b128 a[12:15], v14 offset:3072
    s_add_u32 s70, s70, 1
    v_mfma_f32_16x16x32_bf16 v[148:151], v[36:39], a[52:55], v[148:151]
    s_cmp_eq_u32 s70, s78
    ds_read_b128 a[16:19], v14 offset:4096
    s_cselect_b32 s70, s77, s70
    v_mfma_f32_16x16x32_bf16 v[164:167], v[36:39], a[56:59], v[164:167]
    ds_read_b128 a[20:23], v14 offset:5120
    v_mfma_f32_16x16x32_bf16 v[180:183], v[36:39], a[60:63], v[180:183]
    s_waitcnt lgkmcnt(10)
    ds_read_b128 a[24:27], v14 offset:6144
    v_mfma_f32_16x16x32_bf16 v[72:75], v[40:43], a[32:35], v[72:75]
    s_add_u32 m0, s73, s87
    ds_read_b128 a[28:31], v14 offset:7168
    s_add_u32 s3, s43, 7168
    buffer_load_dwordx4 v2, s[16:19], s43 offen lds
    v_mfma_f32_16x16x32_bf16 v[88:91], v[40:43], a[36:39], v[88:91]
    ds_read_b64_tr_b16 v[20:21], v11 offset:0
    v_mfma_f32_16x16x32_bf16 v[104:107], v[40:43], a[40:43], v[104:107]
    ds_read_b64_tr_b16 v[22:23], v11 offset:2048
    buffer_load_dwordx4 v2, s[16:19], s3 offen offset:1024 lds
    v_mfma_f32_16x16x32_bf16 v[120:123], v[40:43], a[44:47], v[120:123]
    ds_read_b64_tr_b16 v[24:25], v12 offset:0
    v_mfma_f32_16x16x32_bf16 v[136:139], v[40:43], a[48:51], v[136:139]
    s_add_u32 m0, s73, s88
    ds_read_b64_tr_b16 v[26:27], v12 offset:2048
    v_mfma_f32_16x16x32_bf16 v[152:155], v[40:43], a[52:55], v[152:155]
    s_add_u32 s43, s76, s90
    ds_read_b64_tr_b16 v[28:29], v13 offset:0
    buffer_load_dwordx4 v1, s[24:27], s43 offen offset:0 sc1 lds
    v_mfma_f32_16x16x32_bf16 v[168:171], v[40:43], a[56:59], v[168:171]
    s_add_u32 s43, s76, s91
    ds_read_b64_tr_b16 v[30:31], v13 offset:2048
    v_mfma_f32_16x16x32_bf16 v[184:187], v[40:43], a[60:63], v[184:187]
    s_waitcnt lgkmcnt(15)
    buffer_load_dwordx4 v1, s[24:27], s43 offen offset:1024 sc1 lds
    v_mfma_f32_16x16x32_bf16 v[76:79], v[44:47], a[32:35], v[76:79]
    v_mfma_f32_16x16x32_bf16 v[92:95], v[44:47], a[36:39], v[92:95]
    s_add_u32 s43, s76, s92
    buffer_load_dwordx4 v1, s[24:27], s43 offen offset:2048 sc1 lds
    v_mfma_f32_16x16x32_bf16 v[108:111], v[44:47], a[40:43], v[108:111]
    v_mfma_f32_16x16x32_bf16 v[124:127], v[44:47], a[44:47], v[124:127]
    s_add_u32 s43, s76, s93
    buffer_load_dwordx4 v1, s[24:27], s43 offen offset:3072 sc1 lds
    v_mfma_f32_16x16x32_bf16 v[140:143], v[44:47], a[48:51], v[140:143]
    v_mfma_f32_16x16x32_bf16 v[156:159], v[44:47], a[52:55], v[156:159]
    v_mfma_f32_16x16x32_bf16 v[172:175], v[44:47], a[56:59], v[172:175]
    s_add_u32 s73, s73, 24576
    v_mfma_f32_16x16x32_bf16 v[188:191], v[44:47], a[60:63], v[188:191]
    s_cmp_eq_u32 s73, 147456
    s_cselect_b32 s73, 0, s73
    s_waitcnt lgkmcnt(12)
    v_mfma_f32_16x16x32_bf16 v[64:67], v[16:19], a[0:3], v[64:67]
    s_add_u32 s72, s72, 24576
    v_mfma_f32_16x16x32_bf16 v[80:83], v[16:19], a[4:7], v[80:83]
    s_waitcnt lgkmcnt(6)
    v_mfma_f32_16x16x32_bf16 v[96:99], v[16:19], a[8:11], v[96:99]
    s_cmp_eq_u32 s72, 147456
    v_mfma_f32_16x16x32_bf16 v[112:115], v[16:19], a[12:15], v[112:115]
    s_cselect_b32 s72, 0, s72
    buffer_load_dword v254, v253, s[36:39], s86 offen sc1
    v_mfma_f32_16x16x32_bf16 v[128:131], v[16:19], a[16:19], v[128:131]
    s_waitcnt vmcnt(18)
    s_barrier
    v_add_u32 v10, s72, v4
    v_mfma_f32_16x16x32_bf16 v[144:147], v[16:19], a[20:23], v[144:147]
    s_cmp_eq_u32 s71, 16
    v_add_u32 v14, s72, v8
    v_add_u32 v11, s72, v5
    s_cselect_b32 s70, s79, s70
    v_mfma_f32_16x16x32_bf16 v[160:163], v[16:19], a[24:27], v[160:163]
    s_cselect_b32 s77, s80, s77
    v_add_u32 v12, s72, v6
    v_add_u32 v13, s72, v7
    s_cmp_lt_u32 s70, 128
    v_mfma_f32_16x16x32_bf16 v[176:179], v[16:19], a[28:31], v[176:179]
    s_waitcnt lgkmcnt(4)
    ds_read_b64_tr_b16 v[32:33], v10 offset:0
    s_cselect_b64 s[16:17], s[8:9], s[12:13]
    s_cselect_b32 s18, s10, s14
    v_mfma_f32_16x16x32_bf16 v[68:71], v[20:23], a[0:3], v[68:71]
    s_cselect_b32 s78, 16, 7
    ds_read_b64_tr_b16 v[34:35], v10 offset:2048
    s_add_u32 s78, s78, s77
    v_mfma_f32_16x16x32_bf16 v[84:87], v[20:23], a[4:7], v[84:87]
    s_and_b32 s43, s70, 127
    ds_read_b128 a[32:35], v14 offset:0
    s_lshl_b32 s43, s43, 15
    v_mfma_f32_16x16x32_bf16 v[100:103], v[20:23], a[8:11], v[100:103]
    s_lshl_b32 s76, s70, 10
    ds_read_b128 a[36:39], v14 offset:1024
    s_sub_u32 s71, s71, 1
    v_mfma_f32_16x16x32_bf16 v[116:119], v[20:23], a[12:15], v[116:119]
    s_cselect_b32 s18, 0, s18
    ds_read_b128 a[40:43], v14 offset:2048
    s_cselect_b32 s26, 0, s75
    v_mfma_f32_16x16x32_bf16 v[132:135], v[20:23], a[16:19], v[132:135]
    s_cselect_b32 s71, 0, s71
    ds_read_b128 a[44:47], v14 offset:3072
    s_add_u32 s70, s70, 1
    v_mfma_f32_16x16x32_bf16 v[148:151], v[20:23], a[20:23], v[148:151]
    s_cmp_eq_u32 s70, s78
    ds_read_b128 a[48:51], v14 offset:4096
    s_cselect_b32 s70, s77, s70
    v_mfma_f32_16x16x32_bf16 v[164:167], v[20:23], a[24:27], v[164:167]
    ds_read_b128 a[52:55], v14 offset:5120
    v_mfma_f32_16x16x32_bf16 v[180:183], v[20:23], a[28:31], v[180:183]
    s_waitcnt lgkmcnt(10)
    ds_read_b128 a[56:59], v14 offset:6144
    v_mfma_f32_16x16x32_bf16 v[72:75], v[24:27], a[0:3], v[72:75]
    s_add_u32 m0, s73, s87
    ds_read_b128 a[60:63], v14 offset:7168
    s_add_u32 s3, s43, 7168
    buffer_load_dwordx4 v2, s[16:19], s43 offen lds
    v_mfma_f32_16x16x32_bf16 v[88:91], v[24:27], a[4:7], v[88:91]
    ds_read_b64_tr_b16 v[36:37], v11 offset:0
    v_mfma_f32_16x16x32_bf16 v[104:107], v[24:27], a[8:11], v[104:107]
    ds_read_b64_tr_b16 v[38:39], v11 offset:2048
    buffer_load_dwordx4 v2, s[16:19], s3 offen offset:1024 lds
    v_mfma_f32_16x16x32_bf16 v[120:123], v[24:27], a[12:15], v[120:123]
    ds_read_b64_tr_b16 v[40:41], v12 offset:0
    v_mfma_f32_16x16x32_bf16 v[136:139], v[24:27], a[16:19], v[136:139]
    s_add_u32 m0, s73, s88
    ds_read_b64_tr_b16 v[42:43], v12 offset:2048
    v_mfma_f32_16x16x32_bf16 v[152:155], v[24:27], a[20:23], v[152:155]
    s_add_u32 s43, s76, s90
    ds_read_b64_tr_b16 v[44:45], v13 offset:0
    buffer_load_dwordx4 v1, s[24:27], s43 offen offset:0 sc1 lds
    v_mfma_f32_16x16x32_bf16 v[168:171], v[24:27], a[24:27], v[168:171]
    s_add_u32 s43, s76, s91
    ds_read_b64_tr_b16 v[46:47], v13 offset:2048
    v_mfma_f32_16x16x32_bf16 v[184:187], v[24:27], a[28:31], v[184:187]
    s_waitcnt lgkmcnt(15)
    buffer_load_dwordx4 v1, s[24:27], s43 offen offset:1024 sc1 lds
    v_mfma_f32_16x16x32_bf16 v[76:79], v[28:31], a[0:3], v[76:79]
    v_mfma_f32_16x16x32_bf16 v[92:95], v[28:31], a[4:7], v[92:95]
    s_add_u32 s43, s76, s92
    buffer_load_dwordx4 v1, s[24:27], s43 offen offset:2048 sc1 lds
    v_mfma_f32_16x16x32_bf16 v[108:111], v[28:31], a[8:11], v[108:111]
    v_mfma_f32_16x16x32_bf16 v[124:127], v[28:31], a[12:15], v[124:127]
    s_add_u32 s43, s76, s93
    buffer_load_dwordx4 v1, s[24:27], s43 offen offset:3072 sc1 lds
    v_mfma_f32_16x16x32_bf16 v[140:143], v[28:31], a[16:19], v[140:143]
    v_mfma_f32_16x16x32_bf16 v[156:159], v[28:31], a[20:23], v[156:159]
    v_mfma_f32_16x16x32_bf16 v[172:175], v[28:31], a[24:27], v[172:175]
    s_add_u32 s73, s73, 24576
    v_mfma_f32_16x16x32_bf16 v[188:191], v[28:31], a[28:31], v[188:191]
    s_cmp_eq_u32 s73, 147456
    s_cselect_b32 s73, 0, s73
    s_mov_b64 s[16:17], s[8:9]
    s_mov_b32 s18, s10
    s_bitcmp1_b32 s2, 0
    s_cselect_b32 s74, 7, 7
    s_cselect_b32 s85, 1, 1
    s_waitcnt vmcnt(6)
    v_cmp_gt_u32 vcc, 1, v254
    s_nop 3
    s_cbranch_vccnz L_spin3
L_spun3:
    s_xor_b32 s86, s86, 128
.p2align 6
k3_loop:
    s_waitcnt lgkmcnt(12)
    v_mfma_f32_16x16x32_bf16 v[64:67], v[32:35], a[32:35], v[64:67]
    s_add_u32 s72, s72, 24576
    v_mfma_f32_16x16x32_bf16 v[80:83], v[32:35], a[36:39], v[80:83]
    s_waitcnt lgkmcnt(6)
    v_mfma_f32_16x16x32_bf16 v[96:99], v[32:35], a[40:43], v[96:99]
    s_cmp_eq_u32 s72, 147456
    v_mfma_f32_16x16x32_bf16 v[112:115], v[32:35], a[44:47], v[112:115]
    s_cselect_b32 s72, 0, s72
    v_mfma_f32_16x16x32_bf16 v[128:131], v[32:35], a[48:51], v[128:131]
    s_waitcnt vmcnt(12)
    s_barrier
    v_add_u32 v10, s72, v4
    v_mfma_f32_16x16x32_bf16 v[144:147], v[32:35], a[52:55], v[144:147]
    s_lshl_b32 s43, s79, 15
    v_add_u32 v14, s72, v8
    v_add_u32 v11, s72, v5
    v_mfma_f32_16x16x32_bf16 v[160:163], v[32:35], a[56:59], v[160:163]
    s_lshl_b32 s76, s79, 10
    v_add_u32 v12, s72, v6
    v_add_u32 v13, s72, v7
    v_mfma_f32_16x16x32_bf16 v[176:179], v[32:35], a[60:63], v[176:179]
    s_waitcnt lgkmcnt(4)
    ds_read_b64_tr_b16 v[16:17], v10 offset:0
    v_mfma_f32_16x16x32_bf16 v[68:71], v[36:39], a[32:35], v[68:71]
    s_add_u32 s79, s79, 1
    ds_read_b64_tr_b16 v[18:19], v10 offset:2048
    v_mfma_f32_16x16x32_bf16 v[84:87], v[36:39], a[36:39], v[84:87]
    s_and_b32 s79, s79, 15
    ds_read_b128 a[0:3], v14 offset:0
    v_mfma_f32_16x16x32_bf16 v[100:103], v[36:39], a[40:43], v[100:103]
    s_or_b32 s79, s79, s80
    ds_read_b128 a[4:7], v14 offset:1024
    v_mfma_f32_16x16x32_bf16 v[116:119], v[36:39], a[44:47], v[116:119]
    ds_read_b128 a[8:11], v14 offset:2048
    v_mfma_f32_16x16x32_bf16 v[132:135], v[36:39], a[48:51], v[132:135]
    s_add_u32 m0, s73, s87
    ds_read_b128 a[12:15], v14 offset:3072
    v_mfma_f32_16x16x32_bf16 v[148:151], v[36:39], a[52:55], v[148:151]
    s_add_u32 s3, s43, 7168
    ds_read_b128 a[16:19], v14 offset:4096
    buffer_load_dwordx4 v2, s[16:19], s43 offen lds
    v_mfma_f32_16x16x32_bf16 v[164:167], v[36:39], a[56:59], v[164:167]
    ds_read_b128 a[20:23], v14 offset:5120
    v_mfma_f32_16x16x32_bf16 v[180:183], v[36:39], a[60:63], v[180:183]
    s_waitcnt lgkmcnt(10)
    ds_read_b128 a[24:27], v14 offset:6144
    v_mfma_f32_16x16x32_bf16 v[72:75], v[40:43], a[32:35], v[72:75]
    ds_read_b128 a[28:31], v14 offset:7168
    buffer_load_dwordx4 v2, s[16:19], s3 offen offset:1024 lds
    v_mfma_f32_16x16x32_bf16 v[88:91], v[40:43], a[36:39], v[88:91]
    ds_read_b64_tr_b16 v[20:21], v11 offset:0
    v_mfma_f32_16x16x32_bf16 v[104:107], v[40:43], a[40:43], v[104:107]
    s_add_u32 m0, s73, s88
    ds_read_b64_tr_b16 v[22:23], v11 offset:2048
    v_mfma_f32_16x16x32_bf16 v[120:123], v[40:43], a[44:47], v[120:123]
    s_add_u32 s43, s76, s90
    ds_read_b64_tr_b16 v[24:25], v12 offset:0
    buffer_load_dwordx4 v1, s[24:27], s43 offen offset:0 sc1 lds
    v_mfma_f32_16x16x32_bf16 v[136:139], v[40:43], a[48:51], v[136:139]
    ds_read_b64_tr_b16 v[26:27], v12 offset:2048
    v_mfma_f32_16x16x32_bf16 v[152:155], v[40:43], a[52:55], v[152:155]
    s_add_u32 s43, s76, s91
    ds_read_b64_tr_b16 v[28:29], v13 offset:0
    v_mfma_f32_16x16x32_bf16 v[168:171], v[40:43], a[56:59], v[168:171]
    ds_read_b64_tr_b16 v[30:31], v13 offset:2048
    buffer_load_dwordx4 v1, s[24:27], s43 offen offset:1024 sc1 lds
    v_mfma_f32_16x16x32_bf16 v[184:187], v[40:43], a[60:63], v[184:187]
    s_waitcnt lgkmcnt(15)
    v_mfma_f32_16x16x32_bf16 v[76:79], v[44:47], a[32:35], v[76:79]
    s_add_u32 s43, s76, s92
    buffer_load_dwordx4 v1, s[24:27], s43 offen offset:2048 sc1 lds
    v_mfma_f32_16x16x32_bf16 v[92:95], v[44:47], a[36:39], v[92:95]
    v_mfma_f32_16x16x32_bf16 v[108:111], v[44:47], a[40:43], v[108:111]
    v_mfma_f32_16x16x32_bf16 v[124:127], v[44:47], a[44:47], v[124:127]
    s_add_u32 s43, s76, s93
    buffer_load_dwordx4 v1, s[24:27], s43 offen offset:3072 sc1 lds
    v_mfma_f32_16x16x32_bf16 v[140:143], v[44:47], a[48:51], v[140:143]
    v_mfma_f32_16x16x32_bf16 v[156:159], v[44:47], a[52:55], v[156:159]
    v_mfma_f32_16x16x32_bf16 v[172:175], v[44:47], a[56:59], v[172:175]
    s_add_u32 s73, s73, 24576
    v_mfma_f32_16x16x32_bf16 v[188:191], v[44:47], a[60:63], v[188:191]
    s_cmp_eq_u32 s73, 147456
    s_cselect_b32 s73, 0, s73
    s_waitcnt lgkmcnt(12)
    v_mfma_f32_16x16x32_bf16 v[64:67], v[16:19], a[0:3], v[64:67]
    s_add_u32 s72, s72, 24576
    v_mfma_f32_16x16x32_bf16 v[80:83], v[16:19], a[4:7], v[80:83]
    s_waitcnt lgkmcnt(6)
    v_mfma_f32_16x16x32_bf16 v[96:99], v[16:19], a[8:11], v[96:99]
    s_cmp_eq_u32 s72, 147456
    v_mfma_f32_16x16x32_bf16 v[112:115], v[16:19], a[12:15], v[112:115]
    s_cselect_b32 s72, 0, s72
    v_mfma_f32_16x16x32_bf16 v[128:131], v[16:19], a[16:19], v[128:131]
    s_waitcnt vmcnt(12)
    s_barrier
    v_add_u32 v10, s72, v4
    v_mfma_f32_16x16x32_bf16 v[144:147], v[16:19], a[20:23], v[144:147]
    s_lshl_b32 s43, s79, 15
    v_add_u32 v14, s72, v8
    v_add_u32 v11, s72, v5
    v_mfma_f32_16x16x32_bf16 v[160:163], v[16:19], a[24:27], v[160:163]
    s_lshl_b32 s76, s79, 10
    v_add_u32 v12, s72, v6
    v_add_u32 v13, s72, v7
    v_mfma_f32_16x16x32_bf16 v[176:179], v[16:19], a[28:31], v[176:179]
    s_waitcnt lgkmcnt(4)
    ds_read_b64_tr_b16 v[32:33], v10 offset:0
    v_mfma_f32_16x16x32_bf16 v[68:71], v[20:23], a[0:3], v[68:71]
    s_add_u32 s79, s79, 1
    ds_read_b64_tr_b16 v[34:35], v10 offset:2048
    v_mfma_f32_16x16x32_bf16 v[84:87], v[20:23], a[4:7], v[84:87]
    s_and_b32 s79, s79, 15
    ds_read_b128 a[32:35], v14 offset:0
    v_mfma_f32_16x16x32_bf16 v[100:103], v[20:23], a[8:11], v[100:103]
    s_or_b32 s79, s79, s80
    ds_read_b128 a[36:39], v14 offset:1024
    v_mfma_f32_16x16x32_bf16 v[116:119], v[20:23], a[12:15], v[116:119]
    ds_read_b128 a[40:43], v14 offset:2048
    v_mfma_f32_16x16x32_bf16 v[132:135], v[20:23], a[16:19], v[132:135]
    s_add_u32 m0, s73, s87
    ds_read_b128 a[44:47], v14 offset:3072
    v_mfma_f32_16x16x32_bf16 v[148:151], v[20:23], a[20:23], v[148:151]
    s_add_u32 s3, s43, 7168
    ds_read_b128 a[48:51], v14 offset:4096
    buffer_load_dwordx4 v2, s[16:19], s43 offen lds
    v_mfma_f32_16x16x32_bf16 v[164:167], v[20:23], a[24:27], v[164:167]
    ds_read_b128 a[52:55], v14 offset:5120
    v_mfma_f32_16x16x32_bf16 v[180:183], v[20:23], a[28:31], v[180:183]
    s_waitcnt lgkmcnt(10)
    ds_read_b128 a[56:59], v14 offset:6144
    v_mfma_f32_16x16x32_bf16 v[72:75], v[24:27], a[0:3], v[72:75]
    ds_read_b128 a[60:63], v14 offset:7168
    buffer_load_dwordx4 v2, s[16:19], s3 offen offset:1024 lds
    v_mfma_f32_16x16x32_bf16 v[88:91], v[24:27], a[4:7], v[88:91]
    ds_read_b64_tr_b16 v[36:37], v11 offset:0
    v_mfma_f32_16x16x32_bf16 v[104:107], v[24:27], a[8:11], v[104:107]
    s_add_u32 m0, s73, s88
    ds_read_b64_tr_b16 v[38:39], v11 offset:2048
    v_mfma_f32_16x16x32_bf16 v[120:123], v[24:27], a[12:15], v[120:123]
    s_add_u32 s43, s76, s90
    ds_read_b64_tr_b16 v[40:41], v12 offset:0
    buffer_load_dwordx4 v1, s[24:27], s43 offen offset:0 sc1 lds
    v_mfma_f32_16x16x32_bf16 v[136:139], v[24:27], a[16:19], v[136:139]
    ds_read_b64_tr_b16 v[42:43], v12 offset:2048
    v_mfma_f32_16x16x32_bf16 v[152:155], v[24:27], a[20:23], v[152:155]
    s_add_u32 s43, s76, s91
    ds_read_b64_tr_b16 v[44:45], v13 offset:0
    v_mfma_f32_16x16x32_bf16 v[168:171], v[24:27], a[24:27], v[168:171]
    ds_read_b64_tr_b16 v[46:47], v13 offset:2048
    buffer_load_dwordx4 v1, s[24:27], s43 offen offset:1024 sc1 lds
    v_mfma_f32_16x16x32_bf16 v[184:187], v[24:27], a[28:31], v[184:187]
    s_waitcnt lgkmcnt(15)
    v_mfma_f32_16x16x32_bf16 v[76:79], v[28:31], a[0:3], v[76:79]
    s_add_u32 s43, s76, s92
    buffer_load_dwordx4 v1, s[24:27], s43 offen offset:2048 sc1 lds
    v_mfma_f32_16x16x32_bf16 v[92:95], v[28:31], a[4:7], v[92:95]
    v_mfma_f32_16x16x32_bf16 v[108:111], v[28:31], a[8:11], v[108:111]
    v_mfma_f32_16x16x32_bf16 v[124:127], v[28:31], a[12:15], v[124:127]
    s_add_u32 s43, s76, s93
    buffer_load_dwordx4 v1, s[24:27], s43 offen offset:3072 sc1 lds
    v_mfma_f32_16x16x32_bf16 v[140:143], v[28:31], a[16:19], v[140:143]
    v_mfma_f32_16x16x32_bf16 v[156:159], v[28:31], a[20:23], v[156:159]
    v_mfma_f32_16x16x32_bf16 v[172:175], v[28:31], a[24:27], v[172:175]
    s_add_u32 s73, s73, 24576
    v_mfma_f32_16x16x32_bf16 v[188:191], v[28:31], a[28:31], v[188:191]
    s_cmp_eq_u32 s73, 147456
    s_cselect_b32 s73, 0, s73
    s_sub_u32 s74, s74, 1
    s_cmp_lg_u32 s74, 0
    s_cbranch_scc1 k3_loop
k3_done:
    s_lshl_b32 s7, s40, 11
    s_lshl_b32 s43, s79, 15
    s_lshl_b32 s76, s79, 10
    s_add_u32 s79, s79, 1
    s_and_b32 s79, s79, 15
    s_or_b32 s79, s79, s80
    s_add_u32 m0, s73, s87
    s_add_u32 s3, s43, 7168
    buffer_load_dwordx4 v2, s[16:19], s43 offen lds
    buffer_load_dwordx4 v2, s[16:19], s3 offen offset:1024 lds
    s_add_u32 m0, s73, s88
    s_add_u32 s43, s76, s90
    buffer_load_dwordx4 v1, s[24:27], s43 offen offset:0 sc1 lds
    s_add_u32 s43, s76, s91
    buffer_load_dwordx4 v1, s[24:27], s43 offen offset:1024 sc1 lds
    s_add_u32 s43, s76, s92
    buffer_load_dwordx4 v1, s[24:27], s43 offen offset:2048 sc1 lds
    s_add_u32 s43, s76, s93
    buffer_load_dwordx4 v1, s[24:27], s43 offen offset:3072 sc1 lds
    s_add_u32 s73, s73, 24576
    s_cmp_eq_u32 s73, 147456
    s_cselect_b32 s73, 0, s73
    v_add_u32 v10, 49152, v4
    v_add_u32 v224, 98304, v4
    v_add_u32 v11, 49152, v5
    v_add_u32 v225, 98304, v5
    v_add_u32 v12, 49152, v6
    v_add_u32 v226, 98304, v6
    v_add_u32 v13, 49152, v7
    v_add_u32 v227, 98304, v7
    v_add_u32 v14, 49152, v8
    v_add_u32 v228, 98304, v8
    s_waitcnt lgkmcnt(0)
    s_waitcnt vmcnt(6)
    s_barrier
    ds_read_b128 a[0:3], v228 offset:31744
    ds_read_b128 a[4:7], v228 offset:30720
    ds_read_b128 a[8:11], v228 offset:29696
    ds_read_b128 a[16:19], v8 offset:7168
    ds_read_b128 a[20:23], v8 offset:6144
    ds_read_b128 a[24:27], v8 offset:5120
    ds_read_b64_tr_b16 v[16:17], v224 offset:24576
    ds_read_b64_tr_b16 v[18:19], v224 offset:26624
    ds_read_b64_tr_b16 v[20:21], v4 offset:0
    ds_read_b64_tr_b16 v[22:23], v4 offset:2048
    ds_read_b64_tr_b16 v[24:25], v225 offset:24576
    ds_read_b64_tr_b16 v[26:27], v225 offset:26624
    ds_read_b64_tr_b16 v[28:29], v5 offset:0
    ds_read_b64_tr_b16 v[30:31], v5 offset:2048
    ds_read_b64_tr_b16 v[32:33], v226 offset:24576
    ds_read_b64_tr_b16 v[34:35], v226 offset:26624
    ds_read_b64_tr_b16 v[36:37], v6 offset:0
    ds_read_b64_tr_b16 v[38:39], v6 offset:2048
    ds_read_b64_tr_b16 v[40:41], v227 offset:24576
    ds_read_b64_tr_b16 v[42:43], v227 offset:26624
    ds_read_b64_tr_b16 v[44:45], v7 offset:0
    ds_read_b64_tr_b16 v[46:47], v7 offset:2048
    s_lshl_b32 s43, s79, 15
    s_lshl_b32 s76, s79, 10
    s_add_u32 s79, s79, 1
    s_and_b32 s79, s79, 15
    s_or_b32 s79, s79, s80
    s_add_u32 m0, s73, s87
    s_add_u32 s3, s43, 7168
    buffer_load_dwordx4 v2, s[16:19], s43 offen lds
    buffer_load_dwordx4 v2, s[16:19], s3 offen offset:1024 lds
    s_add_u32 m0, s73, s88
    s_add_u32 s43, s76, s90
    buffer_load_dwordx4 v1, s[24:27], s43 offen offset:0 sc1 lds
    s_add_u32 s43, s76, s91
    buffer_load_dwordx4 v1, s[24:27], s43 offen offset:1024 sc1 lds
    s_add_u32 s43, s76, s92
    buffer_load_dwordx4 v1, s[24:27], s43 offen offset:2048 sc1 lds
    s_add_u32 s43, s76, s93
    buffer_load_dwordx4 v1, s[24:27], s43 offen offset:3072 sc1 lds
    s_add_u32 s73, s73, 24576
    s_cmp_eq_u32 s73, 147456
    s_cselect_b32 s73, 0, s73
    s_lshr_b32 s3, s2, 3
    s_lshl_b32 s3, s3, 3
    s_and_b32 s5, s2, 7
    s_add_u32 s3, s3, s5
    s_lshl_b32 s3, s3, 4
    s_add_u32 s5, s3, 8192
    v_lshrrev_b32 v253, 4, v1
    s_add_u32 s3, s68, 1
    v_add_u32 v253, s3, v253
    v_and_b32 v253, 7, v253
    v_lshlrev_b32 v253, 4, v253
    s_lshl_b32 s3, s40, 2
    s_add_u32 s5, s5, s3
    s_and_b32 s6, s5, 0xffffff8f
    v_cmp_eq_u32 vcc, 0, v1
    v_mov_b32 v248, 0x40000000
    s_nop 0
    v_cndmask_b32 v255, v248, v1, vcc
    s_waitcnt lgkmcnt(12)
    v_mfma_f32_16x16x32_bf16 v[176:179], v[16:19], a[0:3], v[176:179]
    ds_read_b128 a[32:35], v8 offset:31744
    v_mfma_f32_16x16x32_bf16 v[176:179], v[20:23], a[16:19], v[176:179]
    ds_read_b128 a[36:39], v8 offset:30720
    v_mfma_f32_16x16x32_bf16 v[160:163], v[16:19], a[4:7], v[160:163]
    ds_read_b128 a[40:43], v8 offset:29696
    v_mfma_f32_16x16x32_bf16 v[160:163], v[20:23], a[20:23], v[160:163]
    ds_read_b128 a[48:51], v14 offset:7168
    v_mfma_f32_16x16x32_bf16 v[144:147], v[16:19], a[8:11], v[144:147]
    ds_read_b128 a[52:55], v14 offset:6144
    v_mfma_f32_16x16x32_bf16 v[144:147], v[20:23], a[24:27], v[144:147]
    s_waitcnt lgkmcnt(13)
    ds_read_b128 a[56:59], v14 offset:5120
    v_mfma_f32_16x16x32_bf16 v[180:183], v[24:27], a[0:3], v[180:183]
    ds_read_b64_tr_b16 v[192:193], v4 offset:24576
    v_mfma_f32_16x16x32_bf16 v[180:183], v[28:31], a[16:19], v[180:183]
    ds_read_b64_tr_b16 v[194:195], v4 offset:26624
    v_mfma_f32_16x16x32_bf16 v[164:167], v[24:27], a[4:7], v[164:167]
    ds_read_b64_tr_b16 v[196:197], v10 offset:0
    v_mfma_f32_16x16x32_bf16 v[164:167], v[28:31], a[20:23], v[164:167]
    ds_read_b64_tr_b16 v[198:199], v10 offset:2048
    v_mfma_f32_16x16x32_bf16 v[148:151], v[24:27], a[8:11], v[148:151]
    ds_read_b64_tr_b16 v[200:201], v5 offset:24576
    v_mfma_f32_16x16x32_bf16 v[148:151], v[28:31], a[24:27], v[148:151]
    s_waitcnt lgkmcnt(15)
    ds_read_b64_tr_b16 v[202:203], v5 offset:26624
    v_mfma_f32_16x16x32_bf16 v[184:187], v[32:35], a[0:3], v[184:187]
    ds_read_b64_tr_b16 v[204:205], v11 offset:0
    v_mfma_f32_16x16x32_bf16 v[184:187], v[36:39], a[16:19], v[184:187]
    ds_read_b64_tr_b16 v[206:207], v11 offset:2048
    v_mfma_f32_16x16x32_bf16 v[168:171], v[32:35], a[4:7], v[168:171]
    ds_read_b64_tr_b16 v[208:209], v6 offset:24576
    v_mfma_f32_16x16x32_bf16 v[168:171], v[36:39], a[20:23], v[168:171]
    ds_read_b64_tr_b16 v[210:211], v6 offset:26624
    v_mfma_f32_16x16x32_bf16 v[152:155], v[32:35], a[8:11], v[152:155]
    ds_read_b64_tr_b16 v[212:213], v12 offset:0
    v_mfma_f32_16x16x32_bf16 v[152:155], v[36:39], a[24:27], v[152:155]
    s_waitcnt lgkmcnt(15)
    ds_read_b64_tr_b16 v[214:215], v12 offset:2048
    v_mfma_f32_16x16x32_bf16 v[188:191], v[40:43], a[0:3], v[188:191]
    ds_read_b64_tr_b16 v[216:217], v7 offset:24576
    v_mfma_f32_16x16x32_bf16 v[188:191], v[44:47], a[16:19], v[188:191]
    ds_read_b64_tr_b16 v[218:219], v7 offset:26624
    v_mfma_f32_16x16x32_bf16 v[172:175], v[40:43], a[4:7], v[172:175]
    ds_read_b64_tr_b16 v[220:221], v13 offset:0
    v_mfma_f32_16x16x32_bf16 v[172:175], v[44:47], a[20:23], v[172:175]
    ds_read_b64_tr_b16 v[222:223], v13 offset:2048
    v_mfma_f32_16x16x32_bf16 v[156:159], v[40:43], a[8:11], v[156:159]
    v_mfma_f32_16x16x32_bf16 v[156:159], v[44:47], a[24:27], v[156:159]
    s_waitcnt lgkmcnt(12)
    v_mfma_f32_16x16x32_bf16 v[176:179], v[192:195], a[32:35], v[176:179]
    v_mfma_f32_16x16x32_bf16 v[176:179], v[196:199], a[48:51], v[176:179]
    v_mfma_f32_16x16x32_bf16 v[160:163], v[192:195], a[36:39], v[160:163]
    v_mfma_f32_16x16x32_bf16 v[160:163], v[196:199], a[52:55], v[160:163]
    v_mfma_f32_16x16x32_bf16 v[144:147], v[192:195], a[40:43], v[144:147]
    v_mfma_f32_16x16x32_bf16 v[144:147], v[196:199], a[56:59], v[144:147]
    s_waitcnt lgkmcnt(8)
    v_mfma_f32_16x16x32_bf16 v[180:183], v[200:203], a[32:35], v[180:183]
    v_mfma_f32_16x16x32_bf16 v[180:183], v[204:207], a[48:51], v[180:183]
    v_mfma_f32_16x16x32_bf16 v[164:167], v[200:203], a[36:39], v[164:167]
    s_waitcnt vmcnt(0)
    s_barrier
    ds_read_b128 a[0:3], v14 offset:31744
    ds_read_b128 a[4:7], v14 offset:30720
    v_mfma_f32_16x16x32_bf16 v[164:167], v[204:207], a[52:55], v[164:167]
    ds_read_b128 a[8:11], v14 offset:29696
    v_mfma_f32_16x16x32_bf16 v[148:151], v[200:203], a[40:43], v[148:151]
    ds_read_b128 a[16:19], v228 offset:7168
    ds_read_b128 a[20:23], v228 offset:6144
    v_mfma_f32_16x16x32_bf16 v[148:151], v[204:207], a[56:59], v[148:151]
    s_waitcnt lgkmcnt(9)
    ds_read_b128 a[24:27], v228 offset:5120
    v_mfma_f32_16x16x32_bf16 v[184:187], v[208:211], a[32:35], v[184:187]
    ds_read_b64_tr_b16 v[16:17], v10 offset:24576
    v_mfma_f32_16x16x32_bf16 v[184:187], v[212:215], a[48:51], v[184:187]
    ds_read_b64_tr_b16 v[18:19], v10 offset:26624
    ds_read_b64_tr_b16 v[20:21], v224 offset:0
    v_mfma_f32_16x16x32_bf16 v[168:171], v[208:211], a[36:39], v[168:171]
    ds_read_b64_tr_b16 v[22:23], v224 offset:2048
    v_mfma_f32_16x16x32_bf16 v[168:171], v[212:215], a[52:55], v[168:171]
    ds_read_b64_tr_b16 v[24:25], v11 offset:24576
    v_mfma_f32_16x16x32_bf16 v[152:155], v[208:211], a[40:43], v[152:155]
    ds_read_b64_tr_b16 v[26:27], v11 offset:26624
    ds_read_b64_tr_b16 v[28:29], v225 offset:0
    v_mfma_f32_16x16x32_bf16 v[152:155], v[212:215], a[56:59], v[152:155]
    s_waitcnt lgkmcnt(13)
    ds_read_b64_tr_b16 v[30:31], v225 offset:2048
    v_mfma_f32_16x16x32_bf16 v[188:191], v[216:219], a[32:35], v[188:191]
    ds_read_b64_tr_b16 v[32:33], v12 offset:24576
    ds_read_b64_tr_b16 v[34:35], v12 offset:26624
    v_mfma_f32_16x16x32_bf16 v[188:191], v[220:223], a[48:51], v[188:191]
    ds_read_b64_tr_b16 v[36:37], v226 offset:0
    v_mfma_f32_16x16x32_bf16 v[172:175], v[216:219], a[36:39], v[172:175]
    ds_read_b64_tr_b16 v[38:39], v226 offset:2048
    v_mfma_f32_16x16x32_bf16 v[172:175], v[220:223], a[52:55], v[172:175]
    ds_read_b64_tr_b16 v[40:41], v13 offset:24576
    ds_read_b64_tr_b16 v[42:43], v13 offset:26624
    v_mfma_f32_16x16x32_bf16 v[156:159], v[216:219], a[40:43], v[156:159]
    ds_read_b64_tr_b16 v[44:45], v227 offset:0
    v_mfma_f32_16x16x32_bf16 v[156:159], v[220:223], a[56:59], v[156:159]
    s_waitcnt lgkmcnt(11)
    ds_read_b64_tr_b16 v[46:47], v227 offset:2048
    v_mfma_f32_16x16x32_bf16 v[176:179], v[16:19], a[0:3], v[176:179]
    ds_read_b128 a[32:35], v228 offset:28672
    v_mfma_f32_16x16x32_bf16 v[176:179], v[20:23], a[16:19], v[176:179]
    ds_read_b128 a[36:39], v228 offset:27648
    v_mfma_f32_16x16x32_bf16 v[160:163], v[16:19], a[4:7], v[160:163]
    ds_read_b128 a[40:43], v228 offset:26624
    v_mfma_f32_16x16x32_bf16 v[160:163], v[20:23], a[20:23], v[160:163]
    ds_read_b128 a[48:51], v8 offset:4096
    v_mfma_f32_16x16x32_bf16 v[144:147], v[16:19], a[8:11], v[144:147]
    ds_read_b128 a[52:55], v8 offset:3072
    v_mfma_f32_16x16x32_bf16 v[144:147], v[20:23], a[24:27], v[144:147]
    s_waitcnt lgkmcnt(13)
    ds_read_b128 a[56:59], v8 offset:2048
    v_mfma_f32_16x16x32_bf16 v[180:183], v[24:27], a[0:3], v[180:183]
    ds_read_b64_tr_b16 v[192:193], v224 offset:24576
    v_mfma_f32_16x16x32_bf16 v[180:183], v[28:31], a[16:19], v[180:183]
    ds_read_b64_tr_b16 v[194:195], v224 offset:26624
    v_mfma_f32_16x16x32_bf16 v[164:167], v[24:27], a[4:7], v[164:167]
    ds_read_b64_tr_b16 v[196:197], v4 offset:0
    v_mfma_f32_16x16x32_bf16 v[164:167], v[28:31], a[20:23], v[164:167]
    ds_read_b64_tr_b16 v[198:199], v4 offset:2048
    v_mfma_f32_16x16x32_bf16 v[148:151], v[24:27], a[8:11], v[148:151]
    ds_read_b64_tr_b16 v[200:201], v225 offset:24576
    v_mfma_f32_16x16x32_bf16 v[148:151], v[28:31], a[24:27], v[148:151]
    s_waitcnt lgkmcnt(15)
    ds_read_b64_tr_b16 v[202:203], v225 offset:26624
    v_mfma_f32_16x16x32_bf16 v[184:187], v[32:35], a[0:3], v[184:187]
    ds_read_b64_tr_b16 v[204:205], v5 offset:0
    v_mfma_f32_16x16x32_bf16 v[184:187], v[36:39], a[16:19], v[184:187]
    ds_read_b64_tr_b16 v[206:207], v5 offset:2048
    v_mfma_f32_16x16x32_bf16 v[168:171], v[32:35], a[4:7], v[168:171]
    ds_read_b64_tr_b16 v[208:209], v226 offset:24576
    v_mfma_f32_16x16x32_bf16 v[168:171], v[36:39], a[20:23], v[168:171]
    ds_read_b64_tr_b16 v[210:211], v226 offset:26624
    v_mfma_f32_16x16x32_bf16 v[152:155], v[32:35], a[8:11], v[152:155]
    ds_read_b64_tr_b16 v[212:213], v6 offset:0
    v_mfma_f32_16x16x32_bf16 v[152:155], v[36:39], a[24:27], v[152:155]
    s_waitcnt lgkmcnt(15)
    ds_read_b64_tr_b16 v[214:215], v6 offset:2048
    v_mfma_f32_16x16x32_bf16 v[188:191], v[40:43], a[0:3], v[188:191]
    ds_read_b64_tr_b16 v[216:217], v227 offset:24576
    v_mfma_f32_16x16x32_bf16 v[188:191], v[44:47], a[16:19], v[188:191]
    ds_read_b64_tr_b16 v[218:219], v227 offset:26624
    v_mfma_f32_16x16x32_bf16 v[172:175], v[40:43], a[4:7], v[172:175]
    ds_read_b64_tr_b16 v[220:221], v7 offset:0
    v_mfma_f32_16x16x32_bf16 v[172:175], v[44:47], a[20:23], v[172:175]
    ds_read_b64_tr_b16 v[222:223], v7 offset:2048
    v_mfma_f32_16x16x32_bf16 v[156:159], v[40:43], a[8:11], v[156:159]
    v_mfma_f32_16x16x32_bf16 v[156:159], v[44:47], a[24:27], v[156:159]
    s_waitcnt lgkmcnt(12)
    v_mfma_f32_16x16x32_bf16 v[128:131], v[192:195], a[32:35], v[128:131]
    ds_read_b128 a[0:3], v8 offset:28672
    v_mfma_f32_16x16x32_bf16 v[128:131], v[196:199], a[48:51], v[128:131]
    ds_read_b128 a[4:7], v8 offset:27648
    v_mfma_f32_16x16x32_bf16 v[112:115], v[192:195], a[36:39], v[112:115]
    ds_read_b128 a[8:11], v8 offset:26624
    v_mfma_f32_16x16x32_bf16 v[112:115], v[196:199], a[52:55], v[112:115]
    ds_read_b128 a[16:19], v14 offset:4096
    v_mfma_f32_16x16x32_bf16 v[96:99], v[192:195], a[40:43], v[96:99]
    ds_read_b128 a[20:23], v14 offset:3072
    v_cvt_pk_bf16_f32 v176, v176, v177
    v_mfma_f32_16x16x32_bf16 v[96:99], v[196:199], a[56:59], v[96:99]
    s_waitcnt lgkmcnt(13)
    ds_read_b128 a[24:27], v14 offset:2048
    v_cvt_pk_bf16_f32 v177, v178, v179
    v_mfma_f32_16x16x32_bf16 v[132:135], v[200:203], a[32:35], v[132:135]
    ds_read_b64_tr_b16 v[16:17], v4 offset:24576
    v_cvt_pk_bf16_f32 v178, v180, v181
    v_mfma_f32_16x16x32_bf16 v[132:135], v[204:207], a[48:51], v[132:135]
    ds_read_b64_tr_b16 v[18:19], v4 offset:26624
    v_cvt_pk_bf16_f32 v179, v182, v183
    v_mfma_f32_16x16x32_bf16 v[116:119], v[200:203], a[36:39], v[116:119]
    ds_read_b64_tr_b16 v[20:21], v10 offset:0
    v_cvt_pk_bf16_f32 v180, v184, v185
    v_mfma_f32_16x16x32_bf16 v[116:119], v[204:207], a[52:55], v[116:119]
    ds_read_b64_tr_b16 v[22:23], v10 offset:2048
    v_cvt_pk_bf16_f32 v181, v186, v187
    v_mfma_f32_16x16x32_bf16 v[100:103], v[200:203], a[40:43], v[100:103]
    ds_read_b64_tr_b16 v[24:25], v5 offset:24576
    v_cvt_pk_bf16_f32 v182, v188, v189
    v_mfma_f32_16x16x32_bf16 v[100:103], v[204:207], a[56:59], v[100:103]
    s_waitcnt lgkmcnt(15)
    ds_read_b64_tr_b16 v[26:27], v5 offset:26624
    v_cvt_pk_bf16_f32 v183, v190, v191
    v_mfma_f32_16x16x32_bf16 v[136:139], v[208:211], a[32:35], v[136:139]
    ds_read_b64_tr_b16 v[28:29], v11 offset:0
    v_mfma_f32_16x16x32_bf16 v[136:139], v[212:215], a[48:51], v[136:139]
    ds_read_b64_tr_b16 v[30:31], v11 offset:2048
    v_mfma_f32_16x16x32_bf16 v[120:123], v[208:211], a[36:39], v[120:123]
    ds_read_b64_tr_b16 v[32:33], v6 offset:24576
    v_mfma_f32_16x16x32_bf16 v[120:123], v[212:215], a[52:55], v[120:123]
    ds_read_b64_tr_b16 v[34:35], v6 offset:26624
    v_mfma_f32_16x16x32_bf16 v[104:107], v[208:211], a[40:43], v[104:107]
    ds_read_b64_tr_b16 v[36:37], v12 offset:0
    v_mfma_f32_16x16x32_bf16 v[104:107], v[212:215], a[56:59], v[104:107]
    s_waitcnt lgkmcnt(15)
    ds_read_b64_tr_b16 v[38:39], v12 offset:2048
    v_mfma_f32_16x16x32_bf16 v[140:143], v[216:219], a[32:35], v[140:143]
    ds_read_b64_tr_b16 v[40:41], v7 offset:24576
    v_mfma_f32_16x16x32_bf16 v[140:143], v[220:223], a[48:51], v[140:143]
    ds_read_b64_tr_b16 v[42:43], v7 offset:26624
    v_mfma_f32_16x16x32_bf16 v[124:127], v[216:219], a[36:39], v[124:127]
    ds_read_b64_tr_b16 v[44:45], v13 offset:0
    v_mfma_f32_16x16x32_bf16 v[124:127], v[220:223], a[52:55], v[124:127]
    ds_read_b64_tr_b16 v[46:47], v13 offset:2048
    v_mfma_f32_16x16x32_bf16 v[108:111], v[216:219], a[40:43], v[108:111]
    v_mfma_f32_16x16x32_bf16 v[108:111], v[220:223], a[56:59], v[108:111]
    s_waitcnt lgkmcnt(12)
    v_mfma_f32_16x16x32_bf16 v[128:131], v[16:19], a[0:3], v[128:131]
    ds_read_b128 a[32:35], v14 offset:28672
    v_mfma_f32_16x16x32_bf16 v[128:131], v[20:23], a[16:19], v[128:131]
    ds_read_b128 a[36:39], v14 offset:27648
    v_mfma_f32_16x16x32_bf16 v[112:115], v[16:19], a[4:7], v[112:115]
    ds_read_b128 a[40:43], v14 offset:26624
    v_mfma_f32_16x16x32_bf16 v[112:115], v[20:23], a[20:23], v[112:115]
    ds_read_b128 a[48:51], v228 offset:4096
    v_mfma_f32_16x16x32_bf16 v[96:99], v[16:19], a[8:11], v[96:99]
    ds_read_b128 a[52:55], v228 offset:3072
    v_mfma_f32_16x16x32_bf16 v[96:99], v[20:23], a[24:27], v[96:99]
    s_waitcnt lgkmcnt(13)
    ds_read_b128 a[56:59], v228 offset:2048
    v_mfma_f32_16x16x32_bf16 v[132:135], v[24:27], a[0:3], v[132:135]
    ds_read_b64_tr_b16 v[192:193], v10 offset:24576
    v_mfma_f32_16x16x32_bf16 v[132:135], v[28:31], a[16:19], v[132:135]
    ds_read_b64_tr_b16 v[194:195], v10 offset:26624
    v_mfma_f32_16x16x32_bf16 v[116:119], v[24:27], a[4:7], v[116:119]
    ds_read_b64_tr_b16 v[196:197], v224 offset:0
    v_mfma_f32_16x16x32_bf16 v[116:119], v[28:31], a[20:23], v[116:119]
    ds_read_b64_tr_b16 v[198:199], v224 offset:2048
    v_mfma_f32_16x16x32_bf16 v[100:103], v[24:27], a[8:11], v[100:103]
    ds_read_b64_tr_b16 v[200:201], v11 offset:24576
    v_mfma_f32_16x16x32_bf16 v[100:103], v[28:31], a[24:27], v[100:103]
    s_waitcnt lgkmcnt(15)
    ds_read_b64_tr_b16 v[202:203], v11 offset:26624
    v_mfma_f32_16x16x32_bf16 v[136:139], v[32:35], a[0:3], v[136:139]
    ds_read_b64_tr_b16 v[204:205], v225 offset:0
    v_mfma_f32_16x16x32_bf16 v[136:139], v[36:39], a[16:19], v[136:139]
    ds_read_b64_tr_b16 v[206:207], v225 offset:2048
    v_mfma_f32_16x16x32_bf16 v[120:123], v[32:35], a[4:7], v[120:123]
    ds_read_b64_tr_b16 v[208:209], v12 offset:24576
    v_mfma_f32_16x16x32_bf16 v[120:123], v[36:39], a[20:23], v[120:123]
    ds_read_b64_tr_b16 v[210:211], v12 offset:26624
    v_mfma_f32_16x16x32_bf16 v[104:107], v[32:35], a[8:11], v[104:107]
    ds_read_b64_tr_b16 v[212:213], v226 offset:0
    v_mfma_f32_16x16x32_bf16 v[104:107], v[36:39], a[24:27], v[104:107]
    s_waitcnt lgkmcnt(15)
    ds_read_b64_tr_b16 v[214:215], v226 offset:2048
    v_mfma_f32_16x16x32_bf16 v[140:143], v[40:43], a[0:3], v[140:143]
    ds_read_b64_tr_b16 v[216:217], v13 offset:24576
    v_mfma_f32_16x16x32_bf16 v[140:143], v[44:47], a[16:19], v[140:143]
    ds_read_b64_tr_b16 v[218:219], v13 offset:26624
    v_mfma_f32_16x16x32_bf16 v[124:127], v[40:43], a[4:7], v[124:127]
    ds_read_b64_tr_b16 v[220:221], v227 offset:0
    v_mfma_f32_16x16x32_bf16 v[124:127], v[44:47], a[20:23], v[124:127]
    ds_read_b64_tr_b16 v[222:223], v227 offset:2048
    v_mfma_f32_16x16x32_bf16 v[108:111], v[40:43], a[8:11], v[108:111]
    v_mfma_f32_16x16x32_bf16 v[108:111], v[44:47], a[24:27], v[108:111]
    s_waitcnt lgkmcnt(12)
    v_mfma_f32_16x16x32_bf16 v[128:131], v[192:195], a[32:35], v[128:131]
    ds_read_b128 a[0:3], v228 offset:25600
    v_mfma_f32_16x16x32_bf16 v[128:131], v[196:199], a[48:51], v[128:131]
    ds_read_b128 a[4:7], v228 offset:24576
    v_mfma_f32_16x16x32_bf16 v[112:115], v[192:195], a[36:39], v[112:115]
    ds_read_b128 a[16:19], v8 offset:1024
    v_mfma_f32_16x16x32_bf16 v[112:115], v[196:199], a[52:55], v[112:115]
    ds_read_b128 a[20:23], v8 offset:0
    v_mfma_f32_16x16x32_bf16 v[96:99], v[192:195], a[40:43], v[96:99]
    ds_read_b64_tr_b16 v[16:17], v224 offset:24576
    v_mfma_f32_16x16x32_bf16 v[96:99], v[196:199], a[56:59], v[96:99]
    s_waitcnt lgkmcnt(13)
    ds_read_b64_tr_b16 v[18:19], v224 offset:26624
    v_mfma_f32_16x16x32_bf16 v[132:135], v[200:203], a[32:35], v[132:135]
    ds_read_b64_tr_b16 v[20:21], v4 offset:0
    v_mfma_f32_16x16x32_bf16 v[132:135], v[204:207], a[48:51], v[132:135]
    ds_read_b64_tr_b16 v[22:23], v4 offset:2048
    v_mfma_f32_16x16x32_bf16 v[116:119], v[200:203], a[36:39], v[116:119]
    ds_read_b64_tr_b16 v[24:25], v225 offset:24576
    v_mfma_f32_16x16x32_bf16 v[116:119], v[204:207], a[52:55], v[116:119]
    ds_read_b64_tr_b16 v[26:27], v225 offset:26624
    buffer_store_dwordx4 v[176:179], v1, s[20:23], s55 offen offset:0 sc0 sc1
    v_mfma_f32_16x16x32_bf16 v[100:103], v[200:203], a[40:43], v[100:103]
    ds_read_b64_tr_b16 v[28:29], v5 offset:0
    v_mfma_f32_16x16x32_bf16 v[100:103], v[204:207], a[56:59], v[100:103]
    s_waitcnt lgkmcnt(15)
    ds_read_b64_tr_b16 v[30:31], v5 offset:2048
    v_mfma_f32_16x16x32_bf16 v[136:139], v[208:211], a[32:35], v[136:139]
    ds_read_b64_tr_b16 v[32:33], v226 offset:24576
    buffer_store_dwordx4 v[180:183], v1, s[20:23], s55 offen offset:1024 sc0 sc1
    v_mfma_f32_16x16x32_bf16 v[136:139], v[212:215], a[48:51], v[136:139]
    ds_read_b64_tr_b16 v[34:35], v226 offset:26624
    v_cvt_pk_bf16_f32 v160, v160, v161
    v_mfma_f32_16x16x32_bf16 v[120:123], v[208:211], a[36:39], v[120:123]
    ds_read_b64_tr_b16 v[36:37], v6 offset:0
    v_cvt_pk_bf16_f32 v161, v162, v163
    v_mfma_f32_16x16x32_bf16 v[120:123], v[212:215], a[52:55], v[120:123]
    ds_read_b64_tr_b16 v[38:39], v6 offset:2048
    v_cvt_pk_bf16_f32 v162, v164, v165
    v_mfma_f32_16x16x32_bf16 v[104:107], v[208:211], a[40:43], v[104:107]
    ds_read_b64_tr_b16 v[40:41], v227 offset:24576
    v_cvt_pk_bf16_f32 v163, v166, v167
    v_mfma_f32_16x16x32_bf16 v[104:107], v[212:215], a[56:59], v[104:107]
    s_waitcnt lgkmcnt(15)
    ds_read_b64_tr_b16 v[42:43], v227 offset:26624
    v_cvt_pk_bf16_f32 v164, v168, v169
    v_mfma_f32_16x16x32_bf16 v[140:143], v[216:219], a[32:35], v[140:143]
    ds_read_b64_tr_b16 v[44:45], v7 offset:0
    v_cvt_pk_bf16_f32 v165, v170, v171
    v_mfma_f32_16x16x32_bf16 v[140:143], v[220:223], a[48:51], v[140:143]
    ds_read_b64_tr_b16 v[46:47], v7 offset:2048
    v_cvt_pk_bf16_f32 v166, v172, v173
    v_mfma_f32_16x16x32_bf16 v[124:127], v[216:219], a[36:39], v[124:127]
    v_cvt_pk_bf16_f32 v167, v174, v175
    v_mfma_f32_16x16x32_bf16 v[124:127], v[220:223], a[52:55], v[124:127]
    v_mfma_f32_16x16x32_bf16 v[108:111], v[216:219], a[40:43], v[108:111]
    buffer_store_dwordx4 v[160:163], v1, s[20:23], s54 offen offset:0 sc0 sc1
    v_mfma_f32_16x16x32_bf16 v[108:111], v[220:223], a[56:59], v[108:111]
    s_waitcnt lgkmcnt(12)
    buffer_store_dwordx4 v[164:167], v1, s[20:23], s54 offen offset:1024 sc0 sc1
    v_mfma_f32_16x16x32_bf16 v[80:83], v[16:19], a[0:3], v[80:83]
    ds_read_b128 a[32:35], v8 offset:25600
    ds_read_b128 a[36:39], v8 offset:24576
    v_mfma_f32_16x16x32_bf16 v[80:83], v[20:23], a[16:19], v[80:83]
    ds_read_b128 a[48:51], v14 offset:1024
    v_cvt_pk_bf16_f32 v144, v144, v145
    v_mfma_f32_16x16x32_bf16 v[64:67], v[16:19], a[4:7], v[64:67]
    ds_read_b128 a[52:55], v14 offset:0
    v_cvt_pk_bf16_f32 v145, v146, v147
    v_mfma_f32_16x16x32_bf16 v[64:67], v[20:23], a[20:23], v[64:67]
    s_waitcnt lgkmcnt(12)
    ds_read_b64_tr_b16 v[192:193], v4 offset:24576
    v_cvt_pk_bf16_f32 v146, v148, v149
    v_mfma_f32_16x16x32_bf16 v[84:87], v[24:27], a[0:3], v[84:87]
    ds_read_b64_tr_b16 v[194:195], v4 offset:26624
    ds_read_b64_tr_b16 v[196:197], v10 offset:0
    v_mfma_f32_16x16x32_bf16 v[84:87], v[28:31], a[16:19], v[84:87]
    ds_read_b64_tr_b16 v[198:199], v10 offset:2048
    v_cvt_pk_bf16_f32 v147, v150, v151
    v_mfma_f32_16x16x32_bf16 v[68:71], v[24:27], a[4:7], v[68:71]
    ds_read_b64_tr_b16 v[200:201], v5 offset:24576
    v_cvt_pk_bf16_f32 v148, v152, v153
    v_mfma_f32_16x16x32_bf16 v[68:71], v[28:31], a[20:23], v[68:71]
    s_waitcnt lgkmcnt(13)
    ds_read_b64_tr_b16 v[202:203], v5 offset:26624
    v_cvt_pk_bf16_f32 v149, v154, v155
    v_mfma_f32_16x16x32_bf16 v[88:91], v[32:35], a[0:3], v[88:91]
    ds_read_b64_tr_b16 v[204:205], v11 offset:0
    ds_read_b64_tr_b16 v[206:207], v11 offset:2048
    v_mfma_f32_16x16x32_bf16 v[88:91], v[36:39], a[16:19], v[88:91]
    ds_read_b64_tr_b16 v[208:209], v6 offset:24576
    v_cvt_pk_bf16_f32 v150, v156, v157
    v_mfma_f32_16x16x32_bf16 v[72:75], v[32:35], a[4:7], v[72:75]
    ds_read_b64_tr_b16 v[210:211], v6 offset:26624
    v_cvt_pk_bf16_f32 v151, v158, v159
    v_mfma_f32_16x16x32_bf16 v[72:75], v[36:39], a[20:23], v[72:75]
    s_waitcnt lgkmcnt(14)
    ds_read_b64_tr_b16 v[212:213], v12 offset:0
    v_mfma_f32_16x16x32_bf16 v[92:95], v[40:43], a[0:3], v[92:95]
    ds_read_b64_tr_b16 v[214:215], v12 offset:2048
    ds_read_b64_tr_b16 v[216:217], v7 offset:24576
    v_mfma_f32_16x16x32_bf16 v[92:95], v[44:47], a[16:19], v[92:95]
    ds_read_b64_tr_b16 v[218:219], v7 offset:26624
    buffer_store_dwordx4 v[144:147], v1, s[20:23], s53 offen offset:0 sc0 sc1
    v_mfma_f32_16x16x32_bf16 v[76:79], v[40:43], a[4:7], v[76:79]
    ds_read_b64_tr_b16 v[220:221], v13 offset:0
    v_mfma_f32_16x16x32_bf16 v[76:79], v[44:47], a[20:23], v[76:79]
    s_waitcnt lgkmcnt(11)
    ds_read_b64_tr_b16 v[222:223], v13 offset:2048
    v_mfma_f32_16x16x32_bf16 v[80:83], v[192:195], a[32:35], v[80:83]
    ds_read_b128 a[0:3], v14 offset:25600
    ds_read_b128 a[4:7], v14 offset:24576
    v_mfma_f32_16x16x32_bf16 v[80:83], v[196:199], a[48:51], v[80:83]
    ds_read_b128 a[16:19], v228 offset:1024
    buffer_store_dwordx4 v[148:151], v1, s[20:23], s53 offen offset:1024 sc0 sc1
    v_mfma_f32_16x16x32_bf16 v[64:67], v[192:195], a[36:39], v[64:67]
    ds_read_b128 a[20:23], v228 offset:0
    v_cvt_pk_bf16_f32 v128, v128, v129
    v_mfma_f32_16x16x32_bf16 v[64:67], v[196:199], a[52:55], v[64:67]
    s_waitcnt lgkmcnt(12)
    ds_read_b64_tr_b16 v[16:17], v10 offset:24576
    v_cvt_pk_bf16_f32 v129, v130, v131
    v_mfma_f32_16x16x32_bf16 v[84:87], v[200:203], a[32:35], v[84:87]
    ds_read_b64_tr_b16 v[18:19], v10 offset:26624
    ds_read_b64_tr_b16 v[20:21], v224 offset:0
    v_mfma_f32_16x16x32_bf16 v[84:87], v[204:207], a[48:51], v[84:87]
    ds_read_b64_tr_b16 v[22:23], v224 offset:2048
    v_cvt_pk_bf16_f32 v130, v132, v133
    v_mfma_f32_16x16x32_bf16 v[68:71], v[200:203], a[36:39], v[68:71]
    ds_read_b64_tr_b16 v[24:25], v11 offset:24576
    v_cvt_pk_bf16_f32 v131, v134, v135
    v_mfma_f32_16x16x32_bf16 v[68:71], v[204:207], a[52:55], v[68:71]
    s_waitcnt lgkmcnt(13)
    ds_read_b64_tr_b16 v[26:27], v11 offset:26624
    v_cvt_pk_bf16_f32 v132, v136, v137
    v_mfma_f32_16x16x32_bf16 v[88:91], v[208:211], a[32:35], v[88:91]
    ds_read_b64_tr_b16 v[28:29], v225 offset:0
    ds_read_b64_tr_b16 v[30:31], v225 offset:2048
    v_mfma_f32_16x16x32_bf16 v[88:91], v[212:215], a[48:51], v[88:91]
    ds_read_b64_tr_b16 v[32:33], v12 offset:24576
    v_cvt_pk_bf16_f32 v133, v138, v139
    v_mfma_f32_16x16x32_bf16 v[72:75], v[208:211], a[36:39], v[72:75]
    ds_read_b64_tr_b16 v[34:35], v12 offset:26624
    v_cvt_pk_bf16_f32 v134, v140, v141
    v_mfma_f32_16x16x32_bf16 v[72:75], v[212:215], a[52:55], v[72:75]
    s_waitcnt lgkmcnt(14)
    ds_read_b64_tr_b16 v[36:37], v226 offset:0
    v_cvt_pk_bf16_f32 v135, v142, v143
    v_mfma_f32_16x16x32_bf16 v[92:95], v[216:219], a[32:35], v[92:95]
    ds_read_b64_tr_b16 v[38:39], v226 offset:2048
    ds_read_b64_tr_b16 v[40:41], v13 offset:24576
    v_mfma_f32_16x16x32_bf16 v[92:95], v[220:223], a[48:51], v[92:95]
    ds_read_b64_tr_b16 v[42:43], v13 offset:26624
    v_mfma_f32_16x16x32_bf16 v[76:79], v[216:219], a[36:39], v[76:79]
    ds_read_b64_tr_b16 v[44:45], v227 offset:0
    v_mfma_f32_16x16x32_bf16 v[76:79], v[220:223], a[52:55], v[76:79]
    s_waitcnt lgkmcnt(11)
    ds_read_b64_tr_b16 v[46:47], v227 offset:2048
    buffer_store_dwordx4 v[128:131], v1, s[20:23], s52 offen offset:0 sc0 sc1
    v_mfma_f32_16x16x32_bf16 v[80:83], v[16:19], a[0:3], v[80:83]
    v_mfma_f32_16x16x32_bf16 v[80:83], v[20:23], a[16:19], v[80:83]
    buffer_store_dwordx4 v[132:135], v1, s[20:23], s52 offen offset:1024 sc0 sc1
    v_mfma_f32_16x16x32_bf16 v[64:67], v[16:19], a[4:7], v[64:67]
    v_cvt_pk_bf16_f32 v112, v112, v113
    v_cvt_pk_bf16_f32 v113, v114, v115
    v_mfma_f32_16x16x32_bf16 v[64:67], v[20:23], a[20:23], v[64:67]
    s_waitcnt lgkmcnt(8)
    v_cvt_pk_bf16_f32 v114, v116, v117
    v_cvt_pk_bf16_f32 v115, v118, v119
    v_mfma_f32_16x16x32_bf16 v[84:87], v[24:27], a[0:3], v[84:87]
    v_cvt_pk_bf16_f32 v116, v120, v121
    v_cvt_pk_bf16_f32 v117, v122, v123
    v_mfma_f32_16x16x32_bf16 v[84:87], v[28:31], a[16:19], v[84:87]
    v_cvt_pk_bf16_f32 v118, v124, v125
    v_cvt_pk_bf16_f32 v119, v126, v127
    v_mfma_f32_16x16x32_bf16 v[68:71], v[24:27], a[4:7], v[68:71]
    v_mfma_f32_16x16x32_bf16 v[68:71], v[28:31], a[20:23], v[68:71]
    s_waitcnt lgkmcnt(4)
    buffer_store_dwordx4 v[112:115], v1, s[20:23], s51 offen offset:0 sc0 sc1
    v_mfma_f32_16x16x32_bf16 v[88:91], v[32:35], a[0:3], v[88:91]
    buffer_store_dwordx4 v[116:119], v1, s[20:23], s51 offen offset:1024 sc0 sc1
    v_mfma_f32_16x16x32_bf16 v[88:91], v[36:39], a[16:19], v[88:91]
    v_cvt_pk_bf16_f32 v96, v96, v97
    v_cvt_pk_bf16_f32 v97, v98, v99
    v_mfma_f32_16x16x32_bf16 v[72:75], v[32:35], a[4:7], v[72:75]
    v_cvt_pk_bf16_f32 v98, v100, v101
    v_cvt_pk_bf16_f32 v99, v102, v103
    v_mfma_f32_16x16x32_bf16 v[72:75], v[36:39], a[20:23], v[72:75]
    s_waitcnt lgkmcnt(0)
    v_cvt_pk_bf16_f32 v100, v104, v105
    v_cvt_pk_bf16_f32 v101, v106, v107
    v_mfma_f32_16x16x32_bf16 v[92:95], v[40:43], a[0:3], v[92:95]
    v_cvt_pk_bf16_f32 v102, v108, v109
    v_cvt_pk_bf16_f32 v103, v110, v111
    v_mfma_f32_16x16x32_bf16 v[92:95], v[44:47], a[16:19], v[92:95]
    v_mfma_f32_16x16x32_bf16 v[76:79], v[40:43], a[4:7], v[76:79]
    buffer_store_dwordx4 v[96:99], v1, s[20:23], s50 offen offset:0 sc0 sc1
    v_mfma_f32_16x16x32_bf16 v[76:79], v[44:47], a[20:23], v[76:79]
    buffer_store_dwordx4 v[100:103], v1, s[20:23], s50 offen offset:1024 sc0 sc1
    s_nop 5
    v_cvt_pk_bf16_f32 v80, v80, v81
    v_cvt_pk_bf16_f32 v81, v82, v83
    v_cvt_pk_bf16_f32 v82, v84, v85
    v_cvt_pk_bf16_f32 v83, v86, v87
    v_cvt_pk_bf16_f32 v84, v88, v89
    v_cvt_pk_bf16_f32 v85, v90, v91
    v_cvt_pk_bf16_f32 v86, v92, v93
    v_cvt_pk_bf16_f32 v87, v94, v95
    buffer_store_dwordx4 v[80:83], v1, s[20:23], s49 offen offset:0 sc0 sc1
    buffer_store_dwordx4 v[84:87], v1, s[20:23], s49 offen offset:1024 sc0 sc1
    v_lshlrev_b32 v248, 16, v48
    v_lshlrev_b32 v249, 16, v56
    v_add_f32 v16, v248, v249
    v_and_b32 v248, 0xffff0000, v48
    v_and_b32 v249, 0xffff0000, v56
    v_add_f32 v17, v248, v249
    v_lshlrev_b32 v248, 16, v49
    v_lshlrev_b32 v249, 16, v57
    v_add_f32 v18, v248, v249
    v_and_b32 v248, 0xffff0000, v49
    v_and_b32 v249, 0xffff0000, v57
    v_add_f32 v19, v248, v249
    v_lshlrev_b32 v248, 16, v50
    v_lshlrev_b32 v249, 16, v58
    v_add_f32 v20, v248, v249
    v_and_b32 v248, 0xffff0000, v50
    v_and_b32 v249, 0xffff0000, v58
    v_add_f32 v21, v248, v249
    v_lshlrev_b32 v248, 16, v51
    v_lshlrev_b32 v249, 16, v59
    v_add_f32 v22, v248, v249
    v_and_b32 v248, 0xffff0000, v51
    v_and_b32 v249, 0xffff0000, v59
    v_add_f32 v23, v248, v249
    v_lshlrev_b32 v248, 16, v52
    v_lshlrev_b32 v249, 16, v60
    v_add_f32 v24, v248, v249
    v_and_b32 v248, 0xffff0000, v52
    v_and_b32 v249, 0xffff0000, v60
    v_add_f32 v25, v248, v249
    v_lshlrev_b32 v248, 16, v53
    v_lshlrev_b32 v249, 16, v61
    v_add_f32 v26, v248, v249
    v_and_b32 v248, 0xffff0000, v53
    v_and_b32 v249, 0xffff0000, v61
    v_add_f32 v27, v248, v249
    v_lshlrev_b32 v248, 16, v54
    v_lshlrev_b32 v249, 16, v62
    v_add_f32 v28, v248, v249
    v_and_b32 v248, 0xffff0000, v54
    v_and_b32 v249, 0xffff0000, v62
    v_add_f32 v29, v248, v249
    v_lshlrev_b32 v248, 16, v55
    v_lshlrev_b32 v249, 16, v63
    v_add_f32 v30, v248, v249
    v_and_b32 v248, 0xffff0000, v55
    v_and_b32 v249, 0xffff0000, v63
    v_add_f32 v31, v248, v249
    s_lshl_b32 s4, s68, 13
    s_add_u32 s4, s4, s7
    s_add_u32 s3, s68, 1
    s_and_b32 s3, s3, 7
    s_lshl_b32 s3, s3, 16
    s_add_u32 s48, s3, s4
    s_add_u32 s3, s68, 2
    s_and_b32 s3, s3, 7
    s_lshl_b32 s3, s3, 16
    s_add_u32 s49, s3, s4
    s_add_u32 s3, s68, 3
    s_and_b32 s3, s3, 7
    s_lshl_b32 s3, s3, 16
    s_add_u32 s50, s3, s4
    s_add_u32 s3, s68, 4
    s_and_b32 s3, s3, 7
    s_lshl_b32 s3, s3, 16
    s_add_u32 s51, s3, s4
    s_add_u32 s3, s68, 5
    s_and_b32 s3, s3, 7
    s_lshl_b32 s3, s3, 16
    s_add_u32 s52, s3, s4
    s_add_u32 s3, s68, 6
    s_and_b32 s3, s3, 7
    s_lshl_b32 s3, s3, 16
    s_add_u32 s53, s3, s4
    s_add_u32 s3, s68, 7
    s_and_b32 s3, s3, 7
    s_lshl_b32 s3, s3, 16
    s_add_u32 s54, s3, s4
    v_mov_b32 v250, 0x3f80
    v_mov_b32 v251, 0x3f800000
    s_mov_b32 s56, 0xffffff80
    s_mov_b32 s7, 32768
    buffer_load_dword v254, v253, s[36:39], s6 offen sc1
    s_waitcnt vmcnt(0)
    buffer_store_dword v0, v255, s[36:39], s5 offen sc0 sc1
k3_gl:
    v_cmp_ne_u32 vcc, 0, v254
    s_nop 3
    s_andn2_b32 s57, vcc_lo, s56
    s_or_b32 s56, s56, s57
    s_bitcmp0_b32 s57, 0
    s_cbranch_scc1 k3_ga0
    buffer_load_dwordx4 v[192:195], v1, s[20:23], s48 offen offset:0 sc0 sc1
    buffer_load_dwordx4 v[196:199], v1, s[20:23], s48 offen offset:1024 sc0 sc1
k3_ga0:
    s_bitcmp0_b32 s57, 1
    s_cbranch_scc1 k3_ga1
    buffer_load_dwordx4 v[200:203], v1, s[20:23], s49 offen offset:0 sc0 sc1
    buffer_load_dwordx4 v[204:207], v1, s[20:23], s49 offen offset:1024 sc0 sc1
k3_ga1:
    s_bitcmp0_b32 s57, 2
    s_cbranch_scc1 k3_ga2
    buffer_load_dwordx4 v[208:211], v1, s[20:23], s50 offen offset:0 sc0 sc1
    buffer_load_dwordx4 v[212:215], v1, s[20:23], s50 offen offset:1024 sc0 sc1
k3_ga2:
    s_bitcmp0_b32 s57, 3
    s_cbranch_scc1 k3_ga3
    buffer_load_dwordx4 v[216:219], v1, s[20:23], s51 offen offset:0 sc0 sc1
    buffer_load_dwordx4 v[220:223], v1, s[20:23], s51 offen offset:1024 sc0 sc1
k3_ga3:
    s_bitcmp0_b32 s57, 4
    s_cbranch_scc1 k3_ga4
    buffer_load_dwordx4 v[224:227], v1, s[20:23], s52 offen offset:0 sc0 sc1
    buffer_load_dwordx4 v[228:231], v1, s[20:23], s52 offen offset:1024 sc0 sc1
k3_ga4:
    s_bitcmp0_b32 s57, 5
    s_cbranch_scc1 k3_ga5
    buffer_load_dwordx4 v[232:235], v1, s[20:23], s53 offen offset:0 sc0 sc1
    buffer_load_dwordx4 v[236:239], v1, s[20:23], s53 offen offset:1024 sc0 sc1
k3_ga5:
    s_bitcmp0_b32 s57, 6
    s_cbranch_scc1 k3_ga6
    buffer_load_dwordx4 v[240:243], v1, s[20:23], s54 offen offset:0 sc0 sc1
    buffer_load_dwordx4 v[244:247], v1, s[20:23], s54 offen offset:1024 sc0 sc1
k3_ga6:
    s_cmp_eq_u32 s56, -1
    s_cbranch_scc1 k3_gd
    buffer_load_dword v254, v253, s[36:39], s6 offen sc1
    s_waitcnt vmcnt(0)
    s_sub_u32 s7, s7, 1
    s_cbranch_scc0 k3_gl
k3_gd:
    s_waitcnt vmcnt(0)
    v_dot2_f32_bf16 v64, v192, v250, v64
    v_dot2_f32_bf16 v65, v192, v251, v65
    v_dot2_f32_bf16 v66, v193, v250, v66
    v_dot2_f32_bf16 v67, v193, v251, v67
    v_dot2_f32_bf16 v68, v194, v250, v68
    v_dot2_f32_bf16 v69, v194, v251, v69
    v_dot2_f32_bf16 v70, v195, v250, v70
    v_dot2_f32_bf16 v71, v195, v251, v71
    v_dot2_f32_bf16 v72, v196, v250, v72
    v_dot2_f32_bf16 v73, v196, v251, v73
    v_dot2_f32_bf16 v74, v197, v250, v74
    v_dot2_f32_bf16 v75, v197, v251, v75
    v_dot2_f32_bf16 v76, v198, v250, v76
    v_dot2_f32_bf16 v77, v198, v251, v77
    v_dot2_f32_bf16 v78, v199, v250, v78
    v_dot2_f32_bf16 v79, v199, v251, v79
    v_dot2_f32_bf16 v64, v200, v250, v64
    v_dot2_f32_bf16 v65, v200, v251, v65
    v_dot2_f32_bf16 v66, v201, v250, v66
    v_dot2_f32_bf16 v67, v201, v251, v67
    v_dot2_f32_bf16 v68, v202, v250, v68
    v_dot2_f32_bf16 v69, v202, v251, v69
    v_dot2_f32_bf16 v70, v203, v250, v70
    v_dot2_f32_bf16 v71, v203, v251, v71
    v_dot2_f32_bf16 v72, v204, v250, v72
    v_dot2_f32_bf16 v73, v204, v251, v73
    v_dot2_f32_bf16 v74, v205, v250, v74
    v_dot2_f32_bf16 v75, v205, v251, v75
    v_dot2_f32_bf16 v76, v206, v250, v76
    v_dot2_f32_bf16 v77, v206, v251, v77
    v_dot2_f32_bf16 v78, v207, v250, v78
    v_dot2_f32_bf16 v79, v207, v251, v79
    v_dot2_f32_bf16 v64, v208, v250, v64
    v_dot2_f32_bf16 v65, v208, v251, v65
    v_dot2_f32_bf16 v66, v209, v250, v66
    v_dot2_f32_bf16 v67, v209, v251, v67
    v_dot2_f32_bf16 v68, v210, v250, v68
    v_dot2_f32_bf16 v69, v210, v251, v69
    v_dot2_f32_bf16 v70, v211, v250, v70
    v_dot2_f32_bf16 v71, v211, v251, v71
    v_dot2_f32_bf16 v72, v212, v250, v72
    v_dot2_f32_bf16 v73, v212, v251, v73
    v_dot2_f32_bf16 v74, v213, v250, v74
    v_dot2_f32_bf16 v75, v213, v251, v75
    v_dot2_f32_bf16 v76, v214, v250, v76
    v_dot2_f32_bf16 v77, v214, v251, v77
    v_dot2_f32_bf16 v78, v215, v250, v78
    v_dot2_f32_bf16 v79, v215, v251, v79
    v_dot2_f32_bf16 v64, v216, v250, v64
    v_dot2_f32_bf16 v65, v216, v251, v65
    v_dot2_f32_bf16 v66, v217, v250, v66
    v_dot2_f32_bf16 v67, v217, v251, v67
    v_dot2_f32_bf16 v68, v218, v250, v68
    v_dot2_f32_bf16 v69, v218, v251, v69
    v_dot2_f32_bf16 v70, v219, v250, v70
    v_dot2_f32_bf16 v71, v219, v251, v71
    v_dot2_f32_bf16 v72, v220, v250, v72
    v_dot2_f32_bf16 v73, v220, v251, v73
    v_dot2_f32_bf16 v74, v221, v250, v74
    v_dot2_f32_bf16 v75, v221, v251, v75
    v_dot2_f32_bf16 v76, v222, v250, v76
    v_dot2_f32_bf16 v77, v222, v251, v77
    v_dot2_f32_bf16 v78, v223, v250, v78
    v_dot2_f32_bf16 v79, v223, v251, v79
    v_dot2_f32_bf16 v64, v224, v250, v64
    v_dot2_f32_bf16 v65, v224, v251, v65
    v_dot2_f32_bf16 v66, v225, v250, v66
    v_dot2_f32_bf16 v67, v225, v251, v67
    v_dot2_f32_bf16 v68, v226, v250, v68
    v_dot2_f32_bf16 v69, v226, v251, v69
    v_dot2_f32_bf16 v70, v227, v250, v70
    v_dot2_f32_bf16 v71, v227, v251, v71
    v_dot2_f32_bf16 v72, v228, v250, v72
    v_dot2_f32_bf16 v73, v228, v251, v73
    v_dot2_f32_bf16 v74, v229, v250, v74
    v_dot2_f32_bf16 v75, v229, v251, v75
    v_dot2_f32_bf16 v76, v230, v250, v76
    v_dot2_f32_bf16 v77, v230, v251, v77
    v_dot2_f32_bf16 v78, v231, v250, v78
    v_dot2_f32_bf16 v79, v231, v251, v79
    v_dot2_f32_bf16 v64, v232, v250, v64
    v_dot2_f32_bf16 v65, v232, v251, v65
    v_dot2_f32_bf16 v66, v233, v250, v66
    v_dot2_f32_bf16 v67, v233, v251, v67
    v_dot2_f32_bf16 v68, v234, v250, v68
    v_dot2_f32_bf16 v69, v234, v251, v69
    v_dot2_f32_bf16 v70, v235, v250, v70
    v_dot2_f32_bf16 v71, v235, v251, v71
    v_dot2_f32_bf16 v72, v236, v250, v72
    v_dot2_f32_bf16 v73, v236, v251, v73
    v_dot2_f32_bf16 v74, v237, v250, v74
    v_dot2_f32_bf16 v75, v237, v251, v75
    v_dot2_f32_bf16 v76, v238, v250, v76
    v_dot2_f32_bf16 v77, v238, v251, v77
    v_dot2_f32_bf16 v78, v239, v250, v78
    v_dot2_f32_bf16 v79, v239, v251, v79
    v_dot2_f32_bf16 v64, v240, v250, v64
    v_dot2_f32_bf16 v65, v240, v251, v65
    v_dot2_f32_bf16 v66, v241, v250, v66
    v_dot2_f32_bf16 v67, v241, v251, v67
    v_dot2_f32_bf16 v68, v242, v250, v68
    v_dot2_f32_bf16 v69, v242, v251, v69
    v_dot2_f32_bf16 v70, v243, v250, v70
    v_dot2_f32_bf16 v71, v243, v251, v71
    v_dot2_f32_bf16 v72, v244, v250, v72
    v_dot2_f32_bf16 v73, v244, v251, v73
    v_dot2_f32_bf16 v74, v245, v250, v74
    v_dot2_f32_bf16 v75, v245, v251, v75
    v_dot2_f32_bf16 v76, v246, v250, v76
    v_dot2_f32_bf16 v77, v246, v251, v77
    v_dot2_f32_bf16 v78, v247, v250, v78
    v_dot2_f32_bf16 v79, v247, v251, v79
    s_nop 3
    v_permlane16_swap_b32 v64, v68
    v_permlane16_swap_b32 v65, v69
    v_permlane16_swap_b32 v66, v70
    v_permlane16_swap_b32 v67, v71
    v_permlane16_swap_b32 v72, v76
    v_permlane16_swap_b32 v73, v77
    v_permlane16_swap_b32 v74, v78
    v_permlane16_swap_b32 v75, v79
    v_add_f32 v64, v64, v16
    v_add_f32 v65, v65, v17
    v_add_f32 v66, v66, v18
    v_add_f32 v67, v67, v19
    v_add_f32 v68, v68, v20
    v_add_f32 v69, v69, v21
    v_add_f32 v70, v70, v22
    v_add_f32 v71, v71, v23
    v_add_f32 v72, v72, v24
    v_add_f32 v73, v73, v25
    v_add_f32 v74, v74, v26
    v_add_f32 v75, v75, v27
    v_add_f32 v76, v76, v28
    v_add_f32 v77, v77, v29
    v_add_f32 v78, v78, v30
    v_add_f32 v79, v79, v31
    v_cvt_pk_bf16_f32 v192, v64, v65
    v_cvt_pk_bf16_f32 v193, v66, v67
    v_cvt_pk_bf16_f32 v194, v68, v69
    v_cvt_pk_bf16_f32 v195, v70, v71
    buffer_store_dwordx4 v[192:195], v15, s[64:67], 0 offen offset:0
    v_cvt_pk_bf16_f32 v196, v72, v73
    v_cvt_pk_bf16_f32 v197, v74, v75
    v_cvt_pk_bf16_f32 v198, v76, v77
    v_cvt_pk_bf16_f32 v199, v78, v79
    buffer_store_dwordx4 v[196:199], v15, s[64:67], 0 offen offset:64
L_end:
    s_endpgm
k2_fb0:
    s_call_b64 s[58:59], k2_FB0
    s_branch k2_r0
k2_fb1:
    s_call_b64 s[58:59], k2_FB1
    s_branch k2_r1
k2_fb2:
    s_call_b64 s[58:59], k2_FB0
    s_branch k2_r2
k2_fb3:
    s_call_b64 s[58:59], k2_FB1
    s_branch k2_r3
k2_fb4:
    s_call_b64 s[58:59], k2_FB0
    s_branch k2_r4
k2_fb5:
    s_call_b64 s[58:59], k2_FB1
    s_branch k2_r5
k2_fb6:
    s_call_b64 s[58:59], k2_FB0
    s_branch k2_r6
k2_fb7:
    s_call_b64 s[58:59], k2_FB1
    s_branch k2_r7
k2_fb8:
    s_call_b64 s[58:59], k2_FB0
    s_branch k2_r8
k2_fb9:
    s_call_b64 s[58:59], k2_FB1
    s_branch k2_r9
k2_fb10:
    s_call_b64 s[58:59], k2_FB0
    s_branch k2_r10
k2_fb11:
    s_call_b64 s[58:59], k2_FB1
    s_branch k2_r11
k2_fb12:
    s_call_b64 s[58:59], k2_FB0
    s_branch k2_r12
k2_fb13:
    s_call_b64 s[58:59], k2_FB1
    s_branch k2_r13
k2_fb14:
    s_call_b64 s[58:59], k2_FB0
    s_branch k2_r14
k2_fb15:
    s_call_b64 s[58:59], k2_FB1
    s_branch k2_r15
k2_FB0:
    s_nop 7
    v_max3_f32 v10, v224, v225, v226
    v_max3_f32 v10, v10, v227, v240
    v_max3_f32 v10, v10, v241, v242
    v_max_f32 v10, v10, v243
    v_mov_b32 v11, v10
    s_nop 1
    v_permlane16_swap_b32 v10, v11
    v_max_f32 v10, v10, v11
    v_mov_b32 v11, v10
    s_nop 1
    v_permlane32_swap_b32 v10, v11
    v_max_f32 v10, v10, v11
    v_add_f32 v10, 0x42200000, v10
    v_max_f32 v10, 0, v10
    v_exp_f32 v11, -v10
    v_sub_f32 v160, v160, v10
    v_sub_f32 v161, v161, v10
    v_sub_f32 v162, v162, v10
    v_sub_f32 v163, v163, v10
    v_mul_f32 v2, v2, v11
    v_sub_f32 v224, v224, v10
    v_sub_f32 v225, v225, v10
    v_sub_f32 v226, v226, v10
    v_sub_f32 v227, v227, v10
    v_sub_f32 v240, v240, v10
    v_sub_f32 v241, v241, v10
    v_sub_f32 v242, v242, v10
    v_sub_f32 v243, v243, v10
    v_sub_f32 v96, v96, v10
    v_sub_f32 v97, v97, v10
    v_sub_f32 v98, v98, v10
    v_sub_f32 v99, v99, v10
    v_sub_f32 v112, v112, v10
    v_sub_f32 v113, v113, v10
    v_sub_f32 v114, v114, v10
    v_sub_f32 v115, v115, v10
    v_accvgpr_read_b32 v32, a0
    v_accvgpr_read_b32 v33, a1
    v_accvgpr_read_b32 v34, a2
    v_accvgpr_read_b32 v35, a3
    v_mul_f32 v32, v32, v11
    v_mul_f32 v33, v33, v11
    v_mul_f32 v34, v34, v11
    v_mul_f32 v35, v35, v11
    v_accvgpr_write_b32 a0, v32
    v_accvgpr_write_b32 a1, v33
    v_accvgpr_write_b32 a2, v34
    v_accvgpr_write_b32 a3, v35
    v_accvgpr_read_b32 v32, a4
    v_accvgpr_read_b32 v33, a5
    v_accvgpr_read_b32 v34, a6
    v_accvgpr_read_b32 v35, a7
    v_mul_f32 v32, v32, v11
    v_mul_f32 v33, v33, v11
    v_mul_f32 v34, v34, v11
    v_mul_f32 v35, v35, v11
    v_accvgpr_write_b32 a4, v32
    v_accvgpr_write_b32 a5, v33
    v_accvgpr_write_b32 a6, v34
    v_accvgpr_write_b32 a7, v35
    v_accvgpr_read_b32 v32, a8
    v_accvgpr_read_b32 v33, a9
    v_accvgpr_read_b32 v34, a10
    v_accvgpr_read_b32 v35, a11
    v_mul_f32 v32, v32, v11
    v_mul_f32 v33, v33, v11
    v_mul_f32 v34, v34, v11
    v_mul_f32 v35, v35, v11
    v_accvgpr_write_b32 a8, v32
    v_accvgpr_write_b32 a9, v33
    v_accvgpr_write_b32 a10, v34
    v_accvgpr_write_b32 a11, v35
    v_accvgpr_read_b32 v32, a12
    v_accvgpr_read_b32 v33, a13
    v_accvgpr_read_b32 v34, a14
    v_accvgpr_read_b32 v35, a15
    v_mul_f32 v32, v32, v11
    v_mul_f32 v33, v33, v11
    v_mul_f32 v34, v34, v11
    v_mul_f32 v35, v35, v11
    v_accvgpr_write_b32 a12, v32
    v_accvgpr_write_b32 a13, v33
    v_accvgpr_write_b32 a14, v34
    v_accvgpr_write_b32 a15, v35
    v_accvgpr_read_b32 v32, a16
    v_accvgpr_read_b32 v33, a17
    v_accvgpr_read_b32 v34, a18
    v_accvgpr_read_b32 v35, a19
    v_mul_f32 v32, v32, v11
    v_mul_f32 v33, v33, v11
    v_mul_f32 v34, v34, v11
    v_mul_f32 v35, v35, v11
    v_accvgpr_write_b32 a16, v32
    v_accvgpr_write_b32 a17, v33
    v_accvgpr_write_b32 a18, v34
    v_accvgpr_write_b32 a19, v35
    v_accvgpr_read_b32 v32, a20
    v_accvgpr_read_b32 v33, a21
    v_accvgpr_read_b32 v34, a22
    v_accvgpr_read_b32 v35, a23
    v_mul_f32 v32, v32, v11
    v_mul_f32 v33, v33, v11
    v_mul_f32 v34, v34, v11
    v_mul_f32 v35, v35, v11
    v_accvgpr_write_b32 a20, v32
    v_accvgpr_write_b32 a21, v33
    v_accvgpr_write_b32 a22, v34
    v_accvgpr_write_b32 a23, v35
    v_accvgpr_read_b32 v32, a24
    v_accvgpr_read_b32 v33, a25
    v_accvgpr_read_b32 v34, a26
    v_accvgpr_read_b32 v35, a27
    v_mul_f32 v32, v32, v11
    v_mul_f32 v33, v33, v11
    v_mul_f32 v34, v34, v11
    v_mul_f32 v35, v35, v11
    v_accvgpr_write_b32 a24, v32
    v_accvgpr_write_b32 a25, v33
    v_accvgpr_write_b32 a26, v34
    v_accvgpr_write_b32 a27, v35
    v_accvgpr_read_b32 v32, a28
    v_accvgpr_read_b32 v33, a29
    v_accvgpr_read_b32 v34, a30
    v_accvgpr_read_b32 v35, a31
    v_mul_f32 v32, v32, v11
    v_mul_f32 v33, v33, v11
    v_mul_f32 v34, v34, v11
    v_mul_f32 v35, v35, v11
    v_accvgpr_write_b32 a28, v32
    v_accvgpr_write_b32 a29, v33
    v_accvgpr_write_b32 a30, v34
    v_accvgpr_write_b32 a31, v35
    v_accvgpr_read_b32 v32, a48
    v_accvgpr_read_b32 v33, a49
    v_accvgpr_read_b32 v34, a50
    v_accvgpr_read_b32 v35, a51
    v_mul_f32 v32, v32, v11
    v_mul_f32 v33, v33, v11
    v_mul_f32 v34, v34, v11
    v_mul_f32 v35, v35, v11
    v_accvgpr_write_b32 a48, v32
    v_accvgpr_write_b32 a49, v33
    v_accvgpr_write_b32 a50, v34
    v_accvgpr_write_b32 a51, v35
    v_exp_f32 v32, v224
    v_exp_f32 v33, v225
    v_exp_f32 v34, v226
    v_exp_f32 v35, v227
    v_exp_f32 v36, v240
    v_exp_f32 v37, v241
    v_exp_f32 v38, v242
    v_exp_f32 v39, v243
    v_add_f32 v6, v32, v33
    v_add_f32 v6, v6, v34
    v_add_f32 v6, v6, v35
    v_add_f32 v6, v6, v36
    v_add_f32 v6, v6, v37
    v_add_f32 v6, v6, v38
    v_add_f32 v6, v6, v39
    v_cvt_pk_bf16_f32 v128, v32, v33
    v_cvt_pk_bf16_f32 v129, v34, v35
    v_cvt_pk_bf16_f32 v130, v36, v37
    v_cvt_pk_bf16_f32 v131, v38, v39
    v_max3_f32 v10, v228, v229, v230
    v_max3_f32 v10, v10, v231, v244
    v_max3_f32 v10, v10, v245, v246
    v_max_f32 v10, v10, v247
    v_mov_b32 v11, v10
    s_nop 1
    v_permlane16_swap_b32 v10, v11
    v_max_f32 v10, v10, v11
    v_mov_b32 v11, v10
    s_nop 1
    v_permlane32_swap_b32 v10, v11
    v_max_f32 v10, v10, v11
    v_add_f32 v10, 0x42200000, v10
    v_max_f32 v10, 0, v10
    v_exp_f32 v11, -v10
    v_sub_f32 v164, v164, v10
    v_sub_f32 v165, v165, v10
    v_sub_f32 v166, v166, v10
    v_sub_f32 v167, v167, v10
    v_mul_f32 v3, v3, v11
    v_sub_f32 v228, v228, v10
    v_sub_f32 v229, v229, v10
    v_sub_f32 v230, v230, v10
    v_sub_f32 v231, v231, v10
    v_sub_f32 v244, v244, v10
    v_sub_f32 v245, v245, v10
    v_sub_f32 v246, v246, v10
    v_sub_f32 v247, v247, v10
    v_sub_f32 v100, v100, v10
    v_sub_f32 v101, v101, v10
    v_sub_f32 v102, v102, v10
    v_sub_f32 v103, v103, v10
    v_sub_f32 v116, v116, v10
    v_sub_f32 v117, v117, v10
    v_sub_f32 v118, v118, v10
    v_sub_f32 v119, v119, v10
    v_accvgpr_read_b32 v32, a64
    v_accvgpr_read_b32 v33, a65
    v_accvgpr_read_b32 v34, a66
    v_accvgpr_read_b32 v35, a67
    v_mul_f32 v32, v32, v11
    v_mul_f32 v33, v33, v11
    v_mul_f32 v34, v34, v11
    v_mul_f32 v35, v35, v11
    v_accvgpr_write_b32 a64, v32
    v_accvgpr_write_b32 a65, v33
    v_accvgpr_write_b32 a66, v34
    v_accvgpr_write_b32 a67, v35
    v_accvgpr_read_b32 v32, a68
    v_accvgpr_read_b32 v33, a69
    v_accvgpr_read_b32 v34, a70
    v_accvgpr_read_b32 v35, a71
    v_mul_f32 v32, v32, v11
    v_mul_f32 v33, v33, v11
    v_mul_f32 v34, v34, v11
    v_mul_f32 v35, v35, v11
    v_accvgpr_write_b32 a68, v32
    v_accvgpr_write_b32 a69, v33
    v_accvgpr_write_b32 a70, v34
    v_accvgpr_write_b32 a71, v35
    v_accvgpr_read_b32 v32, a72
    v_accvgpr_read_b32 v33, a73
    v_accvgpr_read_b32 v34, a74
    v_accvgpr_read_b32 v35, a75
    v_mul_f32 v32, v32, v11
    v_mul_f32 v33, v33, v11
    v_mul_f32 v34, v34, v11
    v_mul_f32 v35, v35, v11
    v_accvgpr_write_b32 a72, v32
    v_accvgpr_write_b32 a73, v33
    v_accvgpr_write_b32 a74, v34
    v_accvgpr_write_b32 a75, v35
    v_accvgpr_read_b32 v32, a76
    v_accvgpr_read_b32 v33, a77
    v_accvgpr_read_b32 v34, a78
    v_accvgpr_read_b32 v35, a79
    v_mul_f32 v32, v32, v11
    v_mul_f32 v33, v33, v11
    v_mul_f32 v34, v34, v11
    v_mul_f32 v35, v35, v11
    v_accvgpr_write_b32 a76, v32
    v_accvgpr_write_b32 a77, v33
    v_accvgpr_write_b32 a78, v34
    v_accvgpr_write_b32 a79, v35
    v_accvgpr_read_b32 v32, a80
    v_accvgpr_read_b32 v33, a81
    v_accvgpr_read_b32 v34, a82
    v_accvgpr_read_b32 v35, a83
    v_mul_f32 v32, v32, v11
    v_mul_f32 v33, v33, v11
    v_mul_f32 v34, v34, v11
    v_mul_f32 v35, v35, v11
    v_accvgpr_write_b32 a80, v32
    v_accvgpr_write_b32 a81, v33
    v_accvgpr_write_b32 a82, v34
    v_accvgpr_write_b32 a83, v35
    v_accvgpr_read_b32 v32, a84
    v_accvgpr_read_b32 v33, a85
    v_accvgpr_read_b32 v34, a86
    v_accvgpr_read_b32 v35, a87
    v_mul_f32 v32, v32, v11
    v_mul_f32 v33, v33, v11
    v_mul_f32 v34, v34, v11
    v_mul_f32 v35, v35, v11
    v_accvgpr_write_b32 a84, v32
    v_accvgpr_write_b32 a85, v33
    v_accvgpr_write_b32 a86, v34
    v_accvgpr_write_b32 a87, v35
    v_accvgpr_read_b32 v32, a88
    v_accvgpr_read_b32 v33, a89
    v_accvgpr_read_b32 v34, a90
    v_accvgpr_read_b32 v35, a91
    v_mul_f32 v32, v32, v11
    v_mul_f32 v33, v33, v11
    v_mul_f32 v34, v34, v11
    v_mul_f32 v35, v35, v11
    v_accvgpr_write_b32 a88, v32
    v_accvgpr_write_b32 a89, v33
    v_accvgpr_write_b32 a90, v34
    v_accvgpr_write_b32 a91, v35
    v_accvgpr_read_b32 v32, a92
    v_accvgpr_read_b32 v33, a93
    v_accvgpr_read_b32 v34, a94
    v_accvgpr_read_b32 v35, a95
    v_mul_f32 v32, v32, v11
    v_mul_f32 v33, v33, v11
    v_mul_f32 v34, v34, v11
    v_mul_f32 v35, v35, v11
    v_accvgpr_write_b32 a92, v32
    v_accvgpr_write_b32 a93, v33
    v_accvgpr_write_b32 a94, v34
    v_accvgpr_write_b32 a95, v35
    v_accvgpr_read_b32 v32, a112
    v_accvgpr_read_b32 v33, a113
    v_accvgpr_read_b32 v34, a114
    v_accvgpr_read_b32 v35, a115
    v_mul_f32 v32, v32, v11
    v_mul_f32 v33, v33, v11
    v_mul_f32 v34, v34, v11
    v_mul_f32 v35, v35, v11
    v_accvgpr_write_b32 a112, v32
    v_accvgpr_write_b32 a113, v33
    v_accvgpr_write_b32 a114, v34
    v_accvgpr_write_b32 a115, v35
    v_exp_f32 v32, v228
    v_exp_f32 v33, v229
    v_exp_f32 v34, v230
    v_exp_f32 v35, v231
    v_exp_f32 v36, v244
    v_exp_f32 v37, v245
    v_exp_f32 v38, v246
    v_exp_f32 v39, v247
    v_add_f32 v7, v32, v33
    v_add_f32 v7, v7, v34
    v_add_f32 v7, v7, v35
    v_add_f32 v7, v7, v36
    v_add_f32 v7, v7, v37
    v_add_f32 v7, v7, v38
    v_add_f32 v7, v7, v39
    v_cvt_pk_bf16_f32 v132, v32, v33
    v_cvt_pk_bf16_f32 v133, v34, v35
    v_cvt_pk_bf16_f32 v134, v36, v37
    v_cvt_pk_bf16_f32 v135, v38, v39
    v_max3_f32 v10, v232, v233, v234
    v_max3_f32 v10, v10, v235, v248
    v_max3_f32 v10, v10, v249, v250
    v_max_f32 v10, v10, v251
    v_mov_b32 v11, v10
    s_nop 1
    v_permlane16_swap_b32 v10, v11
    v_max_f32 v10, v10, v11
    v_mov_b32 v11, v10
    s_nop 1
    v_permlane32_swap_b32 v10, v11
    v_max_f32 v10, v10, v11
    v_add_f32 v10, 0x42200000, v10
    v_max_f32 v10, 0, v10
    v_exp_f32 v11, -v10
    v_sub_f32 v168, v168, v10
    v_sub_f32 v169, v169, v10
    v_sub_f32 v170, v170, v10
    v_sub_f32 v171, v171, v10
    v_mul_f32 v4, v4, v11
    v_sub_f32 v232, v232, v10
    v_sub_f32 v233, v233, v10
    v_sub_f32 v234, v234, v10
    v_sub_f32 v235, v235, v10
    v_sub_f32 v248, v248, v10
    v_sub_f32 v249, v249, v10
    v_sub_f32 v250, v250, v10
    v_sub_f32 v251, v251, v10
    v_sub_f32 v104, v104, v10
    v_sub_f32 v105, v105, v10
    v_sub_f32 v106, v106, v10
    v_sub_f32 v107, v107, v10
    v_sub_f32 v120, v120, v10
    v_sub_f32 v121, v121, v10
    v_sub_f32 v122, v122, v10
    v_sub_f32 v123, v123, v10
    v_accvgpr_read_b32 v32, a128
    v_accvgpr_read_b32 v33, a129
    v_accvgpr_read_b32 v34, a130
    v_accvgpr_read_b32 v35, a131
    v_mul_f32 v32, v32, v11
    v_mul_f32 v33, v33, v11
    v_mul_f32 v34, v34, v11
    v_mul_f32 v35, v35, v11
    v_accvgpr_write_b32 a128, v32
    v_accvgpr_write_b32 a129, v33
    v_accvgpr_write_b32 a130, v34
    v_accvgpr_write_b32 a131, v35
    v_accvgpr_read_b32 v32, a132
    v_accvgpr_read_b32 v33, a133
    v_accvgpr_read_b32 v34, a134
    v_accvgpr_read_b32 v35, a135
    v_mul_f32 v32, v32, v11
    v_mul_f32 v33, v33, v11
    v_mul_f32 v34, v34, v11
    v_mul_f32 v35, v35, v11
    v_accvgpr_write_b32 a132, v32
    v_accvgpr_write_b32 a133, v33
    v_accvgpr_write_b32 a134, v34
    v_accvgpr_write_b32 a135, v35
    v_accvgpr_read_b32 v32, a136
    v_accvgpr_read_b32 v33, a137
    v_accvgpr_read_b32 v34, a138
    v_accvgpr_read_b32 v35, a139
    v_mul_f32 v32, v32, v11
    v_mul_f32 v33, v33, v11
    v_mul_f32 v34, v34, v11
    v_mul_f32 v35, v35, v11
    v_accvgpr_write_b32 a136, v32
    v_accvgpr_write_b32 a137, v33
    v_accvgpr_write_b32 a138, v34
    v_accvgpr_write_b32 a139, v35
    v_accvgpr_read_b32 v32, a140
    v_accvgpr_read_b32 v33, a141
    v_accvgpr_read_b32 v34, a142
    v_accvgpr_read_b32 v35, a143
    v_mul_f32 v32, v32, v11
    v_mul_f32 v33, v33, v11
    v_mul_f32 v34, v34, v11
    v_mul_f32 v35, v35, v11
    v_accvgpr_write_b32 a140, v32
    v_accvgpr_write_b32 a141, v33
    v_accvgpr_write_b32 a142, v34
    v_accvgpr_write_b32 a143, v35
    v_accvgpr_read_b32 v32, a144
    v_accvgpr_read_b32 v33, a145
    v_accvgpr_read_b32 v34, a146
    v_accvgpr_read_b32 v35, a147
    v_mul_f32 v32, v32, v11
    v_mul_f32 v33, v33, v11
    v_mul_f32 v34, v34, v11
    v_mul_f32 v35, v35, v11
    v_accvgpr_write_b32 a144, v32
    v_accvgpr_write_b32 a145, v33
    v_accvgpr_write_b32 a146, v34
    v_accvgpr_write_b32 a147, v35
    v_accvgpr_read_b32 v32, a148
    v_accvgpr_read_b32 v33, a149
    v_accvgpr_read_b32 v34, a150
    v_accvgpr_read_b32 v35, a151
    v_mul_f32 v32, v32, v11
    v_mul_f32 v33, v33, v11
    v_mul_f32 v34, v34, v11
    v_mul_f32 v35, v35, v11
    v_accvgpr_write_b32 a148, v32
    v_accvgpr_write_b32 a149, v33
    v_accvgpr_write_b32 a150, v34
    v_accvgpr_write_b32 a151, v35
    v_accvgpr_read_b32 v32, a152
    v_accvgpr_read_b32 v33, a153
    v_accvgpr_read_b32 v34, a154
    v_accvgpr_read_b32 v35, a155
    v_mul_f32 v32, v32, v11
    v_mul_f32 v33, v33, v11
    v_mul_f32 v34, v34, v11
    v_mul_f32 v35, v35, v11
    v_accvgpr_write_b32 a152, v32
    v_accvgpr_write_b32 a153, v33
    v_accvgpr_write_b32 a154, v34
    v_accvgpr_write_b32 a155, v35
    v_accvgpr_read_b32 v32, a156
    v_accvgpr_read_b32 v33, a157
    v_accvgpr_read_b32 v34, a158
    v_accvgpr_read_b32 v35, a159
    v_mul_f32 v32, v32, v11
    v_mul_f32 v33, v33, v11
    v_mul_f32 v34, v34, v11
    v_mul_f32 v35, v35, v11
    v_accvgpr_write_b32 a156, v32
    v_accvgpr_write_b32 a157, v33
    v_accvgpr_write_b32 a158, v34
    v_accvgpr_write_b32 a159, v35
    v_accvgpr_read_b32 v32, a176
    v_accvgpr_read_b32 v33, a177
    v_accvgpr_read_b32 v34, a178
    v_accvgpr_read_b32 v35, a179
    v_mul_f32 v32, v32, v11
    v_mul_f32 v33, v33, v11
    v_mul_f32 v34, v34, v11
    v_mul_f32 v35, v35, v11
    v_accvgpr_write_b32 a176, v32
    v_accvgpr_write_b32 a177, v33
    v_accvgpr_write_b32 a178, v34
    v_accvgpr_write_b32 a179, v35
    v_exp_f32 v32, v232
    v_exp_f32 v33, v233
    v_exp_f32 v34, v234
    v_exp_f32 v35, v235
    v_exp_f32 v36, v248
    v_exp_f32 v37, v249
    v_exp_f32 v38, v250
    v_exp_f32 v39, v251
    v_add_f32 v8, v32, v33
    v_add_f32 v8, v8, v34
    v_add_f32 v8, v8, v35
    v_add_f32 v8, v8, v36
    v_add_f32 v8, v8, v37
    v_add_f32 v8, v8, v38
    v_add_f32 v8, v8, v39
    v_cvt_pk_bf16_f32 v136, v32, v33
    v_cvt_pk_bf16_f32 v137, v34, v35
    v_cvt_pk_bf16_f32 v138, v36, v37
    v_cvt_pk_bf16_f32 v139, v38, v39
    v_max3_f32 v10, v236, v237, v238
    v_max3_f32 v10, v10, v239, v252
    v_max3_f32 v10, v10, v253, v254
    v_max_f32 v10, v10, v255
    v_mov_b32 v11, v10
    s_nop 1
    v_permlane16_swap_b32 v10, v11
    v_max_f32 v10, v10, v11
    v_mov_b32 v11, v10
    s_nop 1
    v_permlane32_swap_b32 v10, v11
    v_max_f32 v10, v10, v11
    v_add_f32 v10, 0x42200000, v10
    v_max_f32 v10, 0, v10
    v_exp_f32 v11, -v10
    v_sub_f32 v172, v172, v10
    v_sub_f32 v173, v173, v10
    v_sub_f32 v174, v174, v10
    v_sub_f32 v175, v175, v10
    v_mul_f32 v5, v5, v11
    v_sub_f32 v236, v236, v10
    v_sub_f32 v237, v237, v10
    v_sub_f32 v238, v238, v10
    v_sub_f32 v239, v239, v10
    v_sub_f32 v252, v252, v10
    v_sub_f32 v253, v253, v10
    v_sub_f32 v254, v254, v10
    v_sub_f32 v255, v255, v10
    v_sub_f32 v108, v108, v10
    v_sub_f32 v109, v109, v10
    v_sub_f32 v110, v110, v10
    v_sub_f32 v111, v111, v10
    v_sub_f32 v124, v124, v10
    v_sub_f32 v125, v125, v10
    v_sub_f32 v126, v126, v10
    v_sub_f32 v127, v127, v10
    v_accvgpr_read_b32 v32, a192
    v_accvgpr_read_b32 v33, a193
    v_accvgpr_read_b32 v34, a194
    v_accvgpr_read_b32 v35, a195
    v_mul_f32 v32, v32, v11
    v_mul_f32 v33, v33, v11
    v_mul_f32 v34, v34, v11
    v_mul_f32 v35, v35, v11
    v_accvgpr_write_b32 a192, v32
    v_accvgpr_write_b32 a193, v33
    v_accvgpr_write_b32 a194, v34
    v_accvgpr_write_b32 a195, v35
    v_accvgpr_read_b32 v32, a196
    v_accvgpr_read_b32 v33, a197
    v_accvgpr_read_b32 v34, a198
    v_accvgpr_read_b32 v35, a199
    v_mul_f32 v32, v32, v11
    v_mul_f32 v33, v33, v11
    v_mul_f32 v34, v34, v11
    v_mul_f32 v35, v35, v11
    v_accvgpr_write_b32 a196, v32
    v_accvgpr_write_b32 a197, v33
    v_accvgpr_write_b32 a198, v34
    v_accvgpr_write_b32 a199, v35
    v_accvgpr_read_b32 v32, a200
    v_accvgpr_read_b32 v33, a201
    v_accvgpr_read_b32 v34, a202
    v_accvgpr_read_b32 v35, a203
    v_mul_f32 v32, v32, v11
    v_mul_f32 v33, v33, v11
    v_mul_f32 v34, v34, v11
    v_mul_f32 v35, v35, v11
    v_accvgpr_write_b32 a200, v32
    v_accvgpr_write_b32 a201, v33
    v_accvgpr_write_b32 a202, v34
    v_accvgpr_write_b32 a203, v35
    v_accvgpr_read_b32 v32, a204
    v_accvgpr_read_b32 v33, a205
    v_accvgpr_read_b32 v34, a206
    v_accvgpr_read_b32 v35, a207
    v_mul_f32 v32, v32, v11
    v_mul_f32 v33, v33, v11
    v_mul_f32 v34, v34, v11
    v_mul_f32 v35, v35, v11
    v_accvgpr_write_b32 a204, v32
    v_accvgpr_write_b32 a205, v33
    v_accvgpr_write_b32 a206, v34
    v_accvgpr_write_b32 a207, v35
    v_accvgpr_read_b32 v32, a208
    v_accvgpr_read_b32 v33, a209
    v_accvgpr_read_b32 v34, a210
    v_accvgpr_read_b32 v35, a211
    v_mul_f32 v32, v32, v11
    v_mul_f32 v33, v33, v11
    v_mul_f32 v34, v34, v11
    v_mul_f32 v35, v35, v11
    v_accvgpr_write_b32 a208, v32
    v_accvgpr_write_b32 a209, v33
    v_accvgpr_write_b32 a210, v34
    v_accvgpr_write_b32 a211, v35
    v_accvgpr_read_b32 v32, a212
    v_accvgpr_read_b32 v33, a213
    v_accvgpr_read_b32 v34, a214
    v_accvgpr_read_b32 v35, a215
    v_mul_f32 v32, v32, v11
    v_mul_f32 v33, v33, v11
    v_mul_f32 v34, v34, v11
    v_mul_f32 v35, v35, v11
    v_accvgpr_write_b32 a212, v32
    v_accvgpr_write_b32 a213, v33
    v_accvgpr_write_b32 a214, v34
    v_accvgpr_write_b32 a215, v35
    v_accvgpr_read_b32 v32, a216
    v_accvgpr_read_b32 v33, a217
    v_accvgpr_read_b32 v34, a218
    v_accvgpr_read_b32 v35, a219
    v_mul_f32 v32, v32, v11
    v_mul_f32 v33, v33, v11
    v_mul_f32 v34, v34, v11
    v_mul_f32 v35, v35, v11
    v_accvgpr_write_b32 a216, v32
    v_accvgpr_write_b32 a217, v33
    v_accvgpr_write_b32 a218, v34
    v_accvgpr_write_b32 a219, v35
    v_accvgpr_read_b32 v32, a220
    v_accvgpr_read_b32 v33, a221
    v_accvgpr_read_b32 v34, a222
    v_accvgpr_read_b32 v35, a223
    v_mul_f32 v32, v32, v11
    v_mul_f32 v33, v33, v11
    v_mul_f32 v34, v34, v11
    v_mul_f32 v35, v35, v11
    v_accvgpr_write_b32 a220, v32
    v_accvgpr_write_b32 a221, v33
    v_accvgpr_write_b32 a222, v34
    v_accvgpr_write_b32 a223, v35
    v_accvgpr_read_b32 v32, a240
    v_accvgpr_read_b32 v33, a241
    v_accvgpr_read_b32 v34, a242
    v_accvgpr_read_b32 v35, a243
    v_mul_f32 v32, v32, v11
    v_mul_f32 v33, v33, v11
    v_mul_f32 v34, v34, v11
    v_mul_f32 v35, v35, v11
    v_accvgpr_write_b32 a240, v32
    v_accvgpr_write_b32 a241, v33
    v_accvgpr_write_b32 a242, v34
    v_accvgpr_write_b32 a243, v35
    v_exp_f32 v32, v236
    v_exp_f32 v33, v237
    v_exp_f32 v34, v238
    v_exp_f32 v35, v239
    v_exp_f32 v36, v252
    v_exp_f32 v37, v253
    v_exp_f32 v38, v254
    v_exp_f32 v39, v255
    v_add_f32 v9, v32, v33
    v_add_f32 v9, v9, v34
    v_add_f32 v9, v9, v35
    v_add_f32 v9, v9, v36
    v_add_f32 v9, v9, v37
    v_add_f32 v9, v9, v38
    v_add_f32 v9, v9, v39
    v_cvt_pk_bf16_f32 v140, v32, v33
    v_cvt_pk_bf16_f32 v141, v34, v35
    v_cvt_pk_bf16_f32 v142, v36, v37
    v_cvt_pk_bf16_f32 v143, v38, v39
    s_nop 1
    s_setpc_b64 s[58:59]
k2_FB1:
    s_nop 7
    v_max3_f32 v10, v96, v97, v98
    v_max3_f32 v10, v10, v99, v112
    v_max3_f32 v10, v10, v113, v114
    v_max_f32 v10, v10, v115
    v_mov_b32 v11, v10
    s_nop 1
    v_permlane16_swap_b32 v10, v11
    v_max_f32 v10, v10, v11
    v_mov_b32 v11, v10
    s_nop 1
    v_permlane32_swap_b32 v10, v11
    v_max_f32 v10, v10, v11
    v_add_f32 v10, 0x42200000, v10
    v_max_f32 v10, 0, v10
    v_exp_f32 v11, -v10
    v_sub_f32 v160, v160, v10
    v_sub_f32 v161, v161, v10
    v_sub_f32 v162, v162, v10
    v_sub_f32 v163, v163, v10
    v_mul_f32 v2, v2, v11
    v_sub_f32 v96, v96, v10
    v_sub_f32 v97, v97, v10
    v_sub_f32 v98, v98, v10
    v_sub_f32 v99, v99, v10
    v_sub_f32 v112, v112, v10
    v_sub_f32 v113, v113, v10
    v_sub_f32 v114, v114, v10
    v_sub_f32 v115, v115, v10
    v_sub_f32 v224, v224, v10
    v_sub_f32 v225, v225, v10
    v_sub_f32 v226, v226, v10
    v_sub_f32 v227, v227, v10
    v_sub_f32 v240, v240, v10
    v_sub_f32 v241, v241, v10
    v_sub_f32 v242, v242, v10
    v_sub_f32 v243, v243, v10
    v_accvgpr_read_b32 v32, a0
    v_accvgpr_read_b32 v33, a1
    v_accvgpr_read_b32 v34, a2
    v_accvgpr_read_b32 v35, a3
    v_mul_f32 v32, v32, v11
    v_mul_f32 v33, v33, v11
    v_mul_f32 v34, v34, v11
    v_mul_f32 v35, v35, v11
    v_accvgpr_write_b32 a0, v32
    v_accvgpr_write_b32 a1, v33
    v_accvgpr_write_b32 a2, v34
    v_accvgpr_write_b32 a3, v35
    v_accvgpr_read_b32 v32, a4
    v_accvgpr_read_b32 v33, a5
    v_accvgpr_read_b32 v34, a6
    v_accvgpr_read_b32 v35, a7
    v_mul_f32 v32, v32, v11
    v_mul_f32 v33, v33, v11
    v_mul_f32 v34, v34, v11
    v_mul_f32 v35, v35, v11
    v_accvgpr_write_b32 a4, v32
    v_accvgpr_write_b32 a5, v33
    v_accvgpr_write_b32 a6, v34
    v_accvgpr_write_b32 a7, v35
    v_accvgpr_read_b32 v32, a8
    v_accvgpr_read_b32 v33, a9
    v_accvgpr_read_b32 v34, a10
    v_accvgpr_read_b32 v35, a11
    v_mul_f32 v32, v32, v11
    v_mul_f32 v33, v33, v11
    v_mul_f32 v34, v34, v11
    v_mul_f32 v35, v35, v11
    v_accvgpr_write_b32 a8, v32
    v_accvgpr_write_b32 a9, v33
    v_accvgpr_write_b32 a10, v34
    v_accvgpr_write_b32 a11, v35
    v_accvgpr_read_b32 v32, a12
    v_accvgpr_read_b32 v33, a13
    v_accvgpr_read_b32 v34, a14
    v_accvgpr_read_b32 v35, a15
    v_mul_f32 v32, v32, v11
    v_mul_f32 v33, v33, v11
    v_mul_f32 v34, v34, v11
    v_mul_f32 v35, v35, v11
    v_accvgpr_write_b32 a12, v32
    v_accvgpr_write_b32 a13, v33
    v_accvgpr_write_b32 a14, v34
    v_accvgpr_write_b32 a15, v35
    v_accvgpr_read_b32 v32, a16
    v_accvgpr_read_b32 v33, a17
    v_accvgpr_read_b32 v34, a18
    v_accvgpr_read_b32 v35, a19
    v_mul_f32 v32, v32, v11
    v_mul_f32 v33, v33, v11
    v_mul_f32 v34, v34, v11
    v_mul_f32 v35, v35, v11
    v_accvgpr_write_b32 a16, v32
    v_accvgpr_write_b32 a17, v33
    v_accvgpr_write_b32 a18, v34
    v_accvgpr_write_b32 a19, v35
    v_accvgpr_read_b32 v32, a20
    v_accvgpr_read_b32 v33, a21
    v_accvgpr_read_b32 v34, a22
    v_accvgpr_read_b32 v35, a23
    v_mul_f32 v32, v32, v11
    v_mul_f32 v33, v33, v11
    v_mul_f32 v34, v34, v11
    v_mul_f32 v35, v35, v11
    v_accvgpr_write_b32 a20, v32
    v_accvgpr_write_b32 a21, v33
    v_accvgpr_write_b32 a22, v34
    v_accvgpr_write_b32 a23, v35
    v_accvgpr_read_b32 v32, a24
    v_accvgpr_read_b32 v33, a25
    v_accvgpr_read_b32 v34, a26
    v_accvgpr_read_b32 v35, a27
    v_mul_f32 v32, v32, v11
    v_mul_f32 v33, v33, v11
    v_mul_f32 v34, v34, v11
    v_mul_f32 v35, v35, v11
    v_accvgpr_write_b32 a24, v32
    v_accvgpr_write_b32 a25, v33
    v_accvgpr_write_b32 a26, v34
    v_accvgpr_write_b32 a27, v35
    v_accvgpr_read_b32 v32, a28
    v_accvgpr_read_b32 v33, a29
    v_accvgpr_read_b32 v34, a30
    v_accvgpr_read_b32 v35, a31
    v_mul_f32 v32, v32, v11
    v_mul_f32 v33, v33, v11
    v_mul_f32 v34, v34, v11
    v_mul_f32 v35, v35, v11
    v_accvgpr_write_b32 a28, v32
    v_accvgpr_write_b32 a29, v33
    v_accvgpr_write_b32 a30, v34
    v_accvgpr_write_b32 a31, v35
    v_accvgpr_read_b32 v32, a48
    v_accvgpr_read_b32 v33, a49
    v_accvgpr_read_b32 v34, a50
    v_accvgpr_read_b32 v35, a51
    v_mul_f32 v32, v32, v11
    v_mul_f32 v33, v33, v11
    v_mul_f32 v34, v34, v11
    v_mul_f32 v35, v35, v11
    v_accvgpr_write_b32 a48, v32
    v_accvgpr_write_b32 a49, v33
    v_accvgpr_write_b32 a50, v34
    v_accvgpr_write_b32 a51, v35
    v_exp_f32 v32, v96
    v_exp_f32 v33, v97
    v_exp_f32 v34, v98
    v_exp_f32 v35, v99
    v_exp_f32 v36, v112
    v_exp_f32 v37, v113
    v_exp_f32 v38, v114
    v_exp_f32 v39, v115
    v_add_f32 v6, v32, v33
    v_add_f32 v6, v6, v34
    v_add_f32 v6, v6, v35
    v_add_f32 v6, v6, v36
    v_add_f32 v6, v6, v37
    v_add_f32 v6, v6, v38
    v_add_f32 v6, v6, v39
    v_cvt_pk_bf16_f32 v144, v32, v33
    v_cvt_pk_bf16_f32 v145, v34, v35
    v_cvt_pk_bf16_f32 v146, v36, v37
    v_cvt_pk_bf16_f32 v147, v38, v39
    v_max3_f32 v10, v100, v101, v102
    v_max3_f32 v10, v10, v103, v116
    v_max3_f32 v10, v10, v117, v118
    v_max_f32 v10, v10, v119
    v_mov_b32 v11, v10
    s_nop 1
    v_permlane16_swap_b32 v10, v11
    v_max_f32 v10, v10, v11
    v_mov_b32 v11, v10
    s_nop 1
    v_permlane32_swap_b32 v10, v11
    v_max_f32 v10, v10, v11
    v_add_f32 v10, 0x42200000, v10
    v_max_f32 v10, 0, v10
    v_exp_f32 v11, -v10
    v_sub_f32 v164, v164, v10
    v_sub_f32 v165, v165, v10
    v_sub_f32 v166, v166, v10
    v_sub_f32 v167, v167, v10
    v_mul_f32 v3, v3, v11
    v_sub_f32 v100, v100, v10
    v_sub_f32 v101, v101, v10
    v_sub_f32 v102, v102, v10
    v_sub_f32 v103, v103, v10
    v_sub_f32 v116, v116, v10
    v_sub_f32 v117, v117, v10
    v_sub_f32 v118, v118, v10
    v_sub_f32 v119, v119, v10
    v_sub_f32 v228, v228, v10
    v_sub_f32 v229, v229, v10
    v_sub_f32 v230, v230, v10
    v_sub_f32 v231, v231, v10
    v_sub_f32 v244, v244, v10
    v_sub_f32 v245, v245, v10
    v_sub_f32 v246, v246, v10
    v_sub_f32 v247, v247, v10
    v_accvgpr_read_b32 v32, a64
    v_accvgpr_read_b32 v33, a65
    v_accvgpr_read_b32 v34, a66
    v_accvgpr_read_b32 v35, a67
    v_mul_f32 v32, v32, v11
    v_mul_f32 v33, v33, v11
    v_mul_f32 v34, v34, v11
    v_mul_f32 v35, v35, v11
    v_accvgpr_write_b32 a64, v32
    v_accvgpr_write_b32 a65, v33
    v_accvgpr_write_b32 a66, v34
    v_accvgpr_write_b32 a67, v35
    v_accvgpr_read_b32 v32, a68
    v_accvgpr_read_b32 v33, a69
    v_accvgpr_read_b32 v34, a70
    v_accvgpr_read_b32 v35, a71
    v_mul_f32 v32, v32, v11
    v_mul_f32 v33, v33, v11
    v_mul_f32 v34, v34, v11
    v_mul_f32 v35, v35, v11
    v_accvgpr_write_b32 a68, v32
    v_accvgpr_write_b32 a69, v33
    v_accvgpr_write_b32 a70, v34
    v_accvgpr_write_b32 a71, v35
    v_accvgpr_read_b32 v32, a72
    v_accvgpr_read_b32 v33, a73
    v_accvgpr_read_b32 v34, a74
    v_accvgpr_read_b32 v35, a75
    v_mul_f32 v32, v32, v11
    v_mul_f32 v33, v33, v11
    v_mul_f32 v34, v34, v11
    v_mul_f32 v35, v35, v11
    v_accvgpr_write_b32 a72, v32
    v_accvgpr_write_b32 a73, v33
    v_accvgpr_write_b32 a74, v34
    v_accvgpr_write_b32 a75, v35
    v_accvgpr_read_b32 v32, a76
    v_accvgpr_read_b32 v33, a77
    v_accvgpr_read_b32 v34, a78
    v_accvgpr_read_b32 v35, a79
    v_mul_f32 v32, v32, v11
    v_mul_f32 v33, v33, v11
    v_mul_f32 v34, v34, v11
    v_mul_f32 v35, v35, v11
    v_accvgpr_write_b32 a76, v32
    v_accvgpr_write_b32 a77, v33
    v_accvgpr_write_b32 a78, v34
    v_accvgpr_write_b32 a79, v35
    v_accvgpr_read_b32 v32, a80
    v_accvgpr_read_b32 v33, a81
    v_accvgpr_read_b32 v34, a82
    v_accvgpr_read_b32 v35, a83
    v_mul_f32 v32, v32, v11
    v_mul_f32 v33, v33, v11
    v_mul_f32 v34, v34, v11
    v_mul_f32 v35, v35, v11
    v_accvgpr_write_b32 a80, v32
    v_accvgpr_write_b32 a81, v33
    v_accvgpr_write_b32 a82, v34
    v_accvgpr_write_b32 a83, v35
    v_accvgpr_read_b32 v32, a84
    v_accvgpr_read_b32 v33, a85
    v_accvgpr_read_b32 v34, a86
    v_accvgpr_read_b32 v35, a87
    v_mul_f32 v32, v32, v11
    v_mul_f32 v33, v33, v11
    v_mul_f32 v34, v34, v11
    v_mul_f32 v35, v35, v11
    v_accvgpr_write_b32 a84, v32
    v_accvgpr_write_b32 a85, v33
    v_accvgpr_write_b32 a86, v34
    v_accvgpr_write_b32 a87, v35
    v_accvgpr_read_b32 v32, a88
    v_accvgpr_read_b32 v33, a89
    v_accvgpr_read_b32 v34, a90
    v_accvgpr_read_b32 v35, a91
    v_mul_f32 v32, v32, v11
    v_mul_f32 v33, v33, v11
    v_mul_f32 v34, v34, v11
    v_mul_f32 v35, v35, v11
    v_accvgpr_write_b32 a88, v32
    v_accvgpr_write_b32 a89, v33
    v_accvgpr_write_b32 a90, v34
    v_accvgpr_write_b32 a91, v35
    v_accvgpr_read_b32 v32, a92
    v_accvgpr_read_b32 v33, a93
    v_accvgpr_read_b32 v34, a94
    v_accvgpr_read_b32 v35, a95
    v_mul_f32 v32, v32, v11
    v_mul_f32 v33, v33, v11
    v_mul_f32 v34, v34, v11
    v_mul_f32 v35, v35, v11
    v_accvgpr_write_b32 a92, v32
    v_accvgpr_write_b32 a93, v33
    v_accvgpr_write_b32 a94, v34
    v_accvgpr_write_b32 a95, v35
    v_accvgpr_read_b32 v32, a112
    v_accvgpr_read_b32 v33, a113
    v_accvgpr_read_b32 v34, a114
    v_accvgpr_read_b32 v35, a115
    v_mul_f32 v32, v32, v11
    v_mul_f32 v33, v33, v11
    v_mul_f32 v34, v34, v11
    v_mul_f32 v35, v35, v11
    v_accvgpr_write_b32 a112, v32
    v_accvgpr_write_b32 a113, v33
    v_accvgpr_write_b32 a114, v34
    v_accvgpr_write_b32 a115, v35
    v_exp_f32 v32, v100
    v_exp_f32 v33, v101
    v_exp_f32 v34, v102
    v_exp_f32 v35, v103
    v_exp_f32 v36, v116
    v_exp_f32 v37, v117
    v_exp_f32 v38, v118
    v_exp_f32 v39, v119
    v_add_f32 v7, v32, v33
    v_add_f32 v7, v7, v34
    v_add_f32 v7, v7, v35
    v_add_f32 v7, v7, v36
    v_add_f32 v7, v7, v37
    v_add_f32 v7, v7, v38
    v_add_f32 v7, v7, v39
    v_cvt_pk_bf16_f32 v148, v32, v33
    v_cvt_pk_bf16_f32 v149, v34, v35
    v_cvt_pk_bf16_f32 v150, v36, v37
    v_cvt_pk_bf16_f32 v151, v38, v39
    v_max3_f32 v10, v104, v105, v106
    v_max3_f32 v10, v10, v107, v120
    v_max3_f32 v10, v10, v121, v122
    v_max_f32 v10, v10, v123
    v_mov_b32 v11, v10
    s_nop 1
    v_permlane16_swap_b32 v10, v11
    v_max_f32 v10, v10, v11
    v_mov_b32 v11, v10
    s_nop 1
    v_permlane32_swap_b32 v10, v11
    v_max_f32 v10, v10, v11
    v_add_f32 v10, 0x42200000, v10
    v_max_f32 v10, 0, v10
    v_exp_f32 v11, -v10
    v_sub_f32 v168, v168, v10
    v_sub_f32 v169, v169, v10
    v_sub_f32 v170, v170, v10
    v_sub_f32 v171, v171, v10
    v_mul_f32 v4, v4, v11
    v_sub_f32 v104, v104, v10
    v_sub_f32 v105, v105, v10
    v_sub_f32 v106, v106, v10
    v_sub_f32 v107, v107, v10
    v_sub_f32 v120, v120, v10
    v_sub_f32 v121, v121, v10
    v_sub_f32 v122, v122, v10
    v_sub_f32 v123, v123, v10
    v_sub_f32 v232, v232, v10
    v_sub_f32 v233, v233, v10
    v_sub_f32 v234, v234, v10
    v_sub_f32 v235, v235, v10
    v_sub_f32 v248, v248, v10
    v_sub_f32 v249, v249, v10
    v_sub_f32 v250, v250, v10
    v_sub_f32 v251, v251, v10
    v_accvgpr_read_b32 v32, a128
    v_accvgpr_read_b32 v33, a129
    v_accvgpr_read_b32 v34, a130
    v_accvgpr_read_b32 v35, a131
    v_mul_f32 v32, v32, v11
    v_mul_f32 v33, v33, v11
    v_mul_f32 v34, v34, v11
    v_mul_f32 v35, v35, v11
    v_accvgpr_write_b32 a128, v32
    v_accvgpr_write_b32 a129, v33
    v_accvgpr_write_b32 a130, v34
    v_accvgpr_write_b32 a131, v35
    v_accvgpr_read_b32 v32, a132
    v_accvgpr_read_b32 v33, a133
    v_accvgpr_read_b32 v34, a134
    v_accvgpr_read_b32 v35, a135
    v_mul_f32 v32, v32, v11
    v_mul_f32 v33, v33, v11
    v_mul_f32 v34, v34, v11
    v_mul_f32 v35, v35, v11
    v_accvgpr_write_b32 a132, v32
    v_accvgpr_write_b32 a133, v33
    v_accvgpr_write_b32 a134, v34
    v_accvgpr_write_b32 a135, v35
    v_accvgpr_read_b32 v32, a136
    v_accvgpr_read_b32 v33, a137
    v_accvgpr_read_b32 v34, a138
    v_accvgpr_read_b32 v35, a139
    v_mul_f32 v32, v32, v11
    v_mul_f32 v33, v33, v11
    v_mul_f32 v34, v34, v11
    v_mul_f32 v35, v35, v11
    v_accvgpr_write_b32 a136, v32
    v_accvgpr_write_b32 a137, v33
    v_accvgpr_write_b32 a138, v34
    v_accvgpr_write_b32 a139, v35
    v_accvgpr_read_b32 v32, a140
    v_accvgpr_read_b32 v33, a141
    v_accvgpr_read_b32 v34, a142
    v_accvgpr_read_b32 v35, a143
    v_mul_f32 v32, v32, v11
    v_mul_f32 v33, v33, v11
    v_mul_f32 v34, v34, v11
    v_mul_f32 v35, v35, v11
    v_accvgpr_write_b32 a140, v32
    v_accvgpr_write_b32 a141, v33
    v_accvgpr_write_b32 a142, v34
    v_accvgpr_write_b32 a143, v35
    v_accvgpr_read_b32 v32, a144
    v_accvgpr_read_b32 v33, a145
    v_accvgpr_read_b32 v34, a146
    v_accvgpr_read_b32 v35, a147
    v_mul_f32 v32, v32, v11
    v_mul_f32 v33, v33, v11
    v_mul_f32 v34, v34, v11
    v_mul_f32 v35, v35, v11
    v_accvgpr_write_b32 a144, v32
    v_accvgpr_write_b32 a145, v33
    v_accvgpr_write_b32 a146, v34
    v_accvgpr_write_b32 a147, v35
    v_accvgpr_read_b32 v32, a148
    v_accvgpr_read_b32 v33, a149
    v_accvgpr_read_b32 v34, a150
    v_accvgpr_read_b32 v35, a151
    v_mul_f32 v32, v32, v11
    v_mul_f32 v33, v33, v11
    v_mul_f32 v34, v34, v11
    v_mul_f32 v35, v35, v11
    v_accvgpr_write_b32 a148, v32
    v_accvgpr_write_b32 a149, v33
    v_accvgpr_write_b32 a150, v34
    v_accvgpr_write_b32 a151, v35
    v_accvgpr_read_b32 v32, a152
    v_accvgpr_read_b32 v33, a153
    v_accvgpr_read_b32 v34, a154
    v_accvgpr_read_b32 v35, a155
    v_mul_f32 v32, v32, v11
    v_mul_f32 v33, v33, v11
    v_mul_f32 v34, v34, v11
    v_mul_f32 v35, v35, v11
    v_accvgpr_write_b32 a152, v32
    v_accvgpr_write_b32 a153, v33
    v_accvgpr_write_b32 a154, v34
    v_accvgpr_write_b32 a155, v35
    v_accvgpr_read_b32 v32, a156
    v_accvgpr_read_b32 v33, a157
    v_accvgpr_read_b32 v34, a158
    v_accvgpr_read_b32 v35, a159
    v_mul_f32 v32, v32, v11
    v_mul_f32 v33, v33, v11
    v_mul_f32 v34, v34, v11
    v_mul_f32 v35, v35, v11
    v_accvgpr_write_b32 a156, v32
    v_accvgpr_write_b32 a157, v33
    v_accvgpr_write_b32 a158, v34
    v_accvgpr_write_b32 a159, v35
    v_accvgpr_read_b32 v32, a176
    v_accvgpr_read_b32 v33, a177
    v_accvgpr_read_b32 v34, a178
    v_accvgpr_read_b32 v35, a179
    v_mul_f32 v32, v32, v11
    v_mul_f32 v33, v33, v11
    v_mul_f32 v34, v34, v11
    v_mul_f32 v35, v35, v11
    v_accvgpr_write_b32 a176, v32
    v_accvgpr_write_b32 a177, v33
    v_accvgpr_write_b32 a178, v34
    v_accvgpr_write_b32 a179, v35
    v_exp_f32 v32, v104
    v_exp_f32 v33, v105
    v_exp_f32 v34, v106
    v_exp_f32 v35, v107
    v_exp_f32 v36, v120
    v_exp_f32 v37, v121
    v_exp_f32 v38, v122
    v_exp_f32 v39, v123
    v_add_f32 v8, v32, v33
    v_add_f32 v8, v8, v34
    v_add_f32 v8, v8, v35
    v_add_f32 v8, v8, v36
    v_add_f32 v8, v8, v37
    v_add_f32 v8, v8, v38
    v_add_f32 v8, v8, v39
    v_cvt_pk_bf16_f32 v152, v32, v33
    v_cvt_pk_bf16_f32 v153, v34, v35
    v_cvt_pk_bf16_f32 v154, v36, v37
    v_cvt_pk_bf16_f32 v155, v38, v39
    v_max3_f32 v10, v108, v109, v110
    v_max3_f32 v10, v10, v111, v124
    v_max3_f32 v10, v10, v125, v126
    v_max_f32 v10, v10, v127
    v_mov_b32 v11, v10
    s_nop 1
    v_permlane16_swap_b32 v10, v11
    v_max_f32 v10, v10, v11
    v_mov_b32 v11, v10
    s_nop 1
    v_permlane32_swap_b32 v10, v11
    v_max_f32 v10, v10, v11
    v_add_f32 v10, 0x42200000, v10
    v_max_f32 v10, 0, v10
    v_exp_f32 v11, -v10
    v_sub_f32 v172, v172, v10
    v_sub_f32 v173, v173, v10
    v_sub_f32 v174, v174, v10
    v_sub_f32 v175, v175, v10
    v_mul_f32 v5, v5, v11
    v_sub_f32 v108, v108, v10
    v_sub_f32 v109, v109, v10
    v_sub_f32 v110, v110, v10
    v_sub_f32 v111, v111, v10
    v_sub_f32 v124, v124, v10
    v_sub_f32 v125, v125, v10
    v_sub_f32 v126, v126, v10
    v_sub_f32 v127, v127, v10
    v_sub_f32 v236, v236, v10
    v_sub_f32 v237, v237, v10
    v_sub_f32 v238, v238, v10
    v_sub_f32 v239, v239, v10
    v_sub_f32 v252, v252, v10
    v_sub_f32 v253, v253, v10
    v_sub_f32 v254, v254, v10
    v_sub_f32 v255, v255, v10
    v_accvgpr_read_b32 v32, a192
    v_accvgpr_read_b32 v33, a193
    v_accvgpr_read_b32 v34, a194
    v_accvgpr_read_b32 v35, a195
    v_mul_f32 v32, v32, v11
    v_mul_f32 v33, v33, v11
    v_mul_f32 v34, v34, v11
    v_mul_f32 v35, v35, v11
    v_accvgpr_write_b32 a192, v32
    v_accvgpr_write_b32 a193, v33
    v_accvgpr_write_b32 a194, v34
    v_accvgpr_write_b32 a195, v35
    v_accvgpr_read_b32 v32, a196
    v_accvgpr_read_b32 v33, a197
    v_accvgpr_read_b32 v34, a198
    v_accvgpr_read_b32 v35, a199
    v_mul_f32 v32, v32, v11
    v_mul_f32 v33, v33, v11
    v_mul_f32 v34, v34, v11
    v_mul_f32 v35, v35, v11
    v_accvgpr_write_b32 a196, v32
    v_accvgpr_write_b32 a197, v33
    v_accvgpr_write_b32 a198, v34
    v_accvgpr_write_b32 a199, v35
    v_accvgpr_read_b32 v32, a200
    v_accvgpr_read_b32 v33, a201
    v_accvgpr_read_b32 v34, a202
    v_accvgpr_read_b32 v35, a203
    v_mul_f32 v32, v32, v11
    v_mul_f32 v33, v33, v11
    v_mul_f32 v34, v34, v11
    v_mul_f32 v35, v35, v11
    v_accvgpr_write_b32 a200, v32
    v_accvgpr_write_b32 a201, v33
    v_accvgpr_write_b32 a202, v34
    v_accvgpr_write_b32 a203, v35
    v_accvgpr_read_b32 v32, a204
    v_accvgpr_read_b32 v33, a205
    v_accvgpr_read_b32 v34, a206
    v_accvgpr_read_b32 v35, a207
    v_mul_f32 v32, v32, v11
    v_mul_f32 v33, v33, v11
    v_mul_f32 v34, v34, v11
    v_mul_f32 v35, v35, v11
    v_accvgpr_write_b32 a204, v32
    v_accvgpr_write_b32 a205, v33
    v_accvgpr_write_b32 a206, v34
    v_accvgpr_write_b32 a207, v35
    v_accvgpr_read_b32 v32, a208
    v_accvgpr_read_b32 v33, a209
    v_accvgpr_read_b32 v34, a210
    v_accvgpr_read_b32 v35, a211
    v_mul_f32 v32, v32, v11
    v_mul_f32 v33, v33, v11
    v_mul_f32 v34, v34, v11
    v_mul_f32 v35, v35, v11
    v_accvgpr_write_b32 a208, v32
    v_accvgpr_write_b32 a209, v33
    v_accvgpr_write_b32 a210, v34
    v_accvgpr_write_b32 a211, v35
    v_accvgpr_read_b32 v32, a212
    v_accvgpr_read_b32 v33, a213
    v_accvgpr_read_b32 v34, a214
    v_accvgpr_read_b32 v35, a215
    v_mul_f32 v32, v32, v11
    v_mul_f32 v33, v33, v11
    v_mul_f32 v34, v34, v11
    v_mul_f32 v35, v35, v11
    v_accvgpr_write_b32 a212, v32
    v_accvgpr_write_b32 a213, v33
    v_accvgpr_write_b32 a214, v34
    v_accvgpr_write_b32 a215, v35
    v_accvgpr_read_b32 v32, a216
    v_accvgpr_read_b32 v33, a217
    v_accvgpr_read_b32 v34, a218
    v_accvgpr_read_b32 v35, a219
    v_mul_f32 v32, v32, v11
    v_mul_f32 v33, v33, v11
    v_mul_f32 v34, v34, v11
    v_mul_f32 v35, v35, v11
    v_accvgpr_write_b32 a216, v32
    v_accvgpr_write_b32 a217, v33
    v_accvgpr_write_b32 a218, v34
    v_accvgpr_write_b32 a219, v35
    v_accvgpr_read_b32 v32, a220
    v_accvgpr_read_b32 v33, a221
    v_accvgpr_read_b32 v34, a222
    v_accvgpr_read_b32 v35, a223
    v_mul_f32 v32, v32, v11
    v_mul_f32 v33, v33, v11
    v_mul_f32 v34, v34, v11
    v_mul_f32 v35, v35, v11
    v_accvgpr_write_b32 a220, v32
    v_accvgpr_write_b32 a221, v33
    v_accvgpr_write_b32 a222, v34
    v_accvgpr_write_b32 a223, v35
    v_accvgpr_read_b32 v32, a240
    v_accvgpr_read_b32 v33, a241
    v_accvgpr_read_b32 v34, a242
    v_accvgpr_read_b32 v35, a243
    v_mul_f32 v32, v32, v11
    v_mul_f32 v33, v33, v11
    v_mul_f32 v34, v34, v11
    v_mul_f32 v35, v35, v11
    v_accvgpr_write_b32 a240, v32
    v_accvgpr_write_b32 a241, v33
    v_accvgpr_write_b32 a242, v34
    v_accvgpr_write_b32 a243, v35
    v_exp_f32 v32, v108
    v_exp_f32 v33, v109
    v_exp_f32 v34, v110
    v_exp_f32 v35, v111
    v_exp_f32 v36, v124
    v_exp_f32 v37, v125
    v_exp_f32 v38, v126
    v_exp_f32 v39, v127
    v_add_f32 v9, v32, v33
    v_add_f32 v9, v9, v34
    v_add_f32 v9, v9, v35
    v_add_f32 v9, v9, v36
    v_add_f32 v9, v9, v37
    v_add_f32 v9, v9, v38
    v_add_f32 v9, v9, v39
    v_cvt_pk_bf16_f32 v156, v32, v33
    v_cvt_pk_bf16_f32 v157, v34, v35
    v_cvt_pk_bf16_f32 v158, v36, v37
    v_cvt_pk_bf16_f32 v159, v38, v39
    s_nop 1
    s_setpc_b64 s[58:59]
L_spin0:
    s_mov_b32 s3, 32768
L_spin0_l:
    s_sleep 2
    buffer_load_dword v15, v14, s[36:39], 0 offen offset:128 sc1
    s_waitcnt vmcnt(0)
    v_cmp_gt_u32 vcc, 16, v15
    s_sub_u32 s3, s3, 1
    s_cbranch_scc1 L_spun0
    s_cbranch_vccnz L_spin0_l
    s_branch L_spun0
L_spin1:
    s_mov_b32 s3, 32768
L_spin1_l:
    s_sleep 2
    buffer_load_dword v21, v20, s[36:39], s7 offen sc1
    s_waitcnt vmcnt(0)
    v_cmp_gt_u32 vcc, 1, v21
    s_sub_u32 s3, s3, 1
    s_cbranch_scc1 L_spun1
    s_cbranch_vccnz L_spin1_l
    s_branch L_spun1
L_spin2:
    s_mov_b32 s3, 32768
L_spin2_l:
    s_sleep 2
    buffer_load_dword v26, v253, s[36:39], s6 offen sc1
    s_waitcnt vmcnt(0)
    v_cmp_gt_u32 vcc, 1, v26
    s_sub_u32 s3, s3, 1
    s_cbranch_scc1 L_spun2
    s_cbranch_vccnz L_spin2_l
    s_branch L_spun2
L_spin3:
    s_mov_b32 s3, 32768
L_spin3_l:
    s_sleep 2
    buffer_load_dword v254, v253, s[36:39], s86 offen sc1
    s_waitcnt vmcnt(0)
    v_cmp_gt_u32 vcc, 1, v254
    s_sub_u32 s3, s3, 1
    s_cbranch_scc1 L_spun3
    s_cbranch_vccnz L_spin3_l
    s_branch L_spun3
.section .rodata,"a"
.p2align 6
.amdhsa_kernel parallel_sum__compressed_kv_cla__dense_activation_gelu__prompt_kernel
  .amdhsa_next_free_vgpr 512
  .amdhsa_next_free_sgpr 102
  .amdhsa_accum_offset 256
  .amdhsa_group_segment_fixed_size 0
  .amdhsa_kernarg_size 112
  .amdhsa_user_sgpr_count 2
  .amdhsa_user_sgpr_kernarg_segment_ptr 1
  .amdhsa_system_sgpr_workgroup_id_x 1
.end_amdhsa_kernel
```
